```python
import torch

def _softmax(x, axis=-1):
    return torch.softmax(x, dim=axis)
def _gelu(x):
    return torch.nn.functional.gelu(x, approximate="tanh")
def _silu(x):
    return torch.nn.functional.silu(x)
def _sigmoid(x):
    return torch.sigmoid(x)
def _layernorm(x, axis=-1, eps=1e-5):
    m = x.mean(dim=axis, keepdim=True)
    v = x.var(dim=axis, keepdim=True, unbiased=False)
    return (x - m) / torch.sqrt(v + eps)
def _scatter_add(tgt, idx, src, axis=0):
    return tgt.clone().index_add_(axis, idx, src)
def _segment_sum(src, seg, n):
    out = torch.zeros((n,) + src.shape[1:], dtype=src.dtype)
    return out.index_add_(0, seg, src)
def _pad(x, pw):
    flat = tuple(v for pair in reversed(pw) for v in pair)
    return torch.nn.functional.pad(x, flat)

kernel_name = 'sequential_preLN__linear_attn_block__glu_gated_glu__prompt'

def setup_inputs():

    _w = (lambda a: (lambda t: t.to(torch.bfloat16) if t.is_floating_point() else t)(torch.as_tensor(a)))
    def _A_setup():
        B, S, D = 1, 2048, 1024
        return {
            "x": _w((lambda *s: torch.randn(*s, dtype=torch.bfloat16) * 0.05)(B, S, D)),
            "wqkv": _w((lambda *s: torch.randn(*s, dtype=torch.bfloat16) * 0.05)(D, 3 * D)),
            "wo": _w((lambda *s: torch.randn(*s, dtype=torch.bfloat16) * 0.05)(D, D)),
        }
    _A_in = _A_setup()

    def _B_setup():
        B, S, D, F = 1, 2048, 1024, 3584
        return {
            "x": _w((lambda *s: torch.randn(*s, dtype=torch.bfloat16) * 0.05)(B, S, D)),
            "w_gate": _w((lambda *s: torch.randn(*s, dtype=torch.bfloat16) * 0.05)(D, F)),
            "w_up": _w((lambda *s: torch.randn(*s, dtype=torch.bfloat16) * 0.05)(D, F)),
            "w_down": _w((lambda *s: torch.randn(*s, dtype=torch.bfloat16) * 0.05)(F, D)),
        }
    _B_in = _B_setup()

    return {
        "A_x": _A_in["x"],
        "A_wqkv": _A_in["wqkv"],
        "A_wo": _A_in["wo"],
        "B_x": _B_in["x"],
        "B_w_gate": _B_in["w_gate"],
        "B_w_up": _B_in["w_up"],
        "B_w_down": _B_in["w_down"],
    }

def reference(A_x, A_wqkv, A_wo, B_x, B_w_gate, B_w_up, B_w_down):
    def _A_ref(x, wqkv, wo):
        B, S, D = x.shape
        H = 32; Dh = D // H
        qkv = (lambda x, *d: x.permute(*d))((x @ wqkv).reshape(B, S, 3, H, Dh), 2, 0, 3, 1, 4)
        q, k, v = qkv[0], qkv[1], qkv[2]
        phi = lambda t: torch.where(t > 0, t + 1, torch.exp(t)) + 1e-6
        pq, pk = phi(q), phi(k)
        kv = torch.einsum("bhsd,bhse->bhde", pk, v)
        z = torch.einsum("bhsd->bhd", pk)
        num = torch.einsum("bhqd,bhde->bhqe", pq, kv)
        den = torch.einsum("bhqd,bhd->bhq", pq, z)[..., None] + 1e-6
        o = num / den
        return (lambda x, *d: x.permute(*d))(o, 0, 2, 1, 3).reshape(B, S, D) @ wo

    def _B_ref(x, w_gate, w_up, w_down):
        g = torch.einsum("bsd,df->bsf", x, w_gate)
        u = torch.einsum("bsd,df->bsf", x, w_up)
        h = _sigmoid(g) * u
        return torch.einsum("bsf,fd->bsd", h, w_down)

    x = A_x
    h = x + _A_ref(_layernorm(x, axis=-1), A_wqkv, A_wo)
    h2 = h + _B_ref(_layernorm(h, axis=-1), B_w_gate, B_w_up, B_w_down)
    return h2
```

```asm
; @launch grid=(256,1,1) block=(256,1,1) lds=163840
.amdgcn_target "amdgcn-amd-amdhsa--gfx950"
.text
.globl sequential_preLN__linear_attn_block__glu_gated_glu__prompt_kernel
.p2align 8
.type sequential_preLN__linear_attn_block__glu_gated_glu__prompt_kernel,@function
sequential_preLN__linear_attn_block__glu_gated_glu__prompt_kernel:
    s_cmp_ge_u32 s2, 256
    s_cbranch_scc1 Lend_1
    s_load_dwordx16 s[4:19], s[0:1], 0
    s_load_dwordx4 s[20:23], s[0:1], 64
    v_mov_b32 v96, v0
    v_lshrrev_b32 v1, 6, v0
    s_nop 0
    v_readfirstlane_b32 s24, v1
    v_and_b32 v97, 63, v0
    v_lshlrev_b32 v116, 7, v97
    s_getpc_b64 s[96:97]
Lpc_3:
    s_add_u32 s96, s96, Lhere_2-Lpc_3
    s_addc_u32 s97, s97, 0
    s_cmp_eq_u32 s24, 3
    s_cselect_b32 s98, Lcode_end-Lhere_2, 0
    s_mov_b32 s99, 0x20000
    s_lshr_b32 s100, s2, 3
    s_lshl_b32 s100, s100, 13
    buffer_load_dword v117, v116, s[96:99], s100 offen
Lhere_2:
    v_lshlrev_b32 v98, 4, v97
    s_and_b32 s25, s2, 1
    s_bfe_u32 s27, s2, 0x30003
    s_lshl_b32 s31, s27, 1
    s_add_u32 s31, s31, s25
    s_lshl_b32 s25, s25, 3
    s_add_u32 s25, s25, s27
    s_bfe_u32 s26, s2, 0x20001
    s_lshr_b32 s27, s2, 6
    s_add_u32 s31, s31, s26
    s_lshl_b32 s28, s27, 2
    s_add_u32 s31, s31, s28
    s_and_b32 s31, s31, 15
    s_lshl_b32 s26, s26, 2
    s_add_u32 s26, s26, s27
    s_lshl_b32 s30, s25, 2
    s_add_u32 s30, s30, s24
    s_lshl_b32 s29, s24, 12
    s_mov_b32 s55, s31
    s_mul_i32 s52, s31, 393216
    s_lshl_b32 s53, s31, 7
    v_lshrrev_b32 v2, 3, v97
    v_mul_u32_u24 v3, 6144, v2
    v_and_b32 v4, 2, v2
    v_and_b32 v5, 7, v97
    v_xor_b32 v4, v4, v5
    v_lshl_add_u32 v3, v4, 4, v3
    s_mul_i32 s27, s24, 98304
    v_add_u32 v100, s27, v3
    v_xor_b32 v3, 64, v100
    v_add_u32 v101, 48128, v3
    v_lshlrev_b32 v3, 11, v2
    v_lshrrev_b32 v4, 4, v97
    v_xor_b32 v4, v4, v5
    v_lshl_add_u32 v102, v4, 4, v3
    v_xor_b32 v3, 64, v102
    v_add_u32 v103, 15360, v3
    v_add_u32 v104, 30720, v102
    v_add_u32 v105, 46080, v3
    s_lshl_b32 s28, s26, 7
    s_lshl_b32 s27, s30, 16
    s_waitcnt lgkmcnt(0)
    s_add_u32 s68, s28, 2048
    s_add_u32 s32, s6, s68
    s_addc_u32 s33, s7, 0
    s_sub_u32 s34, 6291456, s68
    s_mov_b32 s35, 0x20000
    s_add_u32 s40, s6, s28
    s_addc_u32 s41, s7, 0
    s_sub_u32 s42, 6291456, s28
    s_mov_b32 s43, 0x20000
    s_add_u32 s36, s4, s27
    s_addc_u32 s37, s5, 0
    s_mov_b32 s38, 65536
    s_mov_b32 s39, 0x20000
    s_and_b32 s27, s26, 3
    s_sub_u32 s28, 3, s27
    s_lshl_b32 s68, s28, 2
    s_add_u32 s68, s68, s31
    s_add_u32 s68, s68, 1
    s_and_b32 s68, s68, 15
    s_mul_i32 s68, s68, 393216
    s_lshl_b32 s28, s28, 7
    s_add_u32 s68, s68, s28
    s_lshl_b32 s27, s27, 11
    s_add_u32 s68, s68, s27
    s_and_b32 s69, s26, 7
    s_lshl_b32 s27, s24, 3
    s_add_u32 s69, s69, s27
    s_cmp_lt_u32 s69, 2
    s_cselect_b32 s68, s68, 0x4000000
    v_min_u32 v2, 63, v97
    v_mul_u32_u24 v2, 6144, v2
    buffer_load_dword v117, v2, s[32:35], s68 offen
    s_add_u32 m0, s29, 81920
    s_nop 0
    buffer_load_dwordx4 v102, s[36:39], s53 offen offset:0 lds
    buffer_load_dwordx4 v103, s[36:39], s53 offen offset:1024 lds
    buffer_load_dwordx4 v104, s[36:39], s53 offen offset:2048 lds
    buffer_load_dwordx4 v105, s[36:39], s53 offen offset:3072 lds
    s_add_u32 m0, s29, 0
    s_nop 0
    buffer_load_dwordx4 v100, s[32:35], s52 offen offset:0 lds
    buffer_load_dwordx4 v101, s[32:35], s52 offen offset:1024 lds
    buffer_load_dwordx4 v100, s[32:35], s52 offen offset:2048 lds
    buffer_load_dwordx4 v101, s[32:35], s52 offen offset:3072 lds
    s_mul_i32 s54, s55, 393216
    s_add_u32 m0, s29, 131072
    s_nop 0
    buffer_load_dwordx4 v100, s[40:43], s54 offen offset:0 lds
    buffer_load_dwordx4 v101, s[40:43], s54 offen offset:1024 lds
    s_add_u32 s31, s31, 1
    s_and_b32 s31, s31, 15
    s_mul_i32 s52, s31, 393216
    s_lshl_b32 s53, s31, 7
    s_add_u32 s44, s22, 32505856
    s_addc_u32 s45, s23, 0
    s_mov_b32 s46, 1048576
    s_mov_b32 s47, 0x20000
    s_mov_b32 s56, s20
    s_mov_b32 s57, s21
    s_mov_b32 s58, 256
    s_mov_b32 s59, 0x20000
    s_add_u32 s48, s22, 31457280
    s_addc_u32 s49, s23, 0
    s_mov_b32 s50, 327680
    s_mov_b32 s51, 0x20000
    s_mul_i32 s3, s26, 8704
    s_add_u32 s3, s3, 524288
    s_mov_b32 s60, 0x358637bd
    s_mov_b32 s61, s60
    s_mov_b32 s62, 0xffff0000
    s_mov_b32 s0, 1.0
    s_mov_b32 s1, 1.0
    v_lshrrev_b32 v2, 5, v97
    v_lshlrev_b32 v2, 12, v2
    v_bfe_u32 v3, v97, 4, 1
    v_lshl_add_u32 v2, v3, 10, v2
    v_bfe_u32 v4, v97, 2, 2
    v_lshl_add_u32 v2, v4, 7, v2
    v_bfe_u32 v4, v97, 3, 2
    v_lshl_add_u32 v2, v4, 5, v2
    v_and_b32 v4, 3, v97
    v_lshl_add_u32 v106, v4, 3, v2
    v_xor_b32 v107, 32, v106
    v_xor_b32 v108, 64, v106
    v_xor_b32 v109, 96, v106
    v_add_u32 v110, 0x10000, v106
    v_add_u32 v111, 0x10000, v107
    v_add_u32 v112, 0x10000, v108
    v_add_u32 v113, 0x10000, v109
    v_and_b32 v2, 15, v97
    v_lshrrev_b32 v3, 1, v2
    v_lshrrev_b32 v4, 4, v97
    v_xor_b32 v3, v3, v4
    v_lshlrev_b32 v3, 4, v3
    v_lshl_add_u32 v2, v2, 7, v3
    s_add_u32 s27, s29, 81920
    v_add_u32 v114, s27, v2
    v_xor_b32 v115, 64, v114
    v_mov_b32 v252, 0x3f803f80
    v_mov_b32 v253, 0x3f803f80
    v_mov_b32 v254, 0x3f803f80
    v_mov_b32 v255, 0x3f803f80
    v_mov_b32 v250, 1
    s_lshl_b32 s27, s24, 5
    v_xor_b32 v245, s27, v106
    v_add_u32 v246, 131072, v245
    v_lshlrev_b32 v241, 2, v97
    v_and_b32 v243, 0x30, v97
    v_lshrrev_b32 v2, 4, v97
    v_and_b32 v3, 15, v97
    v_lshlrev_b32 v3, 2, v3
    v_cmp_eq_u32 s[68:69], 1, v2
    v_cmp_eq_u32 s[100:101], 2, v2
    v_lshl_add_u32 v4, v2, 8, v3
    v_add_u32 v5, 1, v2
    v_lshrrev_b32 v5, 2, v5
    v_lshl_add_u32 v244, v5, 22, v4
    v_add_u32 v237, 135168, v3
    v_add_u32 v236, 135168, v243
    s_lshl_b32 s27, s24, 13
    s_add_u32 s27, s27, 131072
    v_lshl_add_u32 v233, v3, 1, s27
    v_add_u32 v234, s27, v243
    v_add_u32 v235, s27, v3
    v_add_u32 v238, s27, v98
    v_bfe_u32 v4, v97, 2, 2
    v_and_b32 v5, 3, v97
    v_lshlrev_b32 v6, 8, v4
    v_lshl_add_u32 v6, v5, 4, v6
    v_mul_u32_u24 v7, 3072, v2
    v_add_u32 v249, v6, v7
    s_lshl_b32 s27, s24, 6
    s_add_u32 s27, s27, 135168
    v_add_u32 v232, s27, v6
    v_lshl_add_u32 v6, v5, 2, v243
    v_lshl_add_u32 v242, v4, 22, v6
    s_lshl_b32 s27, s24, 10
    s_add_u32 s27, s27, 131072
    v_add_u32 v239, s27, v98
    s_lshr_b32 s27, s24, 1
    s_lshl_b32 s27, s27, 11
    s_add_u32 s27, s27, 135168
    v_add_u32 v240, s27, v98
    v_lshrrev_b32 v3, 5, v97
    v_lshlrev_b32 v4, 22, v3
    v_lshl_add_u32 v247, v97, 3, v4
    v_and_b32 v2, 15, v97
    v_lshlrev_b32 v3, 8, v243
    v_lshl_add_u32 v248, v2, 4, v3
    v_lshlrev_b32 v4, 18, v243
    v_lshl_add_u32 v99, v2, 3, v4
    v_lshlrev_b32 v119, 22, v96
    v_and_b32 v2, 1, v97
    v_lshlrev_b32 v118, 7, v2
    s_lshl_b32 s94, s25, 14
    s_lshl_b32 s28, s24, 8
    s_add_u32 s94, s94, s28
    s_lshl_b32 s27, s26, 10
    s_add_u32 s96, s94, s27
    s_mul_i32 s95, s26, 12288
    s_lshl_b32 s28, s24, 6
    s_add_u32 s95, s95, s28
    s_add_u32 s95, s95, 262144
    s_mul_i32 s27, s25, 768
    s_add_u32 s97, s95, s27
    s_and_b32 s63, s2, 1
    s_lshl_b32 s63, s63, 7
    s_bfe_u32 s27, s2, 0x20003
    s_lshl_b32 s27, s27, 8
    s_add_u32 s63, s63, s27
    v_lshlrev_b32 v2, 21, v97
    s_mov_b32 s67, 0x20000
    s_add_u32 s64, s22, 1048576
    s_addc_u32 s65, s23, 0
    s_cmp_eq_u32 s24, 3
    s_cselect_b32 s66, 32505856, 0
    s_mov_b32 s99, 0
    buffer_load_dword v117, v2, s[64:67], s99 offen
    s_add_u32 s64, s18, 0
    s_addc_u32 s65, s19, 0
    s_cmp_eq_u32 s24, 3
    s_cselect_b32 s66, 4194304, 0
    s_mov_b32 s99, 0
    buffer_load_dword v117, v2, s[64:67], s99 offen
    s_add_u32 s64, s12, 0
    s_addc_u32 s65, s13, 0
    s_cmp_eq_u32 s24, 3
    s_cselect_b32 s66, 7340032, 0
    s_mov_b32 s99, 0
    buffer_load_dword v117, v2, s[64:67], s99 offen
    s_add_u32 s64, s14, 0
    s_addc_u32 s65, s15, 0
    s_cmp_eq_u32 s24, 3
    s_cselect_b32 s66, 7340032, 0
    s_mov_b32 s99, 0
    buffer_load_dword v117, v2, s[64:67], s99 offen
    s_add_u32 s64, s16, 0
    s_addc_u32 s65, s17, 0
    s_cmp_eq_u32 s24, 3
    s_cselect_b32 s66, 7340032, 0
    s_mov_b32 s99, 0
    buffer_load_dword v117, v2, s[64:67], s99 offen
    s_add_u32 s64, s8, 0
    s_addc_u32 s65, s9, 0
    s_cmp_eq_u32 s24, 3
    s_cselect_b32 s66, 2097152, 0
    s_mov_b32 s99, 0
    buffer_load_dword v117, v2, s[64:67], s99 offen
    s_lshl_b32 s27, s2, 2
    s_add_u32 s27, s27, s24
    s_lshl_b32 s27, s27, 11
    s_add_u32 s64, s8, s27
    s_addc_u32 s65, s9, 0
    s_mov_b32 s66, 2048
    s_mov_b32 s67, 0x20000
    s_lshr_b32 s27, s2, 3
    s_lshl_b32 s27, s27, 6
    s_and_b32 s28, s2, 3
    s_lshl_b32 s28, s28, 4
    s_add_u32 s27, s27, s28
    s_bfe_u32 s28, s2, 0x10002
    s_lshl_b32 s28, s28, 3
    s_add_u32 s27, s27, s28
    s_lshl_b32 s28, s24, 1
    s_add_u32 s27, s27, s28
    s_add_u32 s98, s27, 311296
    v_lshlrev_b32 v151, 20, v97
    v_mov_b32 v208, 0
    v_mov_b32 v209, 0
    v_mov_b32 v210, 0
    v_mov_b32 v211, 0
    v_cmp_gt_u32 vcc, 34, v96
    s_mul_i32 s27, s25, 544
    s_add_u32 s27, s27, s3
    v_mov_b32 v2, 0x400000
    v_cndmask_b32 v2, v2, v98, vcc
    buffer_store_dwordx4 v[208:211], v2, s[44:47], s27 offen sc1
    s_lshl_b32 s27, s2, 7
    s_add_u32 s27, s27, 786432
    buffer_store_dword v208, v119, s[44:47], s27 offen sc1
    v_lshlrev_b32 v96, 4, v97
    s_mov_b64 exec, 0
    s_cmp_eq_u32 s24, 0
    s_cbranch_scc1 Lpad_1
    s_cmp_eq_u32 s24, 1
    s_cbranch_scc1 Lpad_2
    s_cmp_eq_u32 s24, 2
    s_cbranch_scc1 Lpad_3
    s_cmp_eq_u32 s24, 3
    s_cbranch_scc1 Lpad_4
    s_branch Lback_a
.p2align 12
Lback_a:
    s_mov_b64 exec, -1
    s_waitcnt vmcnt(14)
    ds_read_b128 v[212:215], v114 offset:0
    ds_read_b128 v[216:219], v115 offset:0
    ds_read_b128 v[220:223], v114 offset:2048
    ds_read_b128 v[224:227], v115 offset:2048
    ds_read_b128 a[0:3], v114 offset:0
    ds_read_b128 a[4:7], v114 offset:2048
    ds_read_b128 a[8:11], v115 offset:0
    ds_read_b128 a[12:15], v115 offset:2048
    s_waitcnt lgkmcnt(4)
    v_lshlrev_b32 v0, 16, v212
    v_and_b32 v1, s62, v212
    v_lshlrev_b32 v2, 16, v213
    v_and_b32 v3, s62, v213
    v_lshlrev_b32 v4, 16, v214
    v_and_b32 v5, s62, v214
    v_lshlrev_b32 v6, 16, v215
    v_and_b32 v7, s62, v215
    v_lshlrev_b32 v8, 16, v216
    v_and_b32 v9, s62, v216
    v_lshlrev_b32 v10, 16, v217
    v_and_b32 v11, s62, v217
    s_add_u32 m0, s29, 98304
    s_nop 0
    buffer_load_dwordx4 v102, s[36:39], s53 offen offset:0 lds
    v_lshlrev_b32 v12, 16, v218
    v_and_b32 v13, s62, v218
    v_lshlrev_b32 v14, 16, v219
    v_and_b32 v15, s62, v219
    v_lshlrev_b32 v16, 16, v220
    v_and_b32 v17, s62, v220
    v_lshlrev_b32 v18, 16, v221
    v_and_b32 v19, s62, v221
    v_lshlrev_b32 v20, 16, v222
    v_and_b32 v21, s62, v222
    v_lshlrev_b32 v22, 16, v223
    v_and_b32 v23, s62, v223
    buffer_load_dwordx4 v103, s[36:39], s53 offen offset:1024 lds
    v_lshlrev_b32 v24, 16, v224
    v_and_b32 v25, s62, v224
    v_lshlrev_b32 v26, 16, v225
    v_and_b32 v27, s62, v225
    v_lshlrev_b32 v28, 16, v226
    v_and_b32 v29, s62, v226
    v_lshlrev_b32 v30, 16, v227
    v_and_b32 v31, s62, v227
    v_pk_add_f32 v[32:33], v[0:1], v[2:3]
    v_pk_add_f32 v[32:33], v[32:33], v[4:5]
    v_pk_add_f32 v[32:33], v[32:33], v[6:7]
    v_pk_add_f32 v[32:33], v[32:33], v[8:9]
    buffer_load_dwordx4 v104, s[36:39], s53 offen offset:2048 lds
    v_pk_add_f32 v[32:33], v[32:33], v[10:11]
    v_pk_add_f32 v[32:33], v[32:33], v[12:13]
    v_pk_add_f32 v[32:33], v[32:33], v[14:15]
    v_add_f32 v32, v32, v33
    v_pk_add_f32 v[34:35], v[16:17], v[18:19]
    v_pk_add_f32 v[34:35], v[34:35], v[20:21]
    v_pk_add_f32 v[34:35], v[34:35], v[22:23]
    v_pk_add_f32 v[34:35], v[34:35], v[24:25]
    v_pk_add_f32 v[34:35], v[34:35], v[26:27]
    v_pk_add_f32 v[34:35], v[34:35], v[28:29]
    v_pk_add_f32 v[34:35], v[34:35], v[30:31]
    v_add_f32 v34, v34, v35
    buffer_load_dwordx4 v105, s[36:39], s53 offen offset:3072 lds
    v_mov_b32 v40, v32
    v_mov_b32 v41, v34
    s_nop 1
    v_permlane16_swap_b32 v32, v40
    v_permlane16_swap_b32 v34, v41
    v_add_f32 v32, v32, v40
    v_add_f32 v34, v34, v41
    v_mov_b32 v40, v32
    v_mov_b32 v41, v34
    s_nop 1
    v_permlane32_swap_b32 v32, v40
    v_permlane32_swap_b32 v34, v41
    s_add_u32 m0, s29, 16384
    s_nop 0
    buffer_load_dwordx4 v100, s[32:35], s52 offen offset:0 lds
    v_add_f32 v32, v32, v40
    v_add_f32 v34, v34, v41
    v_mul_f32 v33, 0xbc800000, v32
    v_pk_add_f32 v[0:1], v[0:1], v[32:33] op_sel:[0,1] op_sel_hi:[1,1]
    v_pk_add_f32 v[2:3], v[2:3], v[32:33] op_sel:[0,1] op_sel_hi:[1,1]
    v_pk_add_f32 v[4:5], v[4:5], v[32:33] op_sel:[0,1] op_sel_hi:[1,1]
    v_pk_add_f32 v[6:7], v[6:7], v[32:33] op_sel:[0,1] op_sel_hi:[1,1]
    v_pk_add_f32 v[8:9], v[8:9], v[32:33] op_sel:[0,1] op_sel_hi:[1,1]
    v_pk_add_f32 v[10:11], v[10:11], v[32:33] op_sel:[0,1] op_sel_hi:[1,1]
    v_pk_add_f32 v[12:13], v[12:13], v[32:33] op_sel:[0,1] op_sel_hi:[1,1]
    v_pk_add_f32 v[14:15], v[14:15], v[32:33] op_sel:[0,1] op_sel_hi:[1,1]
    v_pk_mul_f32 v[36:37], v[0:1], v[0:1]
    buffer_load_dwordx4 v101, s[32:35], s52 offen offset:1024 lds
    v_pk_fma_f32 v[36:37], v[2:3], v[2:3], v[36:37]
    v_pk_fma_f32 v[36:37], v[4:5], v[4:5], v[36:37]
    v_pk_fma_f32 v[36:37], v[6:7], v[6:7], v[36:37]
    v_pk_fma_f32 v[36:37], v[8:9], v[8:9], v[36:37]
    v_pk_fma_f32 v[36:37], v[10:11], v[10:11], v[36:37]
    v_pk_fma_f32 v[36:37], v[12:13], v[12:13], v[36:37]
    v_pk_fma_f32 v[36:37], v[14:15], v[14:15], v[36:37]
    v_add_f32 v36, v36, v37
    v_mul_f32 v35, 0xbc800000, v34
    v_pk_add_f32 v[16:17], v[16:17], v[34:35] op_sel:[0,1] op_sel_hi:[1,1]
    v_pk_add_f32 v[18:19], v[18:19], v[34:35] op_sel:[0,1] op_sel_hi:[1,1]
    v_pk_add_f32 v[20:21], v[20:21], v[34:35] op_sel:[0,1] op_sel_hi:[1,1]
    buffer_load_dwordx4 v100, s[32:35], s52 offen offset:2048 lds
    v_pk_add_f32 v[22:23], v[22:23], v[34:35] op_sel:[0,1] op_sel_hi:[1,1]
    v_pk_add_f32 v[24:25], v[24:25], v[34:35] op_sel:[0,1] op_sel_hi:[1,1]
    v_pk_add_f32 v[26:27], v[26:27], v[34:35] op_sel:[0,1] op_sel_hi:[1,1]
    v_pk_add_f32 v[28:29], v[28:29], v[34:35] op_sel:[0,1] op_sel_hi:[1,1]
    v_pk_add_f32 v[30:31], v[30:31], v[34:35] op_sel:[0,1] op_sel_hi:[1,1]
    v_pk_mul_f32 v[38:39], v[16:17], v[16:17]
    v_pk_fma_f32 v[38:39], v[18:19], v[18:19], v[38:39]
    v_pk_fma_f32 v[38:39], v[20:21], v[20:21], v[38:39]
    v_pk_fma_f32 v[38:39], v[22:23], v[22:23], v[38:39]
    v_pk_fma_f32 v[38:39], v[24:25], v[24:25], v[38:39]
    v_pk_fma_f32 v[38:39], v[26:27], v[26:27], v[38:39]
    v_pk_fma_f32 v[38:39], v[28:29], v[28:29], v[38:39]
    buffer_load_dwordx4 v101, s[32:35], s52 offen offset:3072 lds
    v_pk_fma_f32 v[38:39], v[30:31], v[30:31], v[38:39]
    v_add_f32 v38, v38, v39
    s_nop 1
    v_permlane16_swap_b32 v36, v38
    v_permlane16_swap_b32 v32, v34
    v_add_f32 v36, v36, v38
    v_mov_b32 v37, v36
    s_nop 1
    v_permlane32_swap_b32 v36, v37
    v_mov_b32 v228, v32
    v_add_f32 v229, v36, v37
    s_add_u32 s31, s31, 1
    s_and_b32 s31, s31, 15
    s_mul_i32 s52, s31, 393216
    s_lshl_b32 s53, s31, 7
    buffer_store_dwordx2 v[228:229], v247, s[44:47], s96 offen sc1
    s_add_u32 m0, s29, 32768
    s_nop 0
    buffer_load_dwordx4 v100, s[32:35], s52 offen offset:0 lds
    buffer_load_dwordx4 v101, s[32:35], s52 offen offset:1024 lds
    buffer_load_dwordx4 v100, s[32:35], s52 offen offset:2048 lds
    buffer_load_dwordx4 v101, s[32:35], s52 offen offset:3072 lds
    s_add_u32 m0, s29, 114688
    s_nop 0
    buffer_load_dwordx4 v102, s[36:39], s53 offen offset:0 lds
    buffer_load_dwordx4 v103, s[36:39], s53 offen offset:1024 lds
    buffer_load_dwordx4 v104, s[36:39], s53 offen offset:2048 lds
    buffer_load_dwordx4 v105, s[36:39], s53 offen offset:3072 lds
    s_add_u32 s31, s31, 1
    s_and_b32 s31, s31, 15
    s_mul_i32 s52, s31, 393216
    s_lshl_b32 s53, s31, 7
    s_waitcnt vmcnt(25)
    s_barrier
    ds_read_b64_tr_b16 v[176:177], v246 offset:0
    ds_read_b64_tr_b16 v[178:179], v246 offset:512
    ds_read_b64_tr_b16 v[180:181], v245 offset:0
    ds_read_b64_tr_b16 v[182:183], v245 offset:512
    ds_read_b64_tr_b16 v[184:185], v245 offset:2048
    ds_read_b64_tr_b16 v[186:187], v245 offset:2560
    ds_read_b64_tr_b16 v[188:189], v246 offset:8192
    ds_read_b64_tr_b16 v[190:191], v246 offset:8704
    ds_read_b64_tr_b16 v[192:193], v245 offset:8192
    ds_read_b64_tr_b16 v[194:195], v245 offset:8704
    ds_read_b64_tr_b16 v[196:197], v245 offset:10240
    ds_read_b64_tr_b16 v[198:199], v245 offset:10752
    s_waitcnt lgkmcnt(6)
    v_mfma_f32_16x16x32_bf16 v[212:215], v[252:255], v[176:179], 0
    ds_read_b64_tr_b16 v[64:65], v106 offset:0
    ds_read_b64_tr_b16 v[66:67], v106 offset:512
    v_mfma_f32_16x16x32_bf16 v[216:219], v[252:255], v[180:183], 0
    ds_read_b64_tr_b16 v[68:69], v107 offset:0
    ds_read_b64_tr_b16 v[70:71], v107 offset:512
    v_mfma_f32_16x16x32_bf16 v[220:223], v[252:255], v[184:187], 0
    ds_read_b64_tr_b16 v[72:73], v108 offset:0
    ds_read_b64_tr_b16 v[74:75], v108 offset:512
    s_waitcnt lgkmcnt(6)
    v_mfma_f32_16x16x32_bf16 v[212:215], v[252:255], v[188:191], v[212:215]
    ds_read_b64_tr_b16 v[76:77], v109 offset:0
    ds_read_b64_tr_b16 v[78:79], v109 offset:512
    v_mfma_f32_16x16x32_bf16 v[216:219], v[252:255], v[192:195], v[216:219]
    ds_read_b64_tr_b16 v[80:81], v106 offset:2048
    ds_read_b64_tr_b16 v[82:83], v106 offset:2560
    v_mfma_f32_16x16x32_bf16 v[220:223], v[252:255], v[196:199], v[220:223]
    ds_read_b64_tr_b16 v[84:85], v107 offset:2048
    ds_read_b64_tr_b16 v[86:87], v107 offset:2560
    s_waitcnt lgkmcnt(8)
    v_mfma_f32_16x16x32_bf16 v[0:3], a[0:3], v[64:67], 0
    s_add_u32 m0, s29, 49152
    ds_read_b64_tr_b16 v[88:89], v108 offset:2048
    ds_read_b64_tr_b16 v[90:91], v108 offset:2560
    v_mfma_f32_16x16x32_bf16 v[4:7], a[4:7], v[64:67], 0
    buffer_load_dwordx4 v100, s[32:35], s52 offen offset:0 lds
    v_mfma_f32_16x16x32_bf16 v[8:11], a[0:3], v[68:71], 0
    ds_read_b64_tr_b16 v[92:93], v109 offset:2048
    ds_read_b64_tr_b16 v[94:95], v109 offset:2560
    v_mfma_f32_16x16x32_bf16 v[12:15], a[4:7], v[68:71], 0
    s_waitcnt lgkmcnt(8)
    v_mfma_f32_16x16x32_bf16 v[16:19], a[0:3], v[72:75], 0
    ds_read_b64_tr_b16 v[64:65], v106 offset:8192
    ds_read_b64_tr_b16 v[66:67], v106 offset:8704
    v_mfma_f32_16x16x32_bf16 v[20:23], a[4:7], v[72:75], 0
    buffer_load_dwordx4 v101, s[32:35], s52 offen offset:1024 lds
    v_mfma_f32_16x16x32_bf16 v[24:27], a[0:3], v[76:79], 0
    ds_read_b64_tr_b16 v[68:69], v107 offset:8192
    ds_read_b64_tr_b16 v[70:71], v107 offset:8704
    v_mfma_f32_16x16x32_bf16 v[28:31], a[4:7], v[76:79], 0
    s_waitcnt lgkmcnt(8)
    v_cndmask_b32 v212, v212, v216, s[68:69]
    v_cndmask_b32 v212, v212, v220, s[100:101]
    v_mfma_f32_16x16x32_bf16 v[32:35], a[0:3], v[80:83], 0
    ds_read_b64_tr_b16 v[72:73], v108 offset:8192
    ds_read_b64_tr_b16 v[74:75], v108 offset:8704
    v_mfma_f32_16x16x32_bf16 v[36:39], a[4:7], v[80:83], 0
    buffer_load_dwordx4 v100, s[32:35], s52 offen offset:2048 lds
    v_mfma_f32_16x16x32_bf16 v[40:43], a[0:3], v[84:87], 0
    ds_read_b64_tr_b16 v[76:77], v109 offset:8192
    ds_read_b64_tr_b16 v[78:79], v109 offset:8704
    v_mfma_f32_16x16x32_bf16 v[44:47], a[4:7], v[84:87], 0
    s_waitcnt lgkmcnt(8)
    buffer_store_dword v212, v244, s[44:47], s97 offen sc1
    v_mfma_f32_16x16x32_bf16 v[48:51], a[0:3], v[88:91], 0
    ds_read_b64_tr_b16 v[80:81], v106 offset:10240
    ds_read_b64_tr_b16 v[82:83], v106 offset:10752
    v_mfma_f32_16x16x32_bf16 v[52:55], a[4:7], v[88:91], 0
    buffer_load_dwordx4 v101, s[32:35], s52 offen offset:3072 lds
    v_mfma_f32_16x16x32_bf16 v[56:59], a[0:3], v[92:95], 0
    ds_read_b64_tr_b16 v[84:85], v107 offset:10240
    ds_read_b64_tr_b16 v[86:87], v107 offset:10752
    v_mfma_f32_16x16x32_bf16 v[60:63], a[4:7], v[92:95], 0
    s_waitcnt lgkmcnt(8)
    v_mfma_f32_16x16x32_bf16 v[0:3], a[8:11], v[64:67], v[0:3]
    s_add_u32 m0, s29, 81920
    ds_read_b64_tr_b16 v[88:89], v108 offset:10240
    ds_read_b64_tr_b16 v[90:91], v108 offset:10752
    v_mfma_f32_16x16x32_bf16 v[4:7], a[12:15], v[64:67], v[4:7]
    buffer_load_dwordx4 v102, s[36:39], s53 offen offset:0 lds
    v_mfma_f32_16x16x32_bf16 v[8:11], a[8:11], v[68:71], v[8:11]
    ds_read_b64_tr_b16 v[92:93], v109 offset:10240
    ds_read_b64_tr_b16 v[94:95], v109 offset:10752
    v_mfma_f32_16x16x32_bf16 v[12:15], a[12:15], v[68:71], v[12:15]
    s_waitcnt vmcnt(15) lgkmcnt(8)
    s_barrier
    ds_read_b128 a[16:19], v114 offset:16384
    v_mfma_f32_16x16x32_bf16 v[16:19], a[8:11], v[72:75], v[16:19]
    s_add_u32 s31, s31, 1
    ds_read_b64_tr_b16 v[64:65], v106 offset:16384
    ds_read_b64_tr_b16 v[66:67], v106 offset:16896
    v_mfma_f32_16x16x32_bf16 v[20:23], a[12:15], v[72:75], v[20:23]
    buffer_load_dwordx4 v103, s[36:39], s53 offen offset:1024 lds
    v_mfma_f32_16x16x32_bf16 v[24:27], a[8:11], v[76:79], v[24:27]
    s_and_b32 s31, s31, 15
    ds_read_b64_tr_b16 v[68:69], v107 offset:16384
    ds_read_b64_tr_b16 v[70:71], v107 offset:16896
    v_mfma_f32_16x16x32_bf16 v[28:31], a[12:15], v[76:79], v[28:31]
    s_waitcnt lgkmcnt(9)
    ds_read_b128 a[20:23], v114 offset:18432
    v_mfma_f32_16x16x32_bf16 v[32:35], a[8:11], v[80:83], v[32:35]
    s_mul_i32 s52, s31, 393216
    ds_read_b64_tr_b16 v[72:73], v108 offset:16384
    ds_read_b64_tr_b16 v[74:75], v108 offset:16896
    v_mfma_f32_16x16x32_bf16 v[36:39], a[12:15], v[80:83], v[36:39]
    buffer_load_dwordx4 v104, s[36:39], s53 offen offset:2048 lds
    v_mfma_f32_16x16x32_bf16 v[40:43], a[8:11], v[84:87], v[40:43]
    ds_read_b64_tr_b16 v[76:77], v109 offset:16384
    ds_read_b64_tr_b16 v[78:79], v109 offset:16896
    v_mfma_f32_16x16x32_bf16 v[44:47], a[12:15], v[84:87], v[44:47]
    s_waitcnt lgkmcnt(10)
    ds_read_b128 a[24:27], v115 offset:16384
    v_mfma_f32_16x16x32_bf16 v[48:51], a[8:11], v[88:91], v[48:51]
    ds_read_b64_tr_b16 v[80:81], v106 offset:18432
    ds_read_b64_tr_b16 v[82:83], v106 offset:18944
    v_mfma_f32_16x16x32_bf16 v[52:55], a[12:15], v[88:91], v[52:55]
    buffer_load_dwordx4 v105, s[36:39], s53 offen offset:3072 lds
    v_mfma_f32_16x16x32_bf16 v[56:59], a[8:11], v[92:95], v[56:59]
    s_lshl_b32 s53, s31, 7
    ds_read_b64_tr_b16 v[84:85], v107 offset:18432
    ds_read_b64_tr_b16 v[86:87], v107 offset:18944
    v_mfma_f32_16x16x32_bf16 v[60:63], a[12:15], v[92:95], v[60:63]
    s_waitcnt lgkmcnt(9)
    ds_read_b128 a[28:31], v115 offset:18432
    v_mfma_f32_16x16x32_bf16 v[0:3], a[16:19], v[64:67], v[0:3]
    s_add_u32 m0, s29, 65536
    ds_read_b64_tr_b16 v[88:89], v108 offset:18432
    ds_read_b64_tr_b16 v[90:91], v108 offset:18944
    v_mfma_f32_16x16x32_bf16 v[4:7], a[20:23], v[64:67], v[4:7]
    buffer_load_dwordx4 v100, s[32:35], s52 offen offset:0 lds
    v_mfma_f32_16x16x32_bf16 v[8:11], a[16:19], v[68:71], v[8:11]
    ds_read_b64_tr_b16 v[92:93], v109 offset:18432
    ds_read_b64_tr_b16 v[94:95], v109 offset:18944
    v_mfma_f32_16x16x32_bf16 v[12:15], a[20:23], v[68:71], v[12:15]
    s_waitcnt lgkmcnt(10)
    v_mfma_f32_16x16x32_bf16 v[16:19], a[16:19], v[72:75], v[16:19]
    ds_read_b64_tr_b16 v[64:65], v106 offset:24576
    ds_read_b64_tr_b16 v[66:67], v106 offset:25088
    v_mfma_f32_16x16x32_bf16 v[20:23], a[20:23], v[72:75], v[20:23]
    buffer_load_dwordx4 v101, s[32:35], s52 offen offset:1024 lds
    v_mfma_f32_16x16x32_bf16 v[24:27], a[16:19], v[76:79], v[24:27]
    ds_read_b64_tr_b16 v[68:69], v107 offset:24576
    ds_read_b64_tr_b16 v[70:71], v107 offset:25088
    v_mfma_f32_16x16x32_bf16 v[28:31], a[20:23], v[76:79], v[28:31]
    s_waitcnt lgkmcnt(9)
    v_mfma_f32_16x16x32_bf16 v[32:35], a[16:19], v[80:83], v[32:35]
    ds_read_b64_tr_b16 v[72:73], v108 offset:24576
    ds_read_b64_tr_b16 v[74:75], v108 offset:25088
    v_mfma_f32_16x16x32_bf16 v[36:39], a[20:23], v[80:83], v[36:39]
    buffer_load_dwordx4 v100, s[32:35], s52 offen offset:2048 lds
    v_mfma_f32_16x16x32_bf16 v[40:43], a[16:19], v[84:87], v[40:43]
    ds_read_b64_tr_b16 v[76:77], v109 offset:24576
    ds_read_b64_tr_b16 v[78:79], v109 offset:25088
    v_mfma_f32_16x16x32_bf16 v[44:47], a[20:23], v[84:87], v[44:47]
    s_waitcnt lgkmcnt(8)
    v_mfma_f32_16x16x32_bf16 v[48:51], a[16:19], v[88:91], v[48:51]
    ds_read_b64_tr_b16 v[80:81], v106 offset:26624
    ds_read_b64_tr_b16 v[82:83], v106 offset:27136
    v_mfma_f32_16x16x32_bf16 v[52:55], a[20:23], v[88:91], v[52:55]
    buffer_load_dwordx4 v101, s[32:35], s52 offen offset:3072 lds
    v_mfma_f32_16x16x32_bf16 v[56:59], a[16:19], v[92:95], v[56:59]
    ds_read_b64_tr_b16 v[84:85], v107 offset:26624
    ds_read_b64_tr_b16 v[86:87], v107 offset:27136
    v_mfma_f32_16x16x32_bf16 v[60:63], a[20:23], v[92:95], v[60:63]
    s_waitcnt lgkmcnt(8)
    v_mfma_f32_16x16x32_bf16 v[0:3], a[24:27], v[64:67], v[0:3]
    s_add_u32 m0, s29, 98304
    ds_read_b64_tr_b16 v[88:89], v108 offset:26624
    ds_read_b64_tr_b16 v[90:91], v108 offset:27136
    v_mfma_f32_16x16x32_bf16 v[4:7], a[28:31], v[64:67], v[4:7]
    buffer_load_dwordx4 v102, s[36:39], s53 offen offset:0 lds
    v_mfma_f32_16x16x32_bf16 v[8:11], a[24:27], v[68:71], v[8:11]
    ds_read_b64_tr_b16 v[92:93], v109 offset:26624
    ds_read_b64_tr_b16 v[94:95], v109 offset:27136
    v_mfma_f32_16x16x32_bf16 v[12:15], a[28:31], v[68:71], v[12:15]
    s_waitcnt vmcnt(14) lgkmcnt(8)
    s_barrier
    ds_read_b128 a[32:35], v114 offset:32768
    v_mfma_f32_16x16x32_bf16 v[16:19], a[24:27], v[72:75], v[16:19]
    s_add_u32 s31, s31, 1
    ds_read_b64_tr_b16 v[64:65], v106 offset:32768
    ds_read_b64_tr_b16 v[66:67], v106 offset:33280
    v_mfma_f32_16x16x32_bf16 v[20:23], a[28:31], v[72:75], v[20:23]
    buffer_load_dwordx4 v103, s[36:39], s53 offen offset:1024 lds
    v_mfma_f32_16x16x32_bf16 v[24:27], a[24:27], v[76:79], v[24:27]
    s_and_b32 s31, s31, 15
    ds_read_b64_tr_b16 v[68:69], v107 offset:32768
    ds_read_b64_tr_b16 v[70:71], v107 offset:33280
    v_mfma_f32_16x16x32_bf16 v[28:31], a[28:31], v[76:79], v[28:31]
    s_waitcnt lgkmcnt(9)
    ds_read_b128 a[36:39], v114 offset:34816
    v_mfma_f32_16x16x32_bf16 v[32:35], a[24:27], v[80:83], v[32:35]
    s_mul_i32 s52, s31, 393216
    ds_read_b64_tr_b16 v[72:73], v108 offset:32768
    ds_read_b64_tr_b16 v[74:75], v108 offset:33280
    v_mfma_f32_16x16x32_bf16 v[36:39], a[28:31], v[80:83], v[36:39]
    buffer_load_dwordx4 v104, s[36:39], s53 offen offset:2048 lds
    v_mfma_f32_16x16x32_bf16 v[40:43], a[24:27], v[84:87], v[40:43]
    ds_read_b64_tr_b16 v[76:77], v109 offset:32768
    ds_read_b64_tr_b16 v[78:79], v109 offset:33280
    v_mfma_f32_16x16x32_bf16 v[44:47], a[28:31], v[84:87], v[44:47]
    s_waitcnt lgkmcnt(10)
    ds_read_b128 a[40:43], v115 offset:32768
    v_mfma_f32_16x16x32_bf16 v[48:51], a[24:27], v[88:91], v[48:51]
    ds_read_b64_tr_b16 v[80:81], v106 offset:34816
    ds_read_b64_tr_b16 v[82:83], v106 offset:35328
    v_mfma_f32_16x16x32_bf16 v[52:55], a[28:31], v[88:91], v[52:55]
    buffer_load_dwordx4 v105, s[36:39], s53 offen offset:3072 lds
    v_mfma_f32_16x16x32_bf16 v[56:59], a[24:27], v[92:95], v[56:59]
    s_lshl_b32 s53, s31, 7
    ds_read_b64_tr_b16 v[84:85], v107 offset:34816
    ds_read_b64_tr_b16 v[86:87], v107 offset:35328
    v_mfma_f32_16x16x32_bf16 v[60:63], a[28:31], v[92:95], v[60:63]
    s_waitcnt lgkmcnt(9)
    ds_read_b128 a[44:47], v115 offset:34816
    v_mfma_f32_16x16x32_bf16 v[0:3], a[32:35], v[64:67], v[0:3]
    s_add_u32 m0, s29, 0
    ds_read_b64_tr_b16 v[88:89], v108 offset:34816
    ds_read_b64_tr_b16 v[90:91], v108 offset:35328
    v_mfma_f32_16x16x32_bf16 v[4:7], a[36:39], v[64:67], v[4:7]
    buffer_load_dwordx4 v100, s[32:35], s52 offen offset:0 lds
    v_mfma_f32_16x16x32_bf16 v[8:11], a[32:35], v[68:71], v[8:11]
    ds_read_b64_tr_b16 v[92:93], v109 offset:34816
    ds_read_b64_tr_b16 v[94:95], v109 offset:35328
    v_mfma_f32_16x16x32_bf16 v[12:15], a[36:39], v[68:71], v[12:15]
    s_waitcnt lgkmcnt(10)
    v_mfma_f32_16x16x32_bf16 v[16:19], a[32:35], v[72:75], v[16:19]
    ds_read_b64_tr_b16 v[64:65], v106 offset:40960
    ds_read_b64_tr_b16 v[66:67], v106 offset:41472
    v_mfma_f32_16x16x32_bf16 v[20:23], a[36:39], v[72:75], v[20:23]
    buffer_load_dwordx4 v101, s[32:35], s52 offen offset:1024 lds
    v_mfma_f32_16x16x32_bf16 v[24:27], a[32:35], v[76:79], v[24:27]
    ds_read_b64_tr_b16 v[68:69], v107 offset:40960
    ds_read_b64_tr_b16 v[70:71], v107 offset:41472
    v_mfma_f32_16x16x32_bf16 v[28:31], a[36:39], v[76:79], v[28:31]
    s_waitcnt lgkmcnt(9)
    v_mfma_f32_16x16x32_bf16 v[32:35], a[32:35], v[80:83], v[32:35]
    ds_read_b64_tr_b16 v[72:73], v108 offset:40960
    ds_read_b64_tr_b16 v[74:75], v108 offset:41472
    v_mfma_f32_16x16x32_bf16 v[36:39], a[36:39], v[80:83], v[36:39]
    buffer_load_dwordx4 v100, s[32:35], s52 offen offset:2048 lds
    v_mfma_f32_16x16x32_bf16 v[40:43], a[32:35], v[84:87], v[40:43]
    ds_read_b64_tr_b16 v[76:77], v109 offset:40960
    ds_read_b64_tr_b16 v[78:79], v109 offset:41472
    v_mfma_f32_16x16x32_bf16 v[44:47], a[36:39], v[84:87], v[44:47]
    s_waitcnt lgkmcnt(8)
    v_mfma_f32_16x16x32_bf16 v[48:51], a[32:35], v[88:91], v[48:51]
    ds_read_b64_tr_b16 v[80:81], v106 offset:43008
    ds_read_b64_tr_b16 v[82:83], v106 offset:43520
    v_mfma_f32_16x16x32_bf16 v[52:55], a[36:39], v[88:91], v[52:55]
    buffer_load_dwordx4 v101, s[32:35], s52 offen offset:3072 lds
    v_mfma_f32_16x16x32_bf16 v[56:59], a[32:35], v[92:95], v[56:59]
    ds_read_b64_tr_b16 v[84:85], v107 offset:43008
    ds_read_b64_tr_b16 v[86:87], v107 offset:43520
    v_mfma_f32_16x16x32_bf16 v[60:63], a[36:39], v[92:95], v[60:63]
    s_waitcnt lgkmcnt(8)
    v_mfma_f32_16x16x32_bf16 v[0:3], a[40:43], v[64:67], v[0:3]
    s_add_u32 m0, s29, 114688
    ds_read_b64_tr_b16 v[88:89], v108 offset:43008
    ds_read_b64_tr_b16 v[90:91], v108 offset:43520
    v_mfma_f32_16x16x32_bf16 v[4:7], a[44:47], v[64:67], v[4:7]
    buffer_load_dwordx4 v102, s[36:39], s53 offen offset:0 lds
    v_mfma_f32_16x16x32_bf16 v[8:11], a[40:43], v[68:71], v[8:11]
    ds_read_b64_tr_b16 v[92:93], v109 offset:43008
    ds_read_b64_tr_b16 v[94:95], v109 offset:43520
    v_mfma_f32_16x16x32_bf16 v[12:15], a[44:47], v[68:71], v[12:15]
    s_waitcnt vmcnt(13) lgkmcnt(8)
    s_barrier
    buffer_atomic_add v250, v119, s[56:59], s63 offen sc1
    s_sub_u32 s63, s63, 256
    s_and_b32 s63, s63, 0xfff
    ds_read_b128 a[48:51], v114 offset:0
    v_mfma_f32_16x16x32_bf16 v[16:19], a[40:43], v[72:75], v[16:19]
    s_add_u32 s31, s31, 1
    ds_read_b64_tr_b16 v[64:65], v106 offset:49152
    ds_read_b64_tr_b16 v[66:67], v106 offset:49664
    v_mfma_f32_16x16x32_bf16 v[20:23], a[44:47], v[72:75], v[20:23]
    buffer_load_dwordx4 v103, s[36:39], s53 offen offset:1024 lds
    v_mfma_f32_16x16x32_bf16 v[24:27], a[40:43], v[76:79], v[24:27]
    s_and_b32 s31, s31, 15
    ds_read_b64_tr_b16 v[68:69], v107 offset:49152
    ds_read_b64_tr_b16 v[70:71], v107 offset:49664
    v_mfma_f32_16x16x32_bf16 v[28:31], a[44:47], v[76:79], v[28:31]
    s_waitcnt lgkmcnt(9)
    ds_read_b128 a[52:55], v114 offset:2048
    v_mfma_f32_16x16x32_bf16 v[32:35], a[40:43], v[80:83], v[32:35]
    s_mul_i32 s52, s31, 393216
    ds_read_b64_tr_b16 v[72:73], v108 offset:49152
    ds_read_b64_tr_b16 v[74:75], v108 offset:49664
    v_mfma_f32_16x16x32_bf16 v[36:39], a[44:47], v[80:83], v[36:39]
    buffer_load_dwordx4 v104, s[36:39], s53 offen offset:2048 lds
    v_mfma_f32_16x16x32_bf16 v[40:43], a[40:43], v[84:87], v[40:43]
    ds_read_b64_tr_b16 v[76:77], v109 offset:49152
    ds_read_b64_tr_b16 v[78:79], v109 offset:49664
    v_mfma_f32_16x16x32_bf16 v[44:47], a[44:47], v[84:87], v[44:47]
    s_waitcnt lgkmcnt(10)
    ds_read_b128 a[56:59], v115 offset:0
    v_mfma_f32_16x16x32_bf16 v[48:51], a[40:43], v[88:91], v[48:51]
    ds_read_b64_tr_b16 v[80:81], v106 offset:51200
    ds_read_b64_tr_b16 v[82:83], v106 offset:51712
    v_mfma_f32_16x16x32_bf16 v[52:55], a[44:47], v[88:91], v[52:55]
    buffer_load_dwordx4 v105, s[36:39], s53 offen offset:3072 lds
    v_mfma_f32_16x16x32_bf16 v[56:59], a[40:43], v[92:95], v[56:59]
    s_lshl_b32 s53, s31, 7
    ds_read_b64_tr_b16 v[84:85], v107 offset:51200
    ds_read_b64_tr_b16 v[86:87], v107 offset:51712
    v_mfma_f32_16x16x32_bf16 v[60:63], a[44:47], v[92:95], v[60:63]
    s_waitcnt lgkmcnt(9)
    ds_read_b128 a[60:63], v115 offset:2048
    v_mfma_f32_16x16x32_bf16 v[0:3], a[48:51], v[64:67], v[0:3]
    s_add_u32 m0, s29, 16384
    ds_read_b64_tr_b16 v[88:89], v108 offset:51200
    ds_read_b64_tr_b16 v[90:91], v108 offset:51712
    v_mfma_f32_16x16x32_bf16 v[4:7], a[52:55], v[64:67], v[4:7]
    buffer_load_dwordx4 v100, s[32:35], s52 offen offset:0 lds
    v_mfma_f32_16x16x32_bf16 v[8:11], a[48:51], v[68:71], v[8:11]
    ds_read_b64_tr_b16 v[92:93], v109 offset:51200
    ds_read_b64_tr_b16 v[94:95], v109 offset:51712
    v_mfma_f32_16x16x32_bf16 v[12:15], a[52:55], v[68:71], v[12:15]
    s_waitcnt lgkmcnt(10)
    v_mfma_f32_16x16x32_bf16 v[16:19], a[48:51], v[72:75], v[16:19]
    ds_read_b64_tr_b16 v[64:65], v106 offset:57344
    ds_read_b64_tr_b16 v[66:67], v106 offset:57856
    v_mfma_f32_16x16x32_bf16 v[20:23], a[52:55], v[72:75], v[20:23]
    buffer_load_dwordx4 v101, s[32:35], s52 offen offset:1024 lds
    v_mfma_f32_16x16x32_bf16 v[24:27], a[48:51], v[76:79], v[24:27]
    ds_read_b64_tr_b16 v[68:69], v107 offset:57344
    ds_read_b64_tr_b16 v[70:71], v107 offset:57856
    v_mfma_f32_16x16x32_bf16 v[28:31], a[52:55], v[76:79], v[28:31]
    s_waitcnt lgkmcnt(9)
    v_mfma_f32_16x16x32_bf16 v[32:35], a[48:51], v[80:83], v[32:35]
    ds_read_b64_tr_b16 v[72:73], v108 offset:57344
    ds_read_b64_tr_b16 v[74:75], v108 offset:57856
    v_mfma_f32_16x16x32_bf16 v[36:39], a[52:55], v[80:83], v[36:39]
    buffer_load_dwordx4 v100, s[32:35], s52 offen offset:2048 lds
    v_mfma_f32_16x16x32_bf16 v[40:43], a[48:51], v[84:87], v[40:43]
    ds_read_b64_tr_b16 v[76:77], v109 offset:57344
    ds_read_b64_tr_b16 v[78:79], v109 offset:57856
    v_mfma_f32_16x16x32_bf16 v[44:47], a[52:55], v[84:87], v[44:47]
    s_waitcnt lgkmcnt(8)
    v_mfma_f32_16x16x32_bf16 v[48:51], a[48:51], v[88:91], v[48:51]
    ds_read_b64_tr_b16 v[80:81], v106 offset:59392
    ds_read_b64_tr_b16 v[82:83], v106 offset:59904
    v_mfma_f32_16x16x32_bf16 v[52:55], a[52:55], v[88:91], v[52:55]
    buffer_load_dwordx4 v101, s[32:35], s52 offen offset:3072 lds
    v_mfma_f32_16x16x32_bf16 v[56:59], a[48:51], v[92:95], v[56:59]
    ds_read_b64_tr_b16 v[84:85], v107 offset:59392
    ds_read_b64_tr_b16 v[86:87], v107 offset:59904
    v_mfma_f32_16x16x32_bf16 v[60:63], a[52:55], v[92:95], v[60:63]
    s_waitcnt lgkmcnt(8)
    v_mfma_f32_16x16x32_bf16 v[0:3], a[56:59], v[64:67], v[0:3]
    s_add_u32 m0, s29, 81920
    ds_read_b64_tr_b16 v[88:89], v108 offset:59392
    ds_read_b64_tr_b16 v[90:91], v108 offset:59904
    v_mfma_f32_16x16x32_bf16 v[4:7], a[60:63], v[64:67], v[4:7]
    buffer_load_dwordx4 v102, s[36:39], s53 offen offset:0 lds
    v_mfma_f32_16x16x32_bf16 v[8:11], a[56:59], v[68:71], v[8:11]
    ds_read_b64_tr_b16 v[92:93], v109 offset:59392
    ds_read_b64_tr_b16 v[94:95], v109 offset:59904
    v_mfma_f32_16x16x32_bf16 v[12:15], a[60:63], v[68:71], v[12:15]
    s_waitcnt vmcnt(14) lgkmcnt(8)
    s_barrier
    buffer_atomic_add v250, v119, s[56:59], s63 offen sc1
    s_sub_u32 s63, s63, 256
    s_and_b32 s63, s63, 0xfff
    ds_read_b128 a[64:67], v114 offset:16384
    v_mfma_f32_16x16x32_bf16 v[16:19], a[56:59], v[72:75], v[16:19]
    s_add_u32 s31, s31, 1
    ds_read_b64_tr_b16 v[64:65], v110 offset:0
    ds_read_b64_tr_b16 v[66:67], v110 offset:512
    v_mfma_f32_16x16x32_bf16 v[20:23], a[60:63], v[72:75], v[20:23]
    buffer_load_dwordx4 v103, s[36:39], s53 offen offset:1024 lds
    v_mfma_f32_16x16x32_bf16 v[24:27], a[56:59], v[76:79], v[24:27]
    s_and_b32 s31, s31, 15
    ds_read_b64_tr_b16 v[68:69], v111 offset:0
    ds_read_b64_tr_b16 v[70:71], v111 offset:512
    v_mfma_f32_16x16x32_bf16 v[28:31], a[60:63], v[76:79], v[28:31]
    s_waitcnt lgkmcnt(9)
    ds_read_b128 a[68:71], v114 offset:18432
    v_mfma_f32_16x16x32_bf16 v[32:35], a[56:59], v[80:83], v[32:35]
    s_mul_i32 s52, s31, 393216
    ds_read_b64_tr_b16 v[72:73], v112 offset:0
    ds_read_b64_tr_b16 v[74:75], v112 offset:512
    v_mfma_f32_16x16x32_bf16 v[36:39], a[60:63], v[80:83], v[36:39]
    buffer_load_dwordx4 v104, s[36:39], s53 offen offset:2048 lds
    v_mfma_f32_16x16x32_bf16 v[40:43], a[56:59], v[84:87], v[40:43]
    ds_read_b64_tr_b16 v[76:77], v113 offset:0
    ds_read_b64_tr_b16 v[78:79], v113 offset:512
    v_mfma_f32_16x16x32_bf16 v[44:47], a[60:63], v[84:87], v[44:47]
    s_waitcnt lgkmcnt(10)
    ds_read_b128 a[72:75], v115 offset:16384
    v_mfma_f32_16x16x32_bf16 v[48:51], a[56:59], v[88:91], v[48:51]
    ds_read_b64_tr_b16 v[80:81], v110 offset:2048
    ds_read_b64_tr_b16 v[82:83], v110 offset:2560
    v_mfma_f32_16x16x32_bf16 v[52:55], a[60:63], v[88:91], v[52:55]
    buffer_load_dwordx4 v105, s[36:39], s53 offen offset:3072 lds
    v_mfma_f32_16x16x32_bf16 v[56:59], a[56:59], v[92:95], v[56:59]
    s_lshl_b32 s53, s31, 7
    ds_read_b64_tr_b16 v[84:85], v111 offset:2048
    ds_read_b64_tr_b16 v[86:87], v111 offset:2560
    v_mfma_f32_16x16x32_bf16 v[60:63], a[60:63], v[92:95], v[60:63]
    s_waitcnt lgkmcnt(9)
    ds_read_b128 a[76:79], v115 offset:18432
    v_mfma_f32_16x16x32_bf16 v[0:3], a[64:67], v[64:67], v[0:3]
    s_add_u32 m0, s29, 32768
    ds_read_b64_tr_b16 v[88:89], v112 offset:2048
    ds_read_b64_tr_b16 v[90:91], v112 offset:2560
    v_mfma_f32_16x16x32_bf16 v[4:7], a[68:71], v[64:67], v[4:7]
    buffer_load_dwordx4 v100, s[32:35], s52 offen offset:0 lds
    v_mfma_f32_16x16x32_bf16 v[8:11], a[64:67], v[68:71], v[8:11]
    ds_read_b64_tr_b16 v[92:93], v113 offset:2048
    ds_read_b64_tr_b16 v[94:95], v113 offset:2560
    v_mfma_f32_16x16x32_bf16 v[12:15], a[68:71], v[68:71], v[12:15]
    s_waitcnt lgkmcnt(10)
    v_mfma_f32_16x16x32_bf16 v[16:19], a[64:67], v[72:75], v[16:19]
    ds_read_b64_tr_b16 v[64:65], v110 offset:8192
    ds_read_b64_tr_b16 v[66:67], v110 offset:8704
    v_mfma_f32_16x16x32_bf16 v[20:23], a[68:71], v[72:75], v[20:23]
    buffer_load_dwordx4 v101, s[32:35], s52 offen offset:1024 lds
    v_mfma_f32_16x16x32_bf16 v[24:27], a[64:67], v[76:79], v[24:27]
Lpad_1:
    s_cbranch_execz Lpad_5
    ds_read_b64_tr_b16 v[68:69], v111 offset:8192
    ds_read_b64_tr_b16 v[70:71], v111 offset:8704
    v_mfma_f32_16x16x32_bf16 v[28:31], a[68:71], v[76:79], v[28:31]
    s_waitcnt lgkmcnt(9)
    v_mfma_f32_16x16x32_bf16 v[32:35], a[64:67], v[80:83], v[32:35]
    ds_read_b64_tr_b16 v[72:73], v112 offset:8192
    ds_read_b64_tr_b16 v[74:75], v112 offset:8704
    v_mfma_f32_16x16x32_bf16 v[36:39], a[68:71], v[80:83], v[36:39]
    buffer_load_dwordx4 v100, s[32:35], s52 offen offset:2048 lds
    v_mfma_f32_16x16x32_bf16 v[40:43], a[64:67], v[84:87], v[40:43]
    ds_read_b64_tr_b16 v[76:77], v113 offset:8192
    ds_read_b64_tr_b16 v[78:79], v113 offset:8704
    v_mfma_f32_16x16x32_bf16 v[44:47], a[68:71], v[84:87], v[44:47]
    s_waitcnt lgkmcnt(8)
    v_mfma_f32_16x16x32_bf16 v[48:51], a[64:67], v[88:91], v[48:51]
    ds_read_b64_tr_b16 v[80:81], v110 offset:10240
    ds_read_b64_tr_b16 v[82:83], v110 offset:10752
    v_mfma_f32_16x16x32_bf16 v[52:55], a[68:71], v[88:91], v[52:55]
    buffer_load_dwordx4 v101, s[32:35], s52 offen offset:3072 lds
    v_mfma_f32_16x16x32_bf16 v[56:59], a[64:67], v[92:95], v[56:59]
    ds_read_b64_tr_b16 v[84:85], v111 offset:10240
    ds_read_b64_tr_b16 v[86:87], v111 offset:10752
    v_mfma_f32_16x16x32_bf16 v[60:63], a[68:71], v[92:95], v[60:63]
    s_waitcnt lgkmcnt(8)
    v_mfma_f32_16x16x32_bf16 v[0:3], a[72:75], v[64:67], v[0:3]
    s_add_u32 m0, s29, 98304
    ds_read_b64_tr_b16 v[88:89], v112 offset:10240
    ds_read_b64_tr_b16 v[90:91], v112 offset:10752
    v_mfma_f32_16x16x32_bf16 v[4:7], a[76:79], v[64:67], v[4:7]
    buffer_load_dwordx4 v102, s[36:39], s53 offen offset:0 lds
    v_mfma_f32_16x16x32_bf16 v[8:11], a[72:75], v[68:71], v[8:11]
    ds_read_b64_tr_b16 v[92:93], v113 offset:10240
    ds_read_b64_tr_b16 v[94:95], v113 offset:10752
    v_mfma_f32_16x16x32_bf16 v[12:15], a[76:79], v[68:71], v[12:15]
    s_waitcnt vmcnt(14) lgkmcnt(8)
    s_barrier
    buffer_atomic_add v250, v119, s[56:59], s63 offen sc1
    s_sub_u32 s63, s63, 256
    s_and_b32 s63, s63, 0xfff
    ds_read_b128 a[80:83], v114 offset:32768
    v_mfma_f32_16x16x32_bf16 v[16:19], a[72:75], v[72:75], v[16:19]
    s_add_u32 s31, s31, 1
    ds_read_b64_tr_b16 v[64:65], v106 offset:0
    ds_read_b64_tr_b16 v[66:67], v106 offset:512
    v_mfma_f32_16x16x32_bf16 v[20:23], a[76:79], v[72:75], v[20:23]
    buffer_load_dwordx4 v103, s[36:39], s53 offen offset:1024 lds
    v_mfma_f32_16x16x32_bf16 v[24:27], a[72:75], v[76:79], v[24:27]
    s_and_b32 s31, s31, 15
    ds_read_b64_tr_b16 v[68:69], v107 offset:0
    ds_read_b64_tr_b16 v[70:71], v107 offset:512
    v_mfma_f32_16x16x32_bf16 v[28:31], a[76:79], v[76:79], v[28:31]
    s_waitcnt lgkmcnt(9)
    ds_read_b128 a[84:87], v114 offset:34816
    v_mfma_f32_16x16x32_bf16 v[32:35], a[72:75], v[80:83], v[32:35]
    s_mul_i32 s52, s31, 393216
    ds_read_b64_tr_b16 v[72:73], v108 offset:0
    ds_read_b64_tr_b16 v[74:75], v108 offset:512
    v_mfma_f32_16x16x32_bf16 v[36:39], a[76:79], v[80:83], v[36:39]
    buffer_load_dwordx4 v104, s[36:39], s53 offen offset:2048 lds
    v_mfma_f32_16x16x32_bf16 v[40:43], a[72:75], v[84:87], v[40:43]
    ds_read_b64_tr_b16 v[76:77], v109 offset:0
    ds_read_b64_tr_b16 v[78:79], v109 offset:512
    v_mfma_f32_16x16x32_bf16 v[44:47], a[76:79], v[84:87], v[44:47]
    s_waitcnt lgkmcnt(10)
    ds_read_b128 a[88:91], v115 offset:32768
    v_mfma_f32_16x16x32_bf16 v[48:51], a[72:75], v[88:91], v[48:51]
    ds_read_b64_tr_b16 v[80:81], v106 offset:2048
    ds_read_b64_tr_b16 v[82:83], v106 offset:2560
    v_mfma_f32_16x16x32_bf16 v[52:55], a[76:79], v[88:91], v[52:55]
    buffer_load_dwordx4 v105, s[36:39], s53 offen offset:3072 lds
    v_mfma_f32_16x16x32_bf16 v[56:59], a[72:75], v[92:95], v[56:59]
    s_lshl_b32 s53, s31, 7
    ds_read_b64_tr_b16 v[84:85], v107 offset:2048
    ds_read_b64_tr_b16 v[86:87], v107 offset:2560
    v_mfma_f32_16x16x32_bf16 v[60:63], a[76:79], v[92:95], v[60:63]
    s_waitcnt lgkmcnt(9)
    ds_read_b128 a[92:95], v115 offset:34816
    v_mfma_f32_16x16x32_bf16 v[0:3], a[80:83], v[64:67], v[0:3]
    s_add_u32 m0, s29, 49152
    ds_read_b64_tr_b16 v[88:89], v108 offset:2048
    ds_read_b64_tr_b16 v[90:91], v108 offset:2560
    v_mfma_f32_16x16x32_bf16 v[4:7], a[84:87], v[64:67], v[4:7]
    buffer_load_dwordx4 v100, s[32:35], s52 offen offset:0 lds
    v_mfma_f32_16x16x32_bf16 v[8:11], a[80:83], v[68:71], v[8:11]
    ds_read_b64_tr_b16 v[92:93], v109 offset:2048
    ds_read_b64_tr_b16 v[94:95], v109 offset:2560
    v_mfma_f32_16x16x32_bf16 v[12:15], a[84:87], v[68:71], v[12:15]
    s_waitcnt lgkmcnt(10)
    v_mfma_f32_16x16x32_bf16 v[16:19], a[80:83], v[72:75], v[16:19]
    ds_read_b64_tr_b16 v[64:65], v106 offset:8192
    ds_read_b64_tr_b16 v[66:67], v106 offset:8704
    v_mfma_f32_16x16x32_bf16 v[20:23], a[84:87], v[72:75], v[20:23]
    buffer_load_dwordx4 v101, s[32:35], s52 offen offset:1024 lds
    v_mfma_f32_16x16x32_bf16 v[24:27], a[80:83], v[76:79], v[24:27]
    ds_read_b64_tr_b16 v[68:69], v107 offset:8192
    ds_read_b64_tr_b16 v[70:71], v107 offset:8704
    v_mfma_f32_16x16x32_bf16 v[28:31], a[84:87], v[76:79], v[28:31]
    s_waitcnt lgkmcnt(9)
    v_mfma_f32_16x16x32_bf16 v[32:35], a[80:83], v[80:83], v[32:35]
    ds_read_b64_tr_b16 v[72:73], v108 offset:8192
    ds_read_b64_tr_b16 v[74:75], v108 offset:8704
    v_mfma_f32_16x16x32_bf16 v[36:39], a[84:87], v[80:83], v[36:39]
    buffer_load_dwordx4 v100, s[32:35], s52 offen offset:2048 lds
    v_mfma_f32_16x16x32_bf16 v[40:43], a[80:83], v[84:87], v[40:43]
    ds_read_b64_tr_b16 v[76:77], v109 offset:8192
    ds_read_b64_tr_b16 v[78:79], v109 offset:8704
    v_mfma_f32_16x16x32_bf16 v[44:47], a[84:87], v[84:87], v[44:47]
    s_waitcnt lgkmcnt(8)
    v_mfma_f32_16x16x32_bf16 v[48:51], a[80:83], v[88:91], v[48:51]
    ds_read_b64_tr_b16 v[80:81], v106 offset:10240
    ds_read_b64_tr_b16 v[82:83], v106 offset:10752
    v_mfma_f32_16x16x32_bf16 v[52:55], a[84:87], v[88:91], v[52:55]
    buffer_load_dwordx4 v101, s[32:35], s52 offen offset:3072 lds
    v_mfma_f32_16x16x32_bf16 v[56:59], a[80:83], v[92:95], v[56:59]
    ds_read_b64_tr_b16 v[84:85], v107 offset:10240
    ds_read_b64_tr_b16 v[86:87], v107 offset:10752
    v_mfma_f32_16x16x32_bf16 v[60:63], a[84:87], v[92:95], v[60:63]
    s_waitcnt lgkmcnt(8)
    v_mfma_f32_16x16x32_bf16 v[0:3], a[88:91], v[64:67], v[0:3]
    s_add_u32 m0, s29, 114688
    ds_read_b64_tr_b16 v[88:89], v108 offset:10240
    ds_read_b64_tr_b16 v[90:91], v108 offset:10752
    v_mfma_f32_16x16x32_bf16 v[4:7], a[92:95], v[64:67], v[4:7]
    buffer_load_dwordx4 v102, s[36:39], s53 offen offset:0 lds
    v_mfma_f32_16x16x32_bf16 v[8:11], a[88:91], v[68:71], v[8:11]
    ds_read_b64_tr_b16 v[92:93], v109 offset:10240
    ds_read_b64_tr_b16 v[94:95], v109 offset:10752
    v_mfma_f32_16x16x32_bf16 v[12:15], a[92:95], v[68:71], v[12:15]
    s_waitcnt vmcnt(14) lgkmcnt(8)
    s_barrier
    buffer_atomic_add v250, v119, s[56:59], s63 offen sc1
    s_sub_u32 s63, s63, 256
    s_and_b32 s63, s63, 0xfff
    ds_read_b128 a[96:99], v114 offset:0
    v_mfma_f32_16x16x32_bf16 v[16:19], a[88:91], v[72:75], v[16:19]
    s_add_u32 s31, s31, 1
    ds_read_b64_tr_b16 v[64:65], v106 offset:16384
    ds_read_b64_tr_b16 v[66:67], v106 offset:16896
    v_mfma_f32_16x16x32_bf16 v[20:23], a[92:95], v[72:75], v[20:23]
    buffer_load_dwordx4 v103, s[36:39], s53 offen offset:1024 lds
    v_mfma_f32_16x16x32_bf16 v[24:27], a[88:91], v[76:79], v[24:27]
    s_and_b32 s31, s31, 15
    ds_read_b64_tr_b16 v[68:69], v107 offset:16384
    ds_read_b64_tr_b16 v[70:71], v107 offset:16896
    v_mfma_f32_16x16x32_bf16 v[28:31], a[92:95], v[76:79], v[28:31]
    s_waitcnt lgkmcnt(9)
    ds_read_b128 a[100:103], v114 offset:2048
    v_mfma_f32_16x16x32_bf16 v[32:35], a[88:91], v[80:83], v[32:35]
    s_mul_i32 s52, s31, 393216
    ds_read_b64_tr_b16 v[72:73], v108 offset:16384
    ds_read_b64_tr_b16 v[74:75], v108 offset:16896
    v_mfma_f32_16x16x32_bf16 v[36:39], a[92:95], v[80:83], v[36:39]
    buffer_load_dwordx4 v104, s[36:39], s53 offen offset:2048 lds
    v_mfma_f32_16x16x32_bf16 v[40:43], a[88:91], v[84:87], v[40:43]
    ds_read_b64_tr_b16 v[76:77], v109 offset:16384
    ds_read_b64_tr_b16 v[78:79], v109 offset:16896
    v_mfma_f32_16x16x32_bf16 v[44:47], a[92:95], v[84:87], v[44:47]
    s_waitcnt lgkmcnt(10)
    ds_read_b128 a[104:107], v115 offset:0
    v_mfma_f32_16x16x32_bf16 v[48:51], a[88:91], v[88:91], v[48:51]
    ds_read_b64_tr_b16 v[80:81], v106 offset:18432
    ds_read_b64_tr_b16 v[82:83], v106 offset:18944
    v_mfma_f32_16x16x32_bf16 v[52:55], a[92:95], v[88:91], v[52:55]
    buffer_load_dwordx4 v105, s[36:39], s53 offen offset:3072 lds
    v_mfma_f32_16x16x32_bf16 v[56:59], a[88:91], v[92:95], v[56:59]
    s_lshl_b32 s53, s31, 7
    ds_read_b64_tr_b16 v[84:85], v107 offset:18432
    ds_read_b64_tr_b16 v[86:87], v107 offset:18944
    v_mfma_f32_16x16x32_bf16 v[60:63], a[92:95], v[92:95], v[60:63]
    s_waitcnt lgkmcnt(9)
    ds_read_b128 a[108:111], v115 offset:2048
    v_mfma_f32_16x16x32_bf16 v[0:3], a[96:99], v[64:67], v[0:3]
    s_add_u32 m0, s29, 65536
    ds_read_b64_tr_b16 v[88:89], v108 offset:18432
    ds_read_b64_tr_b16 v[90:91], v108 offset:18944
    v_mfma_f32_16x16x32_bf16 v[4:7], a[100:103], v[64:67], v[4:7]
    buffer_load_dwordx4 v100, s[32:35], s52 offen offset:0 lds
    v_mfma_f32_16x16x32_bf16 v[8:11], a[96:99], v[68:71], v[8:11]
    ds_read_b64_tr_b16 v[92:93], v109 offset:18432
    ds_read_b64_tr_b16 v[94:95], v109 offset:18944
    v_mfma_f32_16x16x32_bf16 v[12:15], a[100:103], v[68:71], v[12:15]
    s_waitcnt lgkmcnt(10)
    v_mfma_f32_16x16x32_bf16 v[16:19], a[96:99], v[72:75], v[16:19]
    ds_read_b64_tr_b16 v[64:65], v106 offset:24576
    ds_read_b64_tr_b16 v[66:67], v106 offset:25088
    v_mfma_f32_16x16x32_bf16 v[20:23], a[100:103], v[72:75], v[20:23]
    buffer_load_dwordx4 v101, s[32:35], s52 offen offset:1024 lds
    v_mfma_f32_16x16x32_bf16 v[24:27], a[96:99], v[76:79], v[24:27]
    ds_read_b64_tr_b16 v[68:69], v107 offset:24576
    ds_read_b64_tr_b16 v[70:71], v107 offset:25088
    v_mfma_f32_16x16x32_bf16 v[28:31], a[100:103], v[76:79], v[28:31]
    s_waitcnt lgkmcnt(9)
    v_mfma_f32_16x16x32_bf16 v[32:35], a[96:99], v[80:83], v[32:35]
    ds_read_b64_tr_b16 v[72:73], v108 offset:24576
    ds_read_b64_tr_b16 v[74:75], v108 offset:25088
    v_mfma_f32_16x16x32_bf16 v[36:39], a[100:103], v[80:83], v[36:39]
    buffer_load_dwordx4 v100, s[32:35], s52 offen offset:2048 lds
    v_mfma_f32_16x16x32_bf16 v[40:43], a[96:99], v[84:87], v[40:43]
    ds_read_b64_tr_b16 v[76:77], v109 offset:24576
    ds_read_b64_tr_b16 v[78:79], v109 offset:25088
    v_mfma_f32_16x16x32_bf16 v[44:47], a[100:103], v[84:87], v[44:47]
    s_waitcnt lgkmcnt(8)
    v_mfma_f32_16x16x32_bf16 v[48:51], a[96:99], v[88:91], v[48:51]
    ds_read_b64_tr_b16 v[80:81], v106 offset:26624
    ds_read_b64_tr_b16 v[82:83], v106 offset:27136
    v_mfma_f32_16x16x32_bf16 v[52:55], a[100:103], v[88:91], v[52:55]
    buffer_load_dwordx4 v101, s[32:35], s52 offen offset:3072 lds
    v_mfma_f32_16x16x32_bf16 v[56:59], a[96:99], v[92:95], v[56:59]
    ds_read_b64_tr_b16 v[84:85], v107 offset:26624
    ds_read_b64_tr_b16 v[86:87], v107 offset:27136
    v_mfma_f32_16x16x32_bf16 v[60:63], a[100:103], v[92:95], v[60:63]
    s_waitcnt lgkmcnt(8)
    v_mfma_f32_16x16x32_bf16 v[0:3], a[104:107], v[64:67], v[0:3]
    s_add_u32 m0, s29, 81920
    ds_read_b64_tr_b16 v[88:89], v108 offset:26624
    ds_read_b64_tr_b16 v[90:91], v108 offset:27136
    v_mfma_f32_16x16x32_bf16 v[4:7], a[108:111], v[64:67], v[4:7]
    buffer_load_dwordx4 v102, s[36:39], s53 offen offset:0 lds
    v_mfma_f32_16x16x32_bf16 v[8:11], a[104:107], v[68:71], v[8:11]
    ds_read_b64_tr_b16 v[92:93], v109 offset:26624
    ds_read_b64_tr_b16 v[94:95], v109 offset:27136
    v_mfma_f32_16x16x32_bf16 v[12:15], a[108:111], v[68:71], v[12:15]
    s_waitcnt vmcnt(14) lgkmcnt(8)
    s_barrier
    ds_read_b128 a[112:115], v114 offset:16384
    v_mfma_f32_16x16x32_bf16 v[16:19], a[104:107], v[72:75], v[16:19]
    s_add_u32 s31, s31, 1
    ds_read_b64_tr_b16 v[64:65], v106 offset:32768
    ds_read_b64_tr_b16 v[66:67], v106 offset:33280
    v_mfma_f32_16x16x32_bf16 v[20:23], a[108:111], v[72:75], v[20:23]
    buffer_load_dwordx4 v103, s[36:39], s53 offen offset:1024 lds
    v_mfma_f32_16x16x32_bf16 v[24:27], a[104:107], v[76:79], v[24:27]
    s_and_b32 s31, s31, 15
    ds_read_b64_tr_b16 v[68:69], v107 offset:32768
    ds_read_b64_tr_b16 v[70:71], v107 offset:33280
    v_mfma_f32_16x16x32_bf16 v[28:31], a[108:111], v[76:79], v[28:31]
    s_waitcnt lgkmcnt(9)
    ds_read_b128 a[116:119], v114 offset:18432
    v_mfma_f32_16x16x32_bf16 v[32:35], a[104:107], v[80:83], v[32:35]
    s_mul_i32 s52, s31, 393216
    ds_read_b64_tr_b16 v[72:73], v108 offset:32768
    ds_read_b64_tr_b16 v[74:75], v108 offset:33280
    v_mfma_f32_16x16x32_bf16 v[36:39], a[108:111], v[80:83], v[36:39]
    buffer_load_dwordx4 v104, s[36:39], s53 offen offset:2048 lds
    v_mfma_f32_16x16x32_bf16 v[40:43], a[104:107], v[84:87], v[40:43]
    ds_read_b64_tr_b16 v[76:77], v109 offset:32768
    ds_read_b64_tr_b16 v[78:79], v109 offset:33280
    v_mfma_f32_16x16x32_bf16 v[44:47], a[108:111], v[84:87], v[44:47]
    s_waitcnt lgkmcnt(10)
    ds_read_b128 a[120:123], v115 offset:16384
    v_mfma_f32_16x16x32_bf16 v[48:51], a[104:107], v[88:91], v[48:51]
    ds_read_b64_tr_b16 v[80:81], v106 offset:34816
    ds_read_b64_tr_b16 v[82:83], v106 offset:35328
    v_mfma_f32_16x16x32_bf16 v[52:55], a[108:111], v[88:91], v[52:55]
    buffer_load_dwordx4 v105, s[36:39], s53 offen offset:3072 lds
    v_mfma_f32_16x16x32_bf16 v[56:59], a[104:107], v[92:95], v[56:59]
    s_lshl_b32 s53, s31, 7
    ds_read_b64_tr_b16 v[84:85], v107 offset:34816
    ds_read_b64_tr_b16 v[86:87], v107 offset:35328
    v_mfma_f32_16x16x32_bf16 v[60:63], a[108:111], v[92:95], v[60:63]
    s_waitcnt lgkmcnt(9)
    ds_read_b128 a[124:127], v115 offset:18432
    v_mfma_f32_16x16x32_bf16 v[0:3], a[112:115], v[64:67], v[0:3]
    s_add_u32 m0, s29, 0
    ds_read_b64_tr_b16 v[88:89], v108 offset:34816
    ds_read_b64_tr_b16 v[90:91], v108 offset:35328
    v_mfma_f32_16x16x32_bf16 v[4:7], a[116:119], v[64:67], v[4:7]
    buffer_load_dwordx4 v100, s[32:35], s52 offen offset:0 lds
    v_mfma_f32_16x16x32_bf16 v[8:11], a[112:115], v[68:71], v[8:11]
    ds_read_b64_tr_b16 v[92:93], v109 offset:34816
    ds_read_b64_tr_b16 v[94:95], v109 offset:35328
    v_mfma_f32_16x16x32_bf16 v[12:15], a[116:119], v[68:71], v[12:15]
    s_waitcnt lgkmcnt(10)
    v_mfma_f32_16x16x32_bf16 v[16:19], a[112:115], v[72:75], v[16:19]
    ds_read_b64_tr_b16 v[64:65], v106 offset:40960
    ds_read_b64_tr_b16 v[66:67], v106 offset:41472
    v_mfma_f32_16x16x32_bf16 v[20:23], a[116:119], v[72:75], v[20:23]
    buffer_load_dwordx4 v101, s[32:35], s52 offen offset:1024 lds
    v_mfma_f32_16x16x32_bf16 v[24:27], a[112:115], v[76:79], v[24:27]
    ds_read_b64_tr_b16 v[68:69], v107 offset:40960
    ds_read_b64_tr_b16 v[70:71], v107 offset:41472
    v_mfma_f32_16x16x32_bf16 v[28:31], a[116:119], v[76:79], v[28:31]
    s_waitcnt lgkmcnt(9)
    v_mfma_f32_16x16x32_bf16 v[32:35], a[112:115], v[80:83], v[32:35]
    ds_read_b64_tr_b16 v[72:73], v108 offset:40960
    ds_read_b64_tr_b16 v[74:75], v108 offset:41472
    v_mfma_f32_16x16x32_bf16 v[36:39], a[116:119], v[80:83], v[36:39]
    buffer_load_dwordx4 v100, s[32:35], s52 offen offset:2048 lds
    v_mfma_f32_16x16x32_bf16 v[40:43], a[112:115], v[84:87], v[40:43]
    ds_read_b64_tr_b16 v[76:77], v109 offset:40960
    ds_read_b64_tr_b16 v[78:79], v109 offset:41472
    v_mfma_f32_16x16x32_bf16 v[44:47], a[116:119], v[84:87], v[44:47]
    s_waitcnt lgkmcnt(8)
    v_mfma_f32_16x16x32_bf16 v[48:51], a[112:115], v[88:91], v[48:51]
    ds_read_b64_tr_b16 v[80:81], v106 offset:43008
    ds_read_b64_tr_b16 v[82:83], v106 offset:43520
    v_mfma_f32_16x16x32_bf16 v[52:55], a[116:119], v[88:91], v[52:55]
    buffer_load_dwordx4 v101, s[32:35], s52 offen offset:3072 lds
    v_mfma_f32_16x16x32_bf16 v[56:59], a[112:115], v[92:95], v[56:59]
    ds_read_b64_tr_b16 v[84:85], v107 offset:43008
    ds_read_b64_tr_b16 v[86:87], v107 offset:43520
    v_mfma_f32_16x16x32_bf16 v[60:63], a[116:119], v[92:95], v[60:63]
    s_waitcnt lgkmcnt(8)
    v_mfma_f32_16x16x32_bf16 v[0:3], a[120:123], v[64:67], v[0:3]
    s_add_u32 m0, s29, 98304
    ds_read_b64_tr_b16 v[88:89], v108 offset:43008
    ds_read_b64_tr_b16 v[90:91], v108 offset:43520
    v_mfma_f32_16x16x32_bf16 v[4:7], a[124:127], v[64:67], v[4:7]
    buffer_load_dwordx4 v102, s[36:39], s53 offen offset:0 lds
    v_mfma_f32_16x16x32_bf16 v[8:11], a[120:123], v[68:71], v[8:11]
    ds_read_b64_tr_b16 v[92:93], v109 offset:43008
    ds_read_b64_tr_b16 v[94:95], v109 offset:43520
    v_mfma_f32_16x16x32_bf16 v[12:15], a[124:127], v[68:71], v[12:15]
    s_waitcnt vmcnt(13) lgkmcnt(8)
    s_barrier
    ds_read_b128 a[128:131], v114 offset:32768
    v_mfma_f32_16x16x32_bf16 v[16:19], a[120:123], v[72:75], v[16:19]
    s_add_u32 s31, s31, 1
    ds_read_b64_tr_b16 v[64:65], v106 offset:49152
    ds_read_b64_tr_b16 v[66:67], v106 offset:49664
    v_mfma_f32_16x16x32_bf16 v[20:23], a[124:127], v[72:75], v[20:23]
    buffer_load_dwordx4 v103, s[36:39], s53 offen offset:1024 lds
    v_mfma_f32_16x16x32_bf16 v[24:27], a[120:123], v[76:79], v[24:27]
    s_and_b32 s31, s31, 15
    ds_read_b64_tr_b16 v[68:69], v107 offset:49152
    ds_read_b64_tr_b16 v[70:71], v107 offset:49664
    v_mfma_f32_16x16x32_bf16 v[28:31], a[124:127], v[76:79], v[28:31]
    s_waitcnt lgkmcnt(9)
    ds_read_b128 a[132:135], v114 offset:34816
    v_mfma_f32_16x16x32_bf16 v[32:35], a[120:123], v[80:83], v[32:35]
    s_mul_i32 s52, s31, 393216
    ds_read_b64_tr_b16 v[72:73], v108 offset:49152
    ds_read_b64_tr_b16 v[74:75], v108 offset:49664
    v_mfma_f32_16x16x32_bf16 v[36:39], a[124:127], v[80:83], v[36:39]
    buffer_load_dwordx4 v104, s[36:39], s53 offen offset:2048 lds
    v_mfma_f32_16x16x32_bf16 v[40:43], a[120:123], v[84:87], v[40:43]
    ds_read_b64_tr_b16 v[76:77], v109 offset:49152
    ds_read_b64_tr_b16 v[78:79], v109 offset:49664
    v_mfma_f32_16x16x32_bf16 v[44:47], a[124:127], v[84:87], v[44:47]
    s_waitcnt lgkmcnt(10)
    ds_read_b128 a[136:139], v115 offset:32768
    v_mfma_f32_16x16x32_bf16 v[48:51], a[120:123], v[88:91], v[48:51]
    ds_read_b64_tr_b16 v[80:81], v106 offset:51200
    ds_read_b64_tr_b16 v[82:83], v106 offset:51712
    v_mfma_f32_16x16x32_bf16 v[52:55], a[124:127], v[88:91], v[52:55]
    buffer_load_dwordx4 v105, s[36:39], s53 offen offset:3072 lds
    v_mfma_f32_16x16x32_bf16 v[56:59], a[120:123], v[92:95], v[56:59]
    s_lshl_b32 s53, s31, 7
    ds_read_b64_tr_b16 v[84:85], v107 offset:51200
    ds_read_b64_tr_b16 v[86:87], v107 offset:51712
    v_mfma_f32_16x16x32_bf16 v[60:63], a[124:127], v[92:95], v[60:63]
    s_waitcnt lgkmcnt(9)
    ds_read_b128 a[140:143], v115 offset:34816
    v_mfma_f32_16x16x32_bf16 v[0:3], a[128:131], v[64:67], v[0:3]
    s_add_u32 m0, s29, 16384
    ds_read_b64_tr_b16 v[88:89], v108 offset:51200
    ds_read_b64_tr_b16 v[90:91], v108 offset:51712
    v_mfma_f32_16x16x32_bf16 v[4:7], a[132:135], v[64:67], v[4:7]
    buffer_load_dwordx4 v100, s[32:35], s52 offen offset:0 lds
    v_mfma_f32_16x16x32_bf16 v[8:11], a[128:131], v[68:71], v[8:11]
    ds_read_b64_tr_b16 v[92:93], v109 offset:51200
    ds_read_b64_tr_b16 v[94:95], v109 offset:51712
    v_mfma_f32_16x16x32_bf16 v[12:15], a[132:135], v[68:71], v[12:15]
    s_waitcnt lgkmcnt(10)
    v_mfma_f32_16x16x32_bf16 v[16:19], a[128:131], v[72:75], v[16:19]
    ds_read_b64_tr_b16 v[64:65], v106 offset:57344
    ds_read_b64_tr_b16 v[66:67], v106 offset:57856
    v_mfma_f32_16x16x32_bf16 v[20:23], a[132:135], v[72:75], v[20:23]
    buffer_load_dwordx4 v101, s[32:35], s52 offen offset:1024 lds
    v_mfma_f32_16x16x32_bf16 v[24:27], a[128:131], v[76:79], v[24:27]
    ds_read_b64_tr_b16 v[68:69], v107 offset:57344
    ds_read_b64_tr_b16 v[70:71], v107 offset:57856
    v_mfma_f32_16x16x32_bf16 v[28:31], a[132:135], v[76:79], v[28:31]
    s_waitcnt lgkmcnt(9)
    v_mfma_f32_16x16x32_bf16 v[32:35], a[128:131], v[80:83], v[32:35]
    ds_read_b64_tr_b16 v[72:73], v108 offset:57344
    ds_read_b64_tr_b16 v[74:75], v108 offset:57856
    v_mfma_f32_16x16x32_bf16 v[36:39], a[132:135], v[80:83], v[36:39]
    buffer_load_dwordx4 v100, s[32:35], s52 offen offset:2048 lds
    v_mfma_f32_16x16x32_bf16 v[40:43], a[128:131], v[84:87], v[40:43]
    ds_read_b64_tr_b16 v[76:77], v109 offset:57344
    ds_read_b64_tr_b16 v[78:79], v109 offset:57856
    v_mfma_f32_16x16x32_bf16 v[44:47], a[132:135], v[84:87], v[44:47]
    s_waitcnt lgkmcnt(8)
    v_mfma_f32_16x16x32_bf16 v[48:51], a[128:131], v[88:91], v[48:51]
    ds_read_b64_tr_b16 v[80:81], v106 offset:59392
    ds_read_b64_tr_b16 v[82:83], v106 offset:59904
    v_mfma_f32_16x16x32_bf16 v[52:55], a[132:135], v[88:91], v[52:55]
    buffer_load_dwordx4 v101, s[32:35], s52 offen offset:3072 lds
    v_mfma_f32_16x16x32_bf16 v[56:59], a[128:131], v[92:95], v[56:59]
    ds_read_b64_tr_b16 v[84:85], v107 offset:59392
    ds_read_b64_tr_b16 v[86:87], v107 offset:59904
    v_mfma_f32_16x16x32_bf16 v[60:63], a[132:135], v[92:95], v[60:63]
    s_waitcnt lgkmcnt(8)
    v_mfma_f32_16x16x32_bf16 v[0:3], a[136:139], v[64:67], v[0:3]
    s_add_u32 m0, s29, 114688
    ds_read_b64_tr_b16 v[88:89], v108 offset:59392
    ds_read_b64_tr_b16 v[90:91], v108 offset:59904
    v_mfma_f32_16x16x32_bf16 v[4:7], a[140:143], v[64:67], v[4:7]
    buffer_load_dwordx4 v102, s[36:39], s53 offen offset:0 lds
    v_mfma_f32_16x16x32_bf16 v[8:11], a[136:139], v[68:71], v[8:11]
    ds_read_b64_tr_b16 v[92:93], v109 offset:59392
    ds_read_b64_tr_b16 v[94:95], v109 offset:59904
    v_mfma_f32_16x16x32_bf16 v[12:15], a[140:143], v[68:71], v[12:15]
    s_waitcnt vmcnt(13) lgkmcnt(8)
    s_barrier
    ds_read_b128 a[144:147], v114 offset:0
    v_mfma_f32_16x16x32_bf16 v[16:19], a[136:139], v[72:75], v[16:19]
    s_add_u32 s31, s31, 1
    ds_read_b64_tr_b16 v[64:65], v110 offset:0
    ds_read_b64_tr_b16 v[66:67], v110 offset:512
    v_mfma_f32_16x16x32_bf16 v[20:23], a[140:143], v[72:75], v[20:23]
    buffer_load_dwordx4 v103, s[36:39], s53 offen offset:1024 lds
    v_mfma_f32_16x16x32_bf16 v[24:27], a[136:139], v[76:79], v[24:27]
    s_and_b32 s31, s31, 15
    ds_read_b64_tr_b16 v[68:69], v111 offset:0
    ds_read_b64_tr_b16 v[70:71], v111 offset:512
    v_mfma_f32_16x16x32_bf16 v[28:31], a[140:143], v[76:79], v[28:31]
    s_waitcnt lgkmcnt(9)
    ds_read_b128 a[148:151], v114 offset:2048
    v_mfma_f32_16x16x32_bf16 v[32:35], a[136:139], v[80:83], v[32:35]
    s_mul_i32 s52, s31, 393216
    ds_read_b64_tr_b16 v[72:73], v112 offset:0
    ds_read_b64_tr_b16 v[74:75], v112 offset:512
    v_mfma_f32_16x16x32_bf16 v[36:39], a[140:143], v[80:83], v[36:39]
    buffer_load_dwordx4 v104, s[36:39], s53 offen offset:2048 lds
    v_mfma_f32_16x16x32_bf16 v[40:43], a[136:139], v[84:87], v[40:43]
    ds_read_b64_tr_b16 v[76:77], v113 offset:0
    ds_read_b64_tr_b16 v[78:79], v113 offset:512
    v_mfma_f32_16x16x32_bf16 v[44:47], a[140:143], v[84:87], v[44:47]
    s_waitcnt lgkmcnt(10)
    ds_read_b128 a[152:155], v115 offset:0
    v_mfma_f32_16x16x32_bf16 v[48:51], a[136:139], v[88:91], v[48:51]
    ds_read_b64_tr_b16 v[80:81], v110 offset:2048
    ds_read_b64_tr_b16 v[82:83], v110 offset:2560
    v_mfma_f32_16x16x32_bf16 v[52:55], a[140:143], v[88:91], v[52:55]
    buffer_load_dwordx4 v105, s[36:39], s53 offen offset:3072 lds
    v_mfma_f32_16x16x32_bf16 v[56:59], a[136:139], v[92:95], v[56:59]
    s_lshl_b32 s53, s31, 7
    ds_read_b64_tr_b16 v[84:85], v111 offset:2048
    ds_read_b64_tr_b16 v[86:87], v111 offset:2560
    v_mfma_f32_16x16x32_bf16 v[60:63], a[140:143], v[92:95], v[60:63]
    s_waitcnt lgkmcnt(9)
    ds_read_b128 a[156:159], v115 offset:2048
    v_mfma_f32_16x16x32_bf16 v[0:3], a[144:147], v[64:67], v[0:3]
    s_add_u32 m0, s29, 32768
    ds_read_b64_tr_b16 v[88:89], v112 offset:2048
    ds_read_b64_tr_b16 v[90:91], v112 offset:2560
    v_mfma_f32_16x16x32_bf16 v[4:7], a[148:151], v[64:67], v[4:7]
    buffer_load_dwordx4 v100, s[32:35], s52 offen offset:0 lds
    v_mfma_f32_16x16x32_bf16 v[8:11], a[144:147], v[68:71], v[8:11]
    ds_read_b64_tr_b16 v[92:93], v113 offset:2048
    ds_read_b64_tr_b16 v[94:95], v113 offset:2560
    v_mfma_f32_16x16x32_bf16 v[12:15], a[148:151], v[68:71], v[12:15]
    s_waitcnt lgkmcnt(10)
    v_mfma_f32_16x16x32_bf16 v[16:19], a[144:147], v[72:75], v[16:19]
    ds_read_b64_tr_b16 v[64:65], v110 offset:8192
    ds_read_b64_tr_b16 v[66:67], v110 offset:8704
    v_mfma_f32_16x16x32_bf16 v[20:23], a[148:151], v[72:75], v[20:23]
    buffer_load_dwordx4 v101, s[32:35], s52 offen offset:1024 lds
    v_mfma_f32_16x16x32_bf16 v[24:27], a[144:147], v[76:79], v[24:27]
    ds_read_b64_tr_b16 v[68:69], v111 offset:8192
    ds_read_b64_tr_b16 v[70:71], v111 offset:8704
    v_mfma_f32_16x16x32_bf16 v[28:31], a[148:151], v[76:79], v[28:31]
    s_waitcnt lgkmcnt(9)
    v_mfma_f32_16x16x32_bf16 v[32:35], a[144:147], v[80:83], v[32:35]
    ds_read_b64_tr_b16 v[72:73], v112 offset:8192
    ds_read_b64_tr_b16 v[74:75], v112 offset:8704
    v_mfma_f32_16x16x32_bf16 v[36:39], a[148:151], v[80:83], v[36:39]
    buffer_load_dwordx4 v100, s[32:35], s52 offen offset:2048 lds
    v_mfma_f32_16x16x32_bf16 v[40:43], a[144:147], v[84:87], v[40:43]
    ds_read_b64_tr_b16 v[76:77], v113 offset:8192
    ds_read_b64_tr_b16 v[78:79], v113 offset:8704
    v_mfma_f32_16x16x32_bf16 v[44:47], a[148:151], v[84:87], v[44:47]
    s_waitcnt lgkmcnt(8)
    v_mfma_f32_16x16x32_bf16 v[48:51], a[144:147], v[88:91], v[48:51]
    ds_read_b64_tr_b16 v[80:81], v110 offset:10240
    ds_read_b64_tr_b16 v[82:83], v110 offset:10752
    v_mfma_f32_16x16x32_bf16 v[52:55], a[148:151], v[88:91], v[52:55]
    buffer_load_dwordx4 v101, s[32:35], s52 offen offset:3072 lds
    v_mfma_f32_16x16x32_bf16 v[56:59], a[144:147], v[92:95], v[56:59]
    ds_read_b64_tr_b16 v[84:85], v111 offset:10240
    ds_read_b64_tr_b16 v[86:87], v111 offset:10752
    v_mfma_f32_16x16x32_bf16 v[60:63], a[148:151], v[92:95], v[60:63]
    s_waitcnt lgkmcnt(8)
    v_mfma_f32_16x16x32_bf16 v[0:3], a[152:155], v[64:67], v[0:3]
    s_add_u32 m0, s29, 81920
    ds_read_b64_tr_b16 v[88:89], v112 offset:10240
    ds_read_b64_tr_b16 v[90:91], v112 offset:10752
    v_mfma_f32_16x16x32_bf16 v[4:7], a[156:159], v[64:67], v[4:7]
    buffer_load_dwordx4 v102, s[36:39], s53 offen offset:0 lds
    v_mfma_f32_16x16x32_bf16 v[8:11], a[152:155], v[68:71], v[8:11]
    ds_read_b64_tr_b16 v[92:93], v113 offset:10240
    ds_read_b64_tr_b16 v[94:95], v113 offset:10752
    v_mfma_f32_16x16x32_bf16 v[12:15], a[156:159], v[68:71], v[12:15]
    s_waitcnt vmcnt(13) lgkmcnt(8)
    s_barrier
    ds_read_b128 a[160:163], v114 offset:16384
    v_mfma_f32_16x16x32_bf16 v[16:19], a[152:155], v[72:75], v[16:19]
    s_add_u32 s31, s31, 1
    ds_read_b64_tr_b16 v[64:65], v106 offset:0
    ds_read_b64_tr_b16 v[66:67], v106 offset:512
    v_mfma_f32_16x16x32_bf16 v[20:23], a[156:159], v[72:75], v[20:23]
    buffer_load_dwordx4 v103, s[36:39], s53 offen offset:1024 lds
    v_mfma_f32_16x16x32_bf16 v[24:27], a[152:155], v[76:79], v[24:27]
    s_and_b32 s31, s31, 15
    ds_read_b64_tr_b16 v[68:69], v107 offset:0
    ds_read_b64_tr_b16 v[70:71], v107 offset:512
    v_mfma_f32_16x16x32_bf16 v[28:31], a[156:159], v[76:79], v[28:31]
    s_waitcnt lgkmcnt(9)
    ds_read_b128 a[164:167], v114 offset:18432
    v_mfma_f32_16x16x32_bf16 v[32:35], a[152:155], v[80:83], v[32:35]
    s_mul_i32 s52, s31, 393216
    ds_read_b64_tr_b16 v[72:73], v108 offset:0
    ds_read_b64_tr_b16 v[74:75], v108 offset:512
    v_mfma_f32_16x16x32_bf16 v[36:39], a[156:159], v[80:83], v[36:39]
    buffer_load_dwordx4 v104, s[36:39], s53 offen offset:2048 lds
    v_mfma_f32_16x16x32_bf16 v[40:43], a[152:155], v[84:87], v[40:43]
    ds_read_b64_tr_b16 v[76:77], v109 offset:0
    ds_read_b64_tr_b16 v[78:79], v109 offset:512
    v_mfma_f32_16x16x32_bf16 v[44:47], a[156:159], v[84:87], v[44:47]
    s_waitcnt lgkmcnt(10)
    ds_read_b128 a[168:171], v115 offset:16384
    v_mfma_f32_16x16x32_bf16 v[48:51], a[152:155], v[88:91], v[48:51]
    ds_read_b64_tr_b16 v[80:81], v106 offset:2048
    ds_read_b64_tr_b16 v[82:83], v106 offset:2560
    v_mfma_f32_16x16x32_bf16 v[52:55], a[156:159], v[88:91], v[52:55]
    buffer_load_dwordx4 v105, s[36:39], s53 offen offset:3072 lds
    v_mfma_f32_16x16x32_bf16 v[56:59], a[152:155], v[92:95], v[56:59]
    s_lshl_b32 s53, s31, 7
    ds_read_b64_tr_b16 v[84:85], v107 offset:2048
    ds_read_b64_tr_b16 v[86:87], v107 offset:2560
    v_mfma_f32_16x16x32_bf16 v[60:63], a[156:159], v[92:95], v[60:63]
    s_waitcnt lgkmcnt(9)
    ds_read_b128 a[172:175], v115 offset:18432
    v_mfma_f32_16x16x32_bf16 v[0:3], a[160:163], v[64:67], v[0:3]
    s_add_u32 m0, s29, 49152
    ds_read_b64_tr_b16 v[88:89], v108 offset:2048
    ds_read_b64_tr_b16 v[90:91], v108 offset:2560
    v_mfma_f32_16x16x32_bf16 v[4:7], a[164:167], v[64:67], v[4:7]
    buffer_load_dwordx4 v100, s[32:35], s52 offen offset:0 lds
    v_mfma_f32_16x16x32_bf16 v[8:11], a[160:163], v[68:71], v[8:11]
    ds_read_b64_tr_b16 v[92:93], v109 offset:2048
    ds_read_b64_tr_b16 v[94:95], v109 offset:2560
    v_mfma_f32_16x16x32_bf16 v[12:15], a[164:167], v[68:71], v[12:15]
    s_waitcnt lgkmcnt(10)
    buffer_load_dword v251, v118, s[56:59], 0 offen sc1
    v_mfma_f32_16x16x32_bf16 v[16:19], a[160:163], v[72:75], v[16:19]
Lpad_2:
    s_cbranch_execz Lpad_6
    ds_read_b64_tr_b16 v[64:65], v106 offset:8192
    ds_read_b64_tr_b16 v[66:67], v106 offset:8704
    v_mfma_f32_16x16x32_bf16 v[20:23], a[164:167], v[72:75], v[20:23]
    buffer_load_dwordx4 v101, s[32:35], s52 offen offset:1024 lds
    v_mfma_f32_16x16x32_bf16 v[24:27], a[160:163], v[76:79], v[24:27]
    ds_read_b64_tr_b16 v[68:69], v107 offset:8192
    ds_read_b64_tr_b16 v[70:71], v107 offset:8704
    v_mfma_f32_16x16x32_bf16 v[28:31], a[164:167], v[76:79], v[28:31]
    s_waitcnt lgkmcnt(9)
    v_mfma_f32_16x16x32_bf16 v[32:35], a[160:163], v[80:83], v[32:35]
    ds_read_b64_tr_b16 v[72:73], v108 offset:8192
    ds_read_b64_tr_b16 v[74:75], v108 offset:8704
    v_mfma_f32_16x16x32_bf16 v[36:39], a[164:167], v[80:83], v[36:39]
    buffer_load_dwordx4 v100, s[32:35], s52 offen offset:2048 lds
    v_mfma_f32_16x16x32_bf16 v[40:43], a[160:163], v[84:87], v[40:43]
    ds_read_b64_tr_b16 v[76:77], v109 offset:8192
    ds_read_b64_tr_b16 v[78:79], v109 offset:8704
    v_mfma_f32_16x16x32_bf16 v[44:47], a[164:167], v[84:87], v[44:47]
    s_waitcnt lgkmcnt(8)
    v_mfma_f32_16x16x32_bf16 v[48:51], a[160:163], v[88:91], v[48:51]
    ds_read_b64_tr_b16 v[80:81], v106 offset:10240
    ds_read_b64_tr_b16 v[82:83], v106 offset:10752
    v_mfma_f32_16x16x32_bf16 v[52:55], a[164:167], v[88:91], v[52:55]
    buffer_load_dwordx4 v101, s[32:35], s52 offen offset:3072 lds
    v_mfma_f32_16x16x32_bf16 v[56:59], a[160:163], v[92:95], v[56:59]
    ds_read_b64_tr_b16 v[84:85], v107 offset:10240
    ds_read_b64_tr_b16 v[86:87], v107 offset:10752
    v_mfma_f32_16x16x32_bf16 v[60:63], a[164:167], v[92:95], v[60:63]
    s_waitcnt lgkmcnt(8)
    v_mfma_f32_16x16x32_bf16 v[0:3], a[168:171], v[64:67], v[0:3]
    s_add_u32 m0, s29, 98304
    ds_read_b64_tr_b16 v[88:89], v108 offset:10240
    ds_read_b64_tr_b16 v[90:91], v108 offset:10752
    v_mfma_f32_16x16x32_bf16 v[4:7], a[172:175], v[64:67], v[4:7]
    buffer_load_dwordx4 v102, s[36:39], s53 offen offset:0 lds
    v_mfma_f32_16x16x32_bf16 v[8:11], a[168:171], v[68:71], v[8:11]
    ds_read_b64_tr_b16 v[92:93], v109 offset:10240
    ds_read_b64_tr_b16 v[94:95], v109 offset:10752
    v_mfma_f32_16x16x32_bf16 v[12:15], a[172:175], v[68:71], v[12:15]
    s_waitcnt vmcnt(14) lgkmcnt(8)
    s_barrier
    ds_read_b128 a[176:179], v114 offset:32768
    v_mfma_f32_16x16x32_bf16 v[16:19], a[168:171], v[72:75], v[16:19]
    s_add_u32 s31, s31, 1
    ds_read_b64_tr_b16 v[64:65], v106 offset:16384
    ds_read_b64_tr_b16 v[66:67], v106 offset:16896
    v_mfma_f32_16x16x32_bf16 v[20:23], a[172:175], v[72:75], v[20:23]
    buffer_load_dwordx4 v103, s[36:39], s53 offen offset:1024 lds
    v_mfma_f32_16x16x32_bf16 v[24:27], a[168:171], v[76:79], v[24:27]
    s_and_b32 s31, s31, 15
    ds_read_b64_tr_b16 v[68:69], v107 offset:16384
    ds_read_b64_tr_b16 v[70:71], v107 offset:16896
    v_mfma_f32_16x16x32_bf16 v[28:31], a[172:175], v[76:79], v[28:31]
    s_waitcnt lgkmcnt(9)
    ds_read_b128 a[180:183], v114 offset:34816
    v_mfma_f32_16x16x32_bf16 v[32:35], a[168:171], v[80:83], v[32:35]
    s_mul_i32 s52, s31, 393216
    ds_read_b64_tr_b16 v[72:73], v108 offset:16384
    ds_read_b64_tr_b16 v[74:75], v108 offset:16896
    v_mfma_f32_16x16x32_bf16 v[36:39], a[172:175], v[80:83], v[36:39]
    buffer_load_dwordx4 v104, s[36:39], s53 offen offset:2048 lds
    v_mfma_f32_16x16x32_bf16 v[40:43], a[168:171], v[84:87], v[40:43]
    ds_read_b64_tr_b16 v[76:77], v109 offset:16384
    ds_read_b64_tr_b16 v[78:79], v109 offset:16896
    v_mfma_f32_16x16x32_bf16 v[44:47], a[172:175], v[84:87], v[44:47]
    s_waitcnt lgkmcnt(10)
    ds_read_b128 a[184:187], v115 offset:32768
    v_mfma_f32_16x16x32_bf16 v[48:51], a[168:171], v[88:91], v[48:51]
    ds_read_b64_tr_b16 v[80:81], v106 offset:18432
    ds_read_b64_tr_b16 v[82:83], v106 offset:18944
    v_mfma_f32_16x16x32_bf16 v[52:55], a[172:175], v[88:91], v[52:55]
    buffer_load_dwordx4 v105, s[36:39], s53 offen offset:3072 lds
    v_mfma_f32_16x16x32_bf16 v[56:59], a[168:171], v[92:95], v[56:59]
    s_lshl_b32 s53, s31, 7
    ds_read_b64_tr_b16 v[84:85], v107 offset:18432
    ds_read_b64_tr_b16 v[86:87], v107 offset:18944
    v_mfma_f32_16x16x32_bf16 v[60:63], a[172:175], v[92:95], v[60:63]
    s_waitcnt lgkmcnt(9)
    ds_read_b128 a[188:191], v115 offset:34816
    v_mfma_f32_16x16x32_bf16 v[0:3], a[176:179], v[64:67], v[0:3]
    s_add_u32 m0, s29, 65536
    ds_read_b64_tr_b16 v[88:89], v108 offset:18432
    ds_read_b64_tr_b16 v[90:91], v108 offset:18944
    v_mfma_f32_16x16x32_bf16 v[4:7], a[180:183], v[64:67], v[4:7]
    buffer_load_dwordx4 v100, s[32:35], s52 offen offset:0 lds
    v_mfma_f32_16x16x32_bf16 v[8:11], a[176:179], v[68:71], v[8:11]
    ds_read_b64_tr_b16 v[92:93], v109 offset:18432
    ds_read_b64_tr_b16 v[94:95], v109 offset:18944
    v_mfma_f32_16x16x32_bf16 v[12:15], a[180:183], v[68:71], v[12:15]
    s_waitcnt lgkmcnt(10)
    v_mfma_f32_16x16x32_bf16 v[16:19], a[176:179], v[72:75], v[16:19]
    ds_read_b64_tr_b16 v[64:65], v106 offset:24576
    ds_read_b64_tr_b16 v[66:67], v106 offset:25088
    v_mfma_f32_16x16x32_bf16 v[20:23], a[180:183], v[72:75], v[20:23]
    buffer_load_dwordx4 v101, s[32:35], s52 offen offset:1024 lds
    v_mfma_f32_16x16x32_bf16 v[24:27], a[176:179], v[76:79], v[24:27]
    ds_read_b64_tr_b16 v[68:69], v107 offset:24576
    ds_read_b64_tr_b16 v[70:71], v107 offset:25088
    v_mfma_f32_16x16x32_bf16 v[28:31], a[180:183], v[76:79], v[28:31]
    s_waitcnt lgkmcnt(9)
    v_mfma_f32_16x16x32_bf16 v[32:35], a[176:179], v[80:83], v[32:35]
    ds_read_b64_tr_b16 v[72:73], v108 offset:24576
    ds_read_b64_tr_b16 v[74:75], v108 offset:25088
    v_mfma_f32_16x16x32_bf16 v[36:39], a[180:183], v[80:83], v[36:39]
    buffer_load_dwordx4 v100, s[32:35], s52 offen offset:2048 lds
    v_mfma_f32_16x16x32_bf16 v[40:43], a[176:179], v[84:87], v[40:43]
    ds_read_b64_tr_b16 v[76:77], v109 offset:24576
    ds_read_b64_tr_b16 v[78:79], v109 offset:25088
    v_mfma_f32_16x16x32_bf16 v[44:47], a[180:183], v[84:87], v[44:47]
    s_waitcnt lgkmcnt(8)
    v_mfma_f32_16x16x32_bf16 v[48:51], a[176:179], v[88:91], v[48:51]
    ds_read_b64_tr_b16 v[80:81], v106 offset:26624
    ds_read_b64_tr_b16 v[82:83], v106 offset:27136
    v_mfma_f32_16x16x32_bf16 v[52:55], a[180:183], v[88:91], v[52:55]
    buffer_load_dwordx4 v101, s[32:35], s52 offen offset:3072 lds
    v_mfma_f32_16x16x32_bf16 v[56:59], a[176:179], v[92:95], v[56:59]
    ds_read_b64_tr_b16 v[84:85], v107 offset:26624
    ds_read_b64_tr_b16 v[86:87], v107 offset:27136
    v_mfma_f32_16x16x32_bf16 v[60:63], a[180:183], v[92:95], v[60:63]
    s_waitcnt lgkmcnt(8)
    v_mfma_f32_16x16x32_bf16 v[0:3], a[184:187], v[64:67], v[0:3]
    s_add_u32 m0, s29, 114688
    ds_read_b64_tr_b16 v[88:89], v108 offset:26624
    ds_read_b64_tr_b16 v[90:91], v108 offset:27136
    v_mfma_f32_16x16x32_bf16 v[4:7], a[188:191], v[64:67], v[4:7]
    buffer_load_dwordx4 v102, s[36:39], s53 offen offset:0 lds
    v_mfma_f32_16x16x32_bf16 v[8:11], a[184:187], v[68:71], v[8:11]
    ds_read_b64_tr_b16 v[92:93], v109 offset:26624
    ds_read_b64_tr_b16 v[94:95], v109 offset:27136
    v_mfma_f32_16x16x32_bf16 v[12:15], a[188:191], v[68:71], v[12:15]
    s_waitcnt vmcnt(14) lgkmcnt(8)
    s_barrier
    ds_read_b128 a[192:195], v114 offset:0
    v_mfma_f32_16x16x32_bf16 v[16:19], a[184:187], v[72:75], v[16:19]
    s_add_u32 s31, s31, 1
    ds_read_b64_tr_b16 v[64:65], v106 offset:32768
    ds_read_b64_tr_b16 v[66:67], v106 offset:33280
    v_mfma_f32_16x16x32_bf16 v[20:23], a[188:191], v[72:75], v[20:23]
    buffer_load_dwordx4 v103, s[36:39], s53 offen offset:1024 lds
    v_mfma_f32_16x16x32_bf16 v[24:27], a[184:187], v[76:79], v[24:27]
    s_and_b32 s31, s31, 15
    ds_read_b64_tr_b16 v[68:69], v107 offset:32768
    ds_read_b64_tr_b16 v[70:71], v107 offset:33280
    v_mfma_f32_16x16x32_bf16 v[28:31], a[188:191], v[76:79], v[28:31]
    s_waitcnt lgkmcnt(9)
    ds_read_b128 a[196:199], v114 offset:2048
    v_mfma_f32_16x16x32_bf16 v[32:35], a[184:187], v[80:83], v[32:35]
    s_mul_i32 s52, s31, 393216
    ds_read_b64_tr_b16 v[72:73], v108 offset:32768
    ds_read_b64_tr_b16 v[74:75], v108 offset:33280
    v_mfma_f32_16x16x32_bf16 v[36:39], a[188:191], v[80:83], v[36:39]
    buffer_load_dwordx4 v104, s[36:39], s53 offen offset:2048 lds
    v_mfma_f32_16x16x32_bf16 v[40:43], a[184:187], v[84:87], v[40:43]
    ds_read_b64_tr_b16 v[76:77], v109 offset:32768
    ds_read_b64_tr_b16 v[78:79], v109 offset:33280
    v_mfma_f32_16x16x32_bf16 v[44:47], a[188:191], v[84:87], v[44:47]
    s_waitcnt lgkmcnt(10)
    ds_read_b128 a[200:203], v115 offset:0
    v_mfma_f32_16x16x32_bf16 v[48:51], a[184:187], v[88:91], v[48:51]
    ds_read_b64_tr_b16 v[80:81], v106 offset:34816
    ds_read_b64_tr_b16 v[82:83], v106 offset:35328
    v_mfma_f32_16x16x32_bf16 v[52:55], a[188:191], v[88:91], v[52:55]
    buffer_load_dwordx4 v105, s[36:39], s53 offen offset:3072 lds
    v_mfma_f32_16x16x32_bf16 v[56:59], a[184:187], v[92:95], v[56:59]
    s_lshl_b32 s53, s31, 7
    ds_read_b64_tr_b16 v[84:85], v107 offset:34816
    ds_read_b64_tr_b16 v[86:87], v107 offset:35328
    v_mfma_f32_16x16x32_bf16 v[60:63], a[188:191], v[92:95], v[60:63]
    s_waitcnt lgkmcnt(9)
    ds_read_b128 a[204:207], v115 offset:2048
    v_mfma_f32_16x16x32_bf16 v[0:3], a[192:195], v[64:67], v[0:3]
    s_add_u32 m0, s29, 0
    ds_read_b64_tr_b16 v[88:89], v108 offset:34816
    ds_read_b64_tr_b16 v[90:91], v108 offset:35328
    v_mfma_f32_16x16x32_bf16 v[4:7], a[196:199], v[64:67], v[4:7]
    buffer_load_dwordx4 v100, s[32:35], s52 offen offset:0 lds
    v_mfma_f32_16x16x32_bf16 v[8:11], a[192:195], v[68:71], v[8:11]
    ds_read_b64_tr_b16 v[92:93], v109 offset:34816
    ds_read_b64_tr_b16 v[94:95], v109 offset:35328
    v_mfma_f32_16x16x32_bf16 v[12:15], a[196:199], v[68:71], v[12:15]
    s_waitcnt lgkmcnt(10)
    v_mfma_f32_16x16x32_bf16 v[16:19], a[192:195], v[72:75], v[16:19]
    ds_read_b64_tr_b16 v[64:65], v106 offset:40960
    ds_read_b64_tr_b16 v[66:67], v106 offset:41472
    v_mfma_f32_16x16x32_bf16 v[20:23], a[196:199], v[72:75], v[20:23]
    buffer_load_dwordx4 v101, s[32:35], s52 offen offset:1024 lds
    v_mfma_f32_16x16x32_bf16 v[24:27], a[192:195], v[76:79], v[24:27]
    ds_read_b64_tr_b16 v[68:69], v107 offset:40960
    ds_read_b64_tr_b16 v[70:71], v107 offset:41472
    v_mfma_f32_16x16x32_bf16 v[28:31], a[196:199], v[76:79], v[28:31]
    s_waitcnt lgkmcnt(9)
    v_mfma_f32_16x16x32_bf16 v[32:35], a[192:195], v[80:83], v[32:35]
    ds_read_b64_tr_b16 v[72:73], v108 offset:40960
    ds_read_b64_tr_b16 v[74:75], v108 offset:41472
    v_mfma_f32_16x16x32_bf16 v[36:39], a[196:199], v[80:83], v[36:39]
    buffer_load_dwordx4 v100, s[32:35], s52 offen offset:2048 lds
    v_mfma_f32_16x16x32_bf16 v[40:43], a[192:195], v[84:87], v[40:43]
    ds_read_b64_tr_b16 v[76:77], v109 offset:40960
    ds_read_b64_tr_b16 v[78:79], v109 offset:41472
    v_mfma_f32_16x16x32_bf16 v[44:47], a[196:199], v[84:87], v[44:47]
    s_waitcnt lgkmcnt(8)
    v_mfma_f32_16x16x32_bf16 v[48:51], a[192:195], v[88:91], v[48:51]
    ds_read_b64_tr_b16 v[80:81], v106 offset:43008
    ds_read_b64_tr_b16 v[82:83], v106 offset:43520
    v_mfma_f32_16x16x32_bf16 v[52:55], a[196:199], v[88:91], v[52:55]
    buffer_load_dwordx4 v101, s[32:35], s52 offen offset:3072 lds
    v_mfma_f32_16x16x32_bf16 v[56:59], a[192:195], v[92:95], v[56:59]
    ds_read_b64_tr_b16 v[84:85], v107 offset:43008
    ds_read_b64_tr_b16 v[86:87], v107 offset:43520
    v_mfma_f32_16x16x32_bf16 v[60:63], a[196:199], v[92:95], v[60:63]
    s_waitcnt lgkmcnt(8)
    v_mfma_f32_16x16x32_bf16 v[0:3], a[200:203], v[64:67], v[0:3]
    s_add_u32 m0, s29, 81920
    ds_read_b64_tr_b16 v[88:89], v108 offset:43008
    ds_read_b64_tr_b16 v[90:91], v108 offset:43520
    v_mfma_f32_16x16x32_bf16 v[4:7], a[204:207], v[64:67], v[4:7]
    buffer_load_dwordx4 v102, s[36:39], s53 offen offset:0 lds
    v_mfma_f32_16x16x32_bf16 v[8:11], a[200:203], v[68:71], v[8:11]
    ds_read_b64_tr_b16 v[92:93], v109 offset:43008
    ds_read_b64_tr_b16 v[94:95], v109 offset:43520
    v_mfma_f32_16x16x32_bf16 v[12:15], a[204:207], v[68:71], v[12:15]
    s_waitcnt vmcnt(13) lgkmcnt(8)
    s_barrier
    v_cmp_gt_u32 vcc, 0x80, v251
    s_mov_b32 s27, 0x80000
    s_and_b64 vcc, vcc, -1
    s_cbranch_scc0 Lok_4
Lspin_5:
    buffer_load_dword v251, v118, s[56:59], 0 offen sc1
    s_waitcnt vmcnt(0)
    v_cmp_gt_u32 vcc, 0x80, v251
    s_sub_u32 s27, s27, 1
    s_cbranch_scc1 Lok_4
    s_and_b64 vcc, vcc, -1
    s_cbranch_scc1 Lspin_5
Lok_4:
    ds_read_b128 a[208:211], v114 offset:16384
    v_mfma_f32_16x16x32_bf16 v[16:19], a[200:203], v[72:75], v[16:19]
    ds_read_b64_tr_b16 v[64:65], v106 offset:49152
    ds_read_b64_tr_b16 v[66:67], v106 offset:49664
    v_mfma_f32_16x16x32_bf16 v[20:23], a[204:207], v[72:75], v[20:23]
    buffer_load_dwordx4 v103, s[36:39], s53 offen offset:1024 lds
    v_mfma_f32_16x16x32_bf16 v[24:27], a[200:203], v[76:79], v[24:27]
    ds_read_b64_tr_b16 v[68:69], v107 offset:49152
    ds_read_b64_tr_b16 v[70:71], v107 offset:49664
    v_mfma_f32_16x16x32_bf16 v[28:31], a[204:207], v[76:79], v[28:31]
    s_waitcnt lgkmcnt(9)
    ds_read_b128 a[212:215], v114 offset:18432
    v_mfma_f32_16x16x32_bf16 v[32:35], a[200:203], v[80:83], v[32:35]
    ds_read_b64_tr_b16 v[72:73], v108 offset:49152
    ds_read_b64_tr_b16 v[74:75], v108 offset:49664
    v_mfma_f32_16x16x32_bf16 v[36:39], a[204:207], v[80:83], v[36:39]
    buffer_load_dwordx4 v104, s[36:39], s53 offen offset:2048 lds
    v_mfma_f32_16x16x32_bf16 v[40:43], a[200:203], v[84:87], v[40:43]
    ds_read_b64_tr_b16 v[76:77], v109 offset:49152
    ds_read_b64_tr_b16 v[78:79], v109 offset:49664
    v_mfma_f32_16x16x32_bf16 v[44:47], a[204:207], v[84:87], v[44:47]
    s_waitcnt lgkmcnt(10)
    ds_read_b128 a[216:219], v115 offset:16384
    v_mfma_f32_16x16x32_bf16 v[48:51], a[200:203], v[88:91], v[48:51]
    ds_read_b64_tr_b16 v[80:81], v106 offset:51200
    ds_read_b64_tr_b16 v[82:83], v106 offset:51712
    v_mfma_f32_16x16x32_bf16 v[52:55], a[204:207], v[88:91], v[52:55]
    buffer_load_dwordx4 v105, s[36:39], s53 offen offset:3072 lds
    v_mfma_f32_16x16x32_bf16 v[56:59], a[200:203], v[92:95], v[56:59]
    ds_read_b64_tr_b16 v[84:85], v107 offset:51200
    ds_read_b64_tr_b16 v[86:87], v107 offset:51712
    v_mfma_f32_16x16x32_bf16 v[60:63], a[204:207], v[92:95], v[60:63]
    s_waitcnt lgkmcnt(9)
    ds_read_b128 a[220:223], v115 offset:18432
    v_mfma_f32_16x16x32_bf16 v[0:3], a[208:211], v[64:67], v[0:3]
    ds_read_b64_tr_b16 v[88:89], v108 offset:51200
    ds_read_b64_tr_b16 v[90:91], v108 offset:51712
    v_mfma_f32_16x16x32_bf16 v[4:7], a[212:215], v[64:67], v[4:7]
    buffer_load_dwordx4 v[192:195], v249, s[44:47], s95 offen offset:0 sc1
    v_mfma_f32_16x16x32_bf16 v[8:11], a[208:211], v[68:71], v[8:11]
    ds_read_b64_tr_b16 v[92:93], v109 offset:51200
    ds_read_b64_tr_b16 v[94:95], v109 offset:51712
    v_mfma_f32_16x16x32_bf16 v[12:15], a[212:215], v[68:71], v[12:15]
    s_waitcnt lgkmcnt(10)
    v_mfma_f32_16x16x32_bf16 v[16:19], a[208:211], v[72:75], v[16:19]
    ds_read_b64_tr_b16 v[64:65], v106 offset:57344
    ds_read_b64_tr_b16 v[66:67], v106 offset:57856
    v_mfma_f32_16x16x32_bf16 v[20:23], a[212:215], v[72:75], v[20:23]
    buffer_load_dwordx4 v[196:199], v249, s[44:47], s95 offen offset:768 sc1
    v_mfma_f32_16x16x32_bf16 v[24:27], a[208:211], v[76:79], v[24:27]
    ds_read_b64_tr_b16 v[68:69], v107 offset:57344
    ds_read_b64_tr_b16 v[70:71], v107 offset:57856
    v_mfma_f32_16x16x32_bf16 v[28:31], a[212:215], v[76:79], v[28:31]
    s_waitcnt lgkmcnt(9)
    v_mfma_f32_16x16x32_bf16 v[32:35], a[208:211], v[80:83], v[32:35]
    ds_read_b64_tr_b16 v[72:73], v108 offset:57344
    ds_read_b64_tr_b16 v[74:75], v108 offset:57856
    v_mfma_f32_16x16x32_bf16 v[36:39], a[212:215], v[80:83], v[36:39]
    buffer_load_dwordx4 v[200:203], v249, s[44:47], s95 offen offset:1536 sc1
    v_mfma_f32_16x16x32_bf16 v[40:43], a[208:211], v[84:87], v[40:43]
    ds_read_b64_tr_b16 v[76:77], v109 offset:57344
    ds_read_b64_tr_b16 v[78:79], v109 offset:57856
    v_mfma_f32_16x16x32_bf16 v[44:47], a[212:215], v[84:87], v[44:47]
    s_waitcnt lgkmcnt(8)
    v_mfma_f32_16x16x32_bf16 v[48:51], a[208:211], v[88:91], v[48:51]
    ds_read_b64_tr_b16 v[80:81], v106 offset:59392
    ds_read_b64_tr_b16 v[82:83], v106 offset:59904
    v_mfma_f32_16x16x32_bf16 v[52:55], a[212:215], v[88:91], v[52:55]
    buffer_load_dwordx4 v[204:207], v249, s[44:47], s95 offen offset:2304 sc1
    v_mfma_f32_16x16x32_bf16 v[56:59], a[208:211], v[92:95], v[56:59]
    ds_read_b64_tr_b16 v[84:85], v107 offset:59392
    ds_read_b64_tr_b16 v[86:87], v107 offset:59904
    v_mfma_f32_16x16x32_bf16 v[60:63], a[212:215], v[92:95], v[60:63]
    s_waitcnt lgkmcnt(8)
    v_mfma_f32_16x16x32_bf16 v[0:3], a[216:219], v[64:67], v[0:3]
    ds_read_b64_tr_b16 v[88:89], v108 offset:59392
    ds_read_b64_tr_b16 v[90:91], v108 offset:59904
    v_mfma_f32_16x16x32_bf16 v[4:7], a[220:223], v[64:67], v[4:7]
    buffer_load_dwordx4 v[176:179], v248, s[44:47], s94 offen offset:0 sc1
    v_mfma_f32_16x16x32_bf16 v[8:11], a[216:219], v[68:71], v[8:11]
    ds_read_b64_tr_b16 v[92:93], v109 offset:59392
    ds_read_b64_tr_b16 v[94:95], v109 offset:59904
    v_mfma_f32_16x16x32_bf16 v[12:15], a[220:223], v[68:71], v[12:15]
    s_waitcnt vmcnt(13) lgkmcnt(8)
    s_barrier
    ds_read_b128 a[224:227], v114 offset:32768
    v_mfma_f32_16x16x32_bf16 v[16:19], a[216:219], v[72:75], v[16:19]
    ds_read_b64_tr_b16 v[64:65], v110 offset:0
    ds_read_b64_tr_b16 v[66:67], v110 offset:512
    v_mfma_f32_16x16x32_bf16 v[20:23], a[220:223], v[72:75], v[20:23]
    buffer_load_dwordx4 v[180:183], v248, s[44:47], s94 offen offset:1024 sc1
    v_mfma_f32_16x16x32_bf16 v[24:27], a[216:219], v[76:79], v[24:27]
    ds_read_b64_tr_b16 v[68:69], v111 offset:0
    ds_read_b64_tr_b16 v[70:71], v111 offset:512
    v_mfma_f32_16x16x32_bf16 v[28:31], a[220:223], v[76:79], v[28:31]
    s_waitcnt lgkmcnt(9)
    ds_read_b128 a[228:231], v114 offset:34816
    v_mfma_f32_16x16x32_bf16 v[32:35], a[216:219], v[80:83], v[32:35]
    ds_read_b64_tr_b16 v[72:73], v112 offset:0
    ds_read_b64_tr_b16 v[74:75], v112 offset:512
    v_mfma_f32_16x16x32_bf16 v[36:39], a[220:223], v[80:83], v[36:39]
    buffer_load_dwordx4 v[184:187], v248, s[44:47], s94 offen offset:2048 sc1
    v_mfma_f32_16x16x32_bf16 v[40:43], a[216:219], v[84:87], v[40:43]
    ds_read_b64_tr_b16 v[76:77], v113 offset:0
    ds_read_b64_tr_b16 v[78:79], v113 offset:512
    v_mfma_f32_16x16x32_bf16 v[44:47], a[220:223], v[84:87], v[44:47]
    s_waitcnt lgkmcnt(10)
    ds_read_b128 a[232:235], v115 offset:32768
    v_mfma_f32_16x16x32_bf16 v[48:51], a[216:219], v[88:91], v[48:51]
    ds_read_b64_tr_b16 v[80:81], v110 offset:2048
    ds_read_b64_tr_b16 v[82:83], v110 offset:2560
    v_mfma_f32_16x16x32_bf16 v[52:55], a[220:223], v[88:91], v[52:55]
    buffer_load_dwordx4 v[188:191], v248, s[44:47], s94 offen offset:3072 sc1
    v_mfma_f32_16x16x32_bf16 v[56:59], a[216:219], v[92:95], v[56:59]
    s_mul_i32 s54, s55, 393216
    ds_read_b64_tr_b16 v[84:85], v111 offset:2048
    ds_read_b64_tr_b16 v[86:87], v111 offset:2560
    v_mfma_f32_16x16x32_bf16 v[60:63], a[220:223], v[92:95], v[60:63]
    s_waitcnt lgkmcnt(9)
    ds_read_b128 a[236:239], v115 offset:34816
    v_mfma_f32_16x16x32_bf16 v[0:3], a[224:227], v[64:67], v[0:3]
    s_add_u32 m0, s29, 16384
    ds_read_b64_tr_b16 v[88:89], v112 offset:2048
    ds_read_b64_tr_b16 v[90:91], v112 offset:2560
    v_mfma_f32_16x16x32_bf16 v[4:7], a[228:231], v[64:67], v[4:7]
    buffer_load_dwordx4 v100, s[40:43], s54 offen offset:0 lds
    v_mfma_f32_16x16x32_bf16 v[8:11], a[224:227], v[68:71], v[8:11]
    s_add_u32 s55, s55, 1
    ds_read_b64_tr_b16 v[92:93], v113 offset:2048
    ds_read_b64_tr_b16 v[94:95], v113 offset:2560
    v_mfma_f32_16x16x32_bf16 v[12:15], a[228:231], v[68:71], v[12:15]
    s_waitcnt lgkmcnt(10)
    v_mfma_f32_16x16x32_bf16 v[16:19], a[224:227], v[72:75], v[16:19]
    s_and_b32 s55, s55, 15
    ds_read_b64_tr_b16 v[64:65], v110 offset:8192
    ds_read_b64_tr_b16 v[66:67], v110 offset:8704
    v_mfma_f32_16x16x32_bf16 v[20:23], a[228:231], v[72:75], v[20:23]
    buffer_load_dwordx4 v101, s[40:43], s54 offen offset:1024 lds
    v_mfma_f32_16x16x32_bf16 v[24:27], a[224:227], v[76:79], v[24:27]
    s_mul_i32 s54, s55, 393216
    ds_read_b64_tr_b16 v[68:69], v111 offset:8192
    ds_read_b64_tr_b16 v[70:71], v111 offset:8704
    v_mfma_f32_16x16x32_bf16 v[28:31], a[228:231], v[76:79], v[28:31]
    s_waitcnt lgkmcnt(9)
    v_mfma_f32_16x16x32_bf16 v[32:35], a[224:227], v[80:83], v[32:35]
    s_add_u32 m0, s29, 18432
    ds_read_b64_tr_b16 v[72:73], v112 offset:8192
    ds_read_b64_tr_b16 v[74:75], v112 offset:8704
    v_mfma_f32_16x16x32_bf16 v[36:39], a[228:231], v[80:83], v[36:39]
    buffer_load_dwordx4 v100, s[40:43], s54 offen offset:0 lds
    v_mfma_f32_16x16x32_bf16 v[40:43], a[224:227], v[84:87], v[40:43]
    s_add_u32 s55, s55, 1
    ds_read_b64_tr_b16 v[76:77], v113 offset:8192
    ds_read_b64_tr_b16 v[78:79], v113 offset:8704
    v_mfma_f32_16x16x32_bf16 v[44:47], a[228:231], v[84:87], v[44:47]
    s_waitcnt lgkmcnt(8)
    s_waitcnt vmcnt(7)
    v_add_f32 v192, v192, v196
    v_mfma_f32_16x16x32_bf16 v[48:51], a[224:227], v[88:91], v[48:51]
    s_and_b32 s55, s55, 15
    ds_read_b64_tr_b16 v[80:81], v110 offset:10240
    ds_read_b64_tr_b16 v[82:83], v110 offset:10752
    v_mfma_f32_16x16x32_bf16 v[52:55], a[228:231], v[88:91], v[52:55]
    buffer_load_dwordx4 v101, s[40:43], s54 offen offset:1024 lds
    v_mfma_f32_16x16x32_bf16 v[56:59], a[224:227], v[92:95], v[56:59]
    s_mul_i32 s54, s55, 393216
    ds_read_b64_tr_b16 v[84:85], v111 offset:10240
    ds_read_b64_tr_b16 v[86:87], v111 offset:10752
    v_mfma_f32_16x16x32_bf16 v[60:63], a[228:231], v[92:95], v[60:63]
    s_waitcnt lgkmcnt(8)
    v_add_f32 v193, v193, v197
    v_add_f32 v194, v194, v198
    v_mfma_f32_16x16x32_bf16 v[0:3], a[232:235], v[64:67], v[0:3]
    s_add_u32 m0, s29, 32768
    ds_read_b64_tr_b16 v[88:89], v112 offset:10240
    ds_read_b64_tr_b16 v[90:91], v112 offset:10752
    v_mfma_f32_16x16x32_bf16 v[4:7], a[236:239], v[64:67], v[4:7]
    buffer_load_dwordx4 v100, s[40:43], s54 offen offset:0 lds
    v_mfma_f32_16x16x32_bf16 v[8:11], a[232:235], v[68:71], v[8:11]
    s_add_u32 s55, s55, 1
    ds_read_b64_tr_b16 v[92:93], v113 offset:10240
    ds_read_b64_tr_b16 v[94:95], v113 offset:10752
    v_mfma_f32_16x16x32_bf16 v[12:15], a[236:239], v[68:71], v[12:15]
    s_waitcnt lgkmcnt(8)
    s_barrier
    ds_read_b128 a[240:243], v114 offset:0
    v_mfma_f32_16x16x32_bf16 v[16:19], a[232:235], v[72:75], v[16:19]
    s_and_b32 s55, s55, 15
    ds_read_b64_tr_b16 v[64:65], v106 offset:0
    ds_read_b64_tr_b16 v[66:67], v106 offset:512
    v_mfma_f32_16x16x32_bf16 v[20:23], a[236:239], v[72:75], v[20:23]
    buffer_load_dwordx4 v101, s[40:43], s54 offen offset:1024 lds
    v_mfma_f32_16x16x32_bf16 v[24:27], a[232:235], v[76:79], v[24:27]
    s_mul_i32 s54, s55, 393216
    ds_read_b64_tr_b16 v[68:69], v107 offset:0
    ds_read_b64_tr_b16 v[70:71], v107 offset:512
    v_mfma_f32_16x16x32_bf16 v[28:31], a[236:239], v[76:79], v[28:31]
    s_waitcnt lgkmcnt(9)
    ds_read_b128 a[244:247], v114 offset:2048
    v_mfma_f32_16x16x32_bf16 v[32:35], a[232:235], v[80:83], v[32:35]
    s_add_u32 m0, s29, 34816
    ds_read_b64_tr_b16 v[72:73], v108 offset:0
    ds_read_b64_tr_b16 v[74:75], v108 offset:512
    v_mfma_f32_16x16x32_bf16 v[36:39], a[236:239], v[80:83], v[36:39]
    buffer_load_dwordx4 v100, s[40:43], s54 offen offset:0 lds
    v_mfma_f32_16x16x32_bf16 v[40:43], a[232:235], v[84:87], v[40:43]
    s_add_u32 s55, s55, 1
    ds_read_b64_tr_b16 v[76:77], v109 offset:0
    ds_read_b64_tr_b16 v[78:79], v109 offset:512
    v_mfma_f32_16x16x32_bf16 v[44:47], a[236:239], v[84:87], v[44:47]
    s_waitcnt lgkmcnt(10)
    ds_read_b128 a[248:251], v115 offset:0
    v_mfma_f32_16x16x32_bf16 v[48:51], a[232:235], v[88:91], v[48:51]
    s_and_b32 s55, s55, 15
    ds_read_b64_tr_b16 v[80:81], v106 offset:2048
    ds_read_b64_tr_b16 v[82:83], v106 offset:2560
    v_mfma_f32_16x16x32_bf16 v[52:55], a[236:239], v[88:91], v[52:55]
    buffer_load_dwordx4 v101, s[40:43], s54 offen offset:1024 lds
    v_mfma_f32_16x16x32_bf16 v[56:59], a[232:235], v[92:95], v[56:59]
    s_mul_i32 s54, s55, 393216
    ds_read_b64_tr_b16 v[84:85], v107 offset:2048
    ds_read_b64_tr_b16 v[86:87], v107 offset:2560
    v_mfma_f32_16x16x32_bf16 v[60:63], a[236:239], v[92:95], v[60:63]
    s_waitcnt lgkmcnt(9)
    ds_read_b128 a[252:255], v115 offset:2048
    v_mfma_f32_16x16x32_bf16 v[0:3], a[240:243], v[64:67], v[0:3]
    s_add_u32 m0, s29, 98304
    ds_read_b64_tr_b16 v[88:89], v108 offset:2048
    ds_read_b64_tr_b16 v[90:91], v108 offset:2560
    v_mfma_f32_16x16x32_bf16 v[4:7], a[244:247], v[64:67], v[4:7]
    buffer_load_dwordx4 v100, s[40:43], s54 offen offset:0 lds
    v_mfma_f32_16x16x32_bf16 v[8:11], a[240:243], v[68:71], v[8:11]
    s_add_u32 s55, s55, 1
    ds_read_b64_tr_b16 v[92:93], v109 offset:2048
    ds_read_b64_tr_b16 v[94:95], v109 offset:2560
    v_mfma_f32_16x16x32_bf16 v[12:15], a[244:247], v[68:71], v[12:15]
    s_waitcnt lgkmcnt(10)
    v_add_f32 v195, v195, v199
    v_add_f32 v200, v200, v204
    v_mfma_f32_16x16x32_bf16 v[16:19], a[240:243], v[72:75], v[16:19]
    s_and_b32 s55, s55, 15
    ds_read_b64_tr_b16 v[64:65], v106 offset:8192
    ds_read_b64_tr_b16 v[66:67], v106 offset:8704
    v_mfma_f32_16x16x32_bf16 v[20:23], a[244:247], v[72:75], v[20:23]
    buffer_load_dwordx4 v101, s[40:43], s54 offen offset:1024 lds
    v_mfma_f32_16x16x32_bf16 v[24:27], a[240:243], v[76:79], v[24:27]
    s_mul_i32 s54, s55, 393216
    ds_read_b64_tr_b16 v[68:69], v107 offset:8192
    ds_read_b64_tr_b16 v[70:71], v107 offset:8704
    v_mfma_f32_16x16x32_bf16 v[28:31], a[244:247], v[76:79], v[28:31]
    s_waitcnt lgkmcnt(9)
    v_add_f32 v201, v201, v205
    v_add_f32 v202, v202, v206
    v_mfma_f32_16x16x32_bf16 v[32:35], a[240:243], v[80:83], v[32:35]
    s_add_u32 m0, s29, 100352
    ds_read_b64_tr_b16 v[72:73], v108 offset:8192
    ds_read_b64_tr_b16 v[74:75], v108 offset:8704
    v_mfma_f32_16x16x32_bf16 v[36:39], a[244:247], v[80:83], v[36:39]
    buffer_load_dwordx4 v100, s[40:43], s54 offen offset:0 lds
    v_mfma_f32_16x16x32_bf16 v[40:43], a[240:243], v[84:87], v[40:43]
    s_add_u32 s55, s55, 1
    ds_read_b64_tr_b16 v[76:77], v109 offset:8192
    ds_read_b64_tr_b16 v[78:79], v109 offset:8704
    v_mfma_f32_16x16x32_bf16 v[44:47], a[244:247], v[84:87], v[44:47]
    s_waitcnt lgkmcnt(8)
    v_add_f32 v203, v203, v207
    v_add_f32 v192, v192, v200
    v_mfma_f32_16x16x32_bf16 v[48:51], a[240:243], v[88:91], v[48:51]
    s_and_b32 s55, s55, 15
    ds_read_b64_tr_b16 v[80:81], v106 offset:10240
    ds_read_b64_tr_b16 v[82:83], v106 offset:10752
    v_mfma_f32_16x16x32_bf16 v[52:55], a[244:247], v[88:91], v[52:55]
    buffer_load_dwordx4 v101, s[40:43], s54 offen offset:1024 lds
    v_mfma_f32_16x16x32_bf16 v[56:59], a[240:243], v[92:95], v[56:59]
    s_mul_i32 s54, s55, 393216
    ds_read_b64_tr_b16 v[84:85], v107 offset:10240
    ds_read_b64_tr_b16 v[86:87], v107 offset:10752
    v_mfma_f32_16x16x32_bf16 v[60:63], a[244:247], v[92:95], v[60:63]
    s_waitcnt lgkmcnt(8)
    v_add_f32 v193, v193, v201
    v_add_f32 v194, v194, v202
    v_mfma_f32_16x16x32_bf16 v[0:3], a[248:251], v[64:67], v[0:3]
    s_add_u32 m0, s29, 114688
    ds_read_b64_tr_b16 v[88:89], v108 offset:10240
    ds_read_b64_tr_b16 v[90:91], v108 offset:10752
    v_mfma_f32_16x16x32_bf16 v[4:7], a[252:255], v[64:67], v[4:7]
    buffer_load_dwordx4 v100, s[40:43], s54 offen offset:0 lds
    v_mfma_f32_16x16x32_bf16 v[8:11], a[248:251], v[68:71], v[8:11]
    s_add_u32 s55, s55, 1
    ds_read_b64_tr_b16 v[92:93], v109 offset:10240
    ds_read_b64_tr_b16 v[94:95], v109 offset:10752
    v_mfma_f32_16x16x32_bf16 v[12:15], a[252:255], v[68:71], v[12:15]
    s_waitcnt lgkmcnt(8)
    v_add_f32 v195, v195, v203
    v_mov_b32 v196, v192
    v_mfma_f32_16x16x32_bf16 v[16:19], a[248:251], v[72:75], v[16:19]
    s_and_b32 s55, s55, 15
    v_mov_b32 v197, v193
    v_mov_b32 v198, v194
    v_mfma_f32_16x16x32_bf16 v[20:23], a[252:255], v[72:75], v[20:23]
    buffer_load_dwordx4 v101, s[40:43], s54 offen offset:1024 lds
    v_mfma_f32_16x16x32_bf16 v[24:27], a[248:251], v[76:79], v[24:27]
    s_mul_i32 s54, s55, 393216
    v_mov_b32 v199, v195
    v_mfma_f32_16x16x32_bf16 v[28:31], a[252:255], v[76:79], v[28:31]
    s_waitcnt lgkmcnt(4)
    s_nop 1
    v_permlane16_swap_b32 v192, v196
    v_mfma_f32_16x16x32_bf16 v[32:35], a[248:251], v[80:83], v[32:35]
    s_add_u32 m0, s29, 116736
    v_permlane16_swap_b32 v193, v197
    v_permlane16_swap_b32 v194, v198
    v_mfma_f32_16x16x32_bf16 v[36:39], a[252:255], v[80:83], v[36:39]
    buffer_load_dwordx4 v100, s[40:43], s54 offen offset:0 lds
    v_mfma_f32_16x16x32_bf16 v[40:43], a[248:251], v[84:87], v[40:43]
    s_add_u32 s55, s55, 1
    v_permlane16_swap_b32 v195, v199
    v_add_f32 v192, v192, v196
    v_mfma_f32_16x16x32_bf16 v[44:47], a[252:255], v[84:87], v[44:47]
    s_waitcnt lgkmcnt(0)
    v_add_f32 v193, v193, v197
    v_add_f32 v194, v194, v198
    v_mfma_f32_16x16x32_bf16 v[48:51], a[248:251], v[88:91], v[48:51]
    s_and_b32 s55, s55, 15
    v_add_f32 v195, v195, v199
    v_mov_b32 v196, v192
    v_mfma_f32_16x16x32_bf16 v[52:55], a[252:255], v[88:91], v[52:55]
    buffer_load_dwordx4 v101, s[40:43], s54 offen offset:1024 lds
    v_mfma_f32_16x16x32_bf16 v[56:59], a[248:251], v[92:95], v[56:59]
    v_mov_b32 v197, v193
    v_mov_b32 v198, v194
    v_mfma_f32_16x16x32_bf16 v[60:63], a[252:255], v[92:95], v[60:63]
Lpad_3:
    s_cbranch_execz Lpad_7
    v_mov_b32 v199, v195
    buffer_load_dwordx4 v[88:91], v98, s[64:67], 0 offen offset:0
    buffer_load_dwordx4 v[92:95], v98, s[64:67], 0 offen offset:1024
    s_nop 1
    v_permlane32_swap_b32 v192, v196
    v_permlane32_swap_b32 v193, v197
    v_permlane32_swap_b32 v194, v198
    v_permlane32_swap_b32 v195, v199
    v_add_f32 v192, v192, v196
    v_add_f32 v193, v193, v197
    v_add_f32 v194, v194, v198
    v_add_f32 v195, v195, v199
    ds_write_b128 v232, v[192:195]
    s_waitcnt vmcnt(18)
    v_add_f32 v208, v176, v180
    v_add_f32 v214, v184, v188
    v_add_f32 v208, v208, v214
    v_add_f32 v209, v178, v182
    v_add_f32 v215, v186, v190
    v_add_f32 v209, v209, v215
    v_mov_b32 v214, v208
    v_mov_b32 v215, v209
    s_nop 1
    v_permlane16_swap_b32 v208, v214
    v_permlane16_swap_b32 v209, v215
    v_add_f32 v208, v208, v214
    v_add_f32 v209, v209, v215
    v_mov_b32 v214, v208
    v_mov_b32 v215, v209
    s_nop 1
    v_permlane32_swap_b32 v208, v214
    v_permlane32_swap_b32 v209, v215
    v_add_f32 v208, v208, v214
    v_add_f32 v209, v209, v215
    s_mov_b32 s27, 0x3c800000
    v_mul_f32 v208, 0xba800000, v208
    v_add_f32 v212, v177, v181
    v_add_f32 v214, v185, v189
    v_add_f32 v212, v212, v214
    v_mul_f32 v212, s27, v212
    v_fma_f32 v214, v176, s27, v208
    v_fmac_f32 v212, v214, v214
    v_fma_f32 v214, v180, s27, v208
    v_fmac_f32 v212, v214, v214
    v_fma_f32 v214, v184, s27, v208
    v_fmac_f32 v212, v214, v214
    v_fma_f32 v214, v188, s27, v208
    v_fmac_f32 v212, v214, v214
    v_mul_f32 v209, 0xba800000, v209
    v_add_f32 v213, v179, v183
    v_add_f32 v215, v187, v191
    v_add_f32 v213, v213, v215
    v_mul_f32 v213, s27, v213
    v_fma_f32 v214, v178, s27, v209
    v_fmac_f32 v213, v214, v214
    v_fma_f32 v214, v182, s27, v209
    v_fmac_f32 v213, v214, v214
    v_fma_f32 v214, v186, s27, v209
    v_fmac_f32 v213, v214, v214
    v_fma_f32 v214, v190, s27, v209
    v_fmac_f32 v213, v214, v214
    v_mov_b32 v214, v212
    v_mov_b32 v215, v213
    s_nop 1
    v_permlane16_swap_b32 v212, v214
    v_permlane16_swap_b32 v213, v215
    v_add_f32 v212, v212, v214
    v_add_f32 v213, v213, v215
    v_mov_b32 v214, v212
    v_mov_b32 v215, v213
    s_nop 1
    v_permlane32_swap_b32 v212, v214
    v_permlane32_swap_b32 v213, v215
    v_add_f32 v212, v212, v214
    v_add_f32 v213, v213, v215
    v_mov_b32 v214, 0x3727c5ac
    v_fmac_f32 v214, 0x3d800000, v212
    v_rsq_f32 v210, v214
    v_mov_b32 v215, 0x3727c5ac
    v_fmac_f32 v215, 0x3d800000, v213
    v_rsq_f32 v211, v215
    ds_write_b64 v233, v[208:209]
    ds_write_b64 v233, v[210:211] offset:128
    s_waitcnt lgkmcnt(0)
    s_barrier
    ds_read_b128 v[120:123], v234 offset:0
    ds_read_b128 v[124:127], v234 offset:64
    ds_read_b32 v152, v237 offset:256
    ds_read_b32 v153, v237 offset:320
    ds_read_b32 v154, v237 offset:384
    ds_read_b32 v155, v237 offset:448
    ds_read_b32 v156, v237 offset:512
    ds_read_b32 v157, v237 offset:576
    ds_read_b32 v158, v237 offset:640
    ds_read_b32 v159, v237 offset:704
    ds_read_b128 v[128:131], v234 offset:128
    ds_read_b128 v[132:135], v234 offset:192
    ds_read_b32 v144, v235 offset:0
    ds_read_b32 v146, v235 offset:128
    ds_read_b32 v145, v235 offset:64
    ds_read_b32 v147, v235 offset:192
    ds_read_b128 v[160:163], v236 offset:0
    ds_read_b128 v[164:167], v236 offset:64
    ds_read_b128 v[168:171], v236 offset:128
    ds_read_b128 v[172:175], v236 offset:192
    s_mul_i32 s54, s55, 393216
    s_add_u32 m0, s29, 81920
    s_nop 0
    buffer_load_dwordx4 v100, s[40:43], s54 offen offset:0 lds
    s_add_u32 s55, s55, 1
    s_and_b32 s55, s55, 15
    buffer_load_dwordx4 v101, s[40:43], s54 offen offset:1024 lds
    v_sub_f32 v230, 0, v208
    v_sub_f32 v231, 0, v209
    s_lshl_b32 s28, s30, 7
    s_lshl_b32 s27, s26, 20
    s_add_u32 s28, s28, s27
    s_add_u32 s28, s28, 262144
    buffer_store_dwordx2 v[230:231], v99, s[48:51], s28 offen sc1
    s_mov_b32 s27, 0x3fb8aa3b
    s_waitcnt lgkmcnt(10)
    v_pk_fma_f32 v[0:1], v[120:121], v[152:153], v[0:1] op_sel:[0,0,0] op_sel_hi:[1,0,1]
    v_pk_fma_f32 v[2:3], v[122:123], v[152:153], v[2:3] op_sel:[0,0,0] op_sel_hi:[1,0,1]
    v_pk_fma_f32 v[4:5], v[124:125], v[152:153], v[4:5] op_sel:[0,0,0] op_sel_hi:[1,0,1]
    v_pk_fma_f32 v[6:7], v[126:127], v[152:153], v[6:7] op_sel:[0,0,0] op_sel_hi:[1,0,1]
    v_pk_fma_f32 v[8:9], v[120:121], v[152:153], v[8:9] op_sel:[0,1,0] op_sel_hi:[1,1,1]
    v_pk_fma_f32 v[10:11], v[122:123], v[152:153], v[10:11] op_sel:[0,1,0] op_sel_hi:[1,1,1]
    v_pk_fma_f32 v[12:13], v[124:125], v[152:153], v[12:13] op_sel:[0,1,0] op_sel_hi:[1,1,1]
    v_pk_fma_f32 v[14:15], v[126:127], v[152:153], v[14:15] op_sel:[0,1,0] op_sel_hi:[1,1,1]
    v_pk_fma_f32 v[16:17], v[120:121], v[154:155], v[16:17] op_sel:[0,0,0] op_sel_hi:[1,0,1]
    v_pk_fma_f32 v[18:19], v[122:123], v[154:155], v[18:19] op_sel:[0,0,0] op_sel_hi:[1,0,1]
    v_pk_fma_f32 v[20:21], v[124:125], v[154:155], v[20:21] op_sel:[0,0,0] op_sel_hi:[1,0,1]
    v_pk_fma_f32 v[22:23], v[126:127], v[154:155], v[22:23] op_sel:[0,0,0] op_sel_hi:[1,0,1]
    v_pk_fma_f32 v[24:25], v[120:121], v[154:155], v[24:25] op_sel:[0,1,0] op_sel_hi:[1,1,1]
    v_pk_fma_f32 v[26:27], v[122:123], v[154:155], v[26:27] op_sel:[0,1,0] op_sel_hi:[1,1,1]
    v_pk_fma_f32 v[28:29], v[124:125], v[154:155], v[28:29] op_sel:[0,1,0] op_sel_hi:[1,1,1]
    v_pk_fma_f32 v[30:31], v[126:127], v[154:155], v[30:31] op_sel:[0,1,0] op_sel_hi:[1,1,1]
    v_pk_fma_f32 v[32:33], v[120:121], v[156:157], v[32:33] op_sel:[0,0,0] op_sel_hi:[1,0,1]
    v_pk_fma_f32 v[34:35], v[122:123], v[156:157], v[34:35] op_sel:[0,0,0] op_sel_hi:[1,0,1]
    v_pk_fma_f32 v[36:37], v[124:125], v[156:157], v[36:37] op_sel:[0,0,0] op_sel_hi:[1,0,1]
    v_pk_fma_f32 v[38:39], v[126:127], v[156:157], v[38:39] op_sel:[0,0,0] op_sel_hi:[1,0,1]
    s_mul_i32 s54, s55, 393216
    s_add_u32 m0, s29, 83968
    s_nop 0
    buffer_load_dwordx4 v100, s[40:43], s54 offen offset:0 lds
    s_add_u32 s55, s55, 1
    s_and_b32 s55, s55, 15
    buffer_load_dwordx4 v101, s[40:43], s54 offen offset:1024 lds
    v_pk_fma_f32 v[40:41], v[120:121], v[156:157], v[40:41] op_sel:[0,1,0] op_sel_hi:[1,1,1]
    v_pk_fma_f32 v[42:43], v[122:123], v[156:157], v[42:43] op_sel:[0,1,0] op_sel_hi:[1,1,1]
    v_pk_fma_f32 v[44:45], v[124:125], v[156:157], v[44:45] op_sel:[0,1,0] op_sel_hi:[1,1,1]
    v_pk_fma_f32 v[46:47], v[126:127], v[156:157], v[46:47] op_sel:[0,1,0] op_sel_hi:[1,1,1]
    v_pk_fma_f32 v[48:49], v[120:121], v[158:159], v[48:49] op_sel:[0,0,0] op_sel_hi:[1,0,1]
    v_pk_fma_f32 v[50:51], v[122:123], v[158:159], v[50:51] op_sel:[0,0,0] op_sel_hi:[1,0,1]
    v_pk_fma_f32 v[52:53], v[124:125], v[158:159], v[52:53] op_sel:[0,0,0] op_sel_hi:[1,0,1]
    v_pk_fma_f32 v[54:55], v[126:127], v[158:159], v[54:55] op_sel:[0,0,0] op_sel_hi:[1,0,1]
    v_pk_fma_f32 v[56:57], v[120:121], v[158:159], v[56:57] op_sel:[0,1,0] op_sel_hi:[1,1,1]
    v_pk_fma_f32 v[58:59], v[122:123], v[158:159], v[58:59] op_sel:[0,1,0] op_sel_hi:[1,1,1]
    v_pk_fma_f32 v[60:61], v[124:125], v[158:159], v[60:61] op_sel:[0,1,0] op_sel_hi:[1,1,1]
    v_pk_fma_f32 v[62:63], v[126:127], v[158:159], v[62:63] op_sel:[0,1,0] op_sel_hi:[1,1,1]
    s_waitcnt lgkmcnt(0)
    s_barrier
    v_mul_f32 v136, s27, v128
    v_mul_f32 v137, s27, v129
    v_mul_f32 v138, s27, v130
    v_mul_f32 v139, s27, v131
    v_mul_f32 v140, s27, v132
    v_mul_f32 v141, s27, v133
    v_mul_f32 v142, s27, v134
    v_mul_f32 v143, s27, v135
    v_mul_f32 v148, s27, v146
    v_mul_f32 v149, s27, v147
    v_pk_mul_f32 v[32:33], v[32:33], v[128:129]
    v_pk_mul_f32 v[34:35], v[34:35], v[130:131]
    v_pk_mul_f32 v[36:37], v[36:37], v[132:133]
    v_pk_mul_f32 v[38:39], v[38:39], v[134:135]
    s_mul_i32 s54, s55, 393216
    s_add_u32 m0, s29, 49152
    s_nop 0
    buffer_load_dwordx4 v100, s[40:43], s54 offen offset:0 lds
    v_pk_mul_f32 v[40:41], v[40:41], v[128:129]
    v_pk_mul_f32 v[42:43], v[42:43], v[130:131]
    v_pk_mul_f32 v[44:45], v[44:45], v[132:133]
    v_pk_mul_f32 v[46:47], v[46:47], v[134:135]
    v_pk_mul_f32 v[48:49], v[48:49], v[128:129]
    v_pk_mul_f32 v[50:51], v[50:51], v[130:131]
    v_pk_mul_f32 v[52:53], v[52:53], v[132:133]
    v_pk_mul_f32 v[54:55], v[54:55], v[134:135]
    v_pk_mul_f32 v[56:57], v[56:57], v[128:129]
    v_pk_mul_f32 v[58:59], v[58:59], v[130:131]
    v_pk_mul_f32 v[60:61], v[60:61], v[132:133]
    v_pk_mul_f32 v[62:63], v[62:63], v[134:135]
    v_cvt_pk_bf16_f32 v192, v32, v33
    v_cvt_pk_bf16_f32 v193, v34, v35
    s_add_u32 s55, s55, 1
    s_and_b32 s55, s55, 15
    buffer_load_dwordx4 v101, s[40:43], s54 offen offset:1024 lds
    v_cvt_pk_bf16_f32 v194, v36, v37
    v_cvt_pk_bf16_f32 v195, v38, v39
    v_cvt_pk_bf16_f32 v196, v40, v41
    v_cvt_pk_bf16_f32 v197, v42, v43
    v_cvt_pk_bf16_f32 v198, v44, v45
    v_cvt_pk_bf16_f32 v199, v46, v47
    v_cvt_pk_bf16_f32 v200, v48, v49
    v_cvt_pk_bf16_f32 v201, v50, v51
    v_cvt_pk_bf16_f32 v202, v52, v53
    v_cvt_pk_bf16_f32 v203, v54, v55
    v_cvt_pk_bf16_f32 v204, v56, v57
    v_cvt_pk_bf16_f32 v205, v58, v59
    v_cvt_pk_bf16_f32 v206, v60, v61
    v_cvt_pk_bf16_f32 v207, v62, v63
    s_mul_i32 s54, s55, 393216
    s_add_u32 m0, s29, 51200
    s_nop 0
    buffer_load_dwordx4 v100, s[40:43], s54 offen offset:0 lds
    ds_write_b128 v238, v[192:195] offset:4096
    v_pk_mul_f32 v[208:209], v[0:1], v[136:137]
    v_pk_mul_f32 v[210:211], v[2:3], v[138:139]
    v_pk_mul_f32 v[212:213], v[4:5], v[140:141]
    v_pk_mul_f32 v[214:215], v[6:7], v[142:143]
    v_pk_mul_f32 v[216:217], v[8:9], v[136:137]
    v_pk_mul_f32 v[218:219], v[10:11], v[138:139]
    v_pk_mul_f32 v[220:221], v[12:13], v[140:141]
    v_pk_mul_f32 v[222:223], v[14:15], v[142:143]
    v_exp_f32 v208, v208 clamp
    v_exp_f32 v209, v209 clamp
    v_exp_f32 v210, v210 clamp
    v_exp_f32 v211, v211 clamp
    v_exp_f32 v212, v212 clamp
    s_add_u32 s55, s55, 1
    s_and_b32 s55, s55, 15
    buffer_load_dwordx4 v101, s[40:43], s54 offen offset:1024 lds
    v_exp_f32 v213, v213 clamp
    v_exp_f32 v214, v214 clamp
    v_exp_f32 v215, v215 clamp
    ds_write_b128 v238, v[196:199] offset:5120
    v_exp_f32 v216, v216 clamp
    v_exp_f32 v217, v217 clamp
    v_exp_f32 v218, v218 clamp
    v_exp_f32 v219, v219 clamp
    v_exp_f32 v220, v220 clamp
    v_exp_f32 v221, v221 clamp
    v_exp_f32 v222, v222 clamp
    v_exp_f32 v223, v223 clamp
    v_pk_fma_f32 v[0:1], v[0:1], v[128:129], s[0:1]
    v_pk_fma_f32 v[2:3], v[2:3], v[130:131], s[0:1]
    s_mul_i32 s54, s55, 393216
    s_add_u32 m0, s29, 65536
    s_nop 0
    buffer_load_dwordx4 v100, s[40:43], s54 offen offset:0 lds
    v_pk_fma_f32 v[4:5], v[4:5], v[132:133], s[0:1]
    v_pk_fma_f32 v[6:7], v[6:7], v[134:135], s[0:1]
    v_pk_fma_f32 v[8:9], v[8:9], v[128:129], s[0:1]
    v_pk_fma_f32 v[10:11], v[10:11], v[130:131], s[0:1]
    v_pk_fma_f32 v[12:13], v[12:13], v[132:133], s[0:1]
    v_pk_fma_f32 v[14:15], v[14:15], v[134:135], s[0:1]
    ds_write_b128 v238, v[200:203] offset:6144
    v_max_f32 v0, v0, v208
    v_max_f32 v1, v1, v209
    v_max_f32 v2, v2, v210
    v_max_f32 v3, v3, v211
    v_max_f32 v4, v4, v212
    v_max_f32 v5, v5, v213
    v_max_f32 v6, v6, v214
    s_add_u32 s55, s55, 1
    s_and_b32 s55, s55, 15
    buffer_load_dwordx4 v101, s[40:43], s54 offen offset:1024 lds
    v_max_f32 v7, v7, v215
    v_max_f32 v8, v8, v216
    v_max_f32 v9, v9, v217
    v_max_f32 v10, v10, v218
    v_max_f32 v11, v11, v219
    v_max_f32 v12, v12, v220
    v_max_f32 v13, v13, v221
    v_max_f32 v14, v14, v222
    v_max_f32 v15, v15, v223
    ds_write_b128 v238, v[204:207] offset:7168
    v_pk_add_f32 v[0:1], v[0:1], s[60:61]
    v_pk_add_f32 v[2:3], v[2:3], s[60:61]
    v_pk_add_f32 v[4:5], v[4:5], s[60:61]
    v_pk_add_f32 v[6:7], v[6:7], s[60:61]
    s_mul_i32 s54, s55, 393216
    s_add_u32 m0, s29, 67584
    s_nop 0
    buffer_load_dwordx4 v100, s[40:43], s54 offen offset:0 lds
    v_pk_add_f32 v[8:9], v[8:9], s[60:61]
    v_pk_add_f32 v[10:11], v[10:11], s[60:61]
    v_pk_add_f32 v[12:13], v[12:13], s[60:61]
    v_pk_add_f32 v[14:15], v[14:15], s[60:61]
    v_cvt_pk_bf16_f32 v176, v0, v1
    v_cvt_pk_bf16_f32 v177, v2, v3
    v_cvt_pk_bf16_f32 v178, v4, v5
    v_cvt_pk_bf16_f32 v179, v6, v7
    v_cvt_pk_bf16_f32 v180, v8, v9
    v_cvt_pk_bf16_f32 v181, v10, v11
    v_cvt_pk_bf16_f32 v182, v12, v13
    v_cvt_pk_bf16_f32 v183, v14, v15
    ds_write_b128 v238, v[176:179] offset:0
    v_pk_mul_f32 v[208:209], v[16:17], v[136:137]
    s_add_u32 s55, s55, 1
    s_and_b32 s55, s55, 15
    buffer_load_dwordx4 v101, s[40:43], s54 offen offset:1024 lds
    v_pk_mul_f32 v[210:211], v[18:19], v[138:139]
    v_pk_mul_f32 v[212:213], v[20:21], v[140:141]
    v_pk_mul_f32 v[214:215], v[22:23], v[142:143]
    v_pk_mul_f32 v[216:217], v[24:25], v[136:137]
    v_pk_mul_f32 v[218:219], v[26:27], v[138:139]
    v_pk_mul_f32 v[220:221], v[28:29], v[140:141]
    v_pk_mul_f32 v[222:223], v[30:31], v[142:143]
    v_exp_f32 v208, v208 clamp
    v_exp_f32 v209, v209 clamp
    v_exp_f32 v210, v210 clamp
    v_exp_f32 v211, v211 clamp
    v_exp_f32 v212, v212 clamp
    v_exp_f32 v213, v213 clamp
    v_exp_f32 v214, v214 clamp
    s_mul_i32 s54, s55, 393216
    s_add_u32 m0, s29, 0
    s_nop 0
    buffer_load_dwordx4 v100, s[40:43], s54 offen offset:0 lds
    v_exp_f32 v215, v215 clamp
    v_exp_f32 v216, v216 clamp
    v_exp_f32 v217, v217 clamp
    v_exp_f32 v218, v218 clamp
    v_exp_f32 v219, v219 clamp
    v_exp_f32 v220, v220 clamp
    v_exp_f32 v221, v221 clamp
    v_exp_f32 v222, v222 clamp
    v_exp_f32 v223, v223 clamp
    v_pk_fma_f32 v[16:17], v[16:17], v[128:129], s[0:1]
    v_pk_fma_f32 v[18:19], v[18:19], v[130:131], s[0:1]
    v_pk_fma_f32 v[20:21], v[20:21], v[132:133], s[0:1]
    v_pk_fma_f32 v[22:23], v[22:23], v[134:135], s[0:1]
    v_pk_fma_f32 v[24:25], v[24:25], v[128:129], s[0:1]
    s_add_u32 s55, s55, 1
    s_and_b32 s55, s55, 15
    buffer_load_dwordx4 v101, s[40:43], s54 offen offset:1024 lds
    v_pk_fma_f32 v[26:27], v[26:27], v[130:131], s[0:1]
    v_pk_fma_f32 v[28:29], v[28:29], v[132:133], s[0:1]
    v_pk_fma_f32 v[30:31], v[30:31], v[134:135], s[0:1]
    ds_write_b128 v238, v[180:183] offset:1024
    v_max_f32 v16, v16, v208
    v_max_f32 v17, v17, v209
    v_max_f32 v18, v18, v210
    v_max_f32 v19, v19, v211
    v_max_f32 v20, v20, v212
    v_max_f32 v21, v21, v213
    v_max_f32 v22, v22, v214
    v_max_f32 v23, v23, v215
    v_max_f32 v24, v24, v216
    v_max_f32 v25, v25, v217
    s_mul_i32 s54, s55, 393216
    s_add_u32 m0, s29, 2048
    s_nop 0
    buffer_load_dwordx4 v100, s[40:43], s54 offen offset:0 lds
    v_max_f32 v26, v26, v218
    v_max_f32 v27, v27, v219
    v_max_f32 v28, v28, v220
    v_max_f32 v29, v29, v221
    v_max_f32 v30, v30, v222
    v_max_f32 v31, v31, v223
    v_pk_add_f32 v[16:17], v[16:17], s[60:61]
    v_pk_add_f32 v[18:19], v[18:19], s[60:61]
    v_pk_add_f32 v[20:21], v[20:21], s[60:61]
    v_pk_add_f32 v[22:23], v[22:23], s[60:61]
    v_pk_add_f32 v[24:25], v[24:25], s[60:61]
    v_pk_add_f32 v[26:27], v[26:27], s[60:61]
    v_pk_add_f32 v[28:29], v[28:29], s[60:61]
    v_pk_add_f32 v[30:31], v[30:31], s[60:61]
    s_add_u32 s55, s55, 1
    s_and_b32 s55, s55, 15
    buffer_load_dwordx4 v101, s[40:43], s54 offen offset:1024 lds
    v_cvt_pk_bf16_f32 v184, v16, v17
    v_cvt_pk_bf16_f32 v185, v18, v19
    v_cvt_pk_bf16_f32 v186, v20, v21
    v_cvt_pk_bf16_f32 v187, v22, v23
    v_cvt_pk_bf16_f32 v188, v24, v25
    v_cvt_pk_bf16_f32 v189, v26, v27
    v_cvt_pk_bf16_f32 v190, v28, v29
    v_cvt_pk_bf16_f32 v191, v30, v31
    ds_write_b128 v238, v[184:187] offset:2048
    ds_write_b128 v238, v[188:191] offset:3072
    s_waitcnt vmcnt(17)
    v_lshlrev_b32 v62, 16, v88
    v_and_b32 v63, s62, v88
    v_lshlrev_b32 v60, 16, v89
    v_and_b32 v61, s62, v89
    v_pk_add_f32 v[62:63], v[62:63], v[60:61]
    v_lshlrev_b32 v60, 16, v90
    v_and_b32 v61, s62, v90
    v_pk_add_f32 v[62:63], v[62:63], v[60:61]
    v_lshlrev_b32 v60, 16, v91
    v_and_b32 v61, s62, v91
    v_pk_add_f32 v[62:63], v[62:63], v[60:61]
    v_lshlrev_b32 v60, 16, v92
    v_and_b32 v61, s62, v92
    v_pk_add_f32 v[62:63], v[62:63], v[60:61]
    v_lshlrev_b32 v60, 16, v93
    v_and_b32 v61, s62, v93
    v_pk_add_f32 v[62:63], v[62:63], v[60:61]
    v_lshlrev_b32 v60, 16, v94
    v_and_b32 v61, s62, v94
    v_pk_add_f32 v[62:63], v[62:63], v[60:61]
    v_lshlrev_b32 v60, 16, v95
    v_and_b32 v61, s62, v95
    v_pk_add_f32 v[62:63], v[62:63], v[60:61]
    v_add_f32 v62, v62, v63
    s_lshl_b32 s94, s24, 11
    s_add_u32 s94, s94, s3
    s_lshl_b32 s95, s24, 6
    s_add_u32 s95, s95, s3
    s_add_u32 s95, s95, 8192
    s_add_u32 s63, s3, 8448
    s_waitcnt lgkmcnt(0)
    s_barrier
    ds_read_b128 v[176:179], v239 offset:0
    ds_read_b128 v[180:183], v240 offset:0
    ds_read_b128 v[184:187], v240 offset:1024
    ds_read_b128 v[188:191], v239 offset:8192
    ds_read_b128 v[192:195], v240 offset:8192
    ds_read_b128 v[196:199], v240 offset:9216
    ds_read_b128 v[208:211], v239 offset:16384
    ds_read_b128 v[212:215], v240 offset:16384
    ds_read_b128 v[216:219], v240 offset:17408
    ds_read_b128 v[220:223], v239 offset:24576
    ds_read_b128 v[224:227], v240 offset:24576
    ds_read_b128 v[228:231], v240 offset:25600
    v_and_b32 v60, 3, v97
    v_cmp_eq_u32 vcc, 1, v60
    v_cmp_eq_u32 s[68:69], 2, v60
    v_cmp_eq_u32 s[100:101], 3, v60
    v_mov_b32 v118, 0
    s_waitcnt lgkmcnt(9)
    v_mfma_f32_16x16x32_bf16 v[48:51], v[176:179], v[180:183], 0
    v_mfma_f32_16x16x32_bf16 v[52:55], v[176:179], v[184:187], 0
    v_mfma_f32_16x16x32_bf16 v[56:59], v[176:179], v[252:255], 0
    s_waitcnt lgkmcnt(6)
    v_mfma_f32_16x16x32_bf16 v[48:51], v[188:191], v[192:195], v[48:51]
    v_mfma_f32_16x16x32_bf16 v[52:55], v[188:191], v[196:199], v[52:55]
    v_mfma_f32_16x16x32_bf16 v[56:59], v[188:191], v[252:255], v[56:59]
    s_waitcnt lgkmcnt(3)
    v_mfma_f32_16x16x32_bf16 v[48:51], v[208:211], v[212:215], v[48:51]
    ds_read_b64_tr_b16 v[64:65], v106 offset:16384
    ds_read_b64_tr_b16 v[66:67], v106 offset:16896
    v_mfma_f32_16x16x32_bf16 v[52:55], v[208:211], v[216:219], v[52:55]
    ds_read_b64_tr_b16 v[68:69], v107 offset:16384
    ds_read_b64_tr_b16 v[70:71], v107 offset:16896
    v_mfma_f32_16x16x32_bf16 v[56:59], v[208:211], v[252:255], v[56:59]
    ds_read_b64_tr_b16 v[72:73], v108 offset:16384
    ds_read_b64_tr_b16 v[74:75], v108 offset:16896
    s_waitcnt lgkmcnt(6)
    v_mfma_f32_16x16x32_bf16 v[48:51], v[220:223], v[224:227], v[48:51]
    ds_read_b64_tr_b16 v[76:77], v109 offset:16384
    ds_read_b64_tr_b16 v[78:79], v109 offset:16896
    v_mfma_f32_16x16x32_bf16 v[52:55], v[220:223], v[228:231], v[52:55]
    ds_read_b64_tr_b16 v[80:81], v106 offset:24576
    ds_read_b64_tr_b16 v[82:83], v106 offset:25088
    v_mfma_f32_16x16x32_bf16 v[56:59], v[220:223], v[252:255], v[56:59]
    ds_read_b64_tr_b16 v[84:85], v107 offset:24576
    ds_read_b64_tr_b16 v[86:87], v107 offset:25088
    s_waitcnt lgkmcnt(8)
    v_mfma_f32_16x16x32_bf16 v[0:3], v[64:67], a[0:3], 0
    ds_read_b64_tr_b16 v[88:89], v108 offset:24576
    ds_read_b64_tr_b16 v[90:91], v108 offset:25088
    v_mfma_f32_16x16x32_bf16 v[16:19], v[64:67], a[4:7], 0
    v_mfma_f32_16x16x32_bf16 v[4:7], v[68:71], a[0:3], 0
    ds_read_b64_tr_b16 v[92:93], v109 offset:24576
    ds_read_b64_tr_b16 v[94:95], v109 offset:25088
    v_mfma_f32_16x16x32_bf16 v[20:23], v[68:71], a[4:7], 0
    s_waitcnt lgkmcnt(8)
    v_mfma_f32_16x16x32_bf16 v[8:11], v[72:75], a[0:3], 0
    ds_read_b64_tr_b16 v[64:65], v106 offset:18432
    ds_read_b64_tr_b16 v[66:67], v106 offset:18944
    v_mfma_f32_16x16x32_bf16 v[24:27], v[72:75], a[4:7], 0
    buffer_atomic_add_f32 v48, v241, s[44:47], s94 offen offset:0
    v_mfma_f32_16x16x32_bf16 v[12:15], v[76:79], a[0:3], 0
    ds_read_b64_tr_b16 v[68:69], v107 offset:18432
    ds_read_b64_tr_b16 v[70:71], v107 offset:18944
    v_mfma_f32_16x16x32_bf16 v[28:31], v[76:79], a[4:7], 0
    s_waitcnt lgkmcnt(8)
    buffer_atomic_add_f32 v49, v241, s[44:47], s94 offen offset:256
    v_mfma_f32_16x16x32_bf16 v[0:3], v[80:83], a[8:11], v[0:3]
    ds_read_b64_tr_b16 v[72:73], v108 offset:18432
    ds_read_b64_tr_b16 v[74:75], v108 offset:18944
    v_mfma_f32_16x16x32_bf16 v[16:19], v[80:83], a[12:15], v[16:19]
    buffer_atomic_add_f32 v50, v241, s[44:47], s94 offen offset:512
    v_mfma_f32_16x16x32_bf16 v[4:7], v[84:87], a[8:11], v[4:7]
    ds_read_b64_tr_b16 v[76:77], v109 offset:18432
    ds_read_b64_tr_b16 v[78:79], v109 offset:18944
    v_mfma_f32_16x16x32_bf16 v[20:23], v[84:87], a[12:15], v[20:23]
    s_waitcnt lgkmcnt(8)
    buffer_atomic_add_f32 v51, v241, s[44:47], s94 offen offset:768
    v_mfma_f32_16x16x32_bf16 v[8:11], v[88:91], a[8:11], v[8:11]
    ds_read_b64_tr_b16 v[80:81], v106 offset:26624
    ds_read_b64_tr_b16 v[82:83], v106 offset:27136
    v_mfma_f32_16x16x32_bf16 v[24:27], v[88:91], a[12:15], v[24:27]
    buffer_atomic_add_f32 v52, v241, s[44:47], s94 offen offset:1024
    v_mfma_f32_16x16x32_bf16 v[12:15], v[92:95], a[8:11], v[12:15]
    ds_read_b64_tr_b16 v[84:85], v107 offset:26624
    ds_read_b64_tr_b16 v[86:87], v107 offset:27136
    v_mfma_f32_16x16x32_bf16 v[28:31], v[92:95], a[12:15], v[28:31]
    s_waitcnt lgkmcnt(8)
    buffer_atomic_add_f32 v53, v241, s[44:47], s94 offen offset:1280
    v_mfma_f32_16x16x32_bf16 v[0:3], v[64:67], a[16:19], v[0:3]
    ds_read_b64_tr_b16 v[88:89], v108 offset:26624
    ds_read_b64_tr_b16 v[90:91], v108 offset:27136
    v_mfma_f32_16x16x32_bf16 v[16:19], v[64:67], a[20:23], v[16:19]
    buffer_atomic_add_f32 v54, v241, s[44:47], s94 offen offset:1536
    v_mfma_f32_16x16x32_bf16 v[4:7], v[68:71], a[16:19], v[4:7]
    ds_read_b64_tr_b16 v[92:93], v109 offset:26624
    ds_read_b64_tr_b16 v[94:95], v109 offset:27136
    v_mfma_f32_16x16x32_bf16 v[20:23], v[68:71], a[20:23], v[20:23]
    s_waitcnt lgkmcnt(8)
    buffer_atomic_add_f32 v55, v241, s[44:47], s94 offen offset:1792
    v_mfma_f32_16x16x32_bf16 v[8:11], v[72:75], a[16:19], v[8:11]
    ds_read_b64_tr_b16 v[64:65], v106 offset:32768
    ds_read_b64_tr_b16 v[66:67], v106 offset:33280
    v_mfma_f32_16x16x32_bf16 v[24:27], v[72:75], a[20:23], v[24:27]
    v_cndmask_b32 v56, v56, v57, vcc
    v_cndmask_b32 v56, v56, v58, s[68:69]
    v_mfma_f32_16x16x32_bf16 v[12:15], v[76:79], a[16:19], v[12:15]
    ds_read_b64_tr_b16 v[68:69], v107 offset:32768
    ds_read_b64_tr_b16 v[70:71], v107 offset:33280
    v_mfma_f32_16x16x32_bf16 v[28:31], v[76:79], a[20:23], v[28:31]
    s_waitcnt lgkmcnt(8)
    v_cndmask_b32 v56, v56, v59, s[100:101]
    v_mfma_f32_16x16x32_bf16 v[0:3], v[80:83], a[24:27], v[0:3]
    ds_read_b64_tr_b16 v[72:73], v108 offset:32768
    ds_read_b64_tr_b16 v[74:75], v108 offset:33280
    v_mfma_f32_16x16x32_bf16 v[16:19], v[80:83], a[28:31], v[16:19]
    buffer_atomic_add_f32 v56, v242, s[44:47], s95 offen
    v_mfma_f32_16x16x32_bf16 v[4:7], v[84:87], a[24:27], v[4:7]
    s_nop 1
    ds_read_b64_tr_b16 v[76:77], v109 offset:32768
    ds_read_b64_tr_b16 v[78:79], v109 offset:33280
    v_mfma_f32_16x16x32_bf16 v[20:23], v[84:87], a[28:31], v[20:23]
    s_waitcnt lgkmcnt(8)
    v_add_f32_dpp v62, v62, v62 row_ror:8 row_mask:0xf bank_mask:0xf
    v_mfma_f32_16x16x32_bf16 v[8:11], v[88:91], a[24:27], v[8:11]
    s_nop 1
    ds_read_b64_tr_b16 v[80:81], v106 offset:40960
    ds_read_b64_tr_b16 v[82:83], v106 offset:41472
    v_mfma_f32_16x16x32_bf16 v[24:27], v[88:91], a[28:31], v[24:27]
    v_add_f32_dpp v62, v62, v62 row_ror:4 row_mask:0xf bank_mask:0xf
    v_mfma_f32_16x16x32_bf16 v[12:15], v[92:95], a[24:27], v[12:15]
    s_nop 1
    ds_read_b64_tr_b16 v[84:85], v107 offset:40960
    ds_read_b64_tr_b16 v[86:87], v107 offset:41472
    v_mfma_f32_16x16x32_bf16 v[28:31], v[92:95], a[28:31], v[28:31]
    s_waitcnt lgkmcnt(8)
    v_add_f32_dpp v62, v62, v62 row_ror:2 row_mask:0xf bank_mask:0xf
    v_mfma_f32_16x16x32_bf16 v[0:3], v[64:67], a[32:35], v[0:3]
    s_nop 1
    ds_read_b64_tr_b16 v[88:89], v108 offset:40960
    ds_read_b64_tr_b16 v[90:91], v108 offset:41472
    v_mfma_f32_16x16x32_bf16 v[16:19], v[64:67], a[36:39], v[16:19]
    v_add_f32_dpp v62, v62, v62 row_ror:1 row_mask:0xf bank_mask:0xf
    v_mov_b32 v63, v62
    v_mfma_f32_16x16x32_bf16 v[4:7], v[68:71], a[32:35], v[4:7]
    s_nop 1
    ds_read_b64_tr_b16 v[92:93], v109 offset:40960
    ds_read_b64_tr_b16 v[94:95], v109 offset:41472
    v_mfma_f32_16x16x32_bf16 v[20:23], v[68:71], a[36:39], v[20:23]
    s_waitcnt lgkmcnt(8)
    v_permlane16_swap_b32 v62, v63
    v_add_f32 v62, v62, v63
    v_mfma_f32_16x16x32_bf16 v[8:11], v[72:75], a[32:35], v[8:11]
    ds_read_b64_tr_b16 v[64:65], v106 offset:34816
    ds_read_b64_tr_b16 v[66:67], v106 offset:35328
    v_mfma_f32_16x16x32_bf16 v[24:27], v[72:75], a[36:39], v[24:27]
    v_mov_b32 v63, v62
    v_mfma_f32_16x16x32_bf16 v[12:15], v[76:79], a[32:35], v[12:15]
    s_nop 1
    ds_read_b64_tr_b16 v[68:69], v107 offset:34816
    ds_read_b64_tr_b16 v[70:71], v107 offset:35328
    v_mfma_f32_16x16x32_bf16 v[28:31], v[76:79], a[36:39], v[28:31]
    s_waitcnt lgkmcnt(8)
    v_permlane32_swap_b32 v62, v63
    v_add_f32 v62, v62, v63
    v_mfma_f32_16x16x32_bf16 v[0:3], v[80:83], a[40:43], v[0:3]
    ds_read_b64_tr_b16 v[72:73], v108 offset:34816
    ds_read_b64_tr_b16 v[74:75], v108 offset:35328
    v_mfma_f32_16x16x32_bf16 v[16:19], v[80:83], a[44:47], v[16:19]
    v_mul_f32 v62, 0x3a800000, v62
    v_cvt_pk_bf16_f32 v62, v62, v62
    v_mfma_f32_16x16x32_bf16 v[4:7], v[84:87], a[40:43], v[4:7]
    ds_read_b64_tr_b16 v[76:77], v109 offset:34816
    ds_read_b64_tr_b16 v[78:79], v109 offset:35328
    v_mfma_f32_16x16x32_bf16 v[20:23], v[84:87], a[44:47], v[20:23]
    s_waitcnt lgkmcnt(8)
    buffer_store_short v62, v151, s[48:51], s98 offen sc1
    v_mfma_f32_16x16x32_bf16 v[8:11], v[88:91], a[40:43], v[8:11]
    s_bitcmp1_b32 s2, 0
    ds_read_b64_tr_b16 v[80:81], v106 offset:43008
    ds_read_b64_tr_b16 v[82:83], v106 offset:43520
    v_mfma_f32_16x16x32_bf16 v[24:27], v[88:91], a[44:47], v[24:27]
    s_cselect_b32 s64, s14, s12
    s_cselect_b32 s65, s15, s13
    s_cmp_lt_u32 s24, 3
    v_mfma_f32_16x16x32_bf16 v[12:15], v[92:95], a[40:43], v[12:15]
    s_cselect_b32 s66, 7340032, 0
    ds_read_b64_tr_b16 v[84:85], v107 offset:43008
    ds_read_b64_tr_b16 v[86:87], v107 offset:43520
    v_mfma_f32_16x16x32_bf16 v[28:31], v[92:95], a[44:47], v[28:31]
    s_waitcnt lgkmcnt(8)
    s_mov_b32 s67, 0x20000
    s_add_u32 s52, s24, 0
    v_mfma_f32_16x16x32_bf16 v[0:3], v[64:67], a[48:51], v[0:3]
    s_lshl_b32 s52, s52, 7
    ds_read_b64_tr_b16 v[88:89], v108 offset:43008
    ds_read_b64_tr_b16 v[90:91], v108 offset:43520
    v_mfma_f32_16x16x32_bf16 v[16:19], v[64:67], a[52:55], v[16:19]
    s_lshr_b32 s53, s2, 1
    s_add_u32 s52, s52, s53
    s_lshl_b32 s52, s52, 13
    v_mfma_f32_16x16x32_bf16 v[4:7], v[68:71], a[48:51], v[4:7]
Lpad_4:
    s_cbranch_execz Lpad_8
    ds_read_b64_tr_b16 v[92:93], v109 offset:43008
    ds_read_b64_tr_b16 v[94:95], v109 offset:43520
    v_mfma_f32_16x16x32_bf16 v[20:23], v[68:71], a[52:55], v[20:23]
    s_waitcnt vmcnt(10) lgkmcnt(8)
    s_barrier
    buffer_load_dword v117, v116, s[64:67], s52 offen
    v_mfma_f32_16x16x32_bf16 v[8:11], v[72:75], a[48:51], v[8:11]
    s_lshr_b32 s27, s24, 1
    ds_read_b64_tr_b16 v[64:65], v110 offset:32768
    ds_read_b64_tr_b16 v[66:67], v110 offset:33280
    v_mfma_f32_16x16x32_bf16 v[24:27], v[72:75], a[52:55], v[24:27]
    s_and_b32 s28, s24, 1
    s_lshl_b32 s28, s28, 3
    s_add_u32 s28, s28, 131072
    v_mfma_f32_16x16x32_bf16 v[12:15], v[76:79], a[48:51], v[12:15]
    s_lshl_b32 s55, s27, 11
    ds_read_b64_tr_b16 v[68:69], v110 offset:40960
    ds_read_b64_tr_b16 v[70:71], v110 offset:41472
    v_mfma_f32_16x16x32_bf16 v[28:31], v[76:79], a[52:55], v[28:31]
    s_waitcnt lgkmcnt(8)
    s_add_u32 s55, s55, s28
    s_lshl_b32 s27, s27, 6
    v_mfma_f32_16x16x32_bf16 v[0:3], v[80:83], a[56:59], v[0:3]
    s_add_u32 s27, s27, s28
    ds_read_b64_tr_b16 v[72:73], v110 offset:34816
    ds_read_b64_tr_b16 v[74:75], v110 offset:35328
    v_mfma_f32_16x16x32_bf16 v[16:19], v[80:83], a[60:63], v[16:19]
    v_add_u32 v232, s55, v98
    v_add_u32 v233, s27, v243
    v_mfma_f32_16x16x32_bf16 v[4:7], v[84:87], a[56:59], v[4:7]
    ds_read_b64_tr_b16 v[76:77], v110 offset:43008
    ds_read_b64_tr_b16 v[78:79], v110 offset:43520
    v_mfma_f32_16x16x32_bf16 v[20:23], v[84:87], a[60:63], v[20:23]
    s_waitcnt lgkmcnt(8)
    v_add_u32 v234, 131072, v98
    v_add_u32 v235, 131072, v243
    v_mfma_f32_16x16x32_bf16 v[8:11], v[88:91], a[56:59], v[8:11]
    s_lshl_b32 s27, s30, 16
    ds_read_b64_tr_b16 v[80:81], v110 offset:49152
    ds_read_b64_tr_b16 v[82:83], v110 offset:49664
    v_mfma_f32_16x16x32_bf16 v[24:27], v[88:91], a[60:63], v[24:27]
    s_lshl_b32 s28, s26, 12
    s_add_u32 s27, s27, s28
    s_add_u32 s27, s27, 8388608
    v_mfma_f32_16x16x32_bf16 v[12:15], v[92:95], a[56:59], v[12:15]
    s_add_u32 s40, s22, s27
    ds_read_b64_tr_b16 v[84:85], v110 offset:57344
    ds_read_b64_tr_b16 v[86:87], v110 offset:57856
    v_mfma_f32_16x16x32_bf16 v[28:31], v[92:95], a[60:63], v[28:31]
    s_waitcnt lgkmcnt(8)
    s_addc_u32 s41, s23, 0
    s_mov_b32 s42, 33558656
    v_mfma_f32_16x16x32_bf16 v[0:3], v[64:67], a[64:67], v[0:3]
    s_lshl_b32 s96, s25, 7
    ds_read_b64_tr_b16 v[88:89], v110 offset:51200
    ds_read_b64_tr_b16 v[90:91], v110 offset:51712
    v_mfma_f32_16x16x32_bf16 v[16:19], v[64:67], a[68:71], v[16:19]
    s_add_u32 s96, s96, 786432
    v_mbcnt_lo_u32_b32 v100, -1, 0
    v_mbcnt_hi_u32_b32 v100, -1, v100
    v_mfma_f32_16x16x32_bf16 v[0:3], v[68:71], a[72:75], v[0:3]
    s_and_b32 s25, s2, 1
    ds_read_b64_tr_b16 v[92:93], v110 offset:59392
    ds_read_b64_tr_b16 v[94:95], v110 offset:59904
    v_mfma_f32_16x16x32_bf16 v[16:19], v[68:71], a[76:79], v[16:19]
    s_waitcnt lgkmcnt(8)
    s_lshl_b32 s25, s25, 3
    s_and_b32 s98, s2, 2
    v_mfma_f32_16x16x32_bf16 v[0:3], v[72:75], a[80:83], v[0:3]
    s_lshl_b32 s98, s98, 1
    ds_read_b64_tr_b16 v[64:65], v110 offset:16384
    ds_read_b64_tr_b16 v[66:67], v110 offset:16896
    v_mfma_f32_16x16x32_bf16 v[16:19], v[72:75], a[84:87], v[16:19]
    s_add_u32 s25, s25, s98
    s_bfe_u32 s98, s2, 0x20003
    s_add_u32 s25, s25, s98
    v_mfma_f32_16x16x32_bf16 v[0:3], v[76:79], a[88:91], v[0:3]
    s_and_b32 s26, s2, 4
    ds_read_b64_tr_b16 v[68:69], v110 offset:24576
    ds_read_b64_tr_b16 v[70:71], v110 offset:25088
    v_mfma_f32_16x16x32_bf16 v[16:19], v[76:79], a[92:95], v[16:19]
    s_waitcnt lgkmcnt(8)
    s_lshl_b32 s26, s26, 1
    s_lshr_b32 s98, s2, 5
    v_mfma_f32_16x16x32_bf16 v[0:3], v[80:83], a[96:99], v[0:3]
    s_add_u32 s26, s26, s98
    ds_read_b64_tr_b16 v[72:73], v110 offset:18432
    ds_read_b64_tr_b16 v[74:75], v110 offset:18944
    v_mfma_f32_16x16x32_bf16 v[16:19], v[80:83], a[100:103], v[16:19]
    s_lshl_b32 s30, s25, 2
    s_add_u32 s30, s30, s24
    v_lshrrev_b32 v152, 3, v100
    v_mfma_f32_16x16x32_bf16 v[0:3], v[84:87], a[104:107], v[0:3]
    ds_read_b64_tr_b16 v[76:77], v110 offset:26624
    ds_read_b64_tr_b16 v[78:79], v110 offset:27136
    v_mfma_f32_16x16x32_bf16 v[16:19], v[84:87], a[108:111], v[16:19]
    s_waitcnt lgkmcnt(8)
    v_mul_u32_u24 v102, 2048, v152
    v_lshrrev_b32 v152, 3, v100
    v_mfma_f32_16x16x32_bf16 v[0:3], v[88:91], a[112:115], v[0:3]
    ds_read_b64_tr_b16 v[80:81], v106 offset:49152
    ds_read_b64_tr_b16 v[82:83], v106 offset:49664
    v_mfma_f32_16x16x32_bf16 v[16:19], v[88:91], a[116:119], v[16:19]
    v_and_b32 v152, 6, v152
    v_and_b32 v153, 7, v100
    v_mfma_f32_16x16x32_bf16 v[0:3], v[92:95], a[120:123], v[0:3]
    ds_read_b64_tr_b16 v[84:85], v106 offset:57344
    ds_read_b64_tr_b16 v[86:87], v106 offset:57856
    v_mfma_f32_16x16x32_bf16 v[16:19], v[92:95], a[124:127], v[16:19]
    s_waitcnt lgkmcnt(8)
    v_xor_b32 v152, v152, v153
    v_lshl_add_u32 v102, v152, 4, v102
    v_mfma_f32_16x16x32_bf16 v[0:3], v[64:67], a[128:131], v[0:3]
    s_lshl_b32 s98, s24, 15
    ds_read_b64_tr_b16 v[88:89], v106 offset:51200
    ds_read_b64_tr_b16 v[90:91], v106 offset:51712
    v_mfma_f32_16x16x32_bf16 v[16:19], v[64:67], a[132:135], v[16:19]
    v_add_u32 v102, s98, v102
    v_add_u32 v103, 15360, v102
    v_mfma_f32_16x16x32_bf16 v[0:3], v[68:71], a[136:139], v[0:3]
    s_lshl_b32 s29, s24, 11
    ds_read_b64_tr_b16 v[92:93], v106 offset:59392
    ds_read_b64_tr_b16 v[94:95], v106 offset:59904
    v_mfma_f32_16x16x32_bf16 v[16:19], v[68:71], a[140:143], v[16:19]
    s_waitcnt lgkmcnt(8)
    s_lshl_b32 s99, s26, 7
    s_add_u32 s32, s8, s99
    v_mfma_f32_16x16x32_bf16 v[0:3], v[72:75], a[144:147], v[0:3]
    s_addc_u32 s33, s9, 0
    ds_read_b64_tr_b16 v[64:65], v110 offset:0
    ds_read_b64_tr_b16 v[66:67], v110 offset:512
    v_mfma_f32_16x16x32_bf16 v[16:19], v[72:75], a[148:151], v[16:19]
    s_sub_u32 s34, 2097152, s99
    s_lshl_b32 s98, s30, 16
    s_add_u32 s98, s98, s99
    v_mfma_f32_16x16x32_bf16 v[0:3], v[76:79], a[152:155], v[0:3]
    s_add_u32 s56, s4, s98
    ds_read_b64_tr_b16 v[68:69], v110 offset:8192
    ds_read_b64_tr_b16 v[70:71], v110 offset:8704
    v_mfma_f32_16x16x32_bf16 v[16:19], v[76:79], a[156:159], v[16:19]
    s_waitcnt lgkmcnt(8)
    s_addc_u32 s57, s5, 0
    s_mov_b32 s58, 63616
    v_mfma_f32_16x16x32_bf16 v[0:3], v[80:83], a[160:163], v[0:3]
    s_mov_b32 s59, 0x20000
    ds_read_b64_tr_b16 v[72:73], v110 offset:2048
    ds_read_b64_tr_b16 v[74:75], v110 offset:2560
    v_mfma_f32_16x16x32_bf16 v[16:19], v[80:83], a[164:167], v[16:19]
    s_lshl_b32 s97, s24, 12
    s_add_u32 s97, s97, 139264
    v_lshrrev_b32 v152, 3, v100
    v_mfma_f32_16x16x32_bf16 v[0:3], v[84:87], a[168:171], v[0:3]
    ds_read_b64_tr_b16 v[76:77], v110 offset:10240
    ds_read_b64_tr_b16 v[78:79], v110 offset:10752
    v_mfma_f32_16x16x32_bf16 v[16:19], v[84:87], a[172:175], v[16:19]
    s_waitcnt lgkmcnt(8)
    v_lshlrev_b32 v153, 11, v152
    v_lshrrev_b32 v154, 4, v100
    v_mfma_f32_16x16x32_bf16 v[0:3], v[88:91], a[176:179], v[0:3]
    ds_read_b64_tr_b16 v[80:81], v106 offset:0
    ds_read_b64_tr_b16 v[82:83], v106 offset:512
    v_mfma_f32_16x16x32_bf16 v[16:19], v[88:91], a[180:183], v[16:19]
    v_and_b32 v155, 7, v100
    v_xor_b32 v155, v154, v155
    v_mfma_f32_16x16x32_bf16 v[0:3], v[92:95], a[184:187], v[0:3]
    ds_read_b64_tr_b16 v[84:85], v106 offset:8192
    ds_read_b64_tr_b16 v[86:87], v106 offset:8704
    v_mfma_f32_16x16x32_bf16 v[16:19], v[92:95], a[188:191], v[16:19]
    s_waitcnt lgkmcnt(8)
    v_lshl_add_u32 v156, v155, 4, v153
    v_xor_b32 v153, 64, v156
    v_mfma_f32_16x16x32_bf16 v[0:3], v[64:67], a[192:195], v[0:3]
    ds_read_b64_tr_b16 v[88:89], v106 offset:2048
    ds_read_b64_tr_b16 v[90:91], v106 offset:2560
    v_mfma_f32_16x16x32_bf16 v[16:19], v[64:67], a[196:199], v[16:19]
    v_add_u32 v157, 15360, v153
    v_add_u32 v158, 30720, v156
    v_mfma_f32_16x16x32_bf16 v[0:3], v[68:71], a[200:203], v[0:3]
    ds_read_b64_tr_b16 v[92:93], v106 offset:10240
    ds_read_b64_tr_b16 v[94:95], v106 offset:10752
    v_mfma_f32_16x16x32_bf16 v[16:19], v[68:71], a[204:207], v[16:19]
    s_waitcnt lgkmcnt(8)
    v_add_u32 v159, 46080, v153
    v_and_b32 v150, 7, v100
    v_mfma_f32_16x16x32_bf16 v[0:3], v[72:75], a[208:211], v[0:3]
    ds_read_b64_tr_b16 v[64:65], v111 offset:32768
    ds_read_b64_tr_b16 v[66:67], v111 offset:33280
    v_mfma_f32_16x16x32_bf16 v[16:19], v[72:75], a[212:215], v[16:19]
    v_lshlrev_b32 v150, 11, v150
    v_mfma_f32_16x16x32_bf16 v[0:3], v[76:79], a[216:219], v[0:3]
    s_lshr_b32 s98, s2, 3
    ds_read_b64_tr_b16 v[68:69], v111 offset:40960
    ds_read_b64_tr_b16 v[70:71], v111 offset:41472
    v_mfma_f32_16x16x32_bf16 v[16:19], v[76:79], a[220:223], v[16:19]
    s_waitcnt lgkmcnt(8)
    s_lshl_b32 s98, s98, 2
    s_add_u32 s98, s98, s24
    v_mfma_f32_16x16x32_bf16 v[0:3], v[80:83], a[224:227], v[0:3]
    s_lshl_b32 s98, s98, 14
    ds_read_b64_tr_b16 v[72:73], v111 offset:34816
    ds_read_b64_tr_b16 v[74:75], v111 offset:35328
    v_mfma_f32_16x16x32_bf16 v[16:19], v[80:83], a[228:231], v[16:19]
    s_and_b32 s99, s2, 4
    s_lshl_b32 s99, s99, 8
    s_add_u32 s98, s98, s99
    v_mfma_f32_16x16x32_bf16 v[0:3], v[84:87], a[232:235], v[0:3]
    s_add_u32 s98, s98, 384
    ds_read_b64_tr_b16 v[76:77], v111 offset:43008
    ds_read_b64_tr_b16 v[78:79], v111 offset:43520
    v_mfma_f32_16x16x32_bf16 v[16:19], v[84:87], a[236:239], v[16:19]
    s_waitcnt lgkmcnt(8)
    s_mov_b32 s36, s8
    s_mov_b32 s37, s9
    v_mfma_f32_16x16x32_bf16 v[0:3], v[88:91], a[240:243], v[0:3]
    s_mov_b32 s38, 2097152
    ds_read_b64_tr_b16 v[80:81], v111 offset:49152
    ds_read_b64_tr_b16 v[82:83], v111 offset:49664
    v_mfma_f32_16x16x32_bf16 v[16:19], v[88:91], a[244:247], v[16:19]
    buffer_load_dword v117, v150, s[36:39], s98 offen
    v_mfma_f32_16x16x32_bf16 v[0:3], v[92:95], a[248:251], v[0:3]
    ds_read_b64_tr_b16 v[84:85], v111 offset:57344
    ds_read_b64_tr_b16 v[86:87], v111 offset:57856
    v_mfma_f32_16x16x32_bf16 v[16:19], v[92:95], a[252:255], v[16:19]
    s_waitcnt lgkmcnt(8)
    v_mfma_f32_16x16x32_bf16 v[4:7], v[64:67], a[64:67], v[4:7]
    ds_read_b64_tr_b16 v[88:89], v111 offset:51200
    ds_read_b64_tr_b16 v[90:91], v111 offset:51712
    v_mfma_f32_16x16x32_bf16 v[20:23], v[64:67], a[68:71], v[20:23]
    v_mfma_f32_16x16x32_bf16 v[4:7], v[68:71], a[72:75], v[4:7]
    ds_read_b64_tr_b16 v[92:93], v111 offset:59392
    ds_read_b64_tr_b16 v[94:95], v111 offset:59904
    v_mfma_f32_16x16x32_bf16 v[20:23], v[68:71], a[76:79], v[20:23]
    s_waitcnt lgkmcnt(8)
    v_mfma_f32_16x16x32_bf16 v[4:7], v[72:75], a[80:83], v[4:7]
    ds_read_b64_tr_b16 v[64:65], v111 offset:16384
    ds_read_b64_tr_b16 v[66:67], v111 offset:16896
    v_mfma_f32_16x16x32_bf16 v[20:23], v[72:75], a[84:87], v[20:23]
    v_fma_f32 v0, v160, v144, v0
    v_fma_f32 v1, v161, v144, v1
    v_fma_f32 v2, v162, v144, v2
    v_mfma_f32_16x16x32_bf16 v[4:7], v[76:79], a[88:91], v[4:7]
    ds_read_b64_tr_b16 v[68:69], v111 offset:24576
    ds_read_b64_tr_b16 v[70:71], v111 offset:25088
    v_mfma_f32_16x16x32_bf16 v[20:23], v[76:79], a[92:95], v[20:23]
    s_waitcnt lgkmcnt(8)
    v_fma_f32 v3, v163, v144, v3
    v_fma_f32 v16, v160, v145, v16
    v_mfma_f32_16x16x32_bf16 v[4:7], v[80:83], a[96:99], v[4:7]
    ds_read_b64_tr_b16 v[72:73], v111 offset:18432
    ds_read_b64_tr_b16 v[74:75], v111 offset:18944
    v_mfma_f32_16x16x32_bf16 v[20:23], v[80:83], a[100:103], v[20:23]
    v_fma_f32 v17, v161, v145, v17
    v_fma_f32 v18, v162, v145, v18
    v_fma_f32 v19, v163, v145, v19
    v_mfma_f32_16x16x32_bf16 v[4:7], v[84:87], a[104:107], v[4:7]
    ds_read_b64_tr_b16 v[76:77], v111 offset:26624
    ds_read_b64_tr_b16 v[78:79], v111 offset:27136
    v_mfma_f32_16x16x32_bf16 v[20:23], v[84:87], a[108:111], v[20:23]
    s_waitcnt lgkmcnt(8)
    v_mul_f32 v208, v0, v148
    v_mul_f32 v209, v1, v148
    v_mfma_f32_16x16x32_bf16 v[4:7], v[88:91], a[112:115], v[4:7]
    ds_read_b64_tr_b16 v[80:81], v107 offset:49152
    ds_read_b64_tr_b16 v[82:83], v107 offset:49664
    v_mfma_f32_16x16x32_bf16 v[20:23], v[88:91], a[116:119], v[20:23]
    v_mul_f32 v210, v2, v148
    v_mul_f32 v211, v3, v148
    v_mul_f32 v212, v16, v149
    v_mfma_f32_16x16x32_bf16 v[4:7], v[92:95], a[120:123], v[4:7]
    ds_read_b64_tr_b16 v[84:85], v107 offset:57344
    ds_read_b64_tr_b16 v[86:87], v107 offset:57856
    v_mfma_f32_16x16x32_bf16 v[20:23], v[92:95], a[124:127], v[20:23]
    s_waitcnt lgkmcnt(8)
    v_mul_f32 v213, v17, v149
    v_mul_f32 v214, v18, v149
    v_mfma_f32_16x16x32_bf16 v[4:7], v[64:67], a[128:131], v[4:7]
    ds_read_b64_tr_b16 v[88:89], v107 offset:51200
    ds_read_b64_tr_b16 v[90:91], v107 offset:51712
    v_mfma_f32_16x16x32_bf16 v[20:23], v[64:67], a[132:135], v[20:23]
    v_mul_f32 v215, v19, v149
    v_exp_f32 v208, v208 clamp
    v_mfma_f32_16x16x32_bf16 v[4:7], v[68:71], a[136:139], v[4:7]
    ds_read_b64_tr_b16 v[92:93], v107 offset:59392
    ds_read_b64_tr_b16 v[94:95], v107 offset:59904
    v_mfma_f32_16x16x32_bf16 v[20:23], v[68:71], a[140:143], v[20:23]
    s_waitcnt lgkmcnt(8)
    v_exp_f32 v209, v209 clamp
    v_mfma_f32_16x16x32_bf16 v[4:7], v[72:75], a[144:147], v[4:7]
    ds_read_b64_tr_b16 v[64:65], v111 offset:0
    ds_read_b64_tr_b16 v[66:67], v111 offset:512
    v_mfma_f32_16x16x32_bf16 v[20:23], v[72:75], a[148:151], v[20:23]
    v_exp_f32 v210, v210 clamp
    v_mfma_f32_16x16x32_bf16 v[4:7], v[76:79], a[152:155], v[4:7]
    ds_read_b64_tr_b16 v[68:69], v111 offset:8192
    ds_read_b64_tr_b16 v[70:71], v111 offset:8704
    v_mfma_f32_16x16x32_bf16 v[20:23], v[76:79], a[156:159], v[20:23]
    s_waitcnt lgkmcnt(8)
    v_exp_f32 v211, v211 clamp
    v_mfma_f32_16x16x32_bf16 v[4:7], v[80:83], a[160:163], v[4:7]
    ds_read_b64_tr_b16 v[72:73], v111 offset:2048
    ds_read_b64_tr_b16 v[74:75], v111 offset:2560
    v_mfma_f32_16x16x32_bf16 v[20:23], v[80:83], a[164:167], v[20:23]
    v_exp_f32 v212, v212 clamp
    v_mfma_f32_16x16x32_bf16 v[4:7], v[84:87], a[168:171], v[4:7]
    ds_read_b64_tr_b16 v[76:77], v111 offset:10240
    ds_read_b64_tr_b16 v[78:79], v111 offset:10752
    v_mfma_f32_16x16x32_bf16 v[20:23], v[84:87], a[172:175], v[20:23]
    s_waitcnt vmcnt(2) lgkmcnt(8)
    s_barrier
    buffer_atomic_add v250, v119, s[44:47], s63 offen sc1
    v_mfma_f32_16x16x32_bf16 v[4:7], v[88:91], a[176:179], v[4:7]
    s_mov_b32 m0, s97
    ds_read_b64_tr_b16 v[80:81], v107 offset:0
    ds_read_b64_tr_b16 v[82:83], v107 offset:512
    v_mfma_f32_16x16x32_bf16 v[20:23], v[88:91], a[180:183], v[20:23]
    s_nop 0
    buffer_load_dwordx4 v156, s[56:59], 0 offen offset:0 lds
    v_mfma_f32_16x16x32_bf16 v[4:7], v[92:95], a[184:187], v[4:7]
    ds_read_b64_tr_b16 v[84:85], v107 offset:8192
    ds_read_b64_tr_b16 v[86:87], v107 offset:8704
    v_mfma_f32_16x16x32_bf16 v[20:23], v[92:95], a[188:191], v[20:23]
    s_waitcnt lgkmcnt(8)
    buffer_load_dwordx4 v157, s[56:59], 0 offen offset:1024 lds
    v_mfma_f32_16x16x32_bf16 v[4:7], v[64:67], a[192:195], v[4:7]
    ds_read_b64_tr_b16 v[88:89], v107 offset:2048
    ds_read_b64_tr_b16 v[90:91], v107 offset:2560
    v_mfma_f32_16x16x32_bf16 v[20:23], v[64:67], a[196:199], v[20:23]
    buffer_load_dwordx4 v158, s[56:59], 0 offen offset:2048 lds
    v_mfma_f32_16x16x32_bf16 v[4:7], v[68:71], a[200:203], v[4:7]
    ds_read_b64_tr_b16 v[92:93], v107 offset:10240
    ds_read_b64_tr_b16 v[94:95], v107 offset:10752
    v_mfma_f32_16x16x32_bf16 v[20:23], v[68:71], a[204:207], v[20:23]
    s_waitcnt lgkmcnt(8)
    buffer_load_dwordx4 v159, s[56:59], 0 offen offset:3072 lds
    v_mfma_f32_16x16x32_bf16 v[4:7], v[72:75], a[208:211], v[4:7]
    s_mov_b32 s31, 262144
    ds_read_b64_tr_b16 v[64:65], v112 offset:32768
    ds_read_b64_tr_b16 v[66:67], v112 offset:33280
    v_mfma_f32_16x16x32_bf16 v[20:23], v[72:75], a[212:215], v[20:23]
    s_add_u32 m0, s29, 16384
    s_nop 0
    v_mfma_f32_16x16x32_bf16 v[4:7], v[76:79], a[216:219], v[4:7]
    ds_read_b64_tr_b16 v[68:69], v112 offset:40960
    ds_read_b64_tr_b16 v[70:71], v112 offset:41472
    v_mfma_f32_16x16x32_bf16 v[20:23], v[76:79], a[220:223], v[20:23]
    s_waitcnt lgkmcnt(8)
    buffer_load_dwordx4 v102, s[32:35], s31 offen offset:0 lds
    v_mfma_f32_16x16x32_bf16 v[4:7], v[80:83], a[224:227], v[4:7]
    ds_read_b64_tr_b16 v[72:73], v112 offset:34816
    ds_read_b64_tr_b16 v[74:75], v112 offset:35328
    v_mfma_f32_16x16x32_bf16 v[20:23], v[80:83], a[228:231], v[20:23]
    buffer_load_dwordx4 v103, s[32:35], s31 offen offset:1024 lds
    v_mfma_f32_16x16x32_bf16 v[4:7], v[84:87], a[232:235], v[4:7]
    s_mov_b32 s31, 393216
    ds_read_b64_tr_b16 v[76:77], v112 offset:43008
    ds_read_b64_tr_b16 v[78:79], v112 offset:43520
    v_mfma_f32_16x16x32_bf16 v[20:23], v[84:87], a[236:239], v[20:23]
    s_waitcnt lgkmcnt(8)
    s_add_u32 m0, s29, 24576
    s_nop 0
    v_mfma_f32_16x16x32_bf16 v[4:7], v[88:91], a[240:243], v[4:7]
    ds_read_b64_tr_b16 v[80:81], v112 offset:49152
    ds_read_b64_tr_b16 v[82:83], v112 offset:49664
    v_mfma_f32_16x16x32_bf16 v[20:23], v[88:91], a[244:247], v[20:23]
    buffer_load_dwordx4 v102, s[32:35], s31 offen offset:0 lds
    v_mfma_f32_16x16x32_bf16 v[4:7], v[92:95], a[248:251], v[4:7]
    ds_read_b64_tr_b16 v[84:85], v112 offset:57344
    ds_read_b64_tr_b16 v[86:87], v112 offset:57856
    v_mfma_f32_16x16x32_bf16 v[20:23], v[92:95], a[252:255], v[20:23]
    s_waitcnt lgkmcnt(8)
    buffer_load_dwordx4 v103, s[32:35], s31 offen offset:1024 lds
    v_mfma_f32_16x16x32_bf16 v[8:11], v[64:67], a[64:67], v[8:11]
    s_mov_b32 s31, 524288
    ds_read_b64_tr_b16 v[88:89], v112 offset:51200
    ds_read_b64_tr_b16 v[90:91], v112 offset:51712
    v_mfma_f32_16x16x32_bf16 v[24:27], v[64:67], a[68:71], v[24:27]
    s_add_u32 m0, s29, 32768
    s_nop 0
    v_mfma_f32_16x16x32_bf16 v[8:11], v[68:71], a[72:75], v[8:11]
    ds_read_b64_tr_b16 v[92:93], v112 offset:59392
    ds_read_b64_tr_b16 v[94:95], v112 offset:59904
    v_mfma_f32_16x16x32_bf16 v[24:27], v[68:71], a[76:79], v[24:27]
    s_waitcnt lgkmcnt(8)
    buffer_load_dwordx4 v102, s[32:35], s31 offen offset:0 lds
    v_mfma_f32_16x16x32_bf16 v[8:11], v[72:75], a[80:83], v[8:11]
    ds_read_b64_tr_b16 v[64:65], v112 offset:16384
    ds_read_b64_tr_b16 v[66:67], v112 offset:16896
    v_mfma_f32_16x16x32_bf16 v[24:27], v[72:75], a[84:87], v[24:27]
    buffer_load_dwordx4 v103, s[32:35], s31 offen offset:1024 lds
    v_mfma_f32_16x16x32_bf16 v[8:11], v[76:79], a[88:91], v[8:11]
    s_mov_b32 s31, 655360
    ds_read_b64_tr_b16 v[68:69], v112 offset:24576
    ds_read_b64_tr_b16 v[70:71], v112 offset:25088
    v_mfma_f32_16x16x32_bf16 v[24:27], v[76:79], a[92:95], v[24:27]
    s_waitcnt lgkmcnt(8)
    s_add_u32 m0, s29, 40960
    s_nop 0
    v_mfma_f32_16x16x32_bf16 v[8:11], v[80:83], a[96:99], v[8:11]
    ds_read_b64_tr_b16 v[72:73], v112 offset:18432
    ds_read_b64_tr_b16 v[74:75], v112 offset:18944
    v_mfma_f32_16x16x32_bf16 v[24:27], v[80:83], a[100:103], v[24:27]
    buffer_load_dwordx4 v102, s[32:35], s31 offen offset:0 lds
    v_mfma_f32_16x16x32_bf16 v[8:11], v[84:87], a[104:107], v[8:11]
    ds_read_b64_tr_b16 v[76:77], v112 offset:26624
    ds_read_b64_tr_b16 v[78:79], v112 offset:27136
    v_mfma_f32_16x16x32_bf16 v[24:27], v[84:87], a[108:111], v[24:27]
    s_waitcnt lgkmcnt(8)
    buffer_load_dwordx4 v103, s[32:35], s31 offen offset:1024 lds
    v_mfma_f32_16x16x32_bf16 v[8:11], v[88:91], a[112:115], v[8:11]
    ds_read_b64_tr_b16 v[80:81], v108 offset:49152
    ds_read_b64_tr_b16 v[82:83], v108 offset:49664
    v_mfma_f32_16x16x32_bf16 v[24:27], v[88:91], a[116:119], v[24:27]
    v_mov_b32 v251, 0
    v_mfma_f32_16x16x32_bf16 v[8:11], v[92:95], a[120:123], v[8:11]
    ds_read_b64_tr_b16 v[84:85], v108 offset:57344
    ds_read_b64_tr_b16 v[86:87], v108 offset:57856
    v_mfma_f32_16x16x32_bf16 v[24:27], v[92:95], a[124:127], v[24:27]
    s_waitcnt lgkmcnt(8)
    buffer_atomic_or v251, v151, s[44:47], s63 offen sc0 sc1
    v_mfma_f32_16x16x32_bf16 v[8:11], v[64:67], a[128:131], v[8:11]
    ds_read_b64_tr_b16 v[88:89], v108 offset:51200
    ds_read_b64_tr_b16 v[90:91], v108 offset:51712
    v_mfma_f32_16x16x32_bf16 v[24:27], v[64:67], a[132:135], v[24:27]
    v_exp_f32 v213, v213 clamp
    v_mfma_f32_16x16x32_bf16 v[8:11], v[68:71], a[136:139], v[8:11]
    ds_read_b64_tr_b16 v[92:93], v108 offset:59392
    ds_read_b64_tr_b16 v[94:95], v108 offset:59904
    v_mfma_f32_16x16x32_bf16 v[24:27], v[68:71], a[140:143], v[24:27]
    s_waitcnt lgkmcnt(8)
    v_exp_f32 v214, v214 clamp
    v_mfma_f32_16x16x32_bf16 v[8:11], v[72:75], a[144:147], v[8:11]
    ds_read_b64_tr_b16 v[64:65], v112 offset:0
    ds_read_b64_tr_b16 v[66:67], v112 offset:512
    v_mfma_f32_16x16x32_bf16 v[24:27], v[72:75], a[148:151], v[24:27]
    v_exp_f32 v215, v215 clamp
    v_fma_f32 v0, v0, v146, s0
    v_mfma_f32_16x16x32_bf16 v[8:11], v[76:79], a[152:155], v[8:11]
    ds_read_b64_tr_b16 v[68:69], v112 offset:8192
    ds_read_b64_tr_b16 v[70:71], v112 offset:8704
    v_mfma_f32_16x16x32_bf16 v[24:27], v[76:79], a[156:159], v[24:27]
    s_waitcnt lgkmcnt(8)
    v_fma_f32 v1, v1, v146, s1
    v_fma_f32 v2, v2, v146, s0
    v_mfma_f32_16x16x32_bf16 v[8:11], v[80:83], a[160:163], v[8:11]
    ds_read_b64_tr_b16 v[72:73], v112 offset:2048
    ds_read_b64_tr_b16 v[74:75], v112 offset:2560
    v_mfma_f32_16x16x32_bf16 v[24:27], v[80:83], a[164:167], v[24:27]
    v_fma_f32 v3, v3, v146, s1
    v_fma_f32 v16, v16, v147, s0
    v_fma_f32 v17, v17, v147, s1
    v_mfma_f32_16x16x32_bf16 v[8:11], v[84:87], a[168:171], v[8:11]
    ds_read_b64_tr_b16 v[76:77], v112 offset:10240
    ds_read_b64_tr_b16 v[78:79], v112 offset:10752
    v_mfma_f32_16x16x32_bf16 v[24:27], v[84:87], a[172:175], v[24:27]
    s_waitcnt lgkmcnt(8)
    v_fma_f32 v18, v18, v147, s0
    v_fma_f32 v19, v19, v147, s1
    v_mfma_f32_16x16x32_bf16 v[8:11], v[88:91], a[176:179], v[8:11]
    ds_read_b64_tr_b16 v[80:81], v108 offset:0
    ds_read_b64_tr_b16 v[82:83], v108 offset:512
    v_mfma_f32_16x16x32_bf16 v[24:27], v[88:91], a[180:183], v[24:27]
    v_max_f32 v0, v0, v208
    v_max_f32 v1, v1, v209
    v_max_f32 v2, v2, v210
    v_mfma_f32_16x16x32_bf16 v[8:11], v[92:95], a[184:187], v[8:11]
    ds_read_b64_tr_b16 v[84:85], v108 offset:8192
    ds_read_b64_tr_b16 v[86:87], v108 offset:8704
    v_mfma_f32_16x16x32_bf16 v[24:27], v[92:95], a[188:191], v[24:27]
    s_waitcnt lgkmcnt(8)
    v_max_f32 v3, v3, v211
    v_max_f32 v16, v16, v212
    v_mfma_f32_16x16x32_bf16 v[8:11], v[64:67], a[192:195], v[8:11]
    ds_read_b64_tr_b16 v[88:89], v108 offset:2048
    ds_read_b64_tr_b16 v[90:91], v108 offset:2560
    v_mfma_f32_16x16x32_bf16 v[24:27], v[64:67], a[196:199], v[24:27]
    v_max_f32 v17, v17, v213
    v_max_f32 v18, v18, v214
    v_max_f32 v19, v19, v215
    v_mfma_f32_16x16x32_bf16 v[8:11], v[68:71], a[200:203], v[8:11]
    ds_read_b64_tr_b16 v[92:93], v108 offset:10240
    ds_read_b64_tr_b16 v[94:95], v108 offset:10752
    v_mfma_f32_16x16x32_bf16 v[24:27], v[68:71], a[204:207], v[24:27]
    s_waitcnt lgkmcnt(8)
    v_add_f32 v0, s60, v0
    v_add_f32 v1, s61, v1
    v_mfma_f32_16x16x32_bf16 v[8:11], v[72:75], a[208:211], v[8:11]
    ds_read_b64_tr_b16 v[64:65], v113 offset:32768
    ds_read_b64_tr_b16 v[66:67], v113 offset:33280
    v_mfma_f32_16x16x32_bf16 v[24:27], v[72:75], a[212:215], v[24:27]
    v_add_f32 v2, s60, v2
    v_add_f32 v3, s61, v3
    v_add_f32 v16, s60, v16
    v_mfma_f32_16x16x32_bf16 v[8:11], v[76:79], a[216:219], v[8:11]
    ds_read_b64_tr_b16 v[68:69], v113 offset:40960
    ds_read_b64_tr_b16 v[70:71], v113 offset:41472
    v_mfma_f32_16x16x32_bf16 v[24:27], v[76:79], a[220:223], v[24:27]
    s_waitcnt lgkmcnt(8)
    v_add_f32 v17, s61, v17
    v_add_f32 v18, s60, v18
    v_mfma_f32_16x16x32_bf16 v[8:11], v[80:83], a[224:227], v[8:11]
    ds_read_b64_tr_b16 v[72:73], v113 offset:34816
    ds_read_b64_tr_b16 v[74:75], v113 offset:35328
    v_mfma_f32_16x16x32_bf16 v[24:27], v[80:83], a[228:231], v[24:27]
    v_add_f32 v19, s61, v19
    v_cvt_pk_bf16_f32 v32, v0, v1
    v_cvt_pk_bf16_f32 v33, v2, v3
    v_mfma_f32_16x16x32_bf16 v[8:11], v[84:87], a[232:235], v[8:11]
    ds_read_b64_tr_b16 v[76:77], v113 offset:43008
    ds_read_b64_tr_b16 v[78:79], v113 offset:43520
    v_mfma_f32_16x16x32_bf16 v[24:27], v[84:87], a[236:239], v[24:27]
    s_waitcnt lgkmcnt(8)
    v_cvt_pk_bf16_f32 v40, v16, v17
    v_cvt_pk_bf16_f32 v41, v18, v19
    v_mfma_f32_16x16x32_bf16 v[8:11], v[88:91], a[240:243], v[8:11]
    ds_read_b64_tr_b16 v[80:81], v113 offset:49152
    ds_read_b64_tr_b16 v[82:83], v113 offset:49664
    v_mfma_f32_16x16x32_bf16 v[24:27], v[88:91], a[244:247], v[24:27]
    s_waitcnt vmcnt(0)
    v_cmp_gt_u32 vcc, 16, v251
    s_mov_b32 s27, 0x80000
    s_and_b64 vcc, vcc, 1
    s_cbranch_scc0 Lok_6
Lspin_7:
    s_sleep 2
    v_mov_b32 v251, 0
    buffer_atomic_or v251, v151, s[44:47], s63 offen sc0 sc1
    s_waitcnt vmcnt(0)
    v_cmp_gt_u32 vcc, 16, v251
    s_sub_u32 s27, s27, 1
    s_cbranch_scc1 Lok_6
    s_and_b64 vcc, vcc, 1
    s_cbranch_scc1 Lspin_7
Lok_6:
    buffer_load_dword v48, v241, s[44:47], s94 offen offset:0 sc1
    v_mfma_f32_16x16x32_bf16 v[8:11], v[92:95], a[248:251], v[8:11]
    ds_read_b64_tr_b16 v[84:85], v113 offset:57344
    ds_read_b64_tr_b16 v[86:87], v113 offset:57856
    v_mfma_f32_16x16x32_bf16 v[24:27], v[92:95], a[252:255], v[24:27]
    s_waitcnt lgkmcnt(8)
    buffer_load_dword v49, v241, s[44:47], s94 offen offset:256 sc1
    v_mfma_f32_16x16x32_bf16 v[12:15], v[64:67], a[64:67], v[12:15]
    ds_read_b64_tr_b16 v[88:89], v113 offset:51200
    ds_read_b64_tr_b16 v[90:91], v113 offset:51712
    v_mfma_f32_16x16x32_bf16 v[28:31], v[64:67], a[68:71], v[28:31]
    buffer_load_dword v50, v241, s[44:47], s94 offen offset:512 sc1
    v_mfma_f32_16x16x32_bf16 v[12:15], v[68:71], a[72:75], v[12:15]
    ds_read_b64_tr_b16 v[92:93], v113 offset:59392
    ds_read_b64_tr_b16 v[94:95], v113 offset:59904
    v_mfma_f32_16x16x32_bf16 v[28:31], v[68:71], a[76:79], v[28:31]
    s_waitcnt lgkmcnt(8)
    buffer_load_dword v51, v241, s[44:47], s94 offen offset:768 sc1
    v_mfma_f32_16x16x32_bf16 v[12:15], v[72:75], a[80:83], v[12:15]
    ds_read_b64_tr_b16 v[64:65], v113 offset:16384
    ds_read_b64_tr_b16 v[66:67], v113 offset:16896
    v_mfma_f32_16x16x32_bf16 v[28:31], v[72:75], a[84:87], v[28:31]
    buffer_load_dword v52, v241, s[44:47], s94 offen offset:1024 sc1
    v_mfma_f32_16x16x32_bf16 v[12:15], v[76:79], a[88:91], v[12:15]
    ds_read_b64_tr_b16 v[68:69], v113 offset:24576
    ds_read_b64_tr_b16 v[70:71], v113 offset:25088
    v_mfma_f32_16x16x32_bf16 v[28:31], v[76:79], a[92:95], v[28:31]
    s_waitcnt lgkmcnt(8)
    buffer_load_dword v53, v241, s[44:47], s94 offen offset:1280 sc1
    v_mfma_f32_16x16x32_bf16 v[12:15], v[80:83], a[96:99], v[12:15]
    ds_read_b64_tr_b16 v[72:73], v113 offset:18432
    ds_read_b64_tr_b16 v[74:75], v113 offset:18944
    v_mfma_f32_16x16x32_bf16 v[28:31], v[80:83], a[100:103], v[28:31]
    buffer_load_dword v54, v241, s[44:47], s94 offen offset:1536 sc1
    v_mfma_f32_16x16x32_bf16 v[12:15], v[84:87], a[104:107], v[12:15]
    ds_read_b64_tr_b16 v[76:77], v113 offset:26624
    ds_read_b64_tr_b16 v[78:79], v113 offset:27136
    v_mfma_f32_16x16x32_bf16 v[28:31], v[84:87], a[108:111], v[28:31]
    s_waitcnt lgkmcnt(8)
    buffer_load_dword v55, v241, s[44:47], s94 offen offset:1792 sc1
    v_mfma_f32_16x16x32_bf16 v[12:15], v[88:91], a[112:115], v[12:15]
    ds_read_b64_tr_b16 v[80:81], v109 offset:49152
    ds_read_b64_tr_b16 v[82:83], v109 offset:49664
    v_mfma_f32_16x16x32_bf16 v[28:31], v[88:91], a[116:119], v[28:31]
    buffer_load_dwordx4 v[56:59], v243, s[44:47], s95 offen sc1
    v_mfma_f32_16x16x32_bf16 v[12:15], v[92:95], a[120:123], v[12:15]
    ds_read_b64_tr_b16 v[84:85], v109 offset:57344
    ds_read_b64_tr_b16 v[86:87], v109 offset:57856
    v_mfma_f32_16x16x32_bf16 v[28:31], v[92:95], a[124:127], v[28:31]
    s_waitcnt lgkmcnt(8)
    v_mov_b32 v224, -1
    v_mov_b32 v225, -1
    v_mfma_f32_16x16x32_bf16 v[12:15], v[64:67], a[128:131], v[12:15]
    ds_read_b64_tr_b16 v[88:89], v109 offset:51200
    ds_read_b64_tr_b16 v[90:91], v109 offset:51712
    v_mfma_f32_16x16x32_bf16 v[28:31], v[64:67], a[132:135], v[28:31]
Lpad_5:
    s_cbranch_execz Lpad_9
    v_mov_b32 v226, -1
    v_mov_b32 v227, -1
    v_mfma_f32_16x16x32_bf16 v[12:15], v[68:71], a[136:139], v[12:15]
    s_lshl_b32 s99, s2, 2
    ds_read_b64_tr_b16 v[92:93], v109 offset:59392
    ds_read_b64_tr_b16 v[94:95], v109 offset:59904
    v_mfma_f32_16x16x32_bf16 v[28:31], v[68:71], a[140:143], v[28:31]
    s_waitcnt lgkmcnt(8)
    s_add_u32 s99, s99, s24
    s_lshl_b32 s99, s99, 12
    v_mfma_f32_16x16x32_bf16 v[12:15], v[72:75], a[144:147], v[12:15]
    s_mov_b32 s36, s22
    ds_read_b64_tr_b16 v[64:65], v113 offset:0
    ds_read_b64_tr_b16 v[66:67], v113 offset:512
    v_mfma_f32_16x16x32_bf16 v[28:31], v[72:75], a[148:151], v[28:31]
    s_mov_b32 s37, s23
    s_mov_b32 s38, 37748864
    s_mov_b32 s39, 0x20000
    v_mfma_f32_16x16x32_bf16 v[12:15], v[76:79], a[152:155], v[12:15]
    ds_read_b64_tr_b16 v[68:69], v113 offset:8192
    ds_read_b64_tr_b16 v[70:71], v113 offset:8704
    v_mfma_f32_16x16x32_bf16 v[28:31], v[76:79], a[156:159], v[28:31]
    s_waitcnt lgkmcnt(8)
    buffer_store_dwordx4 v[224:227], v96, s[36:39], s99 offen offset:0 sc1
    v_mfma_f32_16x16x32_bf16 v[12:15], v[80:83], a[160:163], v[12:15]
    ds_read_b64_tr_b16 v[72:73], v113 offset:2048
    ds_read_b64_tr_b16 v[74:75], v113 offset:2560
    v_mfma_f32_16x16x32_bf16 v[28:31], v[80:83], a[164:167], v[28:31]
    buffer_store_dwordx4 v[224:227], v96, s[36:39], s99 offen offset:1024 sc1
    v_mfma_f32_16x16x32_bf16 v[12:15], v[84:87], a[168:171], v[12:15]
    ds_read_b64_tr_b16 v[76:77], v113 offset:10240
    ds_read_b64_tr_b16 v[78:79], v113 offset:10752
    v_mfma_f32_16x16x32_bf16 v[28:31], v[84:87], a[172:175], v[28:31]
    s_waitcnt lgkmcnt(8)
    buffer_store_dwordx4 v[224:227], v96, s[36:39], s99 offen offset:2048 sc1
    v_mfma_f32_16x16x32_bf16 v[12:15], v[88:91], a[176:179], v[12:15]
    ds_read_b64_tr_b16 v[80:81], v109 offset:0
    ds_read_b64_tr_b16 v[82:83], v109 offset:512
    v_mfma_f32_16x16x32_bf16 v[28:31], v[88:91], a[180:183], v[28:31]
    buffer_store_dwordx4 v[224:227], v96, s[36:39], s99 offen offset:3072 sc1
    v_mfma_f32_16x16x32_bf16 v[12:15], v[92:95], a[184:187], v[12:15]
    ds_read_b64_tr_b16 v[84:85], v109 offset:8192
    ds_read_b64_tr_b16 v[86:87], v109 offset:8704
    v_mfma_f32_16x16x32_bf16 v[28:31], v[92:95], a[188:191], v[28:31]
    s_waitcnt lgkmcnt(8)
    v_fma_f32 v4, v164, v144, v4
    v_fma_f32 v5, v165, v144, v5
    v_mfma_f32_16x16x32_bf16 v[12:15], v[64:67], a[192:195], v[12:15]
    ds_read_b64_tr_b16 v[88:89], v109 offset:2048
    ds_read_b64_tr_b16 v[90:91], v109 offset:2560
    v_mfma_f32_16x16x32_bf16 v[28:31], v[64:67], a[196:199], v[28:31]
    v_fma_f32 v6, v166, v144, v6
    v_fma_f32 v7, v167, v144, v7
    v_fma_f32 v20, v164, v145, v20
    v_mfma_f32_16x16x32_bf16 v[12:15], v[68:71], a[200:203], v[12:15]
    ds_read_b64_tr_b16 v[92:93], v109 offset:10240
    ds_read_b64_tr_b16 v[94:95], v109 offset:10752
    v_mfma_f32_16x16x32_bf16 v[28:31], v[68:71], a[204:207], v[28:31]
    s_waitcnt lgkmcnt(8)
    v_fma_f32 v21, v165, v145, v21
    v_fma_f32 v22, v166, v145, v22
    v_mfma_f32_16x16x32_bf16 v[12:15], v[72:75], a[208:211], v[12:15]
    v_fma_f32 v23, v167, v145, v23
    v_mul_f32 v208, v4, v148
    v_mfma_f32_16x16x32_bf16 v[28:31], v[72:75], a[212:215], v[28:31]
    v_mul_f32 v209, v5, v148
    v_mul_f32 v210, v6, v148
    v_mul_f32 v211, v7, v148
    v_mfma_f32_16x16x32_bf16 v[12:15], v[76:79], a[216:219], v[12:15]
    v_mul_f32 v212, v20, v149
    v_mul_f32 v213, v21, v149
    v_mfma_f32_16x16x32_bf16 v[28:31], v[76:79], a[220:223], v[28:31]
    s_waitcnt lgkmcnt(4)
    v_mul_f32 v214, v22, v149
    v_mul_f32 v215, v23, v149
    v_mfma_f32_16x16x32_bf16 v[12:15], v[80:83], a[224:227], v[12:15]
    v_exp_f32 v208, v208 clamp
    v_mfma_f32_16x16x32_bf16 v[28:31], v[80:83], a[228:231], v[28:31]
    v_exp_f32 v209, v209 clamp
    v_mfma_f32_16x16x32_bf16 v[12:15], v[84:87], a[232:235], v[12:15]
    v_exp_f32 v210, v210 clamp
    v_mfma_f32_16x16x32_bf16 v[28:31], v[84:87], a[236:239], v[28:31]
    s_waitcnt lgkmcnt(0)
    v_exp_f32 v211, v211 clamp
    v_mfma_f32_16x16x32_bf16 v[12:15], v[88:91], a[240:243], v[12:15]
    v_exp_f32 v212, v212 clamp
    v_mfma_f32_16x16x32_bf16 v[28:31], v[88:91], a[244:247], v[28:31]
    v_exp_f32 v213, v213 clamp
    v_mfma_f32_16x16x32_bf16 v[12:15], v[92:95], a[248:251], v[12:15]
    v_exp_f32 v214, v214 clamp
    v_mfma_f32_16x16x32_bf16 v[28:31], v[92:95], a[252:255], v[28:31]
    v_exp_f32 v215, v215 clamp
    v_fma_f32 v4, v4, v146, s0
    v_fma_f32 v5, v5, v146, s1
    v_fma_f32 v6, v6, v146, s0
    v_fma_f32 v7, v7, v146, s1
    v_fma_f32 v20, v20, v147, s0
    v_fma_f32 v21, v21, v147, s1
    v_fma_f32 v22, v22, v147, s0
    v_fma_f32 v23, v23, v147, s1
    v_max_f32 v4, v4, v208
    v_max_f32 v5, v5, v209
    v_max_f32 v6, v6, v210
    v_max_f32 v7, v7, v211
    v_max_f32 v20, v20, v212
    v_max_f32 v21, v21, v213
    v_max_f32 v22, v22, v214
    v_max_f32 v23, v23, v215
    v_add_f32 v4, s60, v4
    v_add_f32 v5, s61, v5
    v_add_f32 v6, s60, v6
    v_add_f32 v7, s61, v7
    v_add_f32 v20, s60, v20
    v_add_f32 v21, s61, v21
    v_add_f32 v22, s60, v22
    v_add_f32 v23, s61, v23
    v_cvt_pk_bf16_f32 v34, v4, v5
    v_cvt_pk_bf16_f32 v35, v6, v7
    v_cvt_pk_bf16_f32 v42, v20, v21
    v_cvt_pk_bf16_f32 v43, v22, v23
    v_fma_f32 v8, v168, v144, v8
    v_fma_f32 v9, v169, v144, v9
    v_fma_f32 v10, v170, v144, v10
    v_fma_f32 v11, v171, v144, v11
    v_fma_f32 v24, v168, v145, v24
    v_fma_f32 v25, v169, v145, v25
    v_fma_f32 v26, v170, v145, v26
    v_fma_f32 v27, v171, v145, v27
    v_mul_f32 v208, v8, v148
    v_mul_f32 v209, v9, v148
    v_mul_f32 v210, v10, v148
    v_mul_f32 v211, v11, v148
    v_mul_f32 v212, v24, v149
    v_mul_f32 v213, v25, v149
    v_mul_f32 v214, v26, v149
    v_mul_f32 v215, v27, v149
    v_exp_f32 v208, v208 clamp
    v_exp_f32 v209, v209 clamp
    v_exp_f32 v210, v210 clamp
    v_exp_f32 v211, v211 clamp
    v_exp_f32 v212, v212 clamp
    v_exp_f32 v213, v213 clamp
    v_exp_f32 v214, v214 clamp
    v_exp_f32 v215, v215 clamp
    v_fma_f32 v8, v8, v146, s0
    v_fma_f32 v9, v9, v146, s1
    v_fma_f32 v10, v10, v146, s0
    v_fma_f32 v11, v11, v146, s1
    v_fma_f32 v24, v24, v147, s0
    v_fma_f32 v25, v25, v147, s1
    v_fma_f32 v26, v26, v147, s0
    v_fma_f32 v27, v27, v147, s1
    v_max_f32 v8, v8, v208
    v_max_f32 v9, v9, v209
    v_max_f32 v10, v10, v210
    v_max_f32 v11, v11, v211
    v_max_f32 v24, v24, v212
    v_max_f32 v25, v25, v213
    v_max_f32 v26, v26, v214
    v_max_f32 v27, v27, v215
    v_add_f32 v8, s60, v8
    v_add_f32 v9, s61, v9
    v_add_f32 v10, s60, v10
    v_add_f32 v11, s61, v11
    v_add_f32 v24, s60, v24
    v_add_f32 v25, s61, v25
    v_add_f32 v26, s60, v26
    v_add_f32 v27, s61, v27
    v_cvt_pk_bf16_f32 v36, v8, v9
    v_cvt_pk_bf16_f32 v37, v10, v11
    v_cvt_pk_bf16_f32 v44, v24, v25
    v_cvt_pk_bf16_f32 v45, v26, v27
    s_waitcnt vmcnt(4)
    v_cvt_pk_bf16_f32 v176, v48, v49
    v_cvt_pk_bf16_f32 v177, v50, v51
    v_cvt_pk_bf16_f32 v178, v52, v53
    v_cvt_pk_bf16_f32 v179, v54, v55
    v_cvt_pk_bf16_f32 v180, v56, v57
    v_cvt_pk_bf16_f32 v181, v58, v59
    ds_write_b64 v232, v[176:177]
    ds_write_b64 v232, v[178:179] offset:1024
    ds_write_b64 v233, v[180:181] offset:4096
    v_pk_fma_f32 v[12:13], v[172:173], v[144:145], v[12:13] op_sel:[0,0,0] op_sel_hi:[1,0,1]
    v_pk_fma_f32 v[14:15], v[174:175], v[144:145], v[14:15] op_sel:[0,0,0] op_sel_hi:[1,0,1]
    v_pk_fma_f32 v[28:29], v[172:173], v[144:145], v[28:29] op_sel:[0,1,0] op_sel_hi:[1,1,1]
    v_pk_fma_f32 v[30:31], v[174:175], v[144:145], v[30:31] op_sel:[0,1,0] op_sel_hi:[1,1,1]
    v_pk_mul_f32 v[208:209], v[12:13], v[148:149] op_sel:[0,0] op_sel_hi:[1,0]
    v_pk_mul_f32 v[210:211], v[14:15], v[148:149] op_sel:[0,0] op_sel_hi:[1,0]
    v_pk_mul_f32 v[212:213], v[28:29], v[148:149] op_sel:[0,1] op_sel_hi:[1,1]
    v_pk_mul_f32 v[214:215], v[30:31], v[148:149] op_sel:[0,1] op_sel_hi:[1,1]
    v_exp_f32 v208, v208 clamp
    v_exp_f32 v209, v209 clamp
    v_exp_f32 v210, v210 clamp
    v_exp_f32 v211, v211 clamp
    v_exp_f32 v212, v212 clamp
    v_exp_f32 v213, v213 clamp
    v_exp_f32 v214, v214 clamp
    v_exp_f32 v215, v215 clamp
    s_waitcnt lgkmcnt(0)
    s_barrier
    ds_read_b128 v[64:67], v234 offset:0
    ds_read_b128 v[68:71], v234 offset:1024
    ds_read_b128 v[72:75], v235 offset:4096
    ds_read_b128 v[76:79], v234 offset:2048
    ds_read_b128 v[80:83], v234 offset:3072
    ds_read_b128 v[84:87], v235 offset:4160
    v_pk_fma_f32 v[12:13], v[12:13], v[146:147], s[0:1] op_sel:[0,0,0] op_sel_hi:[1,0,1]
    v_pk_fma_f32 v[14:15], v[14:15], v[146:147], s[0:1] op_sel:[0,0,0] op_sel_hi:[1,0,1]
    v_pk_fma_f32 v[28:29], v[28:29], v[146:147], s[0:1] op_sel:[0,1,0] op_sel_hi:[1,1,1]
    v_pk_fma_f32 v[30:31], v[30:31], v[146:147], s[0:1] op_sel:[0,1,0] op_sel_hi:[1,1,1]
    v_max_f32 v12, v12, v208
    v_max_f32 v13, v13, v209
    v_max_f32 v14, v14, v210
    v_max_f32 v15, v15, v211
    v_max_f32 v28, v28, v212
    v_max_f32 v29, v29, v213
    v_max_f32 v30, v30, v214
    v_max_f32 v31, v31, v215
    v_pk_add_f32 v[12:13], v[12:13], s[60:61]
    v_pk_add_f32 v[14:15], v[14:15], s[60:61]
    v_pk_add_f32 v[28:29], v[28:29], s[60:61]
    v_pk_add_f32 v[30:31], v[30:31], s[60:61]
    v_cvt_pk_bf16_f32 v38, v12, v13
    v_cvt_pk_bf16_f32 v39, v14, v15
    v_cvt_pk_bf16_f32 v46, v28, v29
    v_cvt_pk_bf16_f32 v47, v30, v31
    s_waitcnt lgkmcnt(0)
    v_mfma_f32_16x16x32_bf16 v[184:187], v[72:75], v[32:35], 0
    v_mfma_f32_16x16x32_bf16 v[176:179], v[64:67], v[32:35], 0
    v_mfma_f32_16x16x32_bf16 v[180:183], v[68:71], v[32:35], 0
    v_mfma_f32_16x16x32_bf16 v[196:199], v[72:75], v[40:43], 0
    v_mfma_f32_16x16x32_bf16 v[188:191], v[64:67], v[40:43], 0
    v_mfma_f32_16x16x32_bf16 v[192:195], v[68:71], v[40:43], 0
    v_mfma_f32_16x16x32_bf16 v[208:211], v[84:87], v[36:39], 0
    v_mfma_f32_16x16x32_bf16 v[200:203], v[76:79], v[36:39], 0
    v_mfma_f32_16x16x32_bf16 v[204:207], v[80:83], v[36:39], 0
    v_mfma_f32_16x16x32_bf16 v[220:223], v[84:87], v[44:47], 0
    v_mfma_f32_16x16x32_bf16 v[212:215], v[76:79], v[44:47], 0
    v_mfma_f32_16x16x32_bf16 v[216:219], v[80:83], v[44:47], 0
    s_nop 2
    v_add_f32 v184, s60, v184
    v_add_f32 v196, s60, v196
    v_add_f32 v208, s60, v208
    v_add_f32 v220, s60, v220
    v_rcp_f32 v184, v184
    v_rcp_f32 v196, v196
    v_rcp_f32 v208, v208
    v_rcp_f32 v220, v220
    v_pk_mul_f32 v[176:177], v[176:177], v[184:185] op_sel:[0,0] op_sel_hi:[1,0]
    v_pk_mul_f32 v[178:179], v[178:179], v[184:185] op_sel:[0,0] op_sel_hi:[1,0]
    v_pk_mul_f32 v[180:181], v[180:181], v[184:185] op_sel:[0,0] op_sel_hi:[1,0]
    v_pk_mul_f32 v[182:183], v[182:183], v[184:185] op_sel:[0,0] op_sel_hi:[1,0]
    v_cvt_pk_bf16_f32 v0, v176, v177
    v_cvt_pk_bf16_f32 v1, v178, v179
    v_cvt_pk_bf16_f32 v2, v180, v181
    v_cvt_pk_bf16_f32 v3, v182, v183
    buffer_store_dwordx4 v[0:3], v96, s[40:43], 0 offen offset:0 sc1
    v_pk_mul_f32 v[188:189], v[188:189], v[196:197] op_sel:[0,0] op_sel_hi:[1,0]
    v_pk_mul_f32 v[190:191], v[190:191], v[196:197] op_sel:[0,0] op_sel_hi:[1,0]
    v_pk_mul_f32 v[192:193], v[192:193], v[196:197] op_sel:[0,0] op_sel_hi:[1,0]
    v_pk_mul_f32 v[194:195], v[194:195], v[196:197] op_sel:[0,0] op_sel_hi:[1,0]
    v_cvt_pk_bf16_f32 v4, v188, v189
    v_cvt_pk_bf16_f32 v5, v190, v191
    v_cvt_pk_bf16_f32 v6, v192, v193
    v_cvt_pk_bf16_f32 v7, v194, v195
    buffer_store_dwordx4 v[4:7], v96, s[40:43], 0 offen offset:1024 sc1
    v_pk_mul_f32 v[200:201], v[200:201], v[208:209] op_sel:[0,0] op_sel_hi:[1,0]
    v_pk_mul_f32 v[202:203], v[202:203], v[208:209] op_sel:[0,0] op_sel_hi:[1,0]
    v_pk_mul_f32 v[204:205], v[204:205], v[208:209] op_sel:[0,0] op_sel_hi:[1,0]
    v_pk_mul_f32 v[206:207], v[206:207], v[208:209] op_sel:[0,0] op_sel_hi:[1,0]
    v_cvt_pk_bf16_f32 v8, v200, v201
    v_cvt_pk_bf16_f32 v9, v202, v203
    v_cvt_pk_bf16_f32 v10, v204, v205
    v_cvt_pk_bf16_f32 v11, v206, v207
    buffer_store_dwordx4 v[8:11], v96, s[40:43], 0 offen offset:2048 sc1
    v_pk_mul_f32 v[212:213], v[212:213], v[220:221] op_sel:[0,0] op_sel_hi:[1,0]
    v_pk_mul_f32 v[214:215], v[214:215], v[220:221] op_sel:[0,0] op_sel_hi:[1,0]
    v_pk_mul_f32 v[216:217], v[216:217], v[220:221] op_sel:[0,0] op_sel_hi:[1,0]
    v_pk_mul_f32 v[218:219], v[218:219], v[220:221] op_sel:[0,0] op_sel_hi:[1,0]
    v_cvt_pk_bf16_f32 v12, v212, v213
    v_cvt_pk_bf16_f32 v13, v214, v215
    v_cvt_pk_bf16_f32 v14, v216, v217
    v_cvt_pk_bf16_f32 v15, v218, v219
    buffer_store_dwordx4 v[12:15], v96, s[40:43], 0 offen offset:3072 sc1
    s_mov_b32 s31, 0
    s_add_u32 m0, s29, 0
    s_nop 0
    buffer_load_dwordx4 v102, s[32:35], s31 offen offset:0 lds
    buffer_load_dwordx4 v103, s[32:35], s31 offen offset:1024 lds
    s_mov_b32 s31, 131072
    s_add_u32 m0, s29, 8192
    s_nop 0
    buffer_load_dwordx4 v102, s[32:35], s31 offen offset:0 lds
    buffer_load_dwordx4 v103, s[32:35], s31 offen offset:1024 lds
    s_mov_b32 s31, 786432
    s_add_u32 m0, s29, 49152
    s_nop 0
    buffer_load_dwordx4 v102, s[32:35], s31 offen offset:0 lds
    buffer_load_dwordx4 v103, s[32:35], s31 offen offset:1024 lds
    v_lshlrev_b32 v101, 4, v100
    v_lshlrev_b32 v123, 4, v100
    s_lshl_b32 s54, s30, 16
    s_add_u32 s27, s54, 8388608
    s_add_u32 s36, s22, s27
    s_addc_u32 s37, s23, 0
    s_mov_b32 s38, 33620096
    s_mov_b32 s39, 0x20000
    s_lshl_b32 s27, s26, 12
    s_add_u32 s27, s27, s54
    s_add_u32 s27, s27, 12582912
    s_add_u32 s40, s22, s27
    s_addc_u32 s41, s23, 0
    s_mov_b32 s42, 33558656
    s_mov_b32 s43, 0x20000
    s_lshl_b32 s55, s30, 7
    s_lshl_b32 s53, s25, 7
    s_add_u32 s53, s53, 786432
    s_add_u32 s63, s55, 262144
    s_add_u32 s60, s29, 155648
    v_lshrrev_b32 v154, 4, v100
    v_and_b32 v152, 15, v100
    v_lshlrev_b32 v113, 2, v152
    v_lshrrev_b32 v153, 1, v152
    v_lshrrev_b32 v155, 5, v100
    v_xor_b32 v153, v153, v155
    v_lshlrev_b32 v153, 4, v153
    v_lshl_add_u32 v153, v152, 7, v153
    v_and_b32 v152, 1, v154
    v_lshl_add_u32 v153, v152, 3, v153
    v_add_u32 v118, s97, v153
    v_xor_b32 v119, 32, v118
    v_xor_b32 v120, 64, v118
    v_xor_b32 v121, 96, v118
    v_lshl_add_u32 v112, v154, 4, s60
    v_lshlrev_b32 v155, 20, v155
    v_lshl_add_u32 v122, v100, 2, v155
    v_lshrrev_b32 v152, 2, v100
    v_lshlrev_b32 v152, 7, v152
    v_and_b32 v153, 3, v100
    v_lshl_add_u32 v152, v153, 3, v152
    v_bfe_u32 v153, v100, 3, 2
    v_lshl_add_u32 v104, v153, 5, v152
    v_xor_b32 v105, 32, v104
    v_xor_b32 v106, 64, v104
    v_xor_b32 v107, 96, v104
    v_add_u32 v108, 0x10000, v104
    v_add_u32 v109, 0x10000, v105
    v_add_u32 v110, 0x10000, v106
    v_add_u32 v111, 0x10000, v107
    s_mov_b32 s31, 917504
    s_add_u32 m0, s29, 57344
    s_nop 0
    buffer_load_dwordx4 v102, s[32:35], s31 offen offset:0 lds
    buffer_load_dwordx4 v103, s[32:35], s31 offen offset:1024 lds
    s_lshl_b32 s27, s24, 6
    v_add_lshl_u32 v124, v100, s27, 22
    v_mov_b32 v125, 1
    s_waitcnt vmcnt(8)
    s_barrier
    buffer_atomic_add v125, v124, s[44:47], s96 offen sc1
    s_mov_b32 s31, 1048576
    s_add_u32 m0, s29, 65536
    s_nop 0
    buffer_load_dwordx4 v102, s[32:35], s31 offen offset:0 lds
    buffer_load_dwordx4 v103, s[32:35], s31 offen offset:1024 lds
    s_mov_b32 s31, 1179648
    s_add_u32 m0, s29, 73728
    s_nop 0
    buffer_load_dwordx4 v102, s[32:35], s31 offen offset:0 lds
    buffer_load_dwordx4 v103, s[32:35], s31 offen offset:1024 lds
    s_mov_b32 s31, 1310720
    s_add_u32 m0, s29, 81920
    s_nop 0
    buffer_load_dwordx4 v102, s[32:35], s31 offen offset:0 lds
    buffer_load_dwordx4 v103, s[32:35], s31 offen offset:1024 lds
    s_mov_b32 s31, 1441792
    s_add_u32 m0, s29, 90112
    s_nop 0
    buffer_load_dwordx4 v102, s[32:35], s31 offen offset:0 lds
    buffer_load_dwordx4 v103, s[32:35], s31 offen offset:1024 lds
    s_mov_b32 s31, 1572864
    s_add_u32 m0, s29, 98304
    s_nop 0
    buffer_load_dwordx4 v102, s[32:35], s31 offen offset:0 lds
    buffer_load_dwordx4 v103, s[32:35], s31 offen offset:1024 lds
    s_mov_b32 s31, 1703936
    s_add_u32 m0, s29, 106496
    s_nop 0
    buffer_load_dwordx4 v102, s[32:35], s31 offen offset:0 lds
    buffer_load_dwordx4 v103, s[32:35], s31 offen offset:1024 lds
    s_mov_b32 s31, 1835008
    s_add_u32 m0, s29, 114688
    s_nop 0
    buffer_load_dwordx4 v102, s[32:35], s31 offen offset:0 lds
    buffer_load_dwordx4 v103, s[32:35], s31 offen offset:1024 lds
    s_mov_b32 s31, 1966080
    s_add_u32 m0, s29, 122880
    s_nop 0
    buffer_load_dwordx4 v102, s[32:35], s31 offen offset:0 lds
    buffer_load_dwordx4 v103, s[32:35], s31 offen offset:1024 lds
    s_cmp_lg_u32 s24, 0
    s_cbranch_scc1 Lnopoll_8
    v_mov_b32 v127, 0
    buffer_atomic_or v127, v124, s[44:47], s53 offen sc0 sc1
    s_waitcnt vmcnt(0)
    v_cmp_gt_u32 vcc, 16, v127
    s_mov_b32 s27, 0x80000
    s_and_b64 vcc, vcc, 1
    s_cbranch_scc0 Lok_9
Lspin_10:
    s_sleep 2
    v_mov_b32 v127, 0
    buffer_atomic_or v127, v124, s[44:47], s53 offen sc0 sc1
    s_waitcnt vmcnt(0)
    v_cmp_gt_u32 vcc, 16, v127
    s_sub_u32 s27, s27, 1
    s_cbranch_scc1 Lok_9
    s_and_b64 vcc, vcc, 1
    s_cbranch_scc1 Lspin_10
Lok_9:
Lnopoll_8:
    s_waitcnt vmcnt(0)
    s_barrier
    s_mov_b32 s31, 0
    buffer_load_dwordx4 a[0:3], v101, s[36:39], s31 offen offset:0 sc1
    buffer_load_dwordx4 a[4:7], v101, s[36:39], s31 offen offset:1024 sc1
    s_mov_b32 m0, s60
    s_mov_b32 s27, 311296
    buffer_load_dwordx4 v123, s[48:51], s27 offen offset:0 sc1 lds
    buffer_load_dwordx4 v123, s[48:51], s27 offen offset:1024 sc1 lds
    buffer_load_dwordx4 a[8:11], v101, s[36:39], s31 offen offset:2048 sc1
    buffer_load_dwordx4 a[12:15], v101, s[36:39], s31 offen offset:3072 sc1
    s_mov_b32 s31, 4096
    buffer_load_dwordx4 a[16:19], v101, s[36:39], s31 offen offset:0 sc1
    buffer_load_dwordx4 a[20:23], v101, s[36:39], s31 offen offset:1024 sc1
    buffer_load_dwordx4 a[24:27], v101, s[36:39], s31 offen offset:2048 sc1
    buffer_load_dwordx4 a[28:31], v101, s[36:39], s31 offen offset:3072 sc1
    ds_read_b64_tr_b16 v[48:49], v104 offset:0
    ds_read_b64_tr_b16 v[50:51], v104 offset:2048
    ds_read_b64_tr_b16 v[52:53], v105 offset:0
    ds_read_b64_tr_b16 v[54:55], v105 offset:2048
    ds_read_b64_tr_b16 v[56:57], v106 offset:0
    ds_read_b64_tr_b16 v[58:59], v106 offset:2048
    ds_read_b64_tr_b16 v[60:61], v107 offset:0
    ds_read_b64_tr_b16 v[62:63], v107 offset:2048
    s_waitcnt vmcnt(6) lgkmcnt(4)
    v_mfma_f32_16x16x32_bf16 v[0:3], v[48:51], a[0:3], 0
    s_mov_b32 s31, 8192
    ds_read_b128 v[64:67], v112 offset:0
    v_mfma_f32_16x16x32_bf16 v[16:19], v[48:51], a[4:7], 0
    buffer_load_dwordx4 a[32:35], v101, s[36:39], s31 offen offset:0 sc1
    v_mfma_f32_16x16x32_bf16 v[4:7], v[52:55], a[0:3], 0
    ds_read_b64_tr_b16 v[68:69], v104 offset:4096
    ds_read_b64_tr_b16 v[70:71], v104 offset:6144
    v_mfma_f32_16x16x32_bf16 v[20:23], v[52:55], a[4:7], 0
    s_waitcnt lgkmcnt(3)
    v_mfma_f32_16x16x32_bf16 v[8:11], v[56:59], a[0:3], 0
    ds_read_b64_tr_b16 v[72:73], v105 offset:4096
    ds_read_b64_tr_b16 v[74:75], v105 offset:6144
    v_mfma_f32_16x16x32_bf16 v[24:27], v[56:59], a[4:7], 0
    buffer_load_dwordx4 a[36:39], v101, s[36:39], s31 offen offset:1024 sc1
    v_mfma_f32_16x16x32_bf16 v[12:15], v[60:63], a[0:3], 0
    ds_read_b64_tr_b16 v[76:77], v106 offset:4096
    ds_read_b64_tr_b16 v[78:79], v106 offset:6144
    v_mfma_f32_16x16x32_bf16 v[28:31], v[60:63], a[4:7], 0
    s_waitcnt vmcnt(6) lgkmcnt(4)
    v_mfma_f32_16x16x32_bf16 v[32:35], v[64:67], a[0:3], 0
    ds_read_b64_tr_b16 v[80:81], v107 offset:4096
    ds_read_b64_tr_b16 v[82:83], v107 offset:6144
    v_mfma_f32_16x16x32_bf16 v[36:39], v[64:67], a[4:7], 0
    buffer_load_dwordx4 a[40:43], v101, s[36:39], s31 offen offset:2048 sc1
    v_mfma_f32_16x16x32_bf16 v[0:3], v[68:71], a[8:11], v[0:3]
    ds_read_b128 v[84:87], v112 offset:64
    v_mfma_f32_16x16x32_bf16 v[16:19], v[68:71], a[12:15], v[16:19]
    s_waitcnt lgkmcnt(3)
    ds_read_b64 v[128:129], v118 offset:0
    ds_read_b64 v[130:131], v119 offset:0
    v_mfma_f32_16x16x32_bf16 v[4:7], v[72:75], a[8:11], v[4:7]
    ds_read_b64_tr_b16 v[48:49], v104 offset:8192
    ds_read_b64_tr_b16 v[50:51], v104 offset:10240
    v_mfma_f32_16x16x32_bf16 v[20:23], v[72:75], a[12:15], v[20:23]
    buffer_load_dwordx4 a[44:47], v101, s[36:39], s31 offen offset:3072 sc1
    v_mfma_f32_16x16x32_bf16 v[8:11], v[76:79], a[8:11], v[8:11]
    ds_read_b64_tr_b16 v[52:53], v105 offset:8192
    ds_read_b64_tr_b16 v[54:55], v105 offset:10240
    v_mfma_f32_16x16x32_bf16 v[24:27], v[76:79], a[12:15], v[24:27]
    s_waitcnt lgkmcnt(6)
    ds_read_b64 v[132:133], v120 offset:0
    ds_read_b64 v[134:135], v121 offset:0
    v_mfma_f32_16x16x32_bf16 v[12:15], v[80:83], a[8:11], v[12:15]
    s_mov_b32 s31, 12288
    ds_read_b64_tr_b16 v[56:57], v106 offset:8192
    ds_read_b64_tr_b16 v[58:59], v106 offset:10240
    v_mfma_f32_16x16x32_bf16 v[28:31], v[80:83], a[12:15], v[28:31]
    buffer_load_dwordx4 a[48:51], v101, s[36:39], s31 offen offset:0 sc1
    v_mfma_f32_16x16x32_bf16 v[32:35], v[84:87], a[8:11], v[32:35]
    ds_read_b64_tr_b16 v[60:61], v107 offset:8192
    ds_read_b64_tr_b16 v[62:63], v107 offset:10240
    v_mfma_f32_16x16x32_bf16 v[36:39], v[84:87], a[12:15], v[36:39]
    s_waitcnt vmcnt(7) lgkmcnt(6)
    ds_read_b64 v[136:137], v118 offset:2048
    ds_read_b64 v[138:139], v119 offset:2048
    v_mfma_f32_16x16x32_bf16 v[0:3], v[48:51], a[16:19], v[0:3]
    ds_read_b128 v[64:67], v112 offset:128
    v_mfma_f32_16x16x32_bf16 v[16:19], v[48:51], a[20:23], v[16:19]
    buffer_load_dwordx4 a[52:55], v101, s[36:39], s31 offen offset:1024 sc1
    v_mfma_f32_16x16x32_bf16 v[4:7], v[52:55], a[16:19], v[4:7]
    ds_read_b64_tr_b16 v[68:69], v104 offset:12288
    ds_read_b64_tr_b16 v[70:71], v104 offset:14336
    v_mfma_f32_16x16x32_bf16 v[20:23], v[52:55], a[20:23], v[20:23]
    s_waitcnt lgkmcnt(5)
    ds_read_b64 v[140:141], v120 offset:2048
    ds_read_b64 v[142:143], v121 offset:2048
    v_mfma_f32_16x16x32_bf16 v[8:11], v[56:59], a[16:19], v[8:11]
    ds_read_b64_tr_b16 v[72:73], v105 offset:12288
    ds_read_b64_tr_b16 v[74:75], v105 offset:14336
    v_mfma_f32_16x16x32_bf16 v[24:27], v[56:59], a[20:23], v[24:27]
    buffer_load_dwordx4 a[56:59], v101, s[36:39], s31 offen offset:2048 sc1
    v_mfma_f32_16x16x32_bf16 v[12:15], v[60:63], a[16:19], v[12:15]
    ds_read_b64_tr_b16 v[76:77], v106 offset:12288
    ds_read_b64_tr_b16 v[78:79], v106 offset:14336
    v_mfma_f32_16x16x32_bf16 v[28:31], v[60:63], a[20:23], v[28:31]
    s_waitcnt vmcnt(7) lgkmcnt(6)
    v_mfma_f32_16x16x32_bf16 v[32:35], v[64:67], a[16:19], v[32:35]
    ds_read_b64_tr_b16 v[80:81], v107 offset:12288
    ds_read_b64_tr_b16 v[82:83], v107 offset:14336
    v_mfma_f32_16x16x32_bf16 v[36:39], v[64:67], a[20:23], v[36:39]
    buffer_load_dwordx4 a[60:63], v101, s[36:39], s31 offen offset:3072 sc1
    v_mfma_f32_16x16x32_bf16 v[0:3], v[68:71], a[24:27], v[0:3]
    ds_read_b128 v[84:87], v112 offset:192
    v_mfma_f32_16x16x32_bf16 v[16:19], v[68:71], a[28:31], v[16:19]
    s_waitcnt lgkmcnt(3)
    v_mfma_f32_16x16x32_bf16 v[4:7], v[72:75], a[24:27], v[4:7]
    s_mov_b32 s31, 16384
    ds_read_b64_tr_b16 v[48:49], v104 offset:16384
    ds_read_b64_tr_b16 v[50:51], v104 offset:18432
    v_mfma_f32_16x16x32_bf16 v[20:23], v[72:75], a[28:31], v[20:23]
    buffer_load_dwordx4 a[64:67], v101, s[36:39], s31 offen offset:0 sc1
    v_mfma_f32_16x16x32_bf16 v[8:11], v[76:79], a[24:27], v[8:11]
    ds_read_b64_tr_b16 v[52:53], v105 offset:16384
    ds_read_b64_tr_b16 v[54:55], v105 offset:18432
    v_mfma_f32_16x16x32_bf16 v[24:27], v[76:79], a[28:31], v[24:27]
    s_waitcnt lgkmcnt(4)
    v_mfma_f32_16x16x32_bf16 v[12:15], v[80:83], a[24:27], v[12:15]
    ds_read_b64_tr_b16 v[56:57], v106 offset:16384
    ds_read_b64_tr_b16 v[58:59], v106 offset:18432
    v_mfma_f32_16x16x32_bf16 v[28:31], v[80:83], a[28:31], v[28:31]
    buffer_load_dwordx4 a[68:71], v101, s[36:39], s31 offen offset:1024 sc1
    v_mfma_f32_16x16x32_bf16 v[32:35], v[84:87], a[24:27], v[32:35]
    ds_read_b64_tr_b16 v[60:61], v107 offset:16384
    ds_read_b64_tr_b16 v[62:63], v107 offset:18432
    v_mfma_f32_16x16x32_bf16 v[36:39], v[84:87], a[28:31], v[36:39]
    s_waitcnt vmcnt(8) lgkmcnt(4)
    v_mfma_f32_16x16x32_bf16 v[0:3], v[48:51], a[32:35], v[0:3]
    ds_read_b128 v[64:67], v112 offset:256
    v_mfma_f32_16x16x32_bf16 v[16:19], v[48:51], a[36:39], v[16:19]
    buffer_load_dwordx4 a[72:75], v101, s[36:39], s31 offen offset:2048 sc1
    v_mfma_f32_16x16x32_bf16 v[4:7], v[52:55], a[32:35], v[4:7]
    ds_read_b64_tr_b16 v[68:69], v104 offset:20480
    ds_read_b64_tr_b16 v[70:71], v104 offset:22528
    v_mfma_f32_16x16x32_bf16 v[20:23], v[52:55], a[36:39], v[20:23]
    s_waitcnt lgkmcnt(3)
    v_lshlrev_b32 v160, 16, v128
    v_and_b32 v161, s62, v128
    v_mfma_f32_16x16x32_bf16 v[8:11], v[56:59], a[32:35], v[8:11]
    ds_read_b64_tr_b16 v[72:73], v105 offset:20480
    ds_read_b64_tr_b16 v[74:75], v105 offset:22528
    v_mfma_f32_16x16x32_bf16 v[24:27], v[56:59], a[36:39], v[24:27]
    buffer_load_dwordx4 a[76:79], v101, s[36:39], s31 offen offset:3072 sc1
    v_mfma_f32_16x16x32_bf16 v[12:15], v[60:63], a[32:35], v[12:15]
    ds_read_b64_tr_b16 v[76:77], v106 offset:20480
    ds_read_b64_tr_b16 v[78:79], v106 offset:22528
    v_mfma_f32_16x16x32_bf16 v[28:31], v[60:63], a[36:39], v[28:31]
    s_waitcnt vmcnt(8) lgkmcnt(4)
    v_lshlrev_b32 v162, 16, v129
    v_and_b32 v163, s62, v129
    v_mfma_f32_16x16x32_bf16 v[32:35], v[64:67], a[32:35], v[32:35]
    s_mov_b32 s31, 20480
    ds_read_b64_tr_b16 v[80:81], v107 offset:20480
    ds_read_b64_tr_b16 v[82:83], v107 offset:22528
    v_mfma_f32_16x16x32_bf16 v[36:39], v[64:67], a[36:39], v[36:39]
    buffer_load_dwordx4 a[80:83], v101, s[36:39], s31 offen offset:0 sc1
    v_mfma_f32_16x16x32_bf16 v[0:3], v[68:71], a[40:43], v[0:3]
    ds_read_b128 v[84:87], v112 offset:320
    v_mfma_f32_16x16x32_bf16 v[16:19], v[68:71], a[44:47], v[16:19]
    s_waitcnt lgkmcnt(3)
    v_lshlrev_b32 v164, 16, v130
    v_and_b32 v165, s62, v130
    v_mfma_f32_16x16x32_bf16 v[4:7], v[72:75], a[40:43], v[4:7]
    ds_read_b64_tr_b16 v[48:49], v104 offset:24576
    ds_read_b64_tr_b16 v[50:51], v104 offset:26624
    v_mfma_f32_16x16x32_bf16 v[20:23], v[72:75], a[44:47], v[20:23]
    buffer_load_dwordx4 a[84:87], v101, s[36:39], s31 offen offset:1024 sc1
    v_mfma_f32_16x16x32_bf16 v[8:11], v[76:79], a[40:43], v[8:11]
    ds_read_b64_tr_b16 v[52:53], v105 offset:24576
    ds_read_b64_tr_b16 v[54:55], v105 offset:26624
    v_mfma_f32_16x16x32_bf16 v[24:27], v[76:79], a[44:47], v[24:27]
    s_waitcnt lgkmcnt(4)
    v_lshlrev_b32 v166, 16, v131
    v_and_b32 v167, s62, v131
    v_mfma_f32_16x16x32_bf16 v[12:15], v[80:83], a[40:43], v[12:15]
Lpad_6:
    s_cbranch_execz Lpad_10
    ds_read_b64_tr_b16 v[56:57], v106 offset:24576
    ds_read_b64_tr_b16 v[58:59], v106 offset:26624
    v_mfma_f32_16x16x32_bf16 v[28:31], v[80:83], a[44:47], v[28:31]
    buffer_load_dwordx4 a[88:91], v101, s[36:39], s31 offen offset:2048 sc1
    v_mfma_f32_16x16x32_bf16 v[32:35], v[84:87], a[40:43], v[32:35]
    ds_read_b64_tr_b16 v[60:61], v107 offset:24576
    ds_read_b64_tr_b16 v[62:63], v107 offset:26624
    v_mfma_f32_16x16x32_bf16 v[36:39], v[84:87], a[44:47], v[36:39]
    s_waitcnt vmcnt(9) lgkmcnt(4)
    v_lshlrev_b32 v168, 16, v132
    v_and_b32 v169, s62, v132
    v_mfma_f32_16x16x32_bf16 v[0:3], v[48:51], a[48:51], v[0:3]
    ds_read_b128 v[64:67], v112 offset:384
    v_mfma_f32_16x16x32_bf16 v[16:19], v[48:51], a[52:55], v[16:19]
    v_lshlrev_b32 v170, 16, v133
    v_and_b32 v171, s62, v133
    v_mfma_f32_16x16x32_bf16 v[4:7], v[52:55], a[48:51], v[4:7]
    ds_read_b64_tr_b16 v[68:69], v104 offset:28672
    ds_read_b64_tr_b16 v[70:71], v104 offset:30720
    v_mfma_f32_16x16x32_bf16 v[20:23], v[52:55], a[52:55], v[20:23]
    s_waitcnt lgkmcnt(3)
    v_lshlrev_b32 v172, 16, v134
    v_and_b32 v173, s62, v134
    v_mfma_f32_16x16x32_bf16 v[8:11], v[56:59], a[48:51], v[8:11]
    ds_read_b64_tr_b16 v[72:73], v105 offset:28672
    ds_read_b64_tr_b16 v[74:75], v105 offset:30720
    v_mfma_f32_16x16x32_bf16 v[24:27], v[56:59], a[52:55], v[24:27]
    buffer_load_dwordx4 a[92:95], v101, s[36:39], s31 offen offset:3072 sc1
    v_mfma_f32_16x16x32_bf16 v[12:15], v[60:63], a[48:51], v[12:15]
    ds_read_b64_tr_b16 v[76:77], v106 offset:28672
    ds_read_b64_tr_b16 v[78:79], v106 offset:30720
    v_mfma_f32_16x16x32_bf16 v[28:31], v[60:63], a[52:55], v[28:31]
    s_waitcnt vmcnt(8) lgkmcnt(4)
    v_lshlrev_b32 v174, 16, v135
    v_and_b32 v175, s62, v135
    v_mfma_f32_16x16x32_bf16 v[32:35], v[64:67], a[48:51], v[32:35]
    s_mov_b32 s31, 24576
    ds_read_b64_tr_b16 v[80:81], v107 offset:28672
    ds_read_b64_tr_b16 v[82:83], v107 offset:30720
    v_mfma_f32_16x16x32_bf16 v[36:39], v[64:67], a[52:55], v[36:39]
    buffer_load_dwordx4 a[96:99], v101, s[36:39], s31 offen offset:0 sc1
    v_mfma_f32_16x16x32_bf16 v[0:3], v[68:71], a[56:59], v[0:3]
    ds_read_b128 v[84:87], v112 offset:448
    v_mfma_f32_16x16x32_bf16 v[16:19], v[68:71], a[60:63], v[16:19]
    s_waitcnt lgkmcnt(3)
    v_lshlrev_b32 v176, 16, v136
    v_and_b32 v177, s62, v136
    v_mfma_f32_16x16x32_bf16 v[4:7], v[72:75], a[56:59], v[4:7]
    ds_read_b64_tr_b16 v[48:49], v104 offset:32768
    ds_read_b64_tr_b16 v[50:51], v104 offset:34816
    v_mfma_f32_16x16x32_bf16 v[20:23], v[72:75], a[60:63], v[20:23]
    buffer_load_dwordx4 a[100:103], v101, s[36:39], s31 offen offset:1024 sc1
    v_mfma_f32_16x16x32_bf16 v[8:11], v[76:79], a[56:59], v[8:11]
    ds_read_b64_tr_b16 v[52:53], v105 offset:32768
    ds_read_b64_tr_b16 v[54:55], v105 offset:34816
    v_mfma_f32_16x16x32_bf16 v[24:27], v[76:79], a[60:63], v[24:27]
    s_waitcnt lgkmcnt(4)
    v_lshlrev_b32 v178, 16, v137
    v_and_b32 v179, s62, v137
    v_mfma_f32_16x16x32_bf16 v[12:15], v[80:83], a[56:59], v[12:15]
    ds_read_b64_tr_b16 v[56:57], v106 offset:32768
    ds_read_b64_tr_b16 v[58:59], v106 offset:34816
    v_mfma_f32_16x16x32_bf16 v[28:31], v[80:83], a[60:63], v[28:31]
    buffer_load_dwordx4 a[104:107], v101, s[36:39], s31 offen offset:2048 sc1
    v_mfma_f32_16x16x32_bf16 v[32:35], v[84:87], a[56:59], v[32:35]
    ds_read_b64_tr_b16 v[60:61], v107 offset:32768
    ds_read_b64_tr_b16 v[62:63], v107 offset:34816
    v_mfma_f32_16x16x32_bf16 v[36:39], v[84:87], a[60:63], v[36:39]
    s_waitcnt vmcnt(9) lgkmcnt(4)
    v_lshlrev_b32 v180, 16, v138
    v_and_b32 v181, s62, v138
    v_mfma_f32_16x16x32_bf16 v[0:3], v[48:51], a[64:67], v[0:3]
    ds_read_b128 v[64:67], v112 offset:512
    v_mfma_f32_16x16x32_bf16 v[16:19], v[48:51], a[68:71], v[16:19]
    buffer_load_dwordx4 a[108:111], v101, s[36:39], s31 offen offset:3072 sc1
    v_mfma_f32_16x16x32_bf16 v[4:7], v[52:55], a[64:67], v[4:7]
    ds_read_b64_tr_b16 v[68:69], v104 offset:36864
    ds_read_b64_tr_b16 v[70:71], v104 offset:38912
    v_mfma_f32_16x16x32_bf16 v[20:23], v[52:55], a[68:71], v[20:23]
    s_waitcnt lgkmcnt(3)
    v_lshlrev_b32 v182, 16, v139
    v_and_b32 v183, s62, v139
    v_mfma_f32_16x16x32_bf16 v[8:11], v[56:59], a[64:67], v[8:11]
    s_mov_b32 s31, 28672
    ds_read_b64_tr_b16 v[72:73], v105 offset:36864
    ds_read_b64_tr_b16 v[74:75], v105 offset:38912
    v_mfma_f32_16x16x32_bf16 v[24:27], v[56:59], a[68:71], v[24:27]
    buffer_load_dwordx4 a[112:115], v101, s[36:39], s31 offen offset:0 sc1
    v_mfma_f32_16x16x32_bf16 v[12:15], v[60:63], a[64:67], v[12:15]
    ds_read_b64_tr_b16 v[76:77], v106 offset:36864
    ds_read_b64_tr_b16 v[78:79], v106 offset:38912
    v_mfma_f32_16x16x32_bf16 v[28:31], v[60:63], a[68:71], v[28:31]
    s_waitcnt vmcnt(9) lgkmcnt(4)
    v_lshlrev_b32 v184, 16, v140
    v_and_b32 v185, s62, v140
    v_mfma_f32_16x16x32_bf16 v[32:35], v[64:67], a[64:67], v[32:35]
    ds_read_b64_tr_b16 v[80:81], v107 offset:36864
    ds_read_b64_tr_b16 v[82:83], v107 offset:38912
    v_mfma_f32_16x16x32_bf16 v[36:39], v[64:67], a[68:71], v[36:39]
    buffer_load_dwordx4 a[116:119], v101, s[36:39], s31 offen offset:1024 sc1
    v_mfma_f32_16x16x32_bf16 v[0:3], v[68:71], a[72:75], v[0:3]
    ds_read_b128 v[84:87], v112 offset:576
    v_mfma_f32_16x16x32_bf16 v[16:19], v[68:71], a[76:79], v[16:19]
    s_waitcnt lgkmcnt(3)
    v_lshlrev_b32 v186, 16, v141
    v_and_b32 v187, s62, v141
    v_mfma_f32_16x16x32_bf16 v[4:7], v[72:75], a[72:75], v[4:7]
    ds_read_b64_tr_b16 v[48:49], v104 offset:40960
    ds_read_b64_tr_b16 v[50:51], v104 offset:43008
    v_mfma_f32_16x16x32_bf16 v[20:23], v[72:75], a[76:79], v[20:23]
    buffer_load_dwordx4 a[120:123], v101, s[36:39], s31 offen offset:2048 sc1
    v_mfma_f32_16x16x32_bf16 v[8:11], v[76:79], a[72:75], v[8:11]
    ds_read_b64_tr_b16 v[52:53], v105 offset:40960
    ds_read_b64_tr_b16 v[54:55], v105 offset:43008
    v_mfma_f32_16x16x32_bf16 v[24:27], v[76:79], a[76:79], v[24:27]
    s_waitcnt lgkmcnt(4)
    v_lshlrev_b32 v188, 16, v142
    v_and_b32 v189, s62, v142
    v_mfma_f32_16x16x32_bf16 v[12:15], v[80:83], a[72:75], v[12:15]
    ds_read_b64_tr_b16 v[56:57], v106 offset:40960
    ds_read_b64_tr_b16 v[58:59], v106 offset:43008
    v_mfma_f32_16x16x32_bf16 v[28:31], v[80:83], a[76:79], v[28:31]
    buffer_load_dwordx4 a[124:127], v101, s[36:39], s31 offen offset:3072 sc1
    v_mfma_f32_16x16x32_bf16 v[32:35], v[84:87], a[72:75], v[32:35]
    ds_read_b64_tr_b16 v[60:61], v107 offset:40960
    ds_read_b64_tr_b16 v[62:63], v107 offset:43008
    v_mfma_f32_16x16x32_bf16 v[36:39], v[84:87], a[76:79], v[36:39]
    s_waitcnt vmcnt(10) lgkmcnt(4)
    v_lshlrev_b32 v190, 16, v143
    v_and_b32 v191, s62, v143
    v_mfma_f32_16x16x32_bf16 v[0:3], v[48:51], a[80:83], v[0:3]
    ds_read_b128 v[64:67], v112 offset:640
    v_mfma_f32_16x16x32_bf16 v[16:19], v[48:51], a[84:87], v[16:19]
    buffer_load_dword v144, v113, s[48:51], s63 offen offset:0 sc1
    v_mfma_f32_16x16x32_bf16 v[4:7], v[52:55], a[80:83], v[4:7]
    ds_read_b64_tr_b16 v[68:69], v104 offset:45056
    ds_read_b64_tr_b16 v[70:71], v104 offset:47104
    v_mfma_f32_16x16x32_bf16 v[20:23], v[52:55], a[84:87], v[20:23]
    s_waitcnt lgkmcnt(3)
    v_mbcnt_lo_u32_b32 v225, -1, 0
    v_mbcnt_hi_u32_b32 v225, -1, v225
    v_mfma_f32_16x16x32_bf16 v[8:11], v[56:59], a[80:83], v[8:11]
    s_and_b32 s1, s2, 1
    ds_read_b64_tr_b16 v[72:73], v105 offset:45056
    ds_read_b64_tr_b16 v[74:75], v105 offset:47104
    v_mfma_f32_16x16x32_bf16 v[24:27], v[56:59], a[84:87], v[24:27]
    buffer_load_dword v146, v113, s[48:51], s63 offen offset:64 sc1
    v_mfma_f32_16x16x32_bf16 v[12:15], v[60:63], a[80:83], v[12:15]
    s_lshl_b32 s1, s1, 2
    ds_read_b64_tr_b16 v[76:77], v106 offset:45056
    ds_read_b64_tr_b16 v[78:79], v106 offset:47104
    v_mfma_f32_16x16x32_bf16 v[28:31], v[60:63], a[84:87], v[28:31]
    s_waitcnt vmcnt(10) lgkmcnt(4)
    s_bfe_u32 s68, s2, 0x20003
    s_add_u32 s1, s1, s68
    v_mfma_f32_16x16x32_bf16 v[32:35], v[64:67], a[80:83], v[32:35]
    s_mov_b32 s31, 32768
    ds_read_b64_tr_b16 v[80:81], v107 offset:45056
    ds_read_b64_tr_b16 v[82:83], v107 offset:47104
    v_mfma_f32_16x16x32_bf16 v[36:39], v[64:67], a[84:87], v[36:39]
    buffer_load_dwordx4 a[128:131], v101, s[36:39], s31 offen offset:0 sc1
    v_mfma_f32_16x16x32_bf16 v[0:3], v[68:71], a[88:91], v[0:3]
    s_lshl_b32 s1, s1, 2
    ds_read_b128 v[84:87], v112 offset:704
    v_mfma_f32_16x16x32_bf16 v[16:19], v[68:71], a[92:95], v[16:19]
    s_waitcnt lgkmcnt(3)
    s_add_u32 s1, s1, s24
    s_lshl_b32 s1, s1, 1
    v_mfma_f32_16x16x32_bf16 v[4:7], v[72:75], a[88:91], v[4:7]
    s_bfe_u32 s94, s2, 0x20001
    ds_read_b64_tr_b16 v[48:49], v104 offset:49152
    ds_read_b64_tr_b16 v[50:51], v104 offset:51200
    v_mfma_f32_16x16x32_bf16 v[20:23], v[72:75], a[92:95], v[20:23]
    buffer_load_dwordx4 a[132:135], v101, s[36:39], s31 offen offset:1024 sc1
    v_mfma_f32_16x16x32_bf16 v[8:11], v[76:79], a[88:91], v[8:11]
    s_lshl_b32 s94, s94, 3
    ds_read_b64_tr_b16 v[52:53], v105 offset:49152
    ds_read_b64_tr_b16 v[54:55], v105 offset:51200
    v_mfma_f32_16x16x32_bf16 v[24:27], v[76:79], a[92:95], v[24:27]
    s_waitcnt lgkmcnt(4)
    s_lshr_b32 s68, s2, 5
    s_add_u32 s94, s94, s68
    v_mfma_f32_16x16x32_bf16 v[12:15], v[80:83], a[88:91], v[12:15]
    s_and_b32 s95, s94, 1
    ds_read_b64_tr_b16 v[56:57], v106 offset:49152
    ds_read_b64_tr_b16 v[58:59], v106 offset:51200
    v_mfma_f32_16x16x32_bf16 v[28:31], v[80:83], a[92:95], v[28:31]
    buffer_load_dwordx4 a[136:139], v101, s[36:39], s31 offen offset:2048 sc1
    v_mfma_f32_16x16x32_bf16 v[32:35], v[84:87], a[88:91], v[32:35]
    s_and_b32 s68, s24, 1
    ds_read_b64_tr_b16 v[60:61], v107 offset:49152
    ds_read_b64_tr_b16 v[62:63], v107 offset:51200
    v_mfma_f32_16x16x32_bf16 v[36:39], v[84:87], a[92:95], v[36:39]
    s_waitcnt vmcnt(11) lgkmcnt(4)
    s_mul_i32 s68, s68, 229376
    s_lshl_b32 s69, s95, 1
    v_mfma_f32_16x16x32_bf16 v[0:3], v[48:51], a[96:99], v[0:3]
    s_mul_i32 s3, s24, 7168
    ds_read_b128 v[64:67], v112 offset:768
    v_mfma_f32_16x16x32_bf16 v[16:19], v[48:51], a[100:103], v[16:19]
    s_mul_i32 s100, s94, 224
    s_cmp_lt_u32 s24, 2
    s_cselect_b32 s32, s12, s14
    s_cselect_b32 s33, s13, s15
    s_add_u32 s32, s32, s100
    s_addc_u32 s33, s33, 0
    s_sub_u32 s34, 7340032, s100
    v_mfma_f32_16x16x32_bf16 v[4:7], v[52:55], a[96:99], v[4:7]
    ds_read_b64_tr_b16 v[68:69], v104 offset:53248
    ds_read_b64_tr_b16 v[70:71], v104 offset:55296
    v_mfma_f32_16x16x32_bf16 v[20:23], v[52:55], a[100:103], v[20:23]
    s_waitcnt lgkmcnt(3)
    v_add_u32 v248, 0, v225
    v_mul_u32_u24 v249, 4682, v248
    v_mfma_f32_16x16x32_bf16 v[8:11], v[56:59], a[96:99], v[8:11]
    ds_read_b64_tr_b16 v[72:73], v105 offset:53248
    ds_read_b64_tr_b16 v[74:75], v105 offset:55296
    v_mfma_f32_16x16x32_bf16 v[24:27], v[56:59], a[100:103], v[24:27]
    buffer_load_dwordx4 a[140:143], v101, s[36:39], s31 offen offset:3072 sc1
    v_mfma_f32_16x16x32_bf16 v[12:15], v[60:63], a[96:99], v[12:15]
    ds_read_b64_tr_b16 v[76:77], v106 offset:53248
    ds_read_b64_tr_b16 v[78:79], v106 offset:55296
    v_mfma_f32_16x16x32_bf16 v[28:31], v[60:63], a[100:103], v[28:31]
    s_waitcnt vmcnt(10) lgkmcnt(4)
    v_lshrrev_b32 v249, 16, v249
    v_mad_i32_i24 v248, v249, -14, v248
    v_mfma_f32_16x16x32_bf16 v[32:35], v[64:67], a[96:99], v[32:35]
    s_mov_b32 s31, 36864
    ds_read_b64_tr_b16 v[80:81], v107 offset:53248
    ds_read_b64_tr_b16 v[82:83], v107 offset:55296
    v_mfma_f32_16x16x32_bf16 v[36:39], v[64:67], a[100:103], v[36:39]
    buffer_load_dwordx4 a[144:147], v101, s[36:39], s31 offen offset:0 sc1
    v_mfma_f32_16x16x32_bf16 v[0:3], v[68:71], a[104:107], v[0:3]
    ds_read_b128 v[84:87], v112 offset:832
    v_mfma_f32_16x16x32_bf16 v[16:19], v[68:71], a[108:111], v[16:19]
    s_waitcnt lgkmcnt(3)
    v_add_u32 v248, s69, v248
    v_subrev_u32 v250, 14, v248
    v_mfma_f32_16x16x32_bf16 v[4:7], v[72:75], a[104:107], v[4:7]
    ds_read_b64_tr_b16 v[48:49], v104 offset:57344
    ds_read_b64_tr_b16 v[50:51], v104 offset:59392
    v_mfma_f32_16x16x32_bf16 v[20:23], v[72:75], a[108:111], v[20:23]
    buffer_load_dwordx4 a[148:151], v101, s[36:39], s31 offen offset:1024 sc1
    v_mfma_f32_16x16x32_bf16 v[8:11], v[76:79], a[104:107], v[8:11]
    ds_read_b64_tr_b16 v[52:53], v105 offset:57344
    ds_read_b64_tr_b16 v[54:55], v105 offset:59392
    v_mfma_f32_16x16x32_bf16 v[24:27], v[76:79], a[108:111], v[24:27]
    s_waitcnt lgkmcnt(4)
    v_min_u32 v248, v248, v250
    v_mul_u32_u24 v249, 7168, v249
    v_mfma_f32_16x16x32_bf16 v[12:15], v[80:83], a[104:107], v[12:15]
    ds_read_b64_tr_b16 v[56:57], v106 offset:57344
    ds_read_b64_tr_b16 v[58:59], v106 offset:59392
    v_mfma_f32_16x16x32_bf16 v[28:31], v[80:83], a[108:111], v[28:31]
    buffer_load_dwordx4 a[152:155], v101, s[36:39], s31 offen offset:2048 sc1
    v_mfma_f32_16x16x32_bf16 v[32:35], v[84:87], a[104:107], v[32:35]
    ds_read_b64_tr_b16 v[60:61], v107 offset:57344
    ds_read_b64_tr_b16 v[62:63], v107 offset:59392
    v_mfma_f32_16x16x32_bf16 v[36:39], v[84:87], a[108:111], v[36:39]
    s_waitcnt vmcnt(11) lgkmcnt(4)
    v_lshl_add_u32 v249, v248, 4, v249
    v_add_u32 v230, s68, v249
    v_mfma_f32_16x16x32_bf16 v[0:3], v[48:51], a[112:115], v[0:3]
    ds_read_b128 v[64:67], v112 offset:896
    v_mfma_f32_16x16x32_bf16 v[16:19], v[48:51], a[116:119], v[16:19]
    buffer_load_dwordx4 a[156:159], v101, s[36:39], s31 offen offset:3072 sc1
    v_mfma_f32_16x16x32_bf16 v[4:7], v[52:55], a[112:115], v[4:7]
    ds_read_b64_tr_b16 v[68:69], v104 offset:61440
    ds_read_b64_tr_b16 v[70:71], v104 offset:63488
    v_mfma_f32_16x16x32_bf16 v[20:23], v[52:55], a[116:119], v[20:23]
    s_waitcnt lgkmcnt(3)
    v_add_u32 v248, 64, v225
    v_mul_u32_u24 v249, 4682, v248
    v_mfma_f32_16x16x32_bf16 v[8:11], v[56:59], a[112:115], v[8:11]
    s_mov_b32 s31, 40960
    ds_read_b64_tr_b16 v[72:73], v105 offset:61440
    ds_read_b64_tr_b16 v[74:75], v105 offset:63488
    v_mfma_f32_16x16x32_bf16 v[24:27], v[56:59], a[116:119], v[24:27]
    buffer_load_dwordx4 a[160:163], v101, s[36:39], s31 offen offset:0 sc1
    v_mfma_f32_16x16x32_bf16 v[12:15], v[60:63], a[112:115], v[12:15]
    ds_read_b64_tr_b16 v[76:77], v106 offset:61440
    ds_read_b64_tr_b16 v[78:79], v106 offset:63488
    v_mfma_f32_16x16x32_bf16 v[28:31], v[60:63], a[116:119], v[28:31]
    s_waitcnt vmcnt(11) lgkmcnt(4)
    v_lshrrev_b32 v249, 16, v249
    v_mad_i32_i24 v248, v249, -14, v248
    v_mfma_f32_16x16x32_bf16 v[32:35], v[64:67], a[112:115], v[32:35]
    ds_read_b64_tr_b16 v[80:81], v107 offset:61440
    ds_read_b64_tr_b16 v[82:83], v107 offset:63488
    v_mfma_f32_16x16x32_bf16 v[36:39], v[64:67], a[116:119], v[36:39]
    buffer_load_dwordx4 a[164:167], v101, s[36:39], s31 offen offset:1024 sc1
    v_mfma_f32_16x16x32_bf16 v[0:3], v[68:71], a[120:123], v[0:3]
    ds_read_b128 v[84:87], v112 offset:960
    v_mfma_f32_16x16x32_bf16 v[16:19], v[68:71], a[124:127], v[16:19]
    s_waitcnt lgkmcnt(3)
    v_add_u32 v248, s69, v248
    v_subrev_u32 v250, 14, v248
    v_mfma_f32_16x16x32_bf16 v[4:7], v[72:75], a[120:123], v[4:7]
    ds_read_b64_tr_b16 v[48:49], v108 offset:0
    ds_read_b64_tr_b16 v[50:51], v108 offset:2048
    v_mfma_f32_16x16x32_bf16 v[20:23], v[72:75], a[124:127], v[20:23]
    buffer_load_dwordx4 a[168:171], v101, s[36:39], s31 offen offset:2048 sc1
    v_mfma_f32_16x16x32_bf16 v[8:11], v[76:79], a[120:123], v[8:11]
    ds_read_b64_tr_b16 v[52:53], v109 offset:0
    ds_read_b64_tr_b16 v[54:55], v109 offset:2048
    v_mfma_f32_16x16x32_bf16 v[24:27], v[76:79], a[124:127], v[24:27]
    s_waitcnt lgkmcnt(4)
    v_min_u32 v248, v248, v250
    v_mul_u32_u24 v249, 7168, v249
    v_mfma_f32_16x16x32_bf16 v[12:15], v[80:83], a[120:123], v[12:15]
    ds_read_b64_tr_b16 v[56:57], v110 offset:0
    ds_read_b64_tr_b16 v[58:59], v110 offset:2048
    v_mfma_f32_16x16x32_bf16 v[28:31], v[80:83], a[124:127], v[28:31]
    buffer_load_dwordx4 a[172:175], v101, s[36:39], s31 offen offset:3072 sc1
    v_mfma_f32_16x16x32_bf16 v[32:35], v[84:87], a[120:123], v[32:35]
    ds_read_b64_tr_b16 v[60:61], v111 offset:0
    ds_read_b64_tr_b16 v[62:63], v111 offset:2048
    v_mfma_f32_16x16x32_bf16 v[36:39], v[84:87], a[124:127], v[36:39]
    s_waitcnt vmcnt(10) lgkmcnt(4)
    v_lshl_add_u32 v249, v248, 4, v249
    v_subrev_u32 v249, 1024, v249
    v_mfma_f32_16x16x32_bf16 v[0:3], v[48:51], a[128:131], v[0:3]
    s_mov_b32 s31, 45056
    ds_read_b128 v[64:67], v112 offset:1024
    v_mfma_f32_16x16x32_bf16 v[16:19], v[48:51], a[132:135], v[16:19]
    buffer_load_dwordx4 a[176:179], v101, s[36:39], s31 offen offset:0 sc1
    v_mfma_f32_16x16x32_bf16 v[4:7], v[52:55], a[128:131], v[4:7]
    ds_read_b64_tr_b16 v[68:69], v108 offset:4096
    ds_read_b64_tr_b16 v[70:71], v108 offset:6144
    v_mfma_f32_16x16x32_bf16 v[20:23], v[52:55], a[132:135], v[20:23]
    s_waitcnt lgkmcnt(3)
    v_add_u32 v231, s68, v249
    v_add_u32 v248, 128, v225
    v_mfma_f32_16x16x32_bf16 v[8:11], v[56:59], a[128:131], v[8:11]
    ds_read_b64_tr_b16 v[72:73], v109 offset:4096
    ds_read_b64_tr_b16 v[74:75], v109 offset:6144
    v_mfma_f32_16x16x32_bf16 v[24:27], v[56:59], a[132:135], v[24:27]
    buffer_load_dwordx4 a[180:183], v101, s[36:39], s31 offen offset:1024 sc1
    v_mfma_f32_16x16x32_bf16 v[12:15], v[60:63], a[128:131], v[12:15]
    ds_read_b64_tr_b16 v[76:77], v110 offset:4096
    ds_read_b64_tr_b16 v[78:79], v110 offset:6144
    v_mfma_f32_16x16x32_bf16 v[28:31], v[60:63], a[132:135], v[28:31]
    s_waitcnt vmcnt(10) lgkmcnt(4)
    v_mul_u32_u24 v249, 4682, v248
    v_lshrrev_b32 v249, 16, v249
    v_mfma_f32_16x16x32_bf16 v[32:35], v[64:67], a[128:131], v[32:35]
    ds_read_b64_tr_b16 v[80:81], v111 offset:4096
    ds_read_b64_tr_b16 v[82:83], v111 offset:6144
    v_mfma_f32_16x16x32_bf16 v[36:39], v[64:67], a[132:135], v[36:39]
    buffer_load_dwordx4 a[184:187], v101, s[36:39], s31 offen offset:2048 sc1
    v_mfma_f32_16x16x32_bf16 v[0:3], v[68:71], a[136:139], v[0:3]
    ds_read_b128 v[84:87], v112 offset:1088
    v_mfma_f32_16x16x32_bf16 v[16:19], v[68:71], a[140:143], v[16:19]
    s_waitcnt lgkmcnt(3)
    v_mad_i32_i24 v248, v249, -14, v248
    v_add_u32 v248, s69, v248
    v_mfma_f32_16x16x32_bf16 v[4:7], v[72:75], a[136:139], v[4:7]
    ds_read_b64_tr_b16 v[48:49], v108 offset:8192
    ds_read_b64_tr_b16 v[50:51], v108 offset:10240
    v_mfma_f32_16x16x32_bf16 v[20:23], v[72:75], a[140:143], v[20:23]
    buffer_load_dwordx4 a[188:191], v101, s[36:39], s31 offen offset:3072 sc1
    v_mfma_f32_16x16x32_bf16 v[8:11], v[76:79], a[136:139], v[8:11]
    ds_read_b64_tr_b16 v[52:53], v109 offset:8192
    ds_read_b64_tr_b16 v[54:55], v109 offset:10240
    v_mfma_f32_16x16x32_bf16 v[24:27], v[76:79], a[140:143], v[24:27]
    s_waitcnt lgkmcnt(4)
    v_subrev_u32 v250, 14, v248
    v_min_u32 v248, v248, v250
    v_mfma_f32_16x16x32_bf16 v[12:15], v[80:83], a[136:139], v[12:15]
    s_mov_b32 s31, 49152
    ds_read_b64_tr_b16 v[56:57], v110 offset:8192
    ds_read_b64_tr_b16 v[58:59], v110 offset:10240
    v_mfma_f32_16x16x32_bf16 v[28:31], v[80:83], a[140:143], v[28:31]
    buffer_load_dwordx4 a[192:195], v101, s[36:39], s31 offen offset:0 sc1
    v_mfma_f32_16x16x32_bf16 v[32:35], v[84:87], a[136:139], v[32:35]
    ds_read_b64_tr_b16 v[60:61], v111 offset:8192
    ds_read_b64_tr_b16 v[62:63], v111 offset:10240
    v_mfma_f32_16x16x32_bf16 v[36:39], v[84:87], a[140:143], v[36:39]
    s_waitcnt vmcnt(11) lgkmcnt(4)
    v_mul_u32_u24 v249, 7168, v249
    v_lshl_add_u32 v249, v248, 4, v249
    v_mfma_f32_16x16x32_bf16 v[0:3], v[48:51], a[144:147], v[0:3]
    ds_read_b128 v[64:67], v112 offset:1152
    v_mfma_f32_16x16x32_bf16 v[16:19], v[48:51], a[148:151], v[16:19]
    buffer_load_dwordx4 a[196:199], v101, s[36:39], s31 offen offset:1024 sc1
    v_mfma_f32_16x16x32_bf16 v[4:7], v[52:55], a[144:147], v[4:7]
    ds_read_b64_tr_b16 v[68:69], v108 offset:12288
    ds_read_b64_tr_b16 v[70:71], v108 offset:14336
    v_mfma_f32_16x16x32_bf16 v[20:23], v[52:55], a[148:151], v[20:23]
    s_waitcnt lgkmcnt(3)
    v_subrev_u32 v249, 2048, v249
    v_add_u32 v232, s68, v249
    v_mfma_f32_16x16x32_bf16 v[8:11], v[56:59], a[144:147], v[8:11]
    ds_read_b64_tr_b16 v[72:73], v109 offset:12288
    ds_read_b64_tr_b16 v[74:75], v109 offset:14336
    v_mfma_f32_16x16x32_bf16 v[24:27], v[56:59], a[148:151], v[24:27]
    v_add_u32 v248, 192, v225
    v_mul_u32_u24 v249, 4682, v248
    v_mfma_f32_16x16x32_bf16 v[12:15], v[60:63], a[144:147], v[12:15]
    ds_read_b64_tr_b16 v[76:77], v110 offset:12288
    ds_read_b64_tr_b16 v[78:79], v110 offset:14336
    v_mfma_f32_16x16x32_bf16 v[28:31], v[60:63], a[148:151], v[28:31]
    s_waitcnt vmcnt(10) lgkmcnt(4)
    v_lshrrev_b32 v249, 16, v249
    v_mad_i32_i24 v248, v249, -14, v248
    v_mfma_f32_16x16x32_bf16 v[32:35], v[64:67], a[144:147], v[32:35]
    ds_read_b64_tr_b16 v[80:81], v111 offset:12288
    ds_read_b64_tr_b16 v[82:83], v111 offset:14336
    v_mfma_f32_16x16x32_bf16 v[36:39], v[64:67], a[148:151], v[36:39]
    buffer_load_dwordx4 a[200:203], v101, s[36:39], s31 offen offset:2048 sc1
    v_mfma_f32_16x16x32_bf16 v[0:3], v[68:71], a[152:155], v[0:3]
    ds_read_b128 v[84:87], v112 offset:1216
    v_mfma_f32_16x16x32_bf16 v[16:19], v[68:71], a[156:159], v[16:19]
    s_waitcnt lgkmcnt(3)
    v_add_u32 v248, s69, v248
    v_subrev_u32 v250, 14, v248
    v_mfma_f32_16x16x32_bf16 v[4:7], v[72:75], a[152:155], v[4:7]
    ds_read_b64_tr_b16 v[48:49], v108 offset:16384
    ds_read_b64_tr_b16 v[50:51], v108 offset:18432
    v_mfma_f32_16x16x32_bf16 v[20:23], v[72:75], a[156:159], v[20:23]
    buffer_load_dwordx4 a[204:207], v101, s[36:39], s31 offen offset:3072 sc1
    v_mfma_f32_16x16x32_bf16 v[8:11], v[76:79], a[152:155], v[8:11]
    ds_read_b64_tr_b16 v[52:53], v109 offset:16384
    ds_read_b64_tr_b16 v[54:55], v109 offset:18432
    v_mfma_f32_16x16x32_bf16 v[24:27], v[76:79], a[156:159], v[24:27]
    s_waitcnt lgkmcnt(4)
    v_min_u32 v248, v248, v250
    v_mul_u32_u24 v249, 7168, v249
    v_mfma_f32_16x16x32_bf16 v[12:15], v[80:83], a[152:155], v[12:15]
    s_mov_b32 s31, 53248
    ds_read_b64_tr_b16 v[56:57], v110 offset:16384
    ds_read_b64_tr_b16 v[58:59], v110 offset:18432
    v_mfma_f32_16x16x32_bf16 v[28:31], v[80:83], a[156:159], v[28:31]
    buffer_load_dwordx4 a[208:211], v101, s[36:39], s31 offen offset:0 sc1
    v_mfma_f32_16x16x32_bf16 v[32:35], v[84:87], a[152:155], v[32:35]
    ds_read_b64_tr_b16 v[60:61], v111 offset:16384
    ds_read_b64_tr_b16 v[62:63], v111 offset:18432
    v_mfma_f32_16x16x32_bf16 v[36:39], v[84:87], a[156:159], v[36:39]
    s_waitcnt vmcnt(11) lgkmcnt(4)
    v_lshl_add_u32 v249, v248, 4, v249
    v_subrev_u32 v249, 3072, v249
    v_mfma_f32_16x16x32_bf16 v[0:3], v[48:51], a[160:163], v[0:3]
    ds_read_b128 v[64:67], v112 offset:1280
    v_mfma_f32_16x16x32_bf16 v[16:19], v[48:51], a[164:167], v[16:19]
    buffer_load_dwordx4 a[212:215], v101, s[36:39], s31 offen offset:1024 sc1
    v_mfma_f32_16x16x32_bf16 v[4:7], v[52:55], a[160:163], v[4:7]
    ds_read_b64_tr_b16 v[68:69], v108 offset:20480
    ds_read_b64_tr_b16 v[70:71], v108 offset:22528
    v_mfma_f32_16x16x32_bf16 v[20:23], v[52:55], a[164:167], v[20:23]
    s_waitcnt lgkmcnt(3)
    v_add_u32 v233, s68, v249
    v_add_u32 v248, 256, v225
    v_mfma_f32_16x16x32_bf16 v[8:11], v[56:59], a[160:163], v[8:11]
    ds_read_b64_tr_b16 v[72:73], v109 offset:20480
    ds_read_b64_tr_b16 v[74:75], v109 offset:22528
    v_mfma_f32_16x16x32_bf16 v[24:27], v[56:59], a[164:167], v[24:27]
    buffer_load_dwordx4 a[216:219], v101, s[36:39], s31 offen offset:2048 sc1
    v_mfma_f32_16x16x32_bf16 v[12:15], v[60:63], a[160:163], v[12:15]
    ds_read_b64_tr_b16 v[76:77], v110 offset:20480
    ds_read_b64_tr_b16 v[78:79], v110 offset:22528
    v_mfma_f32_16x16x32_bf16 v[28:31], v[60:63], a[164:167], v[28:31]
    s_waitcnt vmcnt(11) lgkmcnt(4)
    v_mul_u32_u24 v249, 4682, v248
    v_lshrrev_b32 v249, 16, v249
    v_mfma_f32_16x16x32_bf16 v[32:35], v[64:67], a[160:163], v[32:35]
    ds_read_b64_tr_b16 v[80:81], v111 offset:20480
    ds_read_b64_tr_b16 v[82:83], v111 offset:22528
    v_mfma_f32_16x16x32_bf16 v[36:39], v[64:67], a[164:167], v[36:39]
    buffer_load_dwordx4 a[220:223], v101, s[36:39], s31 offen offset:3072 sc1
    v_mfma_f32_16x16x32_bf16 v[0:3], v[68:71], a[168:171], v[0:3]
    ds_read_b128 v[84:87], v112 offset:1344
    v_mfma_f32_16x16x32_bf16 v[16:19], v[68:71], a[172:175], v[16:19]
    s_waitcnt lgkmcnt(3)
    v_mad_i32_i24 v248, v249, -14, v248
    v_add_u32 v248, s69, v248
    v_mfma_f32_16x16x32_bf16 v[4:7], v[72:75], a[168:171], v[4:7]
    s_mov_b32 s31, 57344
    ds_read_b64_tr_b16 v[48:49], v108 offset:24576
    ds_read_b64_tr_b16 v[50:51], v108 offset:26624
    v_mfma_f32_16x16x32_bf16 v[20:23], v[72:75], a[172:175], v[20:23]
    buffer_load_dwordx4 a[224:227], v101, s[36:39], s31 offen offset:0 sc1
    v_mfma_f32_16x16x32_bf16 v[8:11], v[76:79], a[168:171], v[8:11]
    ds_read_b64_tr_b16 v[52:53], v109 offset:24576
    ds_read_b64_tr_b16 v[54:55], v109 offset:26624
    v_mfma_f32_16x16x32_bf16 v[24:27], v[76:79], a[172:175], v[24:27]
    s_waitcnt lgkmcnt(4)
    v_subrev_u32 v250, 14, v248
    v_min_u32 v248, v248, v250
    v_mfma_f32_16x16x32_bf16 v[12:15], v[80:83], a[168:171], v[12:15]
    ds_read_b64_tr_b16 v[56:57], v110 offset:24576
    ds_read_b64_tr_b16 v[58:59], v110 offset:26624
    v_mfma_f32_16x16x32_bf16 v[28:31], v[80:83], a[172:175], v[28:31]
    buffer_load_dwordx4 a[228:231], v101, s[36:39], s31 offen offset:1024 sc1
    v_mfma_f32_16x16x32_bf16 v[32:35], v[84:87], a[168:171], v[32:35]
    ds_read_b64_tr_b16 v[60:61], v111 offset:24576
    ds_read_b64_tr_b16 v[62:63], v111 offset:26624
    v_mfma_f32_16x16x32_bf16 v[36:39], v[84:87], a[172:175], v[36:39]
    s_waitcnt vmcnt(12) lgkmcnt(4)
    v_mul_u32_u24 v249, 7168, v249
    v_lshl_add_u32 v249, v248, 4, v249
    v_mfma_f32_16x16x32_bf16 v[0:3], v[48:51], a[176:179], v[0:3]
    ds_read_b128 v[64:67], v112 offset:1408
    v_mfma_f32_16x16x32_bf16 v[16:19], v[48:51], a[180:183], v[16:19]
    buffer_load_dwordx4 a[232:235], v101, s[36:39], s31 offen offset:2048 sc1
    v_mfma_f32_16x16x32_bf16 v[4:7], v[52:55], a[176:179], v[4:7]
    ds_read_b64_tr_b16 v[68:69], v108 offset:28672
    ds_read_b64_tr_b16 v[70:71], v108 offset:30720
    v_mfma_f32_16x16x32_bf16 v[20:23], v[52:55], a[180:183], v[20:23]
    s_waitcnt lgkmcnt(3)
    v_add_u32 v234, s68, v249
    v_add_u32 v248, 320, v225
    v_mfma_f32_16x16x32_bf16 v[8:11], v[56:59], a[176:179], v[8:11]
    ds_read_b64_tr_b16 v[72:73], v109 offset:28672
    ds_read_b64_tr_b16 v[74:75], v109 offset:30720
    v_mfma_f32_16x16x32_bf16 v[24:27], v[56:59], a[180:183], v[24:27]
    buffer_load_dwordx4 a[236:239], v101, s[36:39], s31 offen offset:3072 sc1
    v_mfma_f32_16x16x32_bf16 v[12:15], v[60:63], a[176:179], v[12:15]
    ds_read_b64_tr_b16 v[76:77], v110 offset:28672
    ds_read_b64_tr_b16 v[78:79], v110 offset:30720
    v_mfma_f32_16x16x32_bf16 v[28:31], v[60:63], a[180:183], v[28:31]
    s_waitcnt vmcnt(12) lgkmcnt(4)
    v_mul_u32_u24 v249, 4682, v248
    v_lshrrev_b32 v249, 16, v249
    v_mfma_f32_16x16x32_bf16 v[32:35], v[64:67], a[176:179], v[32:35]
    s_mov_b32 s31, 61440
    ds_read_b64_tr_b16 v[80:81], v111 offset:28672
    ds_read_b64_tr_b16 v[82:83], v111 offset:30720
    v_mfma_f32_16x16x32_bf16 v[36:39], v[64:67], a[180:183], v[36:39]
    buffer_load_dwordx4 a[240:243], v101, s[36:39], s31 offen offset:0 sc1
    v_mfma_f32_16x16x32_bf16 v[0:3], v[68:71], a[184:187], v[0:3]
    ds_read_b128 v[84:87], v112 offset:1472
    v_mfma_f32_16x16x32_bf16 v[16:19], v[68:71], a[188:191], v[16:19]
    s_waitcnt lgkmcnt(3)
    v_mad_i32_i24 v248, v249, -14, v248
    v_add_u32 v248, s69, v248
    v_mfma_f32_16x16x32_bf16 v[4:7], v[72:75], a[184:187], v[4:7]
    ds_read_b64_tr_b16 v[48:49], v108 offset:32768
    ds_read_b64_tr_b16 v[50:51], v108 offset:34816
    v_mfma_f32_16x16x32_bf16 v[20:23], v[72:75], a[188:191], v[20:23]
    buffer_load_dwordx4 a[244:247], v101, s[36:39], s31 offen offset:1024 sc1
    v_mfma_f32_16x16x32_bf16 v[8:11], v[76:79], a[184:187], v[8:11]
    ds_read_b64_tr_b16 v[52:53], v109 offset:32768
    ds_read_b64_tr_b16 v[54:55], v109 offset:34816
    v_mfma_f32_16x16x32_bf16 v[24:27], v[76:79], a[188:191], v[24:27]
    s_waitcnt lgkmcnt(4)
    v_subrev_u32 v250, 14, v248
    v_min_u32 v248, v248, v250
    v_mfma_f32_16x16x32_bf16 v[12:15], v[80:83], a[184:187], v[12:15]
    ds_read_b64_tr_b16 v[56:57], v110 offset:32768
    ds_read_b64_tr_b16 v[58:59], v110 offset:34816
    v_mfma_f32_16x16x32_bf16 v[28:31], v[80:83], a[188:191], v[28:31]
    buffer_load_dwordx4 a[248:251], v101, s[36:39], s31 offen offset:2048 sc1
    v_mfma_f32_16x16x32_bf16 v[32:35], v[84:87], a[184:187], v[32:35]
    ds_read_b64_tr_b16 v[60:61], v111 offset:32768
    ds_read_b64_tr_b16 v[62:63], v111 offset:34816
    v_mfma_f32_16x16x32_bf16 v[36:39], v[84:87], a[188:191], v[36:39]
    s_waitcnt vmcnt(13) lgkmcnt(4)
    v_mul_u32_u24 v249, 7168, v249
    v_lshl_add_u32 v249, v248, 4, v249
    v_mfma_f32_16x16x32_bf16 v[0:3], v[48:51], a[192:195], v[0:3]
    ds_read_b128 v[64:67], v112 offset:1536
    v_mfma_f32_16x16x32_bf16 v[16:19], v[48:51], a[196:199], v[16:19]
    buffer_load_dwordx4 a[252:255], v101, s[36:39], s31 offen offset:3072 sc1
    v_mfma_f32_16x16x32_bf16 v[4:7], v[52:55], a[192:195], v[4:7]
    ds_read_b64_tr_b16 v[68:69], v108 offset:36864
    ds_read_b64_tr_b16 v[70:71], v108 offset:38912
    v_mfma_f32_16x16x32_bf16 v[20:23], v[52:55], a[196:199], v[20:23]
    s_waitcnt lgkmcnt(3)
    v_subrev_u32 v249, 1024, v249
    v_add_u32 v235, s68, v249
    v_mfma_f32_16x16x32_bf16 v[8:11], v[56:59], a[192:195], v[8:11]
Lpad_7:
    s_cbranch_execz Lpad_11
    ds_read_b64_tr_b16 v[72:73], v109 offset:36864
    ds_read_b64_tr_b16 v[74:75], v109 offset:38912
    v_mfma_f32_16x16x32_bf16 v[24:27], v[56:59], a[196:199], v[24:27]
    v_add_u32 v248, 384, v225
    v_mul_u32_u24 v249, 4682, v248
    v_mfma_f32_16x16x32_bf16 v[12:15], v[60:63], a[192:195], v[12:15]
    ds_read_b64_tr_b16 v[76:77], v110 offset:36864
    ds_read_b64_tr_b16 v[78:79], v110 offset:38912
    v_mfma_f32_16x16x32_bf16 v[28:31], v[60:63], a[196:199], v[28:31]
    s_waitcnt vmcnt(12) lgkmcnt(4)
    v_lshrrev_b32 v249, 16, v249
    v_mad_i32_i24 v248, v249, -14, v248
    v_mfma_f32_16x16x32_bf16 v[32:35], v[64:67], a[192:195], v[32:35]
    ds_read_b64_tr_b16 v[80:81], v111 offset:36864
    ds_read_b64_tr_b16 v[82:83], v111 offset:38912
    v_mfma_f32_16x16x32_bf16 v[36:39], v[64:67], a[196:199], v[36:39]
    v_add_u32 v248, s69, v248
    v_subrev_u32 v250, 14, v248
    v_mfma_f32_16x16x32_bf16 v[0:3], v[68:71], a[200:203], v[0:3]
    ds_read_b128 v[84:87], v112 offset:1600
    v_mfma_f32_16x16x32_bf16 v[16:19], v[68:71], a[204:207], v[16:19]
    s_waitcnt lgkmcnt(3)
    v_min_u32 v248, v248, v250
    v_mul_u32_u24 v249, 7168, v249
    v_mfma_f32_16x16x32_bf16 v[4:7], v[72:75], a[200:203], v[4:7]
    ds_read_b64_tr_b16 v[48:49], v108 offset:40960
    ds_read_b64_tr_b16 v[50:51], v108 offset:43008
    v_mfma_f32_16x16x32_bf16 v[20:23], v[72:75], a[204:207], v[20:23]
    v_lshl_add_u32 v249, v248, 4, v249
    v_subrev_u32 v249, 2048, v249
    v_mfma_f32_16x16x32_bf16 v[8:11], v[76:79], a[200:203], v[8:11]
    ds_read_b64_tr_b16 v[52:53], v109 offset:40960
    ds_read_b64_tr_b16 v[54:55], v109 offset:43008
    v_mfma_f32_16x16x32_bf16 v[24:27], v[76:79], a[204:207], v[24:27]
    s_waitcnt lgkmcnt(4)
    v_add_u32 v236, s68, v249
    v_mfma_f32_16x16x32_bf16 v[12:15], v[80:83], a[200:203], v[12:15]
    ds_read_b64_tr_b16 v[56:57], v110 offset:40960
    ds_read_b64_tr_b16 v[58:59], v110 offset:43008
    v_mfma_f32_16x16x32_bf16 v[28:31], v[80:83], a[204:207], v[28:31]
    v_mfma_f32_16x16x32_bf16 v[32:35], v[84:87], a[200:203], v[32:35]
    ds_read_b64_tr_b16 v[60:61], v111 offset:40960
    ds_read_b64_tr_b16 v[62:63], v111 offset:43008
    v_mfma_f32_16x16x32_bf16 v[36:39], v[84:87], a[204:207], v[36:39]
    s_waitcnt vmcnt(10) lgkmcnt(4)
    v_mfma_f32_16x16x32_bf16 v[0:3], v[48:51], a[208:211], v[0:3]
    ds_read_b128 v[64:67], v112 offset:1664
    v_mfma_f32_16x16x32_bf16 v[16:19], v[48:51], a[212:215], v[16:19]
    v_mfma_f32_16x16x32_bf16 v[4:7], v[52:55], a[208:211], v[4:7]
    ds_read_b64_tr_b16 v[68:69], v108 offset:45056
    ds_read_b64_tr_b16 v[70:71], v108 offset:47104
    v_mfma_f32_16x16x32_bf16 v[20:23], v[52:55], a[212:215], v[20:23]
    s_waitcnt lgkmcnt(3)
    v_mfma_f32_16x16x32_bf16 v[8:11], v[56:59], a[208:211], v[8:11]
    ds_read_b64_tr_b16 v[72:73], v109 offset:45056
    ds_read_b64_tr_b16 v[74:75], v109 offset:47104
    v_mfma_f32_16x16x32_bf16 v[24:27], v[56:59], a[212:215], v[24:27]
    v_mfma_f32_16x16x32_bf16 v[12:15], v[60:63], a[208:211], v[12:15]
    ds_read_b64_tr_b16 v[76:77], v110 offset:45056
    ds_read_b64_tr_b16 v[78:79], v110 offset:47104
    v_mfma_f32_16x16x32_bf16 v[28:31], v[60:63], a[212:215], v[28:31]
    s_waitcnt vmcnt(8) lgkmcnt(4)
    v_mfma_f32_16x16x32_bf16 v[32:35], v[64:67], a[208:211], v[32:35]
    ds_read_b64_tr_b16 v[80:81], v111 offset:45056
    ds_read_b64_tr_b16 v[82:83], v111 offset:47104
    v_mfma_f32_16x16x32_bf16 v[36:39], v[64:67], a[212:215], v[36:39]
    v_mfma_f32_16x16x32_bf16 v[0:3], v[68:71], a[216:219], v[0:3]
    ds_read_b128 v[84:87], v112 offset:1728
    v_mfma_f32_16x16x32_bf16 v[16:19], v[68:71], a[220:223], v[16:19]
    s_waitcnt lgkmcnt(3)
    v_mfma_f32_16x16x32_bf16 v[4:7], v[72:75], a[216:219], v[4:7]
    ds_read_b64_tr_b16 v[48:49], v108 offset:49152
    ds_read_b64_tr_b16 v[50:51], v108 offset:51200
    v_mfma_f32_16x16x32_bf16 v[20:23], v[72:75], a[220:223], v[20:23]
    v_mfma_f32_16x16x32_bf16 v[8:11], v[76:79], a[216:219], v[8:11]
    ds_read_b64_tr_b16 v[52:53], v109 offset:49152
    ds_read_b64_tr_b16 v[54:55], v109 offset:51200
    v_mfma_f32_16x16x32_bf16 v[24:27], v[76:79], a[220:223], v[24:27]
    s_waitcnt lgkmcnt(4)
    v_mfma_f32_16x16x32_bf16 v[12:15], v[80:83], a[216:219], v[12:15]
    ds_read_b64_tr_b16 v[56:57], v110 offset:49152
    ds_read_b64_tr_b16 v[58:59], v110 offset:51200
    v_mfma_f32_16x16x32_bf16 v[28:31], v[80:83], a[220:223], v[28:31]
    v_mfma_f32_16x16x32_bf16 v[32:35], v[84:87], a[216:219], v[32:35]
    ds_read_b64_tr_b16 v[60:61], v111 offset:49152
    ds_read_b64_tr_b16 v[62:63], v111 offset:51200
    v_mfma_f32_16x16x32_bf16 v[36:39], v[84:87], a[220:223], v[36:39]
    s_waitcnt vmcnt(6) lgkmcnt(4)
    v_mfma_f32_16x16x32_bf16 v[0:3], v[48:51], a[224:227], v[0:3]
    ds_read_b128 v[64:67], v112 offset:1792
    v_mfma_f32_16x16x32_bf16 v[16:19], v[48:51], a[228:231], v[16:19]
    v_mfma_f32_16x16x32_bf16 v[4:7], v[52:55], a[224:227], v[4:7]
    ds_read_b64_tr_b16 v[68:69], v108 offset:53248
    ds_read_b64_tr_b16 v[70:71], v108 offset:55296
    v_mfma_f32_16x16x32_bf16 v[20:23], v[52:55], a[228:231], v[20:23]
    s_waitcnt lgkmcnt(3)
    v_mfma_f32_16x16x32_bf16 v[8:11], v[56:59], a[224:227], v[8:11]
    ds_read_b64_tr_b16 v[72:73], v109 offset:53248
    ds_read_b64_tr_b16 v[74:75], v109 offset:55296
    v_mfma_f32_16x16x32_bf16 v[24:27], v[56:59], a[228:231], v[24:27]
    v_mfma_f32_16x16x32_bf16 v[12:15], v[60:63], a[224:227], v[12:15]
    ds_read_b64_tr_b16 v[76:77], v110 offset:53248
    ds_read_b64_tr_b16 v[78:79], v110 offset:55296
    v_mfma_f32_16x16x32_bf16 v[28:31], v[60:63], a[228:231], v[28:31]
    s_waitcnt vmcnt(4) lgkmcnt(4)
    v_mfma_f32_16x16x32_bf16 v[32:35], v[64:67], a[224:227], v[32:35]
    ds_read_b64_tr_b16 v[80:81], v111 offset:53248
    ds_read_b64_tr_b16 v[82:83], v111 offset:55296
    v_mfma_f32_16x16x32_bf16 v[36:39], v[64:67], a[228:231], v[36:39]
    v_mfma_f32_16x16x32_bf16 v[0:3], v[68:71], a[232:235], v[0:3]
    ds_read_b128 v[84:87], v112 offset:1856
    v_mfma_f32_16x16x32_bf16 v[16:19], v[68:71], a[236:239], v[16:19]
    s_waitcnt lgkmcnt(3)
    v_mfma_f32_16x16x32_bf16 v[4:7], v[72:75], a[232:235], v[4:7]
    ds_read_b64_tr_b16 v[48:49], v108 offset:57344
    ds_read_b64_tr_b16 v[50:51], v108 offset:59392
    v_mfma_f32_16x16x32_bf16 v[20:23], v[72:75], a[236:239], v[20:23]
    v_mfma_f32_16x16x32_bf16 v[8:11], v[76:79], a[232:235], v[8:11]
    ds_read_b64_tr_b16 v[52:53], v109 offset:57344
    ds_read_b64_tr_b16 v[54:55], v109 offset:59392
    v_mfma_f32_16x16x32_bf16 v[24:27], v[76:79], a[236:239], v[24:27]
    s_waitcnt lgkmcnt(4)
    v_mfma_f32_16x16x32_bf16 v[12:15], v[80:83], a[232:235], v[12:15]
    ds_read_b64_tr_b16 v[56:57], v110 offset:57344
    ds_read_b64_tr_b16 v[58:59], v110 offset:59392
    v_mfma_f32_16x16x32_bf16 v[28:31], v[80:83], a[236:239], v[28:31]
    v_mfma_f32_16x16x32_bf16 v[32:35], v[84:87], a[232:235], v[32:35]
    ds_read_b64_tr_b16 v[60:61], v111 offset:57344
    ds_read_b64_tr_b16 v[62:63], v111 offset:59392
    v_mfma_f32_16x16x32_bf16 v[36:39], v[84:87], a[236:239], v[36:39]
    s_waitcnt vmcnt(2) lgkmcnt(4)
    v_mfma_f32_16x16x32_bf16 v[0:3], v[48:51], a[240:243], v[0:3]
    ds_read_b128 v[64:67], v112 offset:1920
    v_mfma_f32_16x16x32_bf16 v[16:19], v[48:51], a[244:247], v[16:19]
    v_mfma_f32_16x16x32_bf16 v[4:7], v[52:55], a[240:243], v[4:7]
    ds_read_b64_tr_b16 v[68:69], v108 offset:61440
    ds_read_b64_tr_b16 v[70:71], v108 offset:63488
    v_mfma_f32_16x16x32_bf16 v[20:23], v[52:55], a[244:247], v[20:23]
    s_waitcnt lgkmcnt(3)
    v_mfma_f32_16x16x32_bf16 v[8:11], v[56:59], a[240:243], v[8:11]
    ds_read_b64_tr_b16 v[72:73], v109 offset:61440
    ds_read_b64_tr_b16 v[74:75], v109 offset:63488
    v_mfma_f32_16x16x32_bf16 v[24:27], v[56:59], a[244:247], v[24:27]
    v_mfma_f32_16x16x32_bf16 v[12:15], v[60:63], a[240:243], v[12:15]
    ds_read_b64_tr_b16 v[76:77], v110 offset:61440
    ds_read_b64_tr_b16 v[78:79], v110 offset:63488
    v_mfma_f32_16x16x32_bf16 v[28:31], v[60:63], a[244:247], v[28:31]
    s_waitcnt vmcnt(0) lgkmcnt(4)
    v_mfma_f32_16x16x32_bf16 v[32:35], v[64:67], a[240:243], v[32:35]
    ds_read_b64_tr_b16 v[80:81], v111 offset:61440
    ds_read_b64_tr_b16 v[82:83], v111 offset:63488
    v_mfma_f32_16x16x32_bf16 v[36:39], v[64:67], a[244:247], v[36:39]
    v_mfma_f32_16x16x32_bf16 v[0:3], v[68:71], a[248:251], v[0:3]
    ds_read_b128 v[84:87], v112 offset:1984
    v_mfma_f32_16x16x32_bf16 v[16:19], v[68:71], a[252:255], v[16:19]
    s_waitcnt lgkmcnt(3)
    v_mfma_f32_16x16x32_bf16 v[4:7], v[72:75], a[248:251], v[4:7]
    v_mfma_f32_16x16x32_bf16 v[20:23], v[72:75], a[252:255], v[20:23]
    v_mfma_f32_16x16x32_bf16 v[8:11], v[76:79], a[248:251], v[8:11]
    v_mfma_f32_16x16x32_bf16 v[24:27], v[76:79], a[252:255], v[24:27]
    s_waitcnt lgkmcnt(0)
    v_mfma_f32_16x16x32_bf16 v[12:15], v[80:83], a[248:251], v[12:15]
    v_mfma_f32_16x16x32_bf16 v[28:31], v[80:83], a[252:255], v[28:31]
    v_mfma_f32_16x16x32_bf16 v[32:35], v[84:87], a[248:251], v[32:35]
    v_mfma_f32_16x16x32_bf16 v[36:39], v[84:87], a[252:255], v[36:39]
    s_barrier
    s_mov_b32 s52, 0
    s_add_u32 m0, s3, 0
    s_nop 0
    buffer_load_dwordx4 v230, s[32:35], s52 offen offset:0 lds
    buffer_load_dwordx4 v231, s[32:35], s52 offen offset:1024 lds
    buffer_load_dwordx4 v232, s[32:35], s52 offen offset:2048 lds
    buffer_load_dwordx4 v233, s[32:35], s52 offen offset:3072 lds
    s_add_u32 m0, s3, 4096
    s_nop 0
    buffer_load_dwordx4 v234, s[32:35], s52 offen offset:0 lds
    s_nop 1
    v_add_f32 v144, v144, v32
    v_add_f32 v146, v146, v36
    v_pk_add_f32 v[160:161], v[160:161], v[144:145] op_sel_hi:[1,0] neg_lo:[0,1] neg_hi:[0,1]
    v_pk_add_f32 v[0:1], v[0:1], v[160:161]
    v_pk_add_f32 v[162:163], v[162:163], v[144:145] op_sel_hi:[1,0] neg_lo:[0,1] neg_hi:[0,1]
    v_pk_add_f32 v[2:3], v[2:3], v[162:163]
    v_pk_add_f32 v[164:165], v[164:165], v[144:145] op_sel_hi:[1,0] neg_lo:[0,1] neg_hi:[0,1]
    v_pk_add_f32 v[4:5], v[4:5], v[164:165]
    v_pk_add_f32 v[166:167], v[166:167], v[144:145] op_sel_hi:[1,0] neg_lo:[0,1] neg_hi:[0,1]
    v_pk_add_f32 v[6:7], v[6:7], v[166:167]
    v_pk_add_f32 v[168:169], v[168:169], v[144:145] op_sel_hi:[1,0] neg_lo:[0,1] neg_hi:[0,1]
    v_pk_add_f32 v[8:9], v[8:9], v[168:169]
    v_pk_add_f32 v[170:171], v[170:171], v[144:145] op_sel_hi:[1,0] neg_lo:[0,1] neg_hi:[0,1]
    v_pk_add_f32 v[10:11], v[10:11], v[170:171]
    v_pk_add_f32 v[172:173], v[172:173], v[144:145] op_sel_hi:[1,0] neg_lo:[0,1] neg_hi:[0,1]
    v_pk_add_f32 v[12:13], v[12:13], v[172:173]
    v_pk_add_f32 v[174:175], v[174:175], v[144:145] op_sel_hi:[1,0] neg_lo:[0,1] neg_hi:[0,1]
    v_pk_add_f32 v[14:15], v[14:15], v[174:175]
    v_cvt_pk_bf16_f32 v128, v0, v1
    v_cvt_pk_bf16_f32 v129, v2, v3
    v_cvt_pk_bf16_f32 v130, v4, v5
    v_cvt_pk_bf16_f32 v131, v6, v7
    v_cvt_pk_bf16_f32 v132, v8, v9
    v_cvt_pk_bf16_f32 v133, v10, v11
    v_cvt_pk_bf16_f32 v134, v12, v13
    v_cvt_pk_bf16_f32 v135, v14, v15
    buffer_store_dwordx4 v[128:131], v101, s[40:43], 0 offen offset:0 sc1
    buffer_store_dwordx4 v[132:135], v101, s[40:43], 0 offen offset:2048 sc1
    v_pk_add_f32 v[176:177], v[176:177], v[146:147] op_sel_hi:[1,0] neg_lo:[0,1] neg_hi:[0,1]
    v_pk_add_f32 v[16:17], v[16:17], v[176:177]
    v_pk_add_f32 v[178:179], v[178:179], v[146:147] op_sel_hi:[1,0] neg_lo:[0,1] neg_hi:[0,1]
    v_pk_add_f32 v[18:19], v[18:19], v[178:179]
    v_pk_add_f32 v[180:181], v[180:181], v[146:147] op_sel_hi:[1,0] neg_lo:[0,1] neg_hi:[0,1]
    v_pk_add_f32 v[20:21], v[20:21], v[180:181]
    v_pk_add_f32 v[182:183], v[182:183], v[146:147] op_sel_hi:[1,0] neg_lo:[0,1] neg_hi:[0,1]
    v_pk_add_f32 v[22:23], v[22:23], v[182:183]
    v_pk_add_f32 v[184:185], v[184:185], v[146:147] op_sel_hi:[1,0] neg_lo:[0,1] neg_hi:[0,1]
    v_pk_add_f32 v[24:25], v[24:25], v[184:185]
    v_pk_add_f32 v[186:187], v[186:187], v[146:147] op_sel_hi:[1,0] neg_lo:[0,1] neg_hi:[0,1]
    v_pk_add_f32 v[26:27], v[26:27], v[186:187]
    v_pk_add_f32 v[188:189], v[188:189], v[146:147] op_sel_hi:[1,0] neg_lo:[0,1] neg_hi:[0,1]
    v_pk_add_f32 v[28:29], v[28:29], v[188:189]
    v_pk_add_f32 v[190:191], v[190:191], v[146:147] op_sel_hi:[1,0] neg_lo:[0,1] neg_hi:[0,1]
    v_pk_add_f32 v[30:31], v[30:31], v[190:191]
    v_cvt_pk_bf16_f32 v136, v16, v17
    v_cvt_pk_bf16_f32 v137, v18, v19
    v_cvt_pk_bf16_f32 v138, v20, v21
    v_cvt_pk_bf16_f32 v139, v22, v23
    v_cvt_pk_bf16_f32 v140, v24, v25
    v_cvt_pk_bf16_f32 v141, v26, v27
    v_cvt_pk_bf16_f32 v142, v28, v29
    v_cvt_pk_bf16_f32 v143, v30, v31
    buffer_store_dwordx4 v[136:139], v101, s[40:43], 0 offen offset:1024 sc1
    buffer_store_dwordx4 v[140:143], v101, s[40:43], 0 offen offset:3072 sc1
    v_pk_mul_f32 v[148:149], v[0:1], v[0:1]
    v_pk_fma_f32 v[148:149], v[2:3], v[2:3], v[148:149]
    v_pk_fma_f32 v[148:149], v[4:5], v[4:5], v[148:149]
    v_pk_fma_f32 v[148:149], v[6:7], v[6:7], v[148:149]
    v_pk_fma_f32 v[148:149], v[8:9], v[8:9], v[148:149]
    v_pk_fma_f32 v[148:149], v[10:11], v[10:11], v[148:149]
    v_pk_fma_f32 v[148:149], v[12:13], v[12:13], v[148:149]
    v_pk_fma_f32 v[148:149], v[14:15], v[14:15], v[148:149]
    v_add_f32 v148, v148, v149
    v_pk_mul_f32 v[150:151], v[16:17], v[16:17]
    v_pk_fma_f32 v[150:151], v[18:19], v[18:19], v[150:151]
    v_pk_fma_f32 v[150:151], v[20:21], v[20:21], v[150:151]
    v_pk_fma_f32 v[150:151], v[22:23], v[22:23], v[150:151]
    v_pk_fma_f32 v[150:151], v[24:25], v[24:25], v[150:151]
    v_pk_fma_f32 v[150:151], v[26:27], v[26:27], v[150:151]
    v_pk_fma_f32 v[150:151], v[28:29], v[28:29], v[150:151]
    v_pk_fma_f32 v[150:151], v[30:31], v[30:31], v[150:151]
    v_add_f32 v150, v150, v151
    s_lshl_b32 s27, s26, 13
    s_add_u32 s27, s27, s55
    v_permlane16_swap_b32 v148, v150
    v_permlane16_swap_b32 v144, v146
    v_add_f32 v148, v148, v150
    v_mov_b32 v149, v148
    s_lshl_b32 s28, s26, 20
    s_add_u32 s28, s28, s55
    v_permlane32_swap_b32 v148, v149
    s_add_u32 s28, s28, 278528
    v_add_f32 v148, v148, v149
    buffer_store_dword v148, v122, s[48:51], s27 offen sc1
    buffer_store_dword v144, v122, s[48:51], s28 offen sc1
    s_lshr_b32 s0, s25, 1
    s_lshl_b32 s0, s0, 7
    s_add_u32 s0, s0, 788480
    buffer_load_dwordx4 v235, s[32:35], s52 offen offset:1024 lds
    buffer_load_dwordx4 v236, s[32:35], s52 offen offset:2048 lds
    s_mov_b32 s52, 458752
    s_add_u32 m0, s3, 28672
    s_nop 0
    buffer_load_dwordx4 v230, s[32:35], s52 offen offset:0 lds
    v_lshlrev_b32 v226, 4, v225
    s_lshl_b32 s27, s1, 16
    s_add_u32 s27, s27, 12582912
    s_add_u32 s36, s22, s27
    s_addc_u32 s37, s23, 0
    s_mov_b32 s38, 33620096
    s_mov_b32 s39, 0x20000
    s_add_u32 s27, s27, 65536
    s_add_u32 s40, s22, s27
    s_addc_u32 s41, s23, 0
    s_mov_b32 s42, 33620096
    s_mov_b32 s43, 0x20000
    s_lshr_b32 s31, s1, 3
    s_lshl_b32 s31, s31, 7
    s_add_u32 s31, s31, 788480
    v_lshrrev_b32 v248, 2, v225
    v_mul_u32_u24 v248, 224, v248
    v_and_b32 v249, 3, v225
    v_lshl_add_u32 v227, v249, 3, v248
    v_add_u32 v228, 57344, v227
    v_add_u32 v229, 114688, v227
    v_lshlrev_b32 v237, 7, v225
    v_lshlrev_b32 v239, 3, v225
    s_bitcmp1_b32 s2, 0
    s_cselect_b32 s64, s14, s12
    s_cselect_b32 s65, s15, s13
    s_mov_b32 s96, s16
    s_mov_b32 s97, s17
    s_cmp_eq_u32 s24, 0
    s_cselect_b32 s66, 7340032, 0
    s_mov_b32 s98, s66
    s_mov_b32 s67, 0x20000
    s_mov_b32 s99, 0x20000
    s_bitcmp1_b32 0x98891199, s94
    s_cselect_b32 s66, s66, 0
    s_cselect_b32 s68, 0, 0x4000000
    s_bfm_b32 s63, s94, 0
    s_and_b32 s63, s63, 0x98891199
    s_bcnt1_i32_b32 s63, s63
    s_lshl_b32 s63, s63, 2
    s_bfe_u32 s62, s2, 0x20003
    s_add_u32 s62, s62, s63
    s_lshl_b32 s63, s62, 1
    s_and_b32 s69, s2, 1
    s_add_u32 s63, s63, s69
    s_lshl_b32 s62, s62, 13
    s_lshl_b32 s63, s63, 13
    s_add_u32 s63, s63, s68
    v_and_b32 v248, 15, v225
    v_lshrrev_b32 v249, 4, v225
    v_lshlrev_b32 v249, 15, v249
    v_lshl_add_u32 v244, v248, 4, v249
    s_lshl_b32 s27, s24, 8
    s_add_u32 s27, s27, 143360
    v_lshl_add_u32 v245, v248, 4, s27
    v_lshl_add_u32 v246, v248, 2, s27
    s_lshl_b32 s60, s1, 7
    s_mul_i32 s27, s1, 229376
    s_add_u32 s27, s27, 16777216
    s_add_u32 s56, s22, s27
    s_addc_u32 s57, s23, 0
    s_mov_b32 s58, 34013312
    s_mov_b32 s59, 0x20000
    s_mul_i32 s54, s94, 7
    s_add_u32 s54, s54, s95
    s_lshl_b32 s54, s54, 10
    s_mul_i32 s55, s95, 7680
    s_sub_u32 s55, s54, s55
    s_add_u32 s55, s55, 6144
    buffer_load_dwordx4 v231, s[32:35], s52 offen offset:1024 lds
    s_lshl_b32 s27, s24, 6
    v_add_lshl_u32 v252, v225, s27, 22
    v_mov_b32 v253, 1
    s_waitcnt vmcnt(4)
    s_barrier
    buffer_atomic_add v253, v252, s[44:47], s0 offen sc1
    buffer_load_dwordx4 v232, s[32:35], s52 offen offset:2048 lds
    buffer_load_dwordx4 v233, s[32:35], s52 offen offset:3072 lds
    s_add_u32 m0, s3, 32768
    s_nop 0
    buffer_load_dwordx4 v234, s[32:35], s52 offen offset:0 lds
    buffer_load_dwordx4 v235, s[32:35], s52 offen offset:1024 lds
    buffer_load_dwordx4 v236, s[32:35], s52 offen offset:2048 lds
    s_mov_b32 s52, 917504
    s_add_u32 m0, s3, 57344
    s_nop 0
    buffer_load_dwordx4 v230, s[32:35], s52 offen offset:0 lds
    buffer_load_dwordx4 v231, s[32:35], s52 offen offset:1024 lds
    buffer_load_dwordx4 v232, s[32:35], s52 offen offset:2048 lds
    buffer_load_dwordx4 v233, s[32:35], s52 offen offset:3072 lds
    s_add_u32 m0, s3, 61440
    s_nop 0
    buffer_load_dwordx4 v234, s[32:35], s52 offen offset:0 lds
    buffer_load_dwordx4 v235, s[32:35], s52 offen offset:1024 lds
    buffer_load_dwordx4 v236, s[32:35], s52 offen offset:2048 lds
    s_cmp_lg_u32 s24, 0
    s_cbranch_scc1 Lnopoll_11
    v_mov_b32 v255, 0
    buffer_atomic_or v255, v252, s[44:47], s31 offen sc0 sc1
    s_waitcnt vmcnt(0)
    v_cmp_gt_u32 vcc, 32, v255
    s_mov_b32 s27, 0x80000
    s_and_b64 vcc, vcc, 1
    s_cbranch_scc0 Lok_12
Lspin_13:
    s_sleep 2
    v_mov_b32 v255, 0
    buffer_atomic_or v255, v252, s[44:47], s31 offen sc0 sc1
    s_waitcnt vmcnt(0)
    v_cmp_gt_u32 vcc, 32, v255
    s_sub_u32 s27, s27, 1
    s_cbranch_scc1 Lok_12
    s_and_b64 vcc, vcc, 1
    s_cbranch_scc1 Lspin_13
Lok_12:
Lnopoll_11:
    s_waitcnt vmcnt(0)
    s_barrier
    s_mov_b32 s53, 0
    buffer_load_dwordx4 a[0:3], v226, s[36:39], s53 offen offset:0 sc1
    buffer_load_dwordx4 a[4:7], v226, s[36:39], s53 offen offset:1024 sc1
    buffer_load_dwordx4 a[8:11], v226, s[40:43], s53 offen offset:0 sc1
    buffer_load_dwordx4 a[12:15], v226, s[40:43], s53 offen offset:1024 sc1
    buffer_load_dwordx4 a[16:19], v226, s[36:39], s53 offen offset:2048 sc1
    buffer_load_dwordx4 a[20:23], v226, s[36:39], s53 offen offset:3072 sc1
    buffer_load_dwordx4 a[24:27], v226, s[40:43], s53 offen offset:2048 sc1
    buffer_load_dwordx4 a[28:31], v226, s[40:43], s53 offen offset:3072 sc1
    s_mov_b32 s53, 4096
    buffer_load_dwordx4 a[32:35], v226, s[36:39], s53 offen offset:0 sc1
    buffer_load_dwordx4 a[36:39], v226, s[36:39], s53 offen offset:1024 sc1
    ds_read_b64_tr_b16 a[160:161], v227 offset:0
    ds_read_b64_tr_b16 a[162:163], v227 offset:3584
    ds_read_b64_tr_b16 a[164:165], v227 offset:32
    ds_read_b64_tr_b16 a[166:167], v227 offset:3616
    ds_read_b64_tr_b16 a[168:169], v227 offset:64
    ds_read_b64_tr_b16 a[170:171], v227 offset:3648
    ds_read_b64_tr_b16 a[172:173], v227 offset:96
    ds_read_b64_tr_b16 a[174:175], v227 offset:3680
    s_waitcnt vmcnt(6) lgkmcnt(6)
    v_mfma_f32_16x16x32_bf16 v[0:3], a[160:163], a[0:3], 0
    ds_read_b64_tr_b16 a[176:177], v227 offset:128
    v_mfma_f32_16x16x32_bf16 v[56:59], a[160:163], a[4:7], 0
    buffer_load_dwordx4 a[40:43], v226, s[40:43], s53 offen offset:0 sc1
    v_mfma_f32_16x16x32_bf16 v[112:115], a[160:163], a[8:11], 0
    ds_read_b64_tr_b16 a[178:179], v227 offset:3712
    v_mfma_f32_16x16x32_bf16 v[168:171], a[160:163], a[12:15], 0
    s_waitcnt lgkmcnt(6)
    v_mfma_f32_16x16x32_bf16 v[4:7], a[164:167], a[0:3], 0
    ds_read_b64_tr_b16 a[180:181], v227 offset:160
    v_mfma_f32_16x16x32_bf16 v[60:63], a[164:167], a[4:7], 0
    buffer_load_dwordx4 a[44:47], v226, s[40:43], s53 offen offset:1024 sc1
    v_mfma_f32_16x16x32_bf16 v[116:119], a[164:167], a[8:11], 0
    ds_read_b64_tr_b16 a[182:183], v227 offset:3744
    v_mfma_f32_16x16x32_bf16 v[172:175], a[164:167], a[12:15], 0
    s_waitcnt lgkmcnt(6)
    v_mfma_f32_16x16x32_bf16 v[8:11], a[168:171], a[0:3], 0
    ds_read_b64_tr_b16 a[184:185], v227 offset:192
    v_mfma_f32_16x16x32_bf16 v[64:67], a[168:171], a[4:7], 0
    buffer_load_dwordx4 a[48:51], v226, s[36:39], s53 offen offset:2048 sc1
    v_mfma_f32_16x16x32_bf16 v[120:123], a[168:171], a[8:11], 0
    ds_read_b64_tr_b16 a[186:187], v227 offset:3776
    v_mfma_f32_16x16x32_bf16 v[176:179], a[168:171], a[12:15], 0
    s_waitcnt lgkmcnt(6)
    v_mfma_f32_16x16x32_bf16 v[12:15], a[172:175], a[0:3], 0
    ds_read_b64_tr_b16 a[160:161], v227 offset:14336
    v_mfma_f32_16x16x32_bf16 v[68:71], a[172:175], a[4:7], 0
    buffer_load_dwordx4 a[52:55], v226, s[36:39], s53 offen offset:3072 sc1
    v_mfma_f32_16x16x32_bf16 v[124:127], a[172:175], a[8:11], 0
    ds_read_b64_tr_b16 a[162:163], v227 offset:17920
    v_mfma_f32_16x16x32_bf16 v[180:183], a[172:175], a[12:15], 0
    s_waitcnt lgkmcnt(6)
    v_mfma_f32_16x16x32_bf16 v[16:19], a[176:179], a[0:3], 0
    ds_read_b64_tr_b16 a[164:165], v227 offset:14368
    v_mfma_f32_16x16x32_bf16 v[72:75], a[176:179], a[4:7], 0
    buffer_load_dwordx4 a[56:59], v226, s[40:43], s53 offen offset:2048 sc1
    v_mfma_f32_16x16x32_bf16 v[128:131], a[176:179], a[8:11], 0
    ds_read_b64_tr_b16 a[166:167], v227 offset:17952
    v_mfma_f32_16x16x32_bf16 v[184:187], a[176:179], a[12:15], 0
    s_waitcnt lgkmcnt(6)
    v_mfma_f32_16x16x32_bf16 v[20:23], a[180:183], a[0:3], 0
    ds_read_b64_tr_b16 a[168:169], v227 offset:14400
    v_mfma_f32_16x16x32_bf16 v[76:79], a[180:183], a[4:7], 0
    buffer_load_dwordx4 a[60:63], v226, s[40:43], s53 offen offset:3072 sc1
    v_mfma_f32_16x16x32_bf16 v[132:135], a[180:183], a[8:11], 0
    ds_read_b64_tr_b16 a[170:171], v227 offset:17984
    v_mfma_f32_16x16x32_bf16 v[188:191], a[180:183], a[12:15], 0
    s_waitcnt lgkmcnt(6)
    v_mfma_f32_16x16x32_bf16 v[24:27], a[184:187], a[0:3], 0
    s_mov_b32 s53, 8192
    ds_read_b64_tr_b16 a[172:173], v227 offset:14432
    v_mfma_f32_16x16x32_bf16 v[80:83], a[184:187], a[4:7], 0
    buffer_load_dwordx4 a[64:67], v226, s[36:39], s53 offen offset:0 sc1
    v_mfma_f32_16x16x32_bf16 v[136:139], a[184:187], a[8:11], 0
    ds_read_b64_tr_b16 a[174:175], v227 offset:18016
    v_mfma_f32_16x16x32_bf16 v[192:195], a[184:187], a[12:15], 0
    s_waitcnt lgkmcnt(6)
    v_mfma_f32_16x16x32_bf16 v[28:31], a[160:163], a[0:3], 0
    ds_read_b64_tr_b16 a[176:177], v227 offset:14464
    v_mfma_f32_16x16x32_bf16 v[84:87], a[160:163], a[4:7], 0
    buffer_load_dwordx4 a[68:71], v226, s[36:39], s53 offen offset:1024 sc1
    v_mfma_f32_16x16x32_bf16 v[140:143], a[160:163], a[8:11], 0
    ds_read_b64_tr_b16 a[178:179], v227 offset:18048
    v_mfma_f32_16x16x32_bf16 v[196:199], a[160:163], a[12:15], 0
    s_waitcnt lgkmcnt(6)
    v_mfma_f32_16x16x32_bf16 v[32:35], a[164:167], a[0:3], 0
    ds_read_b64_tr_b16 a[180:181], v227 offset:14496
    v_mfma_f32_16x16x32_bf16 v[88:91], a[164:167], a[4:7], 0
    buffer_load_dwordx4 a[72:75], v226, s[40:43], s53 offen offset:0 sc1
    v_mfma_f32_16x16x32_bf16 v[144:147], a[164:167], a[8:11], 0
    ds_read_b64_tr_b16 a[182:183], v227 offset:18080
    v_mfma_f32_16x16x32_bf16 v[200:203], a[164:167], a[12:15], 0
    s_waitcnt lgkmcnt(6)
    v_mfma_f32_16x16x32_bf16 v[36:39], a[168:171], a[0:3], 0
    ds_read_b64_tr_b16 a[184:185], v227 offset:14528
    v_mfma_f32_16x16x32_bf16 v[92:95], a[168:171], a[4:7], 0
    buffer_load_dwordx4 a[76:79], v226, s[40:43], s53 offen offset:1024 sc1
    v_mfma_f32_16x16x32_bf16 v[148:151], a[168:171], a[8:11], 0
    ds_read_b64_tr_b16 a[186:187], v227 offset:18112
    v_mfma_f32_16x16x32_bf16 v[204:207], a[168:171], a[12:15], 0
    s_waitcnt lgkmcnt(6)
    v_mfma_f32_16x16x32_bf16 v[40:43], a[172:175], a[0:3], 0
    ds_read_b64_tr_b16 a[160:161], v227 offset:7168
    v_mfma_f32_16x16x32_bf16 v[96:99], a[172:175], a[4:7], 0
    buffer_load_dwordx4 a[80:83], v226, s[36:39], s53 offen offset:2048 sc1
    v_mfma_f32_16x16x32_bf16 v[152:155], a[172:175], a[8:11], 0
    ds_read_b64_tr_b16 a[162:163], v227 offset:10752
    v_mfma_f32_16x16x32_bf16 v[208:211], a[172:175], a[12:15], 0
    s_waitcnt lgkmcnt(6)
    v_mfma_f32_16x16x32_bf16 v[44:47], a[176:179], a[0:3], 0
    ds_read_b64_tr_b16 a[164:165], v227 offset:7200
    v_mfma_f32_16x16x32_bf16 v[100:103], a[176:179], a[4:7], 0
    buffer_load_dwordx4 a[84:87], v226, s[36:39], s53 offen offset:3072 sc1
    v_mfma_f32_16x16x32_bf16 v[156:159], a[176:179], a[8:11], 0
    ds_read_b64_tr_b16 a[166:167], v227 offset:10784
    v_mfma_f32_16x16x32_bf16 v[212:215], a[176:179], a[12:15], 0
    s_waitcnt lgkmcnt(6)
    v_mfma_f32_16x16x32_bf16 v[48:51], a[180:183], a[0:3], 0
    ds_read_b64_tr_b16 a[168:169], v227 offset:7232
    v_mfma_f32_16x16x32_bf16 v[104:107], a[180:183], a[4:7], 0
    buffer_load_dwordx4 a[88:91], v226, s[40:43], s53 offen offset:2048 sc1
    v_mfma_f32_16x16x32_bf16 v[160:163], a[180:183], a[8:11], 0
    ds_read_b64_tr_b16 a[170:171], v227 offset:10816
    v_mfma_f32_16x16x32_bf16 v[216:219], a[180:183], a[12:15], 0
    s_waitcnt lgkmcnt(6)
    v_mfma_f32_16x16x32_bf16 v[52:55], a[184:187], a[0:3], 0
    ds_read_b64_tr_b16 a[172:173], v227 offset:7264
    v_mfma_f32_16x16x32_bf16 v[108:111], a[184:187], a[4:7], 0
    buffer_load_dwordx4 a[92:95], v226, s[40:43], s53 offen offset:3072 sc1
    v_mfma_f32_16x16x32_bf16 v[164:167], a[184:187], a[8:11], 0
    ds_read_b64_tr_b16 a[174:175], v227 offset:10848
    v_mfma_f32_16x16x32_bf16 v[220:223], a[184:187], a[12:15], 0
    s_waitcnt vmcnt(16) lgkmcnt(6)
    v_mfma_f32_16x16x32_bf16 v[0:3], a[160:163], a[16:19], v[0:3]
    s_mov_b32 s53, 12288
    ds_read_b64_tr_b16 a[176:177], v227 offset:7296
    v_mfma_f32_16x16x32_bf16 v[56:59], a[160:163], a[20:23], v[56:59]
    buffer_load_dwordx4 a[96:99], v226, s[36:39], s53 offen offset:0 sc1
    v_mfma_f32_16x16x32_bf16 v[112:115], a[160:163], a[24:27], v[112:115]
    s_mov_b32 s52, 1376256
    ds_read_b64_tr_b16 a[178:179], v227 offset:10880
    v_mfma_f32_16x16x32_bf16 v[168:171], a[160:163], a[28:31], v[168:171]
    s_waitcnt lgkmcnt(6)
    v_mfma_f32_16x16x32_bf16 v[4:7], a[164:167], a[16:19], v[4:7]
    s_add_u32 m0, s3, 86016
    ds_read_b64_tr_b16 a[180:181], v227 offset:7328
    v_mfma_f32_16x16x32_bf16 v[60:63], a[164:167], a[20:23], v[60:63]
    buffer_load_dwordx4 v230, s[32:35], s52 offen offset:0 lds
    v_mfma_f32_16x16x32_bf16 v[116:119], a[164:167], a[24:27], v[116:119]
    ds_read_b64_tr_b16 a[182:183], v227 offset:10912
    v_mfma_f32_16x16x32_bf16 v[172:175], a[164:167], a[28:31], v[172:175]
    s_waitcnt lgkmcnt(6)
    v_mfma_f32_16x16x32_bf16 v[8:11], a[168:171], a[16:19], v[8:11]
    ds_read_b64_tr_b16 a[184:185], v227 offset:7360
    v_mfma_f32_16x16x32_bf16 v[64:67], a[168:171], a[20:23], v[64:67]
    v_mfma_f32_16x16x32_bf16 v[120:123], a[168:171], a[24:27], v[120:123]
    ds_read_b64_tr_b16 a[186:187], v227 offset:10944
    v_mfma_f32_16x16x32_bf16 v[176:179], a[168:171], a[28:31], v[176:179]
    s_waitcnt lgkmcnt(6)
    v_mfma_f32_16x16x32_bf16 v[12:15], a[172:175], a[16:19], v[12:15]
    ds_read_b64_tr_b16 a[160:161], v227 offset:21504
    v_mfma_f32_16x16x32_bf16 v[68:71], a[172:175], a[20:23], v[68:71]
    buffer_load_dwordx4 a[100:103], v226, s[36:39], s53 offen offset:1024 sc1
    v_mfma_f32_16x16x32_bf16 v[124:127], a[172:175], a[24:27], v[124:127]
    ds_read_b64_tr_b16 a[162:163], v227 offset:25088
    v_mfma_f32_16x16x32_bf16 v[180:183], a[172:175], a[28:31], v[180:183]
    s_waitcnt lgkmcnt(6)
    v_mfma_f32_16x16x32_bf16 v[16:19], a[176:179], a[16:19], v[16:19]
    ds_read_b64_tr_b16 a[164:165], v227 offset:21536
    v_mfma_f32_16x16x32_bf16 v[72:75], a[176:179], a[20:23], v[72:75]
    v_mfma_f32_16x16x32_bf16 v[128:131], a[176:179], a[24:27], v[128:131]
    ds_read_b64_tr_b16 a[166:167], v227 offset:25120
    v_mfma_f32_16x16x32_bf16 v[184:187], a[176:179], a[28:31], v[184:187]
    s_waitcnt lgkmcnt(6)
    v_mfma_f32_16x16x32_bf16 v[20:23], a[180:183], a[16:19], v[20:23]
    ds_read_b64_tr_b16 a[168:169], v227 offset:21568
    v_mfma_f32_16x16x32_bf16 v[76:79], a[180:183], a[20:23], v[76:79]
    buffer_load_dwordx4 v231, s[32:35], s52 offen offset:1024 lds
    v_mfma_f32_16x16x32_bf16 v[132:135], a[180:183], a[24:27], v[132:135]
    ds_read_b64_tr_b16 a[170:171], v227 offset:25152
    v_mfma_f32_16x16x32_bf16 v[188:191], a[180:183], a[28:31], v[188:191]
    s_waitcnt lgkmcnt(6)
    v_mfma_f32_16x16x32_bf16 v[24:27], a[184:187], a[16:19], v[24:27]
    ds_read_b64_tr_b16 a[172:173], v227 offset:21600
    v_mfma_f32_16x16x32_bf16 v[80:83], a[184:187], a[20:23], v[80:83]
    buffer_load_dwordx4 a[104:107], v226, s[40:43], s53 offen offset:0 sc1
    v_mfma_f32_16x16x32_bf16 v[136:139], a[184:187], a[24:27], v[136:139]
    ds_read_b64_tr_b16 a[174:175], v227 offset:25184
    v_mfma_f32_16x16x32_bf16 v[192:195], a[184:187], a[28:31], v[192:195]
    s_waitcnt lgkmcnt(6)
    v_mfma_f32_16x16x32_bf16 v[28:31], a[160:163], a[16:19], v[28:31]
    ds_read_b64_tr_b16 a[176:177], v227 offset:21632
    v_mfma_f32_16x16x32_bf16 v[84:87], a[160:163], a[20:23], v[84:87]
Lpad_8:
    s_cbranch_execz Lpad_12
    v_mfma_f32_16x16x32_bf16 v[140:143], a[160:163], a[24:27], v[140:143]
    ds_read_b64_tr_b16 a[178:179], v227 offset:25216
    v_mfma_f32_16x16x32_bf16 v[196:199], a[160:163], a[28:31], v[196:199]
    s_waitcnt lgkmcnt(6)
    v_mfma_f32_16x16x32_bf16 v[32:35], a[164:167], a[16:19], v[32:35]
    ds_read_b64_tr_b16 a[180:181], v227 offset:21664
    v_mfma_f32_16x16x32_bf16 v[88:91], a[164:167], a[20:23], v[88:91]
    v_mfma_f32_16x16x32_bf16 v[144:147], a[164:167], a[24:27], v[144:147]
    ds_read_b64_tr_b16 a[182:183], v227 offset:25248
    v_mfma_f32_16x16x32_bf16 v[200:203], a[164:167], a[28:31], v[200:203]
    s_waitcnt lgkmcnt(6)
    v_mfma_f32_16x16x32_bf16 v[36:39], a[168:171], a[16:19], v[36:39]
    ds_read_b64_tr_b16 a[184:185], v227 offset:21696
    v_mfma_f32_16x16x32_bf16 v[92:95], a[168:171], a[20:23], v[92:95]
    buffer_load_dwordx4 v232, s[32:35], s52 offen offset:2048 lds
    v_mfma_f32_16x16x32_bf16 v[148:151], a[168:171], a[24:27], v[148:151]
    ds_read_b64_tr_b16 a[186:187], v227 offset:25280
    v_mfma_f32_16x16x32_bf16 v[204:207], a[168:171], a[28:31], v[204:207]
    s_waitcnt lgkmcnt(6)
    s_barrier
    v_mfma_f32_16x16x32_bf16 v[40:43], a[172:175], a[16:19], v[40:43]
    s_add_u32 s61, s62, 3145728
    ds_read_b64_tr_b16 a[160:161], v227 offset:28672
    v_mfma_f32_16x16x32_bf16 v[96:99], a[172:175], a[20:23], v[96:99]
    buffer_load_dword v238, v237, s[64:67], s61 offen
    v_mfma_f32_16x16x32_bf16 v[152:155], a[172:175], a[24:27], v[152:155]
    ds_read_b64_tr_b16 a[162:163], v227 offset:32256
    v_mfma_f32_16x16x32_bf16 v[208:211], a[172:175], a[28:31], v[208:211]
    s_waitcnt lgkmcnt(6)
    v_mfma_f32_16x16x32_bf16 v[44:47], a[176:179], a[16:19], v[44:47]
    ds_read_b64_tr_b16 a[164:165], v227 offset:28704
    v_mfma_f32_16x16x32_bf16 v[100:103], a[176:179], a[20:23], v[100:103]
    buffer_load_dwordx4 a[108:111], v226, s[40:43], s53 offen offset:1024 sc1
    v_mfma_f32_16x16x32_bf16 v[156:159], a[176:179], a[24:27], v[156:159]
    ds_read_b64_tr_b16 a[166:167], v227 offset:32288
    v_mfma_f32_16x16x32_bf16 v[212:215], a[176:179], a[28:31], v[212:215]
    s_waitcnt lgkmcnt(6)
    v_mfma_f32_16x16x32_bf16 v[48:51], a[180:183], a[16:19], v[48:51]
    ds_read_b64_tr_b16 a[168:169], v227 offset:28736
    v_mfma_f32_16x16x32_bf16 v[104:107], a[180:183], a[20:23], v[104:107]
    v_mfma_f32_16x16x32_bf16 v[160:163], a[180:183], a[24:27], v[160:163]
    ds_read_b64_tr_b16 a[170:171], v227 offset:32320
    v_mfma_f32_16x16x32_bf16 v[216:219], a[180:183], a[28:31], v[216:219]
    s_waitcnt lgkmcnt(6)
    v_mfma_f32_16x16x32_bf16 v[52:55], a[184:187], a[16:19], v[52:55]
    ds_read_b64_tr_b16 a[172:173], v227 offset:28768
    v_mfma_f32_16x16x32_bf16 v[108:111], a[184:187], a[20:23], v[108:111]
    buffer_load_dwordx4 v233, s[32:35], s52 offen offset:3072 lds
    v_mfma_f32_16x16x32_bf16 v[164:167], a[184:187], a[24:27], v[164:167]
    ds_read_b64_tr_b16 a[174:175], v227 offset:32352
    v_mfma_f32_16x16x32_bf16 v[220:223], a[184:187], a[28:31], v[220:223]
    s_waitcnt vmcnt(21) lgkmcnt(6)
    v_mfma_f32_16x16x32_bf16 v[0:3], a[160:163], a[32:35], v[0:3]
    ds_read_b64_tr_b16 a[176:177], v227 offset:28800
    v_mfma_f32_16x16x32_bf16 v[56:59], a[160:163], a[36:39], v[56:59]
    buffer_load_dwordx4 a[112:115], v226, s[36:39], s53 offen offset:2048 sc1
    v_mfma_f32_16x16x32_bf16 v[112:115], a[160:163], a[40:43], v[112:115]
    ds_read_b64_tr_b16 a[178:179], v227 offset:32384
    v_mfma_f32_16x16x32_bf16 v[168:171], a[160:163], a[44:47], v[168:171]
    s_waitcnt lgkmcnt(6)
    v_mfma_f32_16x16x32_bf16 v[4:7], a[164:167], a[32:35], v[4:7]
    ds_read_b64_tr_b16 a[180:181], v227 offset:28832
    v_mfma_f32_16x16x32_bf16 v[60:63], a[164:167], a[36:39], v[60:63]
    v_mfma_f32_16x16x32_bf16 v[116:119], a[164:167], a[40:43], v[116:119]
    ds_read_b64_tr_b16 a[182:183], v227 offset:32416
    v_mfma_f32_16x16x32_bf16 v[172:175], a[164:167], a[44:47], v[172:175]
    s_waitcnt lgkmcnt(6)
    v_mfma_f32_16x16x32_bf16 v[8:11], a[168:171], a[32:35], v[8:11]
    ds_read_b64_tr_b16 a[184:185], v227 offset:28864
    v_mfma_f32_16x16x32_bf16 v[64:67], a[168:171], a[36:39], v[64:67]
    v_mfma_f32_16x16x32_bf16 v[120:123], a[168:171], a[40:43], v[120:123]
    ds_read_b64_tr_b16 a[186:187], v227 offset:32448
    v_mfma_f32_16x16x32_bf16 v[176:179], a[168:171], a[44:47], v[176:179]
    s_waitcnt lgkmcnt(6)
    v_mfma_f32_16x16x32_bf16 v[12:15], a[172:175], a[32:35], v[12:15]
    ds_read_b64_tr_b16 a[160:161], v227 offset:43008
    v_mfma_f32_16x16x32_bf16 v[68:71], a[172:175], a[36:39], v[68:71]
    buffer_load_dwordx4 a[116:119], v226, s[36:39], s53 offen offset:3072 sc1
    v_mfma_f32_16x16x32_bf16 v[124:127], a[172:175], a[40:43], v[124:127]
    ds_read_b64_tr_b16 a[162:163], v227 offset:46592
    v_mfma_f32_16x16x32_bf16 v[180:183], a[172:175], a[44:47], v[180:183]
    s_waitcnt lgkmcnt(6)
    v_mfma_f32_16x16x32_bf16 v[16:19], a[176:179], a[32:35], v[16:19]
    s_add_u32 m0, s3, 90112
    ds_read_b64_tr_b16 a[164:165], v227 offset:43040
    v_mfma_f32_16x16x32_bf16 v[72:75], a[176:179], a[36:39], v[72:75]
    buffer_load_dwordx4 v234, s[32:35], s52 offen offset:0 lds
    v_mfma_f32_16x16x32_bf16 v[128:131], a[176:179], a[40:43], v[128:131]
    ds_read_b64_tr_b16 a[166:167], v227 offset:46624
    v_mfma_f32_16x16x32_bf16 v[184:187], a[176:179], a[44:47], v[184:187]
    s_waitcnt lgkmcnt(6)
    v_mfma_f32_16x16x32_bf16 v[20:23], a[180:183], a[32:35], v[20:23]
    ds_read_b64_tr_b16 a[168:169], v227 offset:43072
    v_mfma_f32_16x16x32_bf16 v[76:79], a[180:183], a[36:39], v[76:79]
    v_mfma_f32_16x16x32_bf16 v[132:135], a[180:183], a[40:43], v[132:135]
    ds_read_b64_tr_b16 a[170:171], v227 offset:46656
    v_mfma_f32_16x16x32_bf16 v[188:191], a[180:183], a[44:47], v[188:191]
    s_waitcnt lgkmcnt(6)
    v_mfma_f32_16x16x32_bf16 v[24:27], a[184:187], a[32:35], v[24:27]
    ds_read_b64_tr_b16 a[172:173], v227 offset:43104
    v_mfma_f32_16x16x32_bf16 v[80:83], a[184:187], a[36:39], v[80:83]
    buffer_load_dwordx4 a[120:123], v226, s[40:43], s53 offen offset:2048 sc1
    v_mfma_f32_16x16x32_bf16 v[136:139], a[184:187], a[40:43], v[136:139]
    ds_read_b64_tr_b16 a[174:175], v227 offset:46688
    v_mfma_f32_16x16x32_bf16 v[192:195], a[184:187], a[44:47], v[192:195]
    s_waitcnt lgkmcnt(6)
    v_mfma_f32_16x16x32_bf16 v[28:31], a[160:163], a[32:35], v[28:31]
    ds_read_b64_tr_b16 a[176:177], v227 offset:43136
    v_mfma_f32_16x16x32_bf16 v[84:87], a[160:163], a[36:39], v[84:87]
    buffer_load_dwordx4 v235, s[32:35], s52 offen offset:1024 lds
    v_mfma_f32_16x16x32_bf16 v[140:143], a[160:163], a[40:43], v[140:143]
    ds_read_b64_tr_b16 a[178:179], v227 offset:46720
    v_mfma_f32_16x16x32_bf16 v[196:199], a[160:163], a[44:47], v[196:199]
    s_waitcnt lgkmcnt(6)
    v_mfma_f32_16x16x32_bf16 v[32:35], a[164:167], a[32:35], v[32:35]
    ds_read_b64_tr_b16 a[180:181], v227 offset:43168
    v_mfma_f32_16x16x32_bf16 v[88:91], a[164:167], a[36:39], v[88:91]
    v_mfma_f32_16x16x32_bf16 v[144:147], a[164:167], a[40:43], v[144:147]
    ds_read_b64_tr_b16 a[182:183], v227 offset:46752
    v_mfma_f32_16x16x32_bf16 v[200:203], a[164:167], a[44:47], v[200:203]
    s_waitcnt lgkmcnt(6)
    v_mfma_f32_16x16x32_bf16 v[36:39], a[168:171], a[32:35], v[36:39]
    ds_read_b64_tr_b16 a[184:185], v227 offset:43200
    v_mfma_f32_16x16x32_bf16 v[92:95], a[168:171], a[36:39], v[92:95]
    v_mfma_f32_16x16x32_bf16 v[148:151], a[168:171], a[40:43], v[148:151]
    ds_read_b64_tr_b16 a[186:187], v227 offset:46784
    v_mfma_f32_16x16x32_bf16 v[204:207], a[168:171], a[44:47], v[204:207]
    s_waitcnt lgkmcnt(6)
    v_mfma_f32_16x16x32_bf16 v[40:43], a[172:175], a[32:35], v[40:43]
    ds_read_b64_tr_b16 a[160:161], v227 offset:35840
    v_mfma_f32_16x16x32_bf16 v[96:99], a[172:175], a[36:39], v[96:99]
    buffer_load_dwordx4 a[124:127], v226, s[40:43], s53 offen offset:3072 sc1
    v_mfma_f32_16x16x32_bf16 v[152:155], a[172:175], a[40:43], v[152:155]
    ds_read_b64_tr_b16 a[162:163], v227 offset:39424
    v_mfma_f32_16x16x32_bf16 v[208:211], a[172:175], a[44:47], v[208:211]
    s_waitcnt lgkmcnt(6)
    v_mfma_f32_16x16x32_bf16 v[44:47], a[176:179], a[32:35], v[44:47]
    ds_read_b64_tr_b16 a[164:165], v227 offset:35872
    v_mfma_f32_16x16x32_bf16 v[100:103], a[176:179], a[36:39], v[100:103]
    buffer_load_dwordx4 v236, s[32:35], s52 offen offset:2048 lds
    v_mfma_f32_16x16x32_bf16 v[156:159], a[176:179], a[40:43], v[156:159]
    ds_read_b64_tr_b16 a[166:167], v227 offset:39456
    v_mfma_f32_16x16x32_bf16 v[212:215], a[176:179], a[44:47], v[212:215]
    s_waitcnt lgkmcnt(6)
    v_mfma_f32_16x16x32_bf16 v[48:51], a[180:183], a[32:35], v[48:51]
    s_add_u32 s61, s62, 3538944
    ds_read_b64_tr_b16 a[168:169], v227 offset:35904
    v_mfma_f32_16x16x32_bf16 v[104:107], a[180:183], a[36:39], v[104:107]
    buffer_load_dword v238, v237, s[64:67], s61 offen
    v_mfma_f32_16x16x32_bf16 v[160:163], a[180:183], a[40:43], v[160:163]
    ds_read_b64_tr_b16 a[170:171], v227 offset:39488
    v_mfma_f32_16x16x32_bf16 v[216:219], a[180:183], a[44:47], v[216:219]
    s_waitcnt lgkmcnt(6)
    v_mfma_f32_16x16x32_bf16 v[52:55], a[184:187], a[32:35], v[52:55]
    s_mov_b32 s53, 16384
    ds_read_b64_tr_b16 a[172:173], v227 offset:35936
    v_mfma_f32_16x16x32_bf16 v[108:111], a[184:187], a[36:39], v[108:111]
    buffer_load_dwordx4 a[128:131], v226, s[36:39], s53 offen offset:0 sc1
    v_mfma_f32_16x16x32_bf16 v[164:167], a[184:187], a[40:43], v[164:167]
    ds_read_b64_tr_b16 a[174:175], v227 offset:39520
    v_mfma_f32_16x16x32_bf16 v[220:223], a[184:187], a[44:47], v[220:223]
    s_waitcnt vmcnt(26) lgkmcnt(6)
    v_mfma_f32_16x16x32_bf16 v[0:3], a[160:163], a[48:51], v[0:3]
    ds_read_b64_tr_b16 a[176:177], v227 offset:35968
    v_mfma_f32_16x16x32_bf16 v[56:59], a[160:163], a[52:55], v[56:59]
    v_mfma_f32_16x16x32_bf16 v[112:115], a[160:163], a[56:59], v[112:115]
    s_mov_b32 s52, 1835008
    ds_read_b64_tr_b16 a[178:179], v227 offset:39552
    v_mfma_f32_16x16x32_bf16 v[168:171], a[160:163], a[60:63], v[168:171]
    s_waitcnt lgkmcnt(6)
    v_mfma_f32_16x16x32_bf16 v[4:7], a[164:167], a[48:51], v[4:7]
    s_add_u32 m0, s3, 114688
    ds_read_b64_tr_b16 a[180:181], v227 offset:36000
    v_mfma_f32_16x16x32_bf16 v[60:63], a[164:167], a[52:55], v[60:63]
    buffer_load_dwordx4 v230, s[32:35], s52 offen offset:0 lds
    v_mfma_f32_16x16x32_bf16 v[116:119], a[164:167], a[56:59], v[116:119]
    ds_read_b64_tr_b16 a[182:183], v227 offset:39584
    v_mfma_f32_16x16x32_bf16 v[172:175], a[164:167], a[60:63], v[172:175]
    s_waitcnt lgkmcnt(6)
    v_mfma_f32_16x16x32_bf16 v[8:11], a[168:171], a[48:51], v[8:11]
    ds_read_b64_tr_b16 a[184:185], v227 offset:36032
    v_mfma_f32_16x16x32_bf16 v[64:67], a[168:171], a[52:55], v[64:67]
    v_mfma_f32_16x16x32_bf16 v[120:123], a[168:171], a[56:59], v[120:123]
    ds_read_b64_tr_b16 a[186:187], v227 offset:39616
    v_mfma_f32_16x16x32_bf16 v[176:179], a[168:171], a[60:63], v[176:179]
    s_waitcnt lgkmcnt(6)
    v_mfma_f32_16x16x32_bf16 v[12:15], a[172:175], a[48:51], v[12:15]
    ds_read_b64_tr_b16 a[160:161], v227 offset:50176
    v_mfma_f32_16x16x32_bf16 v[68:71], a[172:175], a[52:55], v[68:71]
    buffer_load_dwordx4 a[132:135], v226, s[36:39], s53 offen offset:1024 sc1
    v_mfma_f32_16x16x32_bf16 v[124:127], a[172:175], a[56:59], v[124:127]
    ds_read_b64_tr_b16 a[162:163], v227 offset:53760
    v_mfma_f32_16x16x32_bf16 v[180:183], a[172:175], a[60:63], v[180:183]
    s_waitcnt lgkmcnt(6)
    v_mfma_f32_16x16x32_bf16 v[16:19], a[176:179], a[48:51], v[16:19]
    ds_read_b64_tr_b16 a[164:165], v227 offset:50208
    v_mfma_f32_16x16x32_bf16 v[72:75], a[176:179], a[52:55], v[72:75]
    v_mfma_f32_16x16x32_bf16 v[128:131], a[176:179], a[56:59], v[128:131]
    ds_read_b64_tr_b16 a[166:167], v227 offset:53792
    v_mfma_f32_16x16x32_bf16 v[184:187], a[176:179], a[60:63], v[184:187]
    s_waitcnt lgkmcnt(6)
    v_mfma_f32_16x16x32_bf16 v[20:23], a[180:183], a[48:51], v[20:23]
    ds_read_b64_tr_b16 a[168:169], v227 offset:50240
    v_mfma_f32_16x16x32_bf16 v[76:79], a[180:183], a[52:55], v[76:79]
    buffer_load_dwordx4 v231, s[32:35], s52 offen offset:1024 lds
    v_mfma_f32_16x16x32_bf16 v[132:135], a[180:183], a[56:59], v[132:135]
    ds_read_b64_tr_b16 a[170:171], v227 offset:53824
    v_mfma_f32_16x16x32_bf16 v[188:191], a[180:183], a[60:63], v[188:191]
    s_waitcnt lgkmcnt(6)
    v_mfma_f32_16x16x32_bf16 v[24:27], a[184:187], a[48:51], v[24:27]
    ds_read_b64_tr_b16 a[172:173], v227 offset:50272
    v_mfma_f32_16x16x32_bf16 v[80:83], a[184:187], a[52:55], v[80:83]
    buffer_load_dwordx4 a[136:139], v226, s[40:43], s53 offen offset:0 sc1
    v_mfma_f32_16x16x32_bf16 v[136:139], a[184:187], a[56:59], v[136:139]
    ds_read_b64_tr_b16 a[174:175], v227 offset:53856
    v_mfma_f32_16x16x32_bf16 v[192:195], a[184:187], a[60:63], v[192:195]
    s_waitcnt lgkmcnt(6)
    v_mfma_f32_16x16x32_bf16 v[28:31], a[160:163], a[48:51], v[28:31]
    ds_read_b64_tr_b16 a[176:177], v227 offset:50304
    v_mfma_f32_16x16x32_bf16 v[84:87], a[160:163], a[52:55], v[84:87]
    v_mfma_f32_16x16x32_bf16 v[140:143], a[160:163], a[56:59], v[140:143]
    ds_read_b64_tr_b16 a[178:179], v227 offset:53888
    v_mfma_f32_16x16x32_bf16 v[196:199], a[160:163], a[60:63], v[196:199]
    s_waitcnt lgkmcnt(6)
    v_mfma_f32_16x16x32_bf16 v[32:35], a[164:167], a[48:51], v[32:35]
    ds_read_b64_tr_b16 a[180:181], v227 offset:50336
    v_mfma_f32_16x16x32_bf16 v[88:91], a[164:167], a[52:55], v[88:91]
    buffer_load_dwordx4 v232, s[32:35], s52 offen offset:2048 lds
    v_mfma_f32_16x16x32_bf16 v[144:147], a[164:167], a[56:59], v[144:147]
    ds_read_b64_tr_b16 a[182:183], v227 offset:53920
    v_mfma_f32_16x16x32_bf16 v[200:203], a[164:167], a[60:63], v[200:203]
    s_waitcnt lgkmcnt(6)
    v_mfma_f32_16x16x32_bf16 v[36:39], a[168:171], a[48:51], v[36:39]
    ds_read_b64_tr_b16 a[184:185], v227 offset:50368
    v_mfma_f32_16x16x32_bf16 v[92:95], a[168:171], a[52:55], v[92:95]
    v_mfma_f32_16x16x32_bf16 v[148:151], a[168:171], a[56:59], v[148:151]
    ds_read_b64_tr_b16 a[186:187], v227 offset:53952
    v_mfma_f32_16x16x32_bf16 v[204:207], a[168:171], a[60:63], v[204:207]
    s_waitcnt lgkmcnt(6)
    s_barrier
    v_mfma_f32_16x16x32_bf16 v[40:43], a[172:175], a[48:51], v[40:43]
    ds_read_b64_tr_b16 a[160:161], v228 offset:0
    v_mfma_f32_16x16x32_bf16 v[96:99], a[172:175], a[52:55], v[96:99]
    buffer_load_dwordx4 a[140:143], v226, s[40:43], s53 offen offset:1024 sc1
    v_mfma_f32_16x16x32_bf16 v[152:155], a[172:175], a[56:59], v[152:155]
    ds_read_b64_tr_b16 a[162:163], v228 offset:3584
    v_mfma_f32_16x16x32_bf16 v[208:211], a[172:175], a[60:63], v[208:211]
    s_waitcnt lgkmcnt(6)
    v_mfma_f32_16x16x32_bf16 v[44:47], a[176:179], a[48:51], v[44:47]
    ds_read_b64_tr_b16 a[164:165], v228 offset:32
    v_mfma_f32_16x16x32_bf16 v[100:103], a[176:179], a[52:55], v[100:103]
    v_mfma_f32_16x16x32_bf16 v[156:159], a[176:179], a[56:59], v[156:159]
    ds_read_b64_tr_b16 a[166:167], v228 offset:3616
    v_mfma_f32_16x16x32_bf16 v[212:215], a[176:179], a[60:63], v[212:215]
    s_waitcnt lgkmcnt(6)
    v_mfma_f32_16x16x32_bf16 v[48:51], a[180:183], a[48:51], v[48:51]
    ds_read_b64_tr_b16 a[168:169], v228 offset:64
    v_mfma_f32_16x16x32_bf16 v[104:107], a[180:183], a[52:55], v[104:107]
    buffer_load_dwordx4 v233, s[32:35], s52 offen offset:3072 lds
    v_mfma_f32_16x16x32_bf16 v[160:163], a[180:183], a[56:59], v[160:163]
    ds_read_b64_tr_b16 a[170:171], v228 offset:3648
    v_mfma_f32_16x16x32_bf16 v[216:219], a[180:183], a[60:63], v[216:219]
    s_waitcnt lgkmcnt(6)
    v_mfma_f32_16x16x32_bf16 v[52:55], a[184:187], a[48:51], v[52:55]
    ds_read_b64_tr_b16 a[172:173], v228 offset:96
    v_mfma_f32_16x16x32_bf16 v[108:111], a[184:187], a[52:55], v[108:111]
    buffer_load_dwordx4 a[144:147], v226, s[36:39], s53 offen offset:2048 sc1
    v_mfma_f32_16x16x32_bf16 v[164:167], a[184:187], a[56:59], v[164:167]
    ds_read_b64_tr_b16 a[174:175], v228 offset:3680
    v_mfma_f32_16x16x32_bf16 v[220:223], a[184:187], a[60:63], v[220:223]
    s_waitcnt vmcnt(30) lgkmcnt(6)
    v_mfma_f32_16x16x32_bf16 v[0:3], a[160:163], a[64:67], v[0:3]
    s_add_u32 s61, s62, 3932160
    ds_read_b64_tr_b16 a[176:177], v228 offset:128
    v_mfma_f32_16x16x32_bf16 v[56:59], a[160:163], a[68:71], v[56:59]
    buffer_load_dword v238, v237, s[64:67], s61 offen
    v_mfma_f32_16x16x32_bf16 v[112:115], a[160:163], a[72:75], v[112:115]
    ds_read_b64_tr_b16 a[178:179], v228 offset:3712
    v_mfma_f32_16x16x32_bf16 v[168:171], a[160:163], a[76:79], v[168:171]
    s_waitcnt lgkmcnt(6)
    v_mfma_f32_16x16x32_bf16 v[4:7], a[164:167], a[64:67], v[4:7]
    ds_read_b64_tr_b16 a[180:181], v228 offset:160
    v_mfma_f32_16x16x32_bf16 v[60:63], a[164:167], a[68:71], v[60:63]
    v_mfma_f32_16x16x32_bf16 v[116:119], a[164:167], a[72:75], v[116:119]
    ds_read_b64_tr_b16 a[182:183], v228 offset:3744
    v_mfma_f32_16x16x32_bf16 v[172:175], a[164:167], a[76:79], v[172:175]
    s_waitcnt lgkmcnt(6)
    v_mfma_f32_16x16x32_bf16 v[8:11], a[168:171], a[64:67], v[8:11]
    s_add_u32 m0, s3, 118784
    ds_read_b64_tr_b16 a[184:185], v228 offset:192
    v_mfma_f32_16x16x32_bf16 v[64:67], a[168:171], a[68:71], v[64:67]
    buffer_load_dwordx4 v234, s[32:35], s52 offen offset:0 lds
    v_mfma_f32_16x16x32_bf16 v[120:123], a[168:171], a[72:75], v[120:123]
    ds_read_b64_tr_b16 a[186:187], v228 offset:3776
    v_mfma_f32_16x16x32_bf16 v[176:179], a[168:171], a[76:79], v[176:179]
    s_waitcnt lgkmcnt(6)
    v_mfma_f32_16x16x32_bf16 v[12:15], a[172:175], a[64:67], v[12:15]
    ds_read_b64_tr_b16 a[160:161], v228 offset:14336
    v_mfma_f32_16x16x32_bf16 v[68:71], a[172:175], a[68:71], v[68:71]
    buffer_load_dwordx4 a[148:151], v226, s[36:39], s53 offen offset:3072 sc1
    v_mfma_f32_16x16x32_bf16 v[124:127], a[172:175], a[72:75], v[124:127]
    ds_read_b64_tr_b16 a[162:163], v228 offset:17920
    v_mfma_f32_16x16x32_bf16 v[180:183], a[172:175], a[76:79], v[180:183]
    s_waitcnt lgkmcnt(6)
    v_mfma_f32_16x16x32_bf16 v[16:19], a[176:179], a[64:67], v[16:19]
    s_add_u32 s28, s60, 0
    ds_read_b64_tr_b16 a[164:165], v228 offset:14368
    v_mfma_f32_16x16x32_bf16 v[72:75], a[176:179], a[68:71], v[72:75]
    buffer_load_dwordx4 a[200:203], v244, s[48:51], s28 offen sc1
    v_mfma_f32_16x16x32_bf16 v[128:131], a[176:179], a[72:75], v[128:131]
    ds_read_b64_tr_b16 a[166:167], v228 offset:17952
    v_mfma_f32_16x16x32_bf16 v[184:187], a[176:179], a[76:79], v[184:187]
    s_waitcnt lgkmcnt(6)
    v_mfma_f32_16x16x32_bf16 v[20:23], a[180:183], a[64:67], v[20:23]
    ds_read_b64_tr_b16 a[168:169], v228 offset:14400
    v_mfma_f32_16x16x32_bf16 v[76:79], a[180:183], a[68:71], v[76:79]
    v_mfma_f32_16x16x32_bf16 v[132:135], a[180:183], a[72:75], v[132:135]
    ds_read_b64_tr_b16 a[170:171], v228 offset:17984
    v_mfma_f32_16x16x32_bf16 v[188:191], a[180:183], a[76:79], v[188:191]
    s_waitcnt lgkmcnt(6)
    v_mfma_f32_16x16x32_bf16 v[24:27], a[184:187], a[64:67], v[24:27]
    s_add_u32 s28, s60, 8192
    ds_read_b64_tr_b16 a[172:173], v228 offset:14432
    v_mfma_f32_16x16x32_bf16 v[80:83], a[184:187], a[68:71], v[80:83]
    buffer_load_dwordx4 a[204:207], v244, s[48:51], s28 offen sc1
    v_mfma_f32_16x16x32_bf16 v[136:139], a[184:187], a[72:75], v[136:139]
    ds_read_b64_tr_b16 a[174:175], v228 offset:18016
    v_mfma_f32_16x16x32_bf16 v[192:195], a[184:187], a[76:79], v[192:195]
    s_waitcnt lgkmcnt(6)
    v_mfma_f32_16x16x32_bf16 v[28:31], a[160:163], a[64:67], v[28:31]
    ds_read_b64_tr_b16 a[176:177], v228 offset:14464
    v_mfma_f32_16x16x32_bf16 v[84:87], a[160:163], a[68:71], v[84:87]
    buffer_load_dwordx4 v235, s[32:35], s52 offen offset:1024 lds
    v_mfma_f32_16x16x32_bf16 v[140:143], a[160:163], a[72:75], v[140:143]
    ds_read_b64_tr_b16 a[178:179], v228 offset:18048
    v_mfma_f32_16x16x32_bf16 v[196:199], a[160:163], a[76:79], v[196:199]
    s_waitcnt lgkmcnt(6)
    v_mfma_f32_16x16x32_bf16 v[32:35], a[164:167], a[64:67], v[32:35]
    ds_read_b64_tr_b16 a[180:181], v228 offset:14496
    v_mfma_f32_16x16x32_bf16 v[88:91], a[164:167], a[68:71], v[88:91]
    buffer_load_dwordx4 a[152:155], v226, s[40:43], s53 offen offset:2048 sc1
    v_mfma_f32_16x16x32_bf16 v[144:147], a[164:167], a[72:75], v[144:147]
    ds_read_b64_tr_b16 a[182:183], v228 offset:18080
    v_mfma_f32_16x16x32_bf16 v[200:203], a[164:167], a[76:79], v[200:203]
    s_waitcnt lgkmcnt(6)
    v_mfma_f32_16x16x32_bf16 v[36:39], a[168:171], a[64:67], v[36:39]
    s_add_u32 s28, s60, 16384
    ds_read_b64_tr_b16 a[184:185], v228 offset:14528
    v_mfma_f32_16x16x32_bf16 v[92:95], a[168:171], a[68:71], v[92:95]
    buffer_load_dwordx4 a[208:211], v244, s[48:51], s28 offen sc1
    v_mfma_f32_16x16x32_bf16 v[148:151], a[168:171], a[72:75], v[148:151]
    ds_read_b64_tr_b16 a[186:187], v228 offset:18112
    v_mfma_f32_16x16x32_bf16 v[204:207], a[168:171], a[76:79], v[204:207]
    s_waitcnt lgkmcnt(6)
    v_mfma_f32_16x16x32_bf16 v[40:43], a[172:175], a[64:67], v[40:43]
    s_add_u32 s28, s60, 24576
    ds_read_b64_tr_b16 a[160:161], v228 offset:7168
    v_mfma_f32_16x16x32_bf16 v[96:99], a[172:175], a[68:71], v[96:99]
    buffer_load_dwordx4 a[212:215], v244, s[48:51], s28 offen sc1
    v_mfma_f32_16x16x32_bf16 v[152:155], a[172:175], a[72:75], v[152:155]
    ds_read_b64_tr_b16 a[162:163], v228 offset:10752
    v_mfma_f32_16x16x32_bf16 v[208:211], a[172:175], a[76:79], v[208:211]
    s_waitcnt lgkmcnt(6)
    v_mfma_f32_16x16x32_bf16 v[44:47], a[176:179], a[64:67], v[44:47]
    ds_read_b64_tr_b16 a[164:165], v228 offset:7200
    v_mfma_f32_16x16x32_bf16 v[100:103], a[176:179], a[68:71], v[100:103]
    buffer_load_dwordx4 a[156:159], v226, s[40:43], s53 offen offset:3072 sc1
    v_mfma_f32_16x16x32_bf16 v[156:159], a[176:179], a[72:75], v[156:159]
    ds_read_b64_tr_b16 a[166:167], v228 offset:10784
    v_mfma_f32_16x16x32_bf16 v[212:215], a[176:179], a[76:79], v[212:215]
    s_waitcnt lgkmcnt(6)
    v_mfma_f32_16x16x32_bf16 v[48:51], a[180:183], a[64:67], v[48:51]
    ds_read_b64_tr_b16 a[168:169], v228 offset:7232
    v_mfma_f32_16x16x32_bf16 v[104:107], a[180:183], a[68:71], v[104:107]
    buffer_load_dwordx4 v236, s[32:35], s52 offen offset:2048 lds
    v_mfma_f32_16x16x32_bf16 v[160:163], a[180:183], a[72:75], v[160:163]
    ds_read_b64_tr_b16 a[170:171], v228 offset:10816
    v_mfma_f32_16x16x32_bf16 v[216:219], a[180:183], a[76:79], v[216:219]
    s_waitcnt lgkmcnt(6)
    v_mfma_f32_16x16x32_bf16 v[52:55], a[184:187], a[64:67], v[52:55]
    s_mov_b32 s53, 20480
    ds_read_b64_tr_b16 a[172:173], v228 offset:7264
    v_mfma_f32_16x16x32_bf16 v[108:111], a[184:187], a[68:71], v[108:111]
    buffer_load_dwordx4 a[0:3], v226, s[36:39], s53 offen offset:0 sc1
    v_mfma_f32_16x16x32_bf16 v[164:167], a[184:187], a[72:75], v[164:167]
    s_mov_b32 s52, 2293760
    ds_read_b64_tr_b16 a[174:175], v228 offset:10848
    v_mfma_f32_16x16x32_bf16 v[220:223], a[184:187], a[76:79], v[220:223]
    s_waitcnt vmcnt(38) lgkmcnt(6)
    v_mfma_f32_16x16x32_bf16 v[0:3], a[160:163], a[80:83], v[0:3]
    s_add_u32 m0, s3, 0
    ds_read_b64_tr_b16 a[176:177], v228 offset:7296
    v_mfma_f32_16x16x32_bf16 v[56:59], a[160:163], a[84:87], v[56:59]
    buffer_load_dwordx4 v230, s[32:35], s52 offen offset:0 lds
    v_mfma_f32_16x16x32_bf16 v[112:115], a[160:163], a[88:91], v[112:115]
    ds_read_b64_tr_b16 a[178:179], v228 offset:10880
    v_mfma_f32_16x16x32_bf16 v[168:171], a[160:163], a[92:95], v[168:171]
    s_waitcnt lgkmcnt(6)
    v_mfma_f32_16x16x32_bf16 v[4:7], a[164:167], a[80:83], v[4:7]
    ds_read_b64_tr_b16 a[180:181], v228 offset:7328
    v_mfma_f32_16x16x32_bf16 v[60:63], a[164:167], a[84:87], v[60:63]
    v_mfma_f32_16x16x32_bf16 v[116:119], a[164:167], a[88:91], v[116:119]
    ds_read_b64_tr_b16 a[182:183], v228 offset:10912
    v_mfma_f32_16x16x32_bf16 v[172:175], a[164:167], a[92:95], v[172:175]
    s_waitcnt lgkmcnt(6)
    v_mfma_f32_16x16x32_bf16 v[8:11], a[168:171], a[80:83], v[8:11]
    s_add_u32 s61, s62, 4325376
    ds_read_b64_tr_b16 a[184:185], v228 offset:7360
    v_mfma_f32_16x16x32_bf16 v[64:67], a[168:171], a[84:87], v[64:67]
    buffer_load_dword v238, v237, s[64:67], s61 offen
    v_mfma_f32_16x16x32_bf16 v[120:123], a[168:171], a[88:91], v[120:123]
    ds_read_b64_tr_b16 a[186:187], v228 offset:10944
    v_mfma_f32_16x16x32_bf16 v[176:179], a[168:171], a[92:95], v[176:179]
    s_waitcnt lgkmcnt(6)
    v_mfma_f32_16x16x32_bf16 v[12:15], a[172:175], a[80:83], v[12:15]
    ds_read_b64_tr_b16 a[160:161], v228 offset:21504
    v_mfma_f32_16x16x32_bf16 v[68:71], a[172:175], a[84:87], v[68:71]
    buffer_load_dwordx4 a[4:7], v226, s[36:39], s53 offen offset:1024 sc1
    v_mfma_f32_16x16x32_bf16 v[124:127], a[172:175], a[88:91], v[124:127]
    ds_read_b64_tr_b16 a[162:163], v228 offset:25088
    v_mfma_f32_16x16x32_bf16 v[180:183], a[172:175], a[92:95], v[180:183]
    s_waitcnt lgkmcnt(6)
    v_mfma_f32_16x16x32_bf16 v[16:19], a[176:179], a[80:83], v[16:19]
    ds_read_b64_tr_b16 a[164:165], v228 offset:21536
    v_mfma_f32_16x16x32_bf16 v[72:75], a[176:179], a[84:87], v[72:75]
    buffer_load_dwordx4 v231, s[32:35], s52 offen offset:1024 lds
    v_mfma_f32_16x16x32_bf16 v[128:131], a[176:179], a[88:91], v[128:131]
    ds_read_b64_tr_b16 a[166:167], v228 offset:25120
    v_mfma_f32_16x16x32_bf16 v[184:187], a[176:179], a[92:95], v[184:187]
    s_waitcnt lgkmcnt(6)
    v_mfma_f32_16x16x32_bf16 v[20:23], a[180:183], a[80:83], v[20:23]
    ds_read_b64_tr_b16 a[168:169], v228 offset:21568
    v_mfma_f32_16x16x32_bf16 v[76:79], a[180:183], a[84:87], v[76:79]
    v_mfma_f32_16x16x32_bf16 v[132:135], a[180:183], a[88:91], v[132:135]
    ds_read_b64_tr_b16 a[170:171], v228 offset:25152
    v_mfma_f32_16x16x32_bf16 v[188:191], a[180:183], a[92:95], v[188:191]
    s_waitcnt lgkmcnt(6)
    v_mfma_f32_16x16x32_bf16 v[24:27], a[184:187], a[80:83], v[24:27]
    ds_read_b64_tr_b16 a[172:173], v228 offset:21600
    v_mfma_f32_16x16x32_bf16 v[80:83], a[184:187], a[84:87], v[80:83]
    buffer_load_dwordx4 a[8:11], v226, s[40:43], s53 offen offset:0 sc1
    v_mfma_f32_16x16x32_bf16 v[136:139], a[184:187], a[88:91], v[136:139]
    ds_read_b64_tr_b16 a[174:175], v228 offset:25184
    v_mfma_f32_16x16x32_bf16 v[192:195], a[184:187], a[92:95], v[192:195]
    s_waitcnt lgkmcnt(6)
    v_mfma_f32_16x16x32_bf16 v[28:31], a[160:163], a[80:83], v[28:31]
    ds_read_b64_tr_b16 a[176:177], v228 offset:21632
    v_mfma_f32_16x16x32_bf16 v[84:87], a[160:163], a[84:87], v[84:87]
    v_mfma_f32_16x16x32_bf16 v[140:143], a[160:163], a[88:91], v[140:143]
    ds_read_b64_tr_b16 a[178:179], v228 offset:25216
    v_mfma_f32_16x16x32_bf16 v[196:199], a[160:163], a[92:95], v[196:199]
    s_waitcnt lgkmcnt(6)
    v_mfma_f32_16x16x32_bf16 v[32:35], a[164:167], a[80:83], v[32:35]
    ds_read_b64_tr_b16 a[180:181], v228 offset:21664
    v_mfma_f32_16x16x32_bf16 v[88:91], a[164:167], a[84:87], v[88:91]
    buffer_load_dwordx4 v232, s[32:35], s52 offen offset:2048 lds
    v_mfma_f32_16x16x32_bf16 v[144:147], a[164:167], a[88:91], v[144:147]
    ds_read_b64_tr_b16 a[182:183], v228 offset:25248
    v_mfma_f32_16x16x32_bf16 v[200:203], a[164:167], a[92:95], v[200:203]
    s_waitcnt lgkmcnt(6)
    v_mfma_f32_16x16x32_bf16 v[36:39], a[168:171], a[80:83], v[36:39]
    ds_read_b64_tr_b16 a[184:185], v228 offset:21696
    v_mfma_f32_16x16x32_bf16 v[92:95], a[168:171], a[84:87], v[92:95]
    v_mfma_f32_16x16x32_bf16 v[148:151], a[168:171], a[88:91], v[148:151]
    ds_read_b64_tr_b16 a[186:187], v228 offset:25280
    v_mfma_f32_16x16x32_bf16 v[204:207], a[168:171], a[92:95], v[204:207]
    s_waitcnt vmcnt(28) lgkmcnt(6)
    s_barrier
    v_mfma_f32_16x16x32_bf16 v[40:43], a[172:175], a[80:83], v[40:43]
    ds_read_b64_tr_b16 a[160:161], v228 offset:28672
    v_mfma_f32_16x16x32_bf16 v[96:99], a[172:175], a[84:87], v[96:99]
    buffer_load_dwordx4 a[12:15], v226, s[40:43], s53 offen offset:1024 sc1
    v_mfma_f32_16x16x32_bf16 v[152:155], a[172:175], a[88:91], v[152:155]
    ds_read_b64_tr_b16 a[162:163], v228 offset:32256
    v_mfma_f32_16x16x32_bf16 v[208:211], a[172:175], a[92:95], v[208:211]
    s_waitcnt lgkmcnt(6)
    v_mfma_f32_16x16x32_bf16 v[44:47], a[176:179], a[80:83], v[44:47]
    ds_read_b64_tr_b16 a[164:165], v228 offset:28704
    v_mfma_f32_16x16x32_bf16 v[100:103], a[176:179], a[84:87], v[100:103]
    v_mfma_f32_16x16x32_bf16 v[156:159], a[176:179], a[88:91], v[156:159]
    ds_read_b64_tr_b16 a[166:167], v228 offset:32288
    v_mfma_f32_16x16x32_bf16 v[212:215], a[176:179], a[92:95], v[212:215]
    s_waitcnt lgkmcnt(6)
    v_mfma_f32_16x16x32_bf16 v[48:51], a[180:183], a[80:83], v[48:51]
    ds_read_b64_tr_b16 a[168:169], v228 offset:28736
    v_mfma_f32_16x16x32_bf16 v[104:107], a[180:183], a[84:87], v[104:107]
    buffer_load_dwordx4 v233, s[32:35], s52 offen offset:3072 lds
    v_mfma_f32_16x16x32_bf16 v[160:163], a[180:183], a[88:91], v[160:163]
    ds_read_b64_tr_b16 a[170:171], v228 offset:32320
    v_mfma_f32_16x16x32_bf16 v[216:219], a[180:183], a[92:95], v[216:219]
    s_waitcnt lgkmcnt(6)
    v_mfma_f32_16x16x32_bf16 v[52:55], a[184:187], a[80:83], v[52:55]
    ds_read_b64_tr_b16 a[172:173], v228 offset:28768
    v_mfma_f32_16x16x32_bf16 v[108:111], a[184:187], a[84:87], v[108:111]
    buffer_load_dwordx4 a[16:19], v226, s[36:39], s53 offen offset:2048 sc1
    v_mfma_f32_16x16x32_bf16 v[164:167], a[184:187], a[88:91], v[164:167]
    ds_read_b64_tr_b16 a[174:175], v228 offset:32352
    v_mfma_f32_16x16x32_bf16 v[220:223], a[184:187], a[92:95], v[220:223]
    s_waitcnt lgkmcnt(6)
    v_mfma_f32_16x16x32_bf16 v[0:3], a[160:163], a[96:99], v[0:3]
    ds_read_b64_tr_b16 a[176:177], v228 offset:28800
    v_mfma_f32_16x16x32_bf16 v[56:59], a[160:163], a[100:103], v[56:59]
    v_mfma_f32_16x16x32_bf16 v[112:115], a[160:163], a[104:107], v[112:115]
    ds_read_b64_tr_b16 a[178:179], v228 offset:32384
    v_mfma_f32_16x16x32_bf16 v[168:171], a[160:163], a[108:111], v[168:171]
    s_waitcnt lgkmcnt(6)
    v_mfma_f32_16x16x32_bf16 v[4:7], a[164:167], a[96:99], v[4:7]
    s_add_u32 m0, s3, 4096
    ds_read_b64_tr_b16 a[180:181], v228 offset:28832
    v_mfma_f32_16x16x32_bf16 v[60:63], a[164:167], a[100:103], v[60:63]
    buffer_load_dwordx4 v234, s[32:35], s52 offen offset:0 lds
    v_mfma_f32_16x16x32_bf16 v[116:119], a[164:167], a[104:107], v[116:119]
    ds_read_b64_tr_b16 a[182:183], v228 offset:32416
    v_mfma_f32_16x16x32_bf16 v[172:175], a[164:167], a[108:111], v[172:175]
    s_waitcnt lgkmcnt(6)
    v_mfma_f32_16x16x32_bf16 v[8:11], a[168:171], a[96:99], v[8:11]
    ds_read_b64_tr_b16 a[184:185], v228 offset:28864
    v_mfma_f32_16x16x32_bf16 v[64:67], a[168:171], a[100:103], v[64:67]
    v_mfma_f32_16x16x32_bf16 v[120:123], a[168:171], a[104:107], v[120:123]
    ds_read_b64_tr_b16 a[186:187], v228 offset:32448
    v_mfma_f32_16x16x32_bf16 v[176:179], a[168:171], a[108:111], v[176:179]
    s_waitcnt lgkmcnt(6)
    v_mfma_f32_16x16x32_bf16 v[12:15], a[172:175], a[96:99], v[12:15]
    ds_read_b64_tr_b16 a[160:161], v228 offset:43008
    v_mfma_f32_16x16x32_bf16 v[68:71], a[172:175], a[100:103], v[68:71]
    buffer_load_dwordx4 a[20:23], v226, s[36:39], s53 offen offset:3072 sc1
    v_mfma_f32_16x16x32_bf16 v[124:127], a[172:175], a[104:107], v[124:127]
    ds_read_b64_tr_b16 a[162:163], v228 offset:46592
    v_mfma_f32_16x16x32_bf16 v[180:183], a[172:175], a[108:111], v[180:183]
    s_waitcnt lgkmcnt(6)
    v_mfma_f32_16x16x32_bf16 v[16:19], a[176:179], a[96:99], v[16:19]
    ds_read_b64_tr_b16 a[164:165], v228 offset:43040
    v_mfma_f32_16x16x32_bf16 v[72:75], a[176:179], a[100:103], v[72:75]
    v_mfma_f32_16x16x32_bf16 v[128:131], a[176:179], a[104:107], v[128:131]
    ds_read_b64_tr_b16 a[166:167], v228 offset:46624
    v_mfma_f32_16x16x32_bf16 v[184:187], a[176:179], a[108:111], v[184:187]
    s_waitcnt lgkmcnt(6)
    v_mfma_f32_16x16x32_bf16 v[20:23], a[180:183], a[96:99], v[20:23]
    s_add_u32 s61, s62, 4718592
    ds_read_b64_tr_b16 a[168:169], v228 offset:43072
    v_mfma_f32_16x16x32_bf16 v[76:79], a[180:183], a[100:103], v[76:79]
    buffer_load_dword v238, v237, s[64:67], s61 offen
    v_mfma_f32_16x16x32_bf16 v[132:135], a[180:183], a[104:107], v[132:135]
    ds_read_b64_tr_b16 a[170:171], v228 offset:46656
    v_mfma_f32_16x16x32_bf16 v[188:191], a[180:183], a[108:111], v[188:191]
    s_waitcnt lgkmcnt(6)
    v_mfma_f32_16x16x32_bf16 v[24:27], a[184:187], a[96:99], v[24:27]
Lpad_9:
    s_cbranch_execz Lpad_13
    ds_read_b64_tr_b16 a[172:173], v228 offset:43104
    v_mfma_f32_16x16x32_bf16 v[80:83], a[184:187], a[100:103], v[80:83]
    buffer_load_dwordx4 v235, s[32:35], s52 offen offset:1024 lds
    v_mfma_f32_16x16x32_bf16 v[136:139], a[184:187], a[104:107], v[136:139]
    ds_read_b64_tr_b16 a[174:175], v228 offset:46688
    v_mfma_f32_16x16x32_bf16 v[192:195], a[184:187], a[108:111], v[192:195]
    s_waitcnt lgkmcnt(6)
    v_mfma_f32_16x16x32_bf16 v[28:31], a[160:163], a[96:99], v[28:31]
    ds_read_b64_tr_b16 a[176:177], v228 offset:43136
    v_mfma_f32_16x16x32_bf16 v[84:87], a[160:163], a[100:103], v[84:87]
    buffer_load_dwordx4 a[24:27], v226, s[40:43], s53 offen offset:2048 sc1
    v_mfma_f32_16x16x32_bf16 v[140:143], a[160:163], a[104:107], v[140:143]
    ds_read_b64_tr_b16 a[178:179], v228 offset:46720
    v_mfma_f32_16x16x32_bf16 v[196:199], a[160:163], a[108:111], v[196:199]
    s_waitcnt lgkmcnt(6)
    v_mfma_f32_16x16x32_bf16 v[32:35], a[164:167], a[96:99], v[32:35]
    ds_read_b64_tr_b16 a[180:181], v228 offset:43168
    v_mfma_f32_16x16x32_bf16 v[88:91], a[164:167], a[100:103], v[88:91]
    v_mfma_f32_16x16x32_bf16 v[144:147], a[164:167], a[104:107], v[144:147]
    ds_read_b64_tr_b16 a[182:183], v228 offset:46752
    v_mfma_f32_16x16x32_bf16 v[200:203], a[164:167], a[108:111], v[200:203]
    s_waitcnt lgkmcnt(6)
    v_mfma_f32_16x16x32_bf16 v[36:39], a[168:171], a[96:99], v[36:39]
    ds_read_b64_tr_b16 a[184:185], v228 offset:43200
    v_mfma_f32_16x16x32_bf16 v[92:95], a[168:171], a[100:103], v[92:95]
    buffer_load_dwordx4 v236, s[32:35], s52 offen offset:2048 lds
    v_mfma_f32_16x16x32_bf16 v[148:151], a[168:171], a[104:107], v[148:151]
    ds_read_b64_tr_b16 a[186:187], v228 offset:46784
    v_mfma_f32_16x16x32_bf16 v[204:207], a[168:171], a[108:111], v[204:207]
    s_waitcnt lgkmcnt(6)
    v_mfma_f32_16x16x32_bf16 v[40:43], a[172:175], a[96:99], v[40:43]
    ds_read_b64_tr_b16 a[160:161], v228 offset:35840
    v_mfma_f32_16x16x32_bf16 v[96:99], a[172:175], a[100:103], v[96:99]
    buffer_load_dwordx4 a[28:31], v226, s[40:43], s53 offen offset:3072 sc1
    v_mfma_f32_16x16x32_bf16 v[152:155], a[172:175], a[104:107], v[152:155]
    ds_read_b64_tr_b16 a[162:163], v228 offset:39424
    v_mfma_f32_16x16x32_bf16 v[208:211], a[172:175], a[108:111], v[208:211]
    s_waitcnt lgkmcnt(6)
    v_mfma_f32_16x16x32_bf16 v[44:47], a[176:179], a[96:99], v[44:47]
    ds_read_b64_tr_b16 a[164:165], v228 offset:35872
    v_mfma_f32_16x16x32_bf16 v[100:103], a[176:179], a[100:103], v[100:103]
    v_mfma_f32_16x16x32_bf16 v[156:159], a[176:179], a[104:107], v[156:159]
    ds_read_b64_tr_b16 a[166:167], v228 offset:39456
    v_mfma_f32_16x16x32_bf16 v[212:215], a[176:179], a[108:111], v[212:215]
    s_waitcnt lgkmcnt(6)
    v_mfma_f32_16x16x32_bf16 v[48:51], a[180:183], a[96:99], v[48:51]
    ds_read_b64_tr_b16 a[168:169], v228 offset:35904
    v_mfma_f32_16x16x32_bf16 v[104:107], a[180:183], a[100:103], v[104:107]
    v_mfma_f32_16x16x32_bf16 v[160:163], a[180:183], a[104:107], v[160:163]
    ds_read_b64_tr_b16 a[170:171], v228 offset:39488
    v_mfma_f32_16x16x32_bf16 v[216:219], a[180:183], a[108:111], v[216:219]
    s_waitcnt lgkmcnt(6)
    v_mfma_f32_16x16x32_bf16 v[52:55], a[184:187], a[96:99], v[52:55]
    s_mov_b32 s53, 24576
    ds_read_b64_tr_b16 a[172:173], v228 offset:35936
    v_mfma_f32_16x16x32_bf16 v[108:111], a[184:187], a[100:103], v[108:111]
    buffer_load_dwordx4 a[32:35], v226, s[36:39], s53 offen offset:0 sc1
    v_mfma_f32_16x16x32_bf16 v[164:167], a[184:187], a[104:107], v[164:167]
    s_mov_b32 s52, 2752512
    ds_read_b64_tr_b16 a[174:175], v228 offset:39520
    v_mfma_f32_16x16x32_bf16 v[220:223], a[184:187], a[108:111], v[220:223]
    s_waitcnt lgkmcnt(6)
    v_mfma_f32_16x16x32_bf16 v[0:3], a[160:163], a[112:115], v[0:3]
    s_add_u32 m0, s3, 28672
    ds_read_b64_tr_b16 a[176:177], v228 offset:35968
    v_mfma_f32_16x16x32_bf16 v[56:59], a[160:163], a[116:119], v[56:59]
    buffer_load_dwordx4 v230, s[32:35], s52 offen offset:0 lds
    v_mfma_f32_16x16x32_bf16 v[112:115], a[160:163], a[120:123], v[112:115]
    ds_read_b64_tr_b16 a[178:179], v228 offset:39552
    v_mfma_f32_16x16x32_bf16 v[168:171], a[160:163], a[124:127], v[168:171]
    s_waitcnt lgkmcnt(6)
    v_mfma_f32_16x16x32_bf16 v[4:7], a[164:167], a[112:115], v[4:7]
    ds_read_b64_tr_b16 a[180:181], v228 offset:36000
    v_mfma_f32_16x16x32_bf16 v[60:63], a[164:167], a[116:119], v[60:63]
    v_mfma_f32_16x16x32_bf16 v[116:119], a[164:167], a[120:123], v[116:119]
    ds_read_b64_tr_b16 a[182:183], v228 offset:39584
    v_mfma_f32_16x16x32_bf16 v[172:175], a[164:167], a[124:127], v[172:175]
    s_waitcnt lgkmcnt(6)
    v_mfma_f32_16x16x32_bf16 v[8:11], a[168:171], a[112:115], v[8:11]
    s_waitcnt vmcnt(21)
    ds_read_b64_tr_b16 a[184:185], v228 offset:36032
    v_accvgpr_read_b32 v248, a200
    v_mfma_f32_16x16x32_bf16 v[64:67], a[168:171], a[116:119], v[64:67]
    v_accvgpr_read_b32 v249, a201
    v_accvgpr_read_b32 v250, a202
    v_mfma_f32_16x16x32_bf16 v[120:123], a[168:171], a[120:123], v[120:123]
    ds_read_b64_tr_b16 a[186:187], v228 offset:39616
    v_accvgpr_read_b32 v251, a203
    v_mfma_f32_16x16x32_bf16 v[176:179], a[168:171], a[124:127], v[176:179]
    s_waitcnt lgkmcnt(6)
    v_accvgpr_read_b32 v252, a204
    v_accvgpr_read_b32 v253, a205
    v_mfma_f32_16x16x32_bf16 v[12:15], a[172:175], a[112:115], v[12:15]
    ds_read_b64_tr_b16 a[160:161], v228 offset:50176
    v_accvgpr_read_b32 v254, a206
    v_mfma_f32_16x16x32_bf16 v[68:71], a[172:175], a[116:119], v[68:71]
    buffer_load_dwordx4 a[36:39], v226, s[36:39], s53 offen offset:1024 sc1
    v_mfma_f32_16x16x32_bf16 v[124:127], a[172:175], a[120:123], v[124:127]
    ds_read_b64_tr_b16 a[162:163], v228 offset:53760
    v_accvgpr_read_b32 v255, a207
    v_mfma_f32_16x16x32_bf16 v[180:183], a[172:175], a[124:127], v[180:183]
    s_waitcnt lgkmcnt(6)
    v_add_f32 v248, v248, v252
    v_add_f32 v249, v249, v253
    v_mfma_f32_16x16x32_bf16 v[16:19], a[176:179], a[112:115], v[16:19]
    ds_read_b64_tr_b16 a[164:165], v228 offset:50208
    v_add_f32 v250, v250, v254
    v_mfma_f32_16x16x32_bf16 v[72:75], a[176:179], a[116:119], v[72:75]
    buffer_load_dwordx4 v231, s[32:35], s52 offen offset:1024 lds
    v_mfma_f32_16x16x32_bf16 v[128:131], a[176:179], a[120:123], v[128:131]
    ds_read_b64_tr_b16 a[166:167], v228 offset:53792
    v_add_f32 v251, v251, v255
    v_mfma_f32_16x16x32_bf16 v[184:187], a[176:179], a[124:127], v[184:187]
    s_waitcnt lgkmcnt(6)
    v_accvgpr_read_b32 v252, a208
    v_accvgpr_read_b32 v253, a209
    v_mfma_f32_16x16x32_bf16 v[20:23], a[180:183], a[112:115], v[20:23]
    ds_read_b64_tr_b16 a[168:169], v228 offset:50240
    v_accvgpr_read_b32 v254, a210
    v_mfma_f32_16x16x32_bf16 v[76:79], a[180:183], a[116:119], v[76:79]
    v_accvgpr_read_b32 v255, a211
    v_add_f32 v248, v248, v252
    v_mfma_f32_16x16x32_bf16 v[132:135], a[180:183], a[120:123], v[132:135]
    ds_read_b64_tr_b16 a[170:171], v228 offset:53824
    v_add_f32 v249, v249, v253
    v_mfma_f32_16x16x32_bf16 v[188:191], a[180:183], a[124:127], v[188:191]
    s_waitcnt lgkmcnt(6)
    v_add_f32 v250, v250, v254
    v_add_f32 v251, v251, v255
    v_mfma_f32_16x16x32_bf16 v[24:27], a[184:187], a[112:115], v[24:27]
    ds_read_b64_tr_b16 a[172:173], v228 offset:50272
    v_accvgpr_read_b32 v252, a212
    v_mfma_f32_16x16x32_bf16 v[80:83], a[184:187], a[116:119], v[80:83]
    buffer_load_dwordx4 a[40:43], v226, s[40:43], s53 offen offset:0 sc1
    v_mfma_f32_16x16x32_bf16 v[136:139], a[184:187], a[120:123], v[136:139]
    ds_read_b64_tr_b16 a[174:175], v228 offset:53856
    v_accvgpr_read_b32 v253, a213
    v_mfma_f32_16x16x32_bf16 v[192:195], a[184:187], a[124:127], v[192:195]
    s_waitcnt lgkmcnt(6)
    v_accvgpr_read_b32 v254, a214
    v_accvgpr_read_b32 v255, a215
    v_mfma_f32_16x16x32_bf16 v[28:31], a[160:163], a[112:115], v[28:31]
    s_add_u32 s61, s62, 5111808
    ds_read_b64_tr_b16 a[176:177], v228 offset:50304
    v_add_f32 v248, v248, v252
    v_mfma_f32_16x16x32_bf16 v[84:87], a[160:163], a[116:119], v[84:87]
    buffer_load_dword v238, v237, s[64:67], s61 offen
    v_mfma_f32_16x16x32_bf16 v[140:143], a[160:163], a[120:123], v[140:143]
    ds_read_b64_tr_b16 a[178:179], v228 offset:53888
    v_add_f32 v249, v249, v253
    v_mfma_f32_16x16x32_bf16 v[196:199], a[160:163], a[124:127], v[196:199]
    s_waitcnt lgkmcnt(6)
    v_add_f32 v250, v250, v254
    v_add_f32 v251, v251, v255
    v_mfma_f32_16x16x32_bf16 v[32:35], a[164:167], a[112:115], v[32:35]
    ds_read_b64_tr_b16 a[180:181], v228 offset:50336
    v_mov_b32 v252, v248
    v_mfma_f32_16x16x32_bf16 v[88:91], a[164:167], a[116:119], v[88:91]
    buffer_load_dwordx4 v232, s[32:35], s52 offen offset:2048 lds
    v_mfma_f32_16x16x32_bf16 v[144:147], a[164:167], a[120:123], v[144:147]
    ds_read_b64_tr_b16 a[182:183], v228 offset:53920
    v_mov_b32 v253, v249
    v_mfma_f32_16x16x32_bf16 v[200:203], a[164:167], a[124:127], v[200:203]
    s_waitcnt lgkmcnt(6)
    v_mov_b32 v254, v250
    v_mov_b32 v255, v251
    v_mfma_f32_16x16x32_bf16 v[36:39], a[168:171], a[112:115], v[36:39]
    s_nop 1
    ds_read_b64_tr_b16 a[184:185], v228 offset:50368
    v_permlane16_swap_b32 v248, v252
    v_mfma_f32_16x16x32_bf16 v[92:95], a[168:171], a[116:119], v[92:95]
    buffer_load_dwordx4 a[44:47], v226, s[40:43], s53 offen offset:1024 sc1
    v_mfma_f32_16x16x32_bf16 v[148:151], a[168:171], a[120:123], v[148:151]
    ds_read_b64_tr_b16 a[186:187], v228 offset:53952
    v_permlane16_swap_b32 v249, v253
    v_mfma_f32_16x16x32_bf16 v[204:207], a[168:171], a[124:127], v[204:207]
    s_waitcnt vmcnt(25) lgkmcnt(6)
    s_barrier
    v_permlane16_swap_b32 v250, v254
    v_mfma_f32_16x16x32_bf16 v[40:43], a[172:175], a[112:115], v[40:43]
    ds_read_b64_tr_b16 a[160:161], v229 offset:0
    v_permlane16_swap_b32 v251, v255
    v_mfma_f32_16x16x32_bf16 v[96:99], a[172:175], a[116:119], v[96:99]
    v_add_f32 v248, v248, v252
    v_add_f32 v249, v249, v253
    v_mfma_f32_16x16x32_bf16 v[152:155], a[172:175], a[120:123], v[152:155]
    ds_read_b64_tr_b16 a[162:163], v229 offset:3584
    v_add_f32 v250, v250, v254
    v_mfma_f32_16x16x32_bf16 v[208:211], a[172:175], a[124:127], v[208:211]
    s_waitcnt lgkmcnt(6)
    v_add_f32 v251, v251, v255
    v_mov_b32 v252, v248
    v_mfma_f32_16x16x32_bf16 v[44:47], a[176:179], a[112:115], v[44:47]
    ds_read_b64_tr_b16 a[164:165], v229 offset:32
    v_mov_b32 v253, v249
    v_mfma_f32_16x16x32_bf16 v[100:103], a[176:179], a[116:119], v[100:103]
    buffer_load_dwordx4 v233, s[32:35], s52 offen offset:3072 lds
    v_mfma_f32_16x16x32_bf16 v[156:159], a[176:179], a[120:123], v[156:159]
    ds_read_b64_tr_b16 a[166:167], v229 offset:3616
    v_mov_b32 v254, v250
    v_mfma_f32_16x16x32_bf16 v[212:215], a[176:179], a[124:127], v[212:215]
    s_waitcnt lgkmcnt(6)
    v_mov_b32 v255, v251
    v_mfma_f32_16x16x32_bf16 v[48:51], a[180:183], a[112:115], v[48:51]
    s_nop 1
    ds_read_b64_tr_b16 a[168:169], v229 offset:64
    v_permlane32_swap_b32 v248, v252
    v_mfma_f32_16x16x32_bf16 v[104:107], a[180:183], a[116:119], v[104:107]
    v_permlane32_swap_b32 v249, v253
    v_permlane32_swap_b32 v250, v254
    v_mfma_f32_16x16x32_bf16 v[160:163], a[180:183], a[120:123], v[160:163]
    ds_read_b64_tr_b16 a[170:171], v229 offset:3648
    v_permlane32_swap_b32 v251, v255
    v_mfma_f32_16x16x32_bf16 v[216:219], a[180:183], a[124:127], v[216:219]
    s_waitcnt lgkmcnt(6)
    v_add_f32 v248, v248, v252
    v_add_f32 v249, v249, v253
    v_mfma_f32_16x16x32_bf16 v[52:55], a[184:187], a[112:115], v[52:55]
    ds_read_b64_tr_b16 a[172:173], v229 offset:96
    v_add_f32 v250, v250, v254
    v_mfma_f32_16x16x32_bf16 v[108:111], a[184:187], a[116:119], v[108:111]
    buffer_load_dwordx4 a[48:51], v226, s[36:39], s53 offen offset:2048 sc1
    v_mfma_f32_16x16x32_bf16 v[164:167], a[184:187], a[120:123], v[164:167]
    ds_read_b64_tr_b16 a[174:175], v229 offset:3680
    v_add_f32 v251, v251, v255
    v_mfma_f32_16x16x32_bf16 v[220:223], a[184:187], a[124:127], v[220:223]
    s_waitcnt lgkmcnt(6)
    v_mov_b32 v252, 0x3727c5ac
    v_fmac_f32 v252, 0x3a800000, v248
    v_mfma_f32_16x16x32_bf16 v[0:3], a[160:163], a[128:131], v[0:3]
    ds_read_b64_tr_b16 a[176:177], v229 offset:128
    v_mov_b32 v253, 0x3727c5ac
    v_mfma_f32_16x16x32_bf16 v[56:59], a[160:163], a[132:135], v[56:59]
    v_fmac_f32 v253, 0x3a800000, v249
    v_mov_b32 v254, 0x3727c5ac
    v_mfma_f32_16x16x32_bf16 v[112:115], a[160:163], a[136:139], v[112:115]
    ds_read_b64_tr_b16 a[178:179], v229 offset:3712
    v_fmac_f32 v254, 0x3a800000, v250
    v_mfma_f32_16x16x32_bf16 v[168:171], a[160:163], a[140:143], v[168:171]
    s_waitcnt lgkmcnt(6)
    v_mov_b32 v255, 0x3727c5ac
    v_fmac_f32 v255, 0x3a800000, v251
    v_mfma_f32_16x16x32_bf16 v[4:7], a[164:167], a[128:131], v[4:7]
    s_add_u32 m0, s3, 32768
    ds_read_b64_tr_b16 a[180:181], v229 offset:160
    v_mfma_f32_16x16x32_bf16 v[60:63], a[164:167], a[132:135], v[60:63]
    buffer_load_dwordx4 v234, s[32:35], s52 offen offset:0 lds
    v_mfma_f32_16x16x32_bf16 v[116:119], a[164:167], a[136:139], v[116:119]
    ds_read_b64_tr_b16 a[182:183], v229 offset:3744
    v_mfma_f32_16x16x32_bf16 v[172:175], a[164:167], a[140:143], v[172:175]
    s_waitcnt lgkmcnt(6)
    v_rsq_f32 v248, v252
    v_mfma_f32_16x16x32_bf16 v[8:11], a[168:171], a[128:131], v[8:11]
    ds_read_b64_tr_b16 a[184:185], v229 offset:192
    v_mfma_f32_16x16x32_bf16 v[64:67], a[168:171], a[132:135], v[64:67]
    buffer_load_dwordx4 a[52:55], v226, s[36:39], s53 offen offset:3072 sc1
    v_mfma_f32_16x16x32_bf16 v[120:123], a[168:171], a[136:139], v[120:123]
    ds_read_b64_tr_b16 a[186:187], v229 offset:3776
    v_mfma_f32_16x16x32_bf16 v[176:179], a[168:171], a[140:143], v[176:179]
    s_waitcnt lgkmcnt(6)
    v_rsq_f32 v249, v253
    v_mfma_f32_16x16x32_bf16 v[12:15], a[172:175], a[128:131], v[12:15]
    ds_read_b64_tr_b16 a[160:161], v229 offset:14336
    v_mfma_f32_16x16x32_bf16 v[68:71], a[172:175], a[132:135], v[68:71]
    v_rsq_f32 v250, v254
    v_mfma_f32_16x16x32_bf16 v[124:127], a[172:175], a[136:139], v[124:127]
    ds_read_b64_tr_b16 a[162:163], v229 offset:17920
    v_mfma_f32_16x16x32_bf16 v[180:183], a[172:175], a[140:143], v[180:183]
    s_waitcnt lgkmcnt(6)
    v_rsq_f32 v251, v255
    v_mfma_f32_16x16x32_bf16 v[16:19], a[176:179], a[128:131], v[16:19]
    ds_read_b64_tr_b16 a[164:165], v229 offset:14368
    v_lshlrev_b32 v252, 16, v225
    v_mfma_f32_16x16x32_bf16 v[72:75], a[176:179], a[132:135], v[72:75]
    v_and_b32 v252, 0x300000, v252
    v_and_b32 v253, 0xff, v226
    v_mfma_f32_16x16x32_bf16 v[128:131], a[176:179], a[136:139], v[128:131]
    ds_read_b64_tr_b16 a[166:167], v229 offset:17952
    v_or_b32 v252, v252, v253
    v_mfma_f32_16x16x32_bf16 v[184:187], a[176:179], a[140:143], v[184:187]
    s_waitcnt lgkmcnt(6)
    ds_write_b128 v245, v[248:251]
    v_mfma_f32_16x16x32_bf16 v[20:23], a[180:183], a[128:131], v[20:23]
    s_and_b32 s27, s94, 15
    ds_read_b64_tr_b16 a[168:169], v229 offset:14400
    v_mfma_f32_16x16x32_bf16 v[76:79], a[180:183], a[132:135], v[76:79]
    buffer_load_dwordx4 v235, s[32:35], s52 offen offset:1024 lds
    v_mfma_f32_16x16x32_bf16 v[132:135], a[180:183], a[136:139], v[132:135]
    s_lshl_b32 s27, s27, 11
    ds_read_b64_tr_b16 a[170:171], v229 offset:17984
    v_mfma_f32_16x16x32_bf16 v[188:191], a[180:183], a[140:143], v[188:191]
    s_waitcnt lgkmcnt(7)
    s_add_u32 s27, s27, s94
    s_lshl_b32 s27, s27, 9
    v_mfma_f32_16x16x32_bf16 v[24:27], a[184:187], a[128:131], v[24:27]
    s_add_u32 s27, s27, s60
    ds_read_b64_tr_b16 a[172:173], v229 offset:14432
    v_mfma_f32_16x16x32_bf16 v[80:83], a[184:187], a[132:135], v[80:83]
    buffer_load_dwordx4 a[56:59], v226, s[40:43], s53 offen offset:2048 sc1
    v_mfma_f32_16x16x32_bf16 v[136:139], a[184:187], a[136:139], v[136:139]
    s_add_u32 s27, s27, 294912
    ds_read_b64_tr_b16 a[174:175], v229 offset:18016
    v_mfma_f32_16x16x32_bf16 v[192:195], a[184:187], a[140:143], v[192:195]
    s_waitcnt lgkmcnt(7)
    buffer_store_dwordx4 v[248:251], v252, s[48:51], s27 offen sc1
    v_mfma_f32_16x16x32_bf16 v[28:31], a[160:163], a[128:131], v[28:31]
    ds_read_b64_tr_b16 a[176:177], v229 offset:14464
    ds_read_b32 v240, v246 offset:0
    v_mfma_f32_16x16x32_bf16 v[84:87], a[160:163], a[132:135], v[84:87]
    ds_read_b32 v241, v246 offset:64
    ds_read_b32 v242, v246 offset:128
    v_mfma_f32_16x16x32_bf16 v[140:143], a[160:163], a[136:139], v[140:143]
    ds_read_b64_tr_b16 a[178:179], v229 offset:18048
    ds_read_b32 v243, v246 offset:192
    v_mfma_f32_16x16x32_bf16 v[196:199], a[160:163], a[140:143], v[196:199]
    s_waitcnt lgkmcnt(11)
    v_mfma_f32_16x16x32_bf16 v[32:35], a[164:167], a[128:131], v[32:35]
    ds_read_b64_tr_b16 a[180:181], v229 offset:14496
    v_mfma_f32_16x16x32_bf16 v[88:91], a[164:167], a[132:135], v[88:91]
    buffer_load_dwordx4 v236, s[32:35], s52 offen offset:2048 lds
    v_mfma_f32_16x16x32_bf16 v[144:147], a[164:167], a[136:139], v[144:147]
    ds_read_b64_tr_b16 a[182:183], v229 offset:18080
    v_mfma_f32_16x16x32_bf16 v[200:203], a[164:167], a[140:143], v[200:203]
    s_waitcnt lgkmcnt(10)
    v_mfma_f32_16x16x32_bf16 v[36:39], a[168:171], a[128:131], v[36:39]
    s_add_u32 s61, s62, 5505024
    ds_read_b64_tr_b16 a[184:185], v229 offset:14528
    v_mfma_f32_16x16x32_bf16 v[92:95], a[168:171], a[132:135], v[92:95]
    buffer_load_dword v238, v237, s[64:67], s61 offen
    v_mfma_f32_16x16x32_bf16 v[148:151], a[168:171], a[136:139], v[148:151]
    ds_read_b64_tr_b16 a[186:187], v229 offset:18112
    v_mfma_f32_16x16x32_bf16 v[204:207], a[168:171], a[140:143], v[204:207]
    s_waitcnt lgkmcnt(10)
    v_mfma_f32_16x16x32_bf16 v[40:43], a[172:175], a[128:131], v[40:43]
    ds_read_b64_tr_b16 a[160:161], v229 offset:7168
    v_mfma_f32_16x16x32_bf16 v[96:99], a[172:175], a[132:135], v[96:99]
    buffer_load_dwordx4 a[60:63], v226, s[40:43], s53 offen offset:3072 sc1
    v_mfma_f32_16x16x32_bf16 v[152:155], a[172:175], a[136:139], v[152:155]
    ds_read_b64_tr_b16 a[162:163], v229 offset:10752
    v_mfma_f32_16x16x32_bf16 v[208:211], a[172:175], a[140:143], v[208:211]
    s_waitcnt lgkmcnt(7)
    v_mfma_f32_16x16x32_bf16 v[44:47], a[176:179], a[128:131], v[44:47]
    ds_read_b64_tr_b16 a[164:165], v229 offset:7200
    v_mfma_f32_16x16x32_bf16 v[100:103], a[176:179], a[132:135], v[100:103]
    v_mfma_f32_16x16x32_bf16 v[156:159], a[176:179], a[136:139], v[156:159]
    s_mov_b32 s52, 3211264
    ds_read_b64_tr_b16 a[166:167], v229 offset:10784
    v_mfma_f32_16x16x32_bf16 v[212:215], a[176:179], a[140:143], v[212:215]
    s_waitcnt lgkmcnt(6)
    v_mfma_f32_16x16x32_bf16 v[48:51], a[180:183], a[128:131], v[48:51]
    s_add_u32 m0, s3, 57344
    ds_read_b64_tr_b16 a[168:169], v229 offset:7232
    v_mfma_f32_16x16x32_bf16 v[104:107], a[180:183], a[132:135], v[104:107]
    buffer_load_dwordx4 v230, s[32:35], s52 offen offset:0 lds
    v_mfma_f32_16x16x32_bf16 v[160:163], a[180:183], a[136:139], v[160:163]
    ds_read_b64_tr_b16 a[170:171], v229 offset:10816
    v_mfma_f32_16x16x32_bf16 v[216:219], a[180:183], a[140:143], v[216:219]
    s_waitcnt lgkmcnt(6)
    v_mfma_f32_16x16x32_bf16 v[52:55], a[184:187], a[128:131], v[52:55]
    s_mov_b32 s53, 28672
    ds_read_b64_tr_b16 a[172:173], v229 offset:7264
    v_mfma_f32_16x16x32_bf16 v[108:111], a[184:187], a[132:135], v[108:111]
    buffer_load_dwordx4 a[64:67], v226, s[36:39], s53 offen offset:0 sc1
    v_mfma_f32_16x16x32_bf16 v[164:167], a[184:187], a[136:139], v[164:167]
    ds_read_b64_tr_b16 a[174:175], v229 offset:10848
    v_mul_f32 v240, 0xbfb8aa3b, v240
    v_mfma_f32_16x16x32_bf16 v[220:223], a[184:187], a[140:143], v[220:223]
    s_waitcnt lgkmcnt(6)
    v_mul_f32 v241, 0xbfb8aa3b, v241
    v_mul_f32 v242, 0xbfb8aa3b, v242
    v_mfma_f32_16x16x32_bf16 v[0:3], a[160:163], a[144:147], v[0:3]
    ds_read_b64_tr_b16 a[176:177], v229 offset:7296
    v_mul_f32 v243, 0xbfb8aa3b, v243
    v_mfma_f32_16x16x32_bf16 v[56:59], a[160:163], a[148:151], v[56:59]
    v_mfma_f32_16x16x32_bf16 v[112:115], a[160:163], a[152:155], v[112:115]
    ds_read_b64_tr_b16 a[178:179], v229 offset:10880
    v_mfma_f32_16x16x32_bf16 v[168:171], a[160:163], a[156:159], v[168:171]
    s_waitcnt lgkmcnt(6)
    v_mfma_f32_16x16x32_bf16 v[4:7], a[164:167], a[144:147], v[4:7]
    ds_read_b64_tr_b16 a[180:181], v229 offset:7328
    v_mfma_f32_16x16x32_bf16 v[60:63], a[164:167], a[148:151], v[60:63]
    v_mfma_f32_16x16x32_bf16 v[116:119], a[164:167], a[152:155], v[116:119]
    ds_read_b64_tr_b16 a[182:183], v229 offset:10912
    v_mfma_f32_16x16x32_bf16 v[172:175], a[164:167], a[156:159], v[172:175]
    s_waitcnt lgkmcnt(6)
    v_mfma_f32_16x16x32_bf16 v[8:11], a[168:171], a[144:147], v[8:11]
    ds_read_b64_tr_b16 a[184:185], v229 offset:7360
    v_mfma_f32_16x16x32_bf16 v[64:67], a[168:171], a[148:151], v[64:67]
    buffer_load_dwordx4 v231, s[32:35], s52 offen offset:1024 lds
    v_mfma_f32_16x16x32_bf16 v[120:123], a[168:171], a[152:155], v[120:123]
    ds_read_b64_tr_b16 a[186:187], v229 offset:10944
    v_mfma_f32_16x16x32_bf16 v[176:179], a[168:171], a[156:159], v[176:179]
    s_waitcnt lgkmcnt(6)
    v_mfma_f32_16x16x32_bf16 v[12:15], a[172:175], a[144:147], v[12:15]
    ds_read_b64_tr_b16 a[160:161], v229 offset:21504
    v_mfma_f32_16x16x32_bf16 v[68:71], a[172:175], a[148:151], v[68:71]
    buffer_load_dwordx4 a[68:71], v226, s[36:39], s53 offen offset:1024 sc1
    v_mfma_f32_16x16x32_bf16 v[124:127], a[172:175], a[152:155], v[124:127]
    ds_read_b64_tr_b16 a[162:163], v229 offset:25088
    v_mfma_f32_16x16x32_bf16 v[180:183], a[172:175], a[156:159], v[180:183]
    s_waitcnt lgkmcnt(6)
    v_mfma_f32_16x16x32_bf16 v[16:19], a[176:179], a[144:147], v[16:19]
    ds_read_b64_tr_b16 a[164:165], v229 offset:21536
    v_mfma_f32_16x16x32_bf16 v[72:75], a[176:179], a[148:151], v[72:75]
    v_mfma_f32_16x16x32_bf16 v[128:131], a[176:179], a[152:155], v[128:131]
    ds_read_b64_tr_b16 a[166:167], v229 offset:25120
    v_mfma_f32_16x16x32_bf16 v[184:187], a[176:179], a[156:159], v[184:187]
    s_waitcnt lgkmcnt(6)
    v_mfma_f32_16x16x32_bf16 v[20:23], a[180:183], a[144:147], v[20:23]
    ds_read_b64_tr_b16 a[168:169], v229 offset:21568
    v_mfma_f32_16x16x32_bf16 v[76:79], a[180:183], a[148:151], v[76:79]
    v_mfma_f32_16x16x32_bf16 v[132:135], a[180:183], a[152:155], v[132:135]
    ds_read_b64_tr_b16 a[170:171], v229 offset:25152
    v_mfma_f32_16x16x32_bf16 v[188:191], a[180:183], a[156:159], v[188:191]
    s_waitcnt lgkmcnt(6)
    v_mfma_f32_16x16x32_bf16 v[24:27], a[184:187], a[144:147], v[24:27]
    ds_read_b64_tr_b16 a[172:173], v229 offset:21600
    v_mfma_f32_16x16x32_bf16 v[80:83], a[184:187], a[148:151], v[80:83]
    buffer_load_dwordx4 a[72:75], v226, s[40:43], s53 offen offset:0 sc1
    v_mfma_f32_16x16x32_bf16 v[136:139], a[184:187], a[152:155], v[136:139]
    ds_read_b64_tr_b16 a[174:175], v229 offset:25184
    v_mfma_f32_16x16x32_bf16 v[192:195], a[184:187], a[156:159], v[192:195]
    s_waitcnt lgkmcnt(6)
    v_mfma_f32_16x16x32_bf16 v[28:31], a[160:163], a[144:147], v[28:31]
    ds_read_b64_tr_b16 a[176:177], v229 offset:21632
    v_mfma_f32_16x16x32_bf16 v[84:87], a[160:163], a[148:151], v[84:87]
    buffer_load_dwordx4 v232, s[32:35], s52 offen offset:2048 lds
    v_mfma_f32_16x16x32_bf16 v[140:143], a[160:163], a[152:155], v[140:143]
    ds_read_b64_tr_b16 a[178:179], v229 offset:25216
    v_mfma_f32_16x16x32_bf16 v[196:199], a[160:163], a[156:159], v[196:199]
    s_waitcnt lgkmcnt(6)
    v_mfma_f32_16x16x32_bf16 v[32:35], a[164:167], a[144:147], v[32:35]
    ds_read_b64_tr_b16 a[180:181], v229 offset:21664
    v_mfma_f32_16x16x32_bf16 v[88:91], a[164:167], a[148:151], v[88:91]
    v_mfma_f32_16x16x32_bf16 v[144:147], a[164:167], a[152:155], v[144:147]
    ds_read_b64_tr_b16 a[182:183], v229 offset:25248
    v_mfma_f32_16x16x32_bf16 v[200:203], a[164:167], a[156:159], v[200:203]
    s_waitcnt lgkmcnt(6)
    v_mfma_f32_16x16x32_bf16 v[36:39], a[168:171], a[144:147], v[36:39]
    ds_read_b64_tr_b16 a[184:185], v229 offset:21696
    v_mfma_f32_16x16x32_bf16 v[92:95], a[168:171], a[148:151], v[92:95]
    buffer_load_dwordx4 a[76:79], v226, s[40:43], s53 offen offset:1024 sc1
    v_mfma_f32_16x16x32_bf16 v[148:151], a[168:171], a[152:155], v[148:151]
    ds_read_b64_tr_b16 a[186:187], v229 offset:25280
    v_mfma_f32_16x16x32_bf16 v[204:207], a[168:171], a[156:159], v[204:207]
    s_waitcnt vmcnt(26) lgkmcnt(6)
    s_barrier
    v_mfma_f32_16x16x32_bf16 v[40:43], a[172:175], a[144:147], v[40:43]
    ds_read_b64_tr_b16 a[160:161], v227 offset:0
    v_mfma_f32_16x16x32_bf16 v[96:99], a[172:175], a[148:151], v[96:99]
    buffer_load_dwordx4 v233, s[32:35], s52 offen offset:3072 lds
    v_mfma_f32_16x16x32_bf16 v[152:155], a[172:175], a[152:155], v[152:155]
    ds_read_b64_tr_b16 a[162:163], v227 offset:3584
    v_mfma_f32_16x16x32_bf16 v[208:211], a[172:175], a[156:159], v[208:211]
    s_waitcnt lgkmcnt(6)
    v_mfma_f32_16x16x32_bf16 v[44:47], a[176:179], a[144:147], v[44:47]
    ds_read_b64_tr_b16 a[164:165], v227 offset:32
    v_mfma_f32_16x16x32_bf16 v[100:103], a[176:179], a[148:151], v[100:103]
    v_mfma_f32_16x16x32_bf16 v[156:159], a[176:179], a[152:155], v[156:159]
    ds_read_b64_tr_b16 a[166:167], v227 offset:3616
    v_mfma_f32_16x16x32_bf16 v[212:215], a[176:179], a[156:159], v[212:215]
    s_waitcnt lgkmcnt(6)
    v_mfma_f32_16x16x32_bf16 v[48:51], a[180:183], a[144:147], v[48:51]
    s_add_u32 s61, s62, 5898240
    ds_read_b64_tr_b16 a[168:169], v227 offset:64
    v_mfma_f32_16x16x32_bf16 v[104:107], a[180:183], a[148:151], v[104:107]
    buffer_load_dword v238, v237, s[64:67], s61 offen
    v_mfma_f32_16x16x32_bf16 v[160:163], a[180:183], a[152:155], v[160:163]
    ds_read_b64_tr_b16 a[170:171], v227 offset:3648
    v_mfma_f32_16x16x32_bf16 v[216:219], a[180:183], a[156:159], v[216:219]
    s_waitcnt lgkmcnt(6)
    v_mfma_f32_16x16x32_bf16 v[52:55], a[184:187], a[144:147], v[52:55]
    ds_read_b64_tr_b16 a[172:173], v227 offset:96
    v_mfma_f32_16x16x32_bf16 v[108:111], a[184:187], a[148:151], v[108:111]
    buffer_load_dwordx4 a[80:83], v226, s[36:39], s53 offen offset:2048 sc1
    v_mfma_f32_16x16x32_bf16 v[164:167], a[184:187], a[152:155], v[164:167]
    ds_read_b64_tr_b16 a[174:175], v227 offset:3680
    v_mfma_f32_16x16x32_bf16 v[220:223], a[184:187], a[156:159], v[220:223]
    s_waitcnt lgkmcnt(6)
    v_mfma_f32_16x16x32_bf16 v[0:3], a[160:163], a[0:3], v[0:3]
    s_add_u32 m0, s3, 61440
    ds_read_b64_tr_b16 a[176:177], v227 offset:128
    v_mfma_f32_16x16x32_bf16 v[56:59], a[160:163], a[4:7], v[56:59]
    buffer_load_dwordx4 v234, s[32:35], s52 offen offset:0 lds
    v_mfma_f32_16x16x32_bf16 v[112:115], a[160:163], a[8:11], v[112:115]
    ds_read_b64_tr_b16 a[178:179], v227 offset:3712
    v_mfma_f32_16x16x32_bf16 v[168:171], a[160:163], a[12:15], v[168:171]
    s_waitcnt lgkmcnt(6)
    v_mfma_f32_16x16x32_bf16 v[4:7], a[164:167], a[0:3], v[4:7]
    ds_read_b64_tr_b16 a[180:181], v227 offset:160
    v_mfma_f32_16x16x32_bf16 v[60:63], a[164:167], a[4:7], v[60:63]
    v_mfma_f32_16x16x32_bf16 v[116:119], a[164:167], a[8:11], v[116:119]
    ds_read_b64_tr_b16 a[182:183], v227 offset:3744
    v_mfma_f32_16x16x32_bf16 v[172:175], a[164:167], a[12:15], v[172:175]
    s_waitcnt lgkmcnt(6)
    v_mfma_f32_16x16x32_bf16 v[8:11], a[168:171], a[0:3], v[8:11]
    ds_read_b64_tr_b16 a[184:185], v227 offset:192
    v_mfma_f32_16x16x32_bf16 v[64:67], a[168:171], a[4:7], v[64:67]
    buffer_load_dwordx4 a[84:87], v226, s[36:39], s53 offen offset:3072 sc1
    v_mfma_f32_16x16x32_bf16 v[120:123], a[168:171], a[8:11], v[120:123]
    ds_read_b64_tr_b16 a[186:187], v227 offset:3776
    v_mfma_f32_16x16x32_bf16 v[176:179], a[168:171], a[12:15], v[176:179]
    s_waitcnt lgkmcnt(6)
    v_mfma_f32_16x16x32_bf16 v[12:15], a[172:175], a[0:3], v[12:15]
    ds_read_b64_tr_b16 a[160:161], v227 offset:14336
    v_mfma_f32_16x16x32_bf16 v[68:71], a[172:175], a[4:7], v[68:71]
    v_mfma_f32_16x16x32_bf16 v[124:127], a[172:175], a[8:11], v[124:127]
    ds_read_b64_tr_b16 a[162:163], v227 offset:17920
    v_mfma_f32_16x16x32_bf16 v[180:183], a[172:175], a[12:15], v[180:183]
    s_waitcnt lgkmcnt(6)
    v_mfma_f32_16x16x32_bf16 v[16:19], a[176:179], a[0:3], v[16:19]
    ds_read_b64_tr_b16 a[164:165], v227 offset:14368
    v_mfma_f32_16x16x32_bf16 v[72:75], a[176:179], a[4:7], v[72:75]
    buffer_load_dwordx4 v235, s[32:35], s52 offen offset:1024 lds
    v_mfma_f32_16x16x32_bf16 v[128:131], a[176:179], a[8:11], v[128:131]
    ds_read_b64_tr_b16 a[166:167], v227 offset:17952
    v_mfma_f32_16x16x32_bf16 v[184:187], a[176:179], a[12:15], v[184:187]
    s_waitcnt lgkmcnt(6)
    v_mfma_f32_16x16x32_bf16 v[20:23], a[180:183], a[0:3], v[20:23]
    ds_read_b64_tr_b16 a[168:169], v227 offset:14400
    v_mfma_f32_16x16x32_bf16 v[76:79], a[180:183], a[4:7], v[76:79]
    v_mfma_f32_16x16x32_bf16 v[132:135], a[180:183], a[8:11], v[132:135]
    ds_read_b64_tr_b16 a[170:171], v227 offset:17984
    v_mfma_f32_16x16x32_bf16 v[188:191], a[180:183], a[12:15], v[188:191]
    s_waitcnt lgkmcnt(6)
    v_mfma_f32_16x16x32_bf16 v[24:27], a[184:187], a[0:3], v[24:27]
    ds_read_b64_tr_b16 a[172:173], v227 offset:14432
    v_mfma_f32_16x16x32_bf16 v[80:83], a[184:187], a[4:7], v[80:83]
    buffer_load_dwordx4 a[88:91], v226, s[40:43], s53 offen offset:2048 sc1
    v_mfma_f32_16x16x32_bf16 v[136:139], a[184:187], a[8:11], v[136:139]
    ds_read_b64_tr_b16 a[174:175], v227 offset:18016
    v_mfma_f32_16x16x32_bf16 v[192:195], a[184:187], a[12:15], v[192:195]
    s_waitcnt lgkmcnt(6)
    v_mfma_f32_16x16x32_bf16 v[28:31], a[160:163], a[0:3], v[28:31]
    ds_read_b64_tr_b16 a[176:177], v227 offset:14464
    v_mfma_f32_16x16x32_bf16 v[84:87], a[160:163], a[4:7], v[84:87]
    v_mfma_f32_16x16x32_bf16 v[140:143], a[160:163], a[8:11], v[140:143]
    ds_read_b64_tr_b16 a[178:179], v227 offset:18048
    v_mfma_f32_16x16x32_bf16 v[196:199], a[160:163], a[12:15], v[196:199]
    s_waitcnt lgkmcnt(6)
    v_mfma_f32_16x16x32_bf16 v[32:35], a[164:167], a[0:3], v[32:35]
    ds_read_b64_tr_b16 a[180:181], v227 offset:14496
    v_mfma_f32_16x16x32_bf16 v[88:91], a[164:167], a[4:7], v[88:91]
    buffer_load_dwordx4 v236, s[32:35], s52 offen offset:2048 lds
    v_mfma_f32_16x16x32_bf16 v[144:147], a[164:167], a[8:11], v[144:147]
    ds_read_b64_tr_b16 a[182:183], v227 offset:18080
    v_mfma_f32_16x16x32_bf16 v[200:203], a[164:167], a[12:15], v[200:203]
    s_waitcnt lgkmcnt(6)
    v_mfma_f32_16x16x32_bf16 v[36:39], a[168:171], a[0:3], v[36:39]
    ds_read_b64_tr_b16 a[184:185], v227 offset:14528
    v_mfma_f32_16x16x32_bf16 v[92:95], a[168:171], a[4:7], v[92:95]
    buffer_load_dwordx4 a[92:95], v226, s[40:43], s53 offen offset:3072 sc1
    v_mfma_f32_16x16x32_bf16 v[148:151], a[168:171], a[8:11], v[148:151]
    ds_read_b64_tr_b16 a[186:187], v227 offset:18112
    v_mfma_f32_16x16x32_bf16 v[204:207], a[168:171], a[12:15], v[204:207]
    s_waitcnt lgkmcnt(6)
    v_mfma_f32_16x16x32_bf16 v[40:43], a[172:175], a[0:3], v[40:43]
    ds_read_b64_tr_b16 a[160:161], v227 offset:7168
    v_mfma_f32_16x16x32_bf16 v[96:99], a[172:175], a[4:7], v[96:99]
    v_mfma_f32_16x16x32_bf16 v[152:155], a[172:175], a[8:11], v[152:155]
    ds_read_b64_tr_b16 a[162:163], v227 offset:10752
    v_mfma_f32_16x16x32_bf16 v[208:211], a[172:175], a[12:15], v[208:211]
    s_waitcnt lgkmcnt(6)
    v_mfma_f32_16x16x32_bf16 v[44:47], a[176:179], a[0:3], v[44:47]
    ds_read_b64_tr_b16 a[164:165], v227 offset:7200
    v_mfma_f32_16x16x32_bf16 v[100:103], a[176:179], a[4:7], v[100:103]
Lpad_10:
    s_cbranch_execz Lpad_14
    v_mfma_f32_16x16x32_bf16 v[156:159], a[176:179], a[8:11], v[156:159]
    s_mov_b32 s52, 3670016
    ds_read_b64_tr_b16 a[166:167], v227 offset:10784
    v_mfma_f32_16x16x32_bf16 v[212:215], a[176:179], a[12:15], v[212:215]
    s_waitcnt lgkmcnt(6)
    v_mfma_f32_16x16x32_bf16 v[48:51], a[180:183], a[0:3], v[48:51]
    s_add_u32 m0, s3, 86016
    ds_read_b64_tr_b16 a[168:169], v227 offset:7232
    v_mfma_f32_16x16x32_bf16 v[104:107], a[180:183], a[4:7], v[104:107]
    buffer_load_dwordx4 v230, s[32:35], s52 offen offset:0 lds
    v_mfma_f32_16x16x32_bf16 v[160:163], a[180:183], a[8:11], v[160:163]
    ds_read_b64_tr_b16 a[170:171], v227 offset:10816
    v_mfma_f32_16x16x32_bf16 v[216:219], a[180:183], a[12:15], v[216:219]
    s_waitcnt lgkmcnt(6)
    v_mfma_f32_16x16x32_bf16 v[52:55], a[184:187], a[0:3], v[52:55]
    s_mov_b32 s53, 32768
    ds_read_b64_tr_b16 a[172:173], v227 offset:7264
    v_mfma_f32_16x16x32_bf16 v[108:111], a[184:187], a[4:7], v[108:111]
    buffer_load_dwordx4 a[96:99], v226, s[36:39], s53 offen offset:0 sc1
    v_mfma_f32_16x16x32_bf16 v[164:167], a[184:187], a[8:11], v[164:167]
    ds_read_b64_tr_b16 a[174:175], v227 offset:10848
    v_mfma_f32_16x16x32_bf16 v[220:223], a[184:187], a[12:15], v[220:223]
    s_waitcnt vmcnt(36) lgkmcnt(6)
    v_mfma_f32_16x16x32_bf16 v[0:3], a[160:163], a[16:19], v[0:3]
    s_add_u32 s61, s62, 6291456
    ds_read_b64_tr_b16 a[176:177], v227 offset:7296
    v_mfma_f32_16x16x32_bf16 v[56:59], a[160:163], a[20:23], v[56:59]
    buffer_load_dword v238, v237, s[64:67], s61 offen
    v_mfma_f32_16x16x32_bf16 v[112:115], a[160:163], a[24:27], v[112:115]
    ds_read_b64_tr_b16 a[178:179], v227 offset:10880
    v_mfma_f32_16x16x32_bf16 v[168:171], a[160:163], a[28:31], v[168:171]
    s_waitcnt lgkmcnt(6)
    v_mfma_f32_16x16x32_bf16 v[4:7], a[164:167], a[16:19], v[4:7]
    ds_read_b64_tr_b16 a[180:181], v227 offset:7328
    v_mfma_f32_16x16x32_bf16 v[60:63], a[164:167], a[20:23], v[60:63]
    buffer_load_dwordx4 v231, s[32:35], s52 offen offset:1024 lds
    v_mfma_f32_16x16x32_bf16 v[116:119], a[164:167], a[24:27], v[116:119]
    ds_read_b64_tr_b16 a[182:183], v227 offset:10912
    v_mfma_f32_16x16x32_bf16 v[172:175], a[164:167], a[28:31], v[172:175]
    s_waitcnt lgkmcnt(6)
    v_mfma_f32_16x16x32_bf16 v[8:11], a[168:171], a[16:19], v[8:11]
    ds_read_b64_tr_b16 a[184:185], v227 offset:7360
    v_mfma_f32_16x16x32_bf16 v[64:67], a[168:171], a[20:23], v[64:67]
    buffer_load_dwordx4 a[100:103], v226, s[36:39], s53 offen offset:1024 sc1
    v_mfma_f32_16x16x32_bf16 v[120:123], a[168:171], a[24:27], v[120:123]
    ds_read_b64_tr_b16 a[186:187], v227 offset:10944
    v_mfma_f32_16x16x32_bf16 v[176:179], a[168:171], a[28:31], v[176:179]
    s_waitcnt lgkmcnt(6)
    v_mfma_f32_16x16x32_bf16 v[12:15], a[172:175], a[16:19], v[12:15]
    ds_read_b64_tr_b16 a[160:161], v227 offset:21504
    v_mfma_f32_16x16x32_bf16 v[68:71], a[172:175], a[20:23], v[68:71]
    v_mfma_f32_16x16x32_bf16 v[124:127], a[172:175], a[24:27], v[124:127]
    ds_read_b64_tr_b16 a[162:163], v227 offset:25088
    v_mfma_f32_16x16x32_bf16 v[180:183], a[172:175], a[28:31], v[180:183]
    s_waitcnt lgkmcnt(6)
    v_mfma_f32_16x16x32_bf16 v[16:19], a[176:179], a[16:19], v[16:19]
    ds_read_b64_tr_b16 a[164:165], v227 offset:21536
    v_mfma_f32_16x16x32_bf16 v[72:75], a[176:179], a[20:23], v[72:75]
    v_mfma_f32_16x16x32_bf16 v[128:131], a[176:179], a[24:27], v[128:131]
    ds_read_b64_tr_b16 a[166:167], v227 offset:25120
    v_mfma_f32_16x16x32_bf16 v[184:187], a[176:179], a[28:31], v[184:187]
    s_waitcnt lgkmcnt(6)
    v_mfma_f32_16x16x32_bf16 v[20:23], a[180:183], a[16:19], v[20:23]
    ds_read_b64_tr_b16 a[168:169], v227 offset:21568
    v_mfma_f32_16x16x32_bf16 v[76:79], a[180:183], a[20:23], v[76:79]
    buffer_load_dwordx4 v232, s[32:35], s52 offen offset:2048 lds
    v_mfma_f32_16x16x32_bf16 v[132:135], a[180:183], a[24:27], v[132:135]
    ds_read_b64_tr_b16 a[170:171], v227 offset:25152
    v_mfma_f32_16x16x32_bf16 v[188:191], a[180:183], a[28:31], v[188:191]
    s_waitcnt lgkmcnt(6)
    v_mfma_f32_16x16x32_bf16 v[24:27], a[184:187], a[16:19], v[24:27]
    ds_read_b64_tr_b16 a[172:173], v227 offset:21600
    v_mfma_f32_16x16x32_bf16 v[80:83], a[184:187], a[20:23], v[80:83]
    buffer_load_dwordx4 a[104:107], v226, s[40:43], s53 offen offset:0 sc1
    v_mfma_f32_16x16x32_bf16 v[136:139], a[184:187], a[24:27], v[136:139]
    ds_read_b64_tr_b16 a[174:175], v227 offset:25184
    v_mfma_f32_16x16x32_bf16 v[192:195], a[184:187], a[28:31], v[192:195]
    s_waitcnt lgkmcnt(6)
    v_mfma_f32_16x16x32_bf16 v[28:31], a[160:163], a[16:19], v[28:31]
    ds_read_b64_tr_b16 a[176:177], v227 offset:21632
    v_mfma_f32_16x16x32_bf16 v[84:87], a[160:163], a[20:23], v[84:87]
    v_mfma_f32_16x16x32_bf16 v[140:143], a[160:163], a[24:27], v[140:143]
    ds_read_b64_tr_b16 a[178:179], v227 offset:25216
    v_mfma_f32_16x16x32_bf16 v[196:199], a[160:163], a[28:31], v[196:199]
    s_waitcnt lgkmcnt(6)
    v_mfma_f32_16x16x32_bf16 v[32:35], a[164:167], a[16:19], v[32:35]
    ds_read_b64_tr_b16 a[180:181], v227 offset:21664
    v_mfma_f32_16x16x32_bf16 v[88:91], a[164:167], a[20:23], v[88:91]
    v_mfma_f32_16x16x32_bf16 v[144:147], a[164:167], a[24:27], v[144:147]
    ds_read_b64_tr_b16 a[182:183], v227 offset:25248
    v_mfma_f32_16x16x32_bf16 v[200:203], a[164:167], a[28:31], v[200:203]
    s_waitcnt lgkmcnt(6)
    v_mfma_f32_16x16x32_bf16 v[36:39], a[168:171], a[16:19], v[36:39]
    ds_read_b64_tr_b16 a[184:185], v227 offset:21696
    v_mfma_f32_16x16x32_bf16 v[92:95], a[168:171], a[20:23], v[92:95]
    buffer_load_dwordx4 a[108:111], v226, s[40:43], s53 offen offset:1024 sc1
    v_mfma_f32_16x16x32_bf16 v[148:151], a[168:171], a[24:27], v[148:151]
    ds_read_b64_tr_b16 a[186:187], v227 offset:25280
    v_mfma_f32_16x16x32_bf16 v[204:207], a[168:171], a[28:31], v[204:207]
    s_waitcnt vmcnt(26) lgkmcnt(6)
    s_barrier
    v_mfma_f32_16x16x32_bf16 v[40:43], a[172:175], a[16:19], v[40:43]
    ds_read_b64_tr_b16 a[160:161], v227 offset:28672
    v_mfma_f32_16x16x32_bf16 v[96:99], a[172:175], a[20:23], v[96:99]
    buffer_load_dwordx4 v233, s[32:35], s52 offen offset:3072 lds
    v_mfma_f32_16x16x32_bf16 v[152:155], a[172:175], a[24:27], v[152:155]
    ds_read_b64_tr_b16 a[162:163], v227 offset:32256
    v_mfma_f32_16x16x32_bf16 v[208:211], a[172:175], a[28:31], v[208:211]
    s_waitcnt lgkmcnt(6)
    v_mfma_f32_16x16x32_bf16 v[44:47], a[176:179], a[16:19], v[44:47]
    ds_read_b64_tr_b16 a[164:165], v227 offset:28704
    v_mfma_f32_16x16x32_bf16 v[100:103], a[176:179], a[20:23], v[100:103]
    v_mfma_f32_16x16x32_bf16 v[156:159], a[176:179], a[24:27], v[156:159]
    ds_read_b64_tr_b16 a[166:167], v227 offset:32288
    v_mfma_f32_16x16x32_bf16 v[212:215], a[176:179], a[28:31], v[212:215]
    s_waitcnt lgkmcnt(6)
    v_mfma_f32_16x16x32_bf16 v[48:51], a[180:183], a[16:19], v[48:51]
    ds_read_b64_tr_b16 a[168:169], v227 offset:28736
    v_mfma_f32_16x16x32_bf16 v[104:107], a[180:183], a[20:23], v[104:107]
    v_mfma_f32_16x16x32_bf16 v[160:163], a[180:183], a[24:27], v[160:163]
    ds_read_b64_tr_b16 a[170:171], v227 offset:32320
    v_mfma_f32_16x16x32_bf16 v[216:219], a[180:183], a[28:31], v[216:219]
    s_waitcnt lgkmcnt(6)
    v_mfma_f32_16x16x32_bf16 v[52:55], a[184:187], a[16:19], v[52:55]
    ds_read_b64_tr_b16 a[172:173], v227 offset:28768
    v_mfma_f32_16x16x32_bf16 v[108:111], a[184:187], a[20:23], v[108:111]
    buffer_load_dwordx4 a[112:115], v226, s[36:39], s53 offen offset:2048 sc1
    v_mfma_f32_16x16x32_bf16 v[164:167], a[184:187], a[24:27], v[164:167]
    ds_read_b64_tr_b16 a[174:175], v227 offset:32352
    v_mfma_f32_16x16x32_bf16 v[220:223], a[184:187], a[28:31], v[220:223]
    s_waitcnt lgkmcnt(6)
    v_mfma_f32_16x16x32_bf16 v[0:3], a[160:163], a[32:35], v[0:3]
    s_add_u32 m0, s3, 90112
    ds_read_b64_tr_b16 a[176:177], v227 offset:28800
    v_mfma_f32_16x16x32_bf16 v[56:59], a[160:163], a[36:39], v[56:59]
    buffer_load_dwordx4 v234, s[32:35], s52 offen offset:0 lds
    v_mfma_f32_16x16x32_bf16 v[112:115], a[160:163], a[40:43], v[112:115]
    ds_read_b64_tr_b16 a[178:179], v227 offset:32384
    v_mfma_f32_16x16x32_bf16 v[168:171], a[160:163], a[44:47], v[168:171]
    s_waitcnt lgkmcnt(6)
    v_mfma_f32_16x16x32_bf16 v[4:7], a[164:167], a[32:35], v[4:7]
    ds_read_b64_tr_b16 a[180:181], v227 offset:28832
    v_mfma_f32_16x16x32_bf16 v[60:63], a[164:167], a[36:39], v[60:63]
    v_mfma_f32_16x16x32_bf16 v[116:119], a[164:167], a[40:43], v[116:119]
    ds_read_b64_tr_b16 a[182:183], v227 offset:32416
    v_mfma_f32_16x16x32_bf16 v[172:175], a[164:167], a[44:47], v[172:175]
    s_waitcnt lgkmcnt(6)
    v_mfma_f32_16x16x32_bf16 v[8:11], a[168:171], a[32:35], v[8:11]
    s_add_u32 s61, s62, 6684672
    ds_read_b64_tr_b16 a[184:185], v227 offset:28864
    v_mfma_f32_16x16x32_bf16 v[64:67], a[168:171], a[36:39], v[64:67]
    buffer_load_dword v238, v237, s[64:67], s61 offen
    v_mfma_f32_16x16x32_bf16 v[120:123], a[168:171], a[40:43], v[120:123]
    ds_read_b64_tr_b16 a[186:187], v227 offset:32448
    v_mfma_f32_16x16x32_bf16 v[176:179], a[168:171], a[44:47], v[176:179]
    s_waitcnt lgkmcnt(6)
    v_mfma_f32_16x16x32_bf16 v[12:15], a[172:175], a[32:35], v[12:15]
    ds_read_b64_tr_b16 a[160:161], v227 offset:43008
    v_mfma_f32_16x16x32_bf16 v[68:71], a[172:175], a[36:39], v[68:71]
    buffer_load_dwordx4 a[116:119], v226, s[36:39], s53 offen offset:3072 sc1
    v_mfma_f32_16x16x32_bf16 v[124:127], a[172:175], a[40:43], v[124:127]
    ds_read_b64_tr_b16 a[162:163], v227 offset:46592
    v_mfma_f32_16x16x32_bf16 v[180:183], a[172:175], a[44:47], v[180:183]
    s_waitcnt lgkmcnt(6)
    v_mfma_f32_16x16x32_bf16 v[16:19], a[176:179], a[32:35], v[16:19]
    ds_read_b64_tr_b16 a[164:165], v227 offset:43040
    v_mfma_f32_16x16x32_bf16 v[72:75], a[176:179], a[36:39], v[72:75]
    buffer_load_dwordx4 v235, s[32:35], s52 offen offset:1024 lds
    v_mfma_f32_16x16x32_bf16 v[128:131], a[176:179], a[40:43], v[128:131]
    ds_read_b64_tr_b16 a[166:167], v227 offset:46624
    v_mfma_f32_16x16x32_bf16 v[184:187], a[176:179], a[44:47], v[184:187]
    s_waitcnt lgkmcnt(6)
    v_mfma_f32_16x16x32_bf16 v[20:23], a[180:183], a[32:35], v[20:23]
    ds_read_b64_tr_b16 a[168:169], v227 offset:43072
    v_mfma_f32_16x16x32_bf16 v[76:79], a[180:183], a[36:39], v[76:79]
    v_mfma_f32_16x16x32_bf16 v[132:135], a[180:183], a[40:43], v[132:135]
    ds_read_b64_tr_b16 a[170:171], v227 offset:46656
    v_mfma_f32_16x16x32_bf16 v[188:191], a[180:183], a[44:47], v[188:191]
    s_waitcnt lgkmcnt(6)
    v_mfma_f32_16x16x32_bf16 v[24:27], a[184:187], a[32:35], v[24:27]
    ds_read_b64_tr_b16 a[172:173], v227 offset:43104
    v_mfma_f32_16x16x32_bf16 v[80:83], a[184:187], a[36:39], v[80:83]
    buffer_load_dwordx4 a[120:123], v226, s[40:43], s53 offen offset:2048 sc1
    v_mfma_f32_16x16x32_bf16 v[136:139], a[184:187], a[40:43], v[136:139]
    ds_read_b64_tr_b16 a[174:175], v227 offset:46688
    v_mfma_f32_16x16x32_bf16 v[192:195], a[184:187], a[44:47], v[192:195]
    s_waitcnt lgkmcnt(6)
    v_mfma_f32_16x16x32_bf16 v[28:31], a[160:163], a[32:35], v[28:31]
    ds_read_b64_tr_b16 a[176:177], v227 offset:43136
    v_mfma_f32_16x16x32_bf16 v[84:87], a[160:163], a[36:39], v[84:87]
    buffer_load_dwordx4 v236, s[32:35], s52 offen offset:2048 lds
    v_mfma_f32_16x16x32_bf16 v[140:143], a[160:163], a[40:43], v[140:143]
    ds_read_b64_tr_b16 a[178:179], v227 offset:46720
    v_mfma_f32_16x16x32_bf16 v[196:199], a[160:163], a[44:47], v[196:199]
    s_waitcnt lgkmcnt(6)
    v_mfma_f32_16x16x32_bf16 v[32:35], a[164:167], a[32:35], v[32:35]
    ds_read_b64_tr_b16 a[180:181], v227 offset:43168
    v_mfma_f32_16x16x32_bf16 v[88:91], a[164:167], a[36:39], v[88:91]
    v_mfma_f32_16x16x32_bf16 v[144:147], a[164:167], a[40:43], v[144:147]
    ds_read_b64_tr_b16 a[182:183], v227 offset:46752
    v_mfma_f32_16x16x32_bf16 v[200:203], a[164:167], a[44:47], v[200:203]
    s_waitcnt lgkmcnt(6)
    v_mfma_f32_16x16x32_bf16 v[36:39], a[168:171], a[32:35], v[36:39]
    ds_read_b64_tr_b16 a[184:185], v227 offset:43200
    v_mfma_f32_16x16x32_bf16 v[92:95], a[168:171], a[36:39], v[92:95]
    buffer_load_dwordx4 a[124:127], v226, s[40:43], s53 offen offset:3072 sc1
    v_mfma_f32_16x16x32_bf16 v[148:151], a[168:171], a[40:43], v[148:151]
    ds_read_b64_tr_b16 a[186:187], v227 offset:46784
    v_mfma_f32_16x16x32_bf16 v[204:207], a[168:171], a[44:47], v[204:207]
    s_waitcnt lgkmcnt(6)
    v_mfma_f32_16x16x32_bf16 v[40:43], a[172:175], a[32:35], v[40:43]
    ds_read_b64_tr_b16 a[160:161], v227 offset:35840
    v_mfma_f32_16x16x32_bf16 v[96:99], a[172:175], a[36:39], v[96:99]
    v_mfma_f32_16x16x32_bf16 v[152:155], a[172:175], a[40:43], v[152:155]
    s_mov_b32 s52, 4128768
    ds_read_b64_tr_b16 a[162:163], v227 offset:39424
    v_mfma_f32_16x16x32_bf16 v[208:211], a[172:175], a[44:47], v[208:211]
    s_waitcnt lgkmcnt(6)
    v_mfma_f32_16x16x32_bf16 v[44:47], a[176:179], a[32:35], v[44:47]
    s_add_u32 m0, s3, 114688
    ds_read_b64_tr_b16 a[164:165], v227 offset:35872
    v_mfma_f32_16x16x32_bf16 v[100:103], a[176:179], a[36:39], v[100:103]
    buffer_load_dwordx4 v230, s[32:35], s52 offen offset:0 lds
    v_mfma_f32_16x16x32_bf16 v[156:159], a[176:179], a[40:43], v[156:159]
    ds_read_b64_tr_b16 a[166:167], v227 offset:39456
    v_mfma_f32_16x16x32_bf16 v[212:215], a[176:179], a[44:47], v[212:215]
    s_waitcnt lgkmcnt(6)
    v_mfma_f32_16x16x32_bf16 v[48:51], a[180:183], a[32:35], v[48:51]
    ds_read_b64_tr_b16 a[168:169], v227 offset:35904
    v_mfma_f32_16x16x32_bf16 v[104:107], a[180:183], a[36:39], v[104:107]
    v_mfma_f32_16x16x32_bf16 v[160:163], a[180:183], a[40:43], v[160:163]
    ds_read_b64_tr_b16 a[170:171], v227 offset:39488
    v_mfma_f32_16x16x32_bf16 v[216:219], a[180:183], a[44:47], v[216:219]
    s_waitcnt lgkmcnt(6)
    v_mfma_f32_16x16x32_bf16 v[52:55], a[184:187], a[32:35], v[52:55]
    s_mov_b32 s53, 36864
    ds_read_b64_tr_b16 a[172:173], v227 offset:35936
    v_mfma_f32_16x16x32_bf16 v[108:111], a[184:187], a[36:39], v[108:111]
    buffer_load_dwordx4 a[128:131], v226, s[36:39], s53 offen offset:0 sc1
    v_mfma_f32_16x16x32_bf16 v[164:167], a[184:187], a[40:43], v[164:167]
    ds_read_b64_tr_b16 a[174:175], v227 offset:39520
    v_mfma_f32_16x16x32_bf16 v[220:223], a[184:187], a[44:47], v[220:223]
    s_waitcnt vmcnt(35) lgkmcnt(6)
    v_mfma_f32_16x16x32_bf16 v[0:3], a[160:163], a[48:51], v[0:3]
    ds_read_b64_tr_b16 a[176:177], v227 offset:35968
    v_mfma_f32_16x16x32_bf16 v[56:59], a[160:163], a[52:55], v[56:59]
    v_mfma_f32_16x16x32_bf16 v[112:115], a[160:163], a[56:59], v[112:115]
    ds_read_b64_tr_b16 a[178:179], v227 offset:39552
    v_mfma_f32_16x16x32_bf16 v[168:171], a[160:163], a[60:63], v[168:171]
    s_waitcnt lgkmcnt(6)
    v_mfma_f32_16x16x32_bf16 v[4:7], a[164:167], a[48:51], v[4:7]
    ds_read_b64_tr_b16 a[180:181], v227 offset:36000
    v_mfma_f32_16x16x32_bf16 v[60:63], a[164:167], a[52:55], v[60:63]
    buffer_load_dwordx4 v231, s[32:35], s52 offen offset:1024 lds
    v_mfma_f32_16x16x32_bf16 v[116:119], a[164:167], a[56:59], v[116:119]
    ds_read_b64_tr_b16 a[182:183], v227 offset:39584
    v_mfma_f32_16x16x32_bf16 v[172:175], a[164:167], a[60:63], v[172:175]
    s_waitcnt lgkmcnt(6)
    v_mfma_f32_16x16x32_bf16 v[8:11], a[168:171], a[48:51], v[8:11]
    ds_read_b64_tr_b16 a[184:185], v227 offset:36032
    v_mfma_f32_16x16x32_bf16 v[64:67], a[168:171], a[52:55], v[64:67]
    buffer_load_dwordx4 a[132:135], v226, s[36:39], s53 offen offset:1024 sc1
    v_mfma_f32_16x16x32_bf16 v[120:123], a[168:171], a[56:59], v[120:123]
    ds_read_b64_tr_b16 a[186:187], v227 offset:39616
    v_mfma_f32_16x16x32_bf16 v[176:179], a[168:171], a[60:63], v[176:179]
    s_waitcnt lgkmcnt(6)
    v_mfma_f32_16x16x32_bf16 v[12:15], a[172:175], a[48:51], v[12:15]
    ds_read_b64_tr_b16 a[160:161], v227 offset:50176
    v_mfma_f32_16x16x32_bf16 v[68:71], a[172:175], a[52:55], v[68:71]
    v_mfma_f32_16x16x32_bf16 v[124:127], a[172:175], a[56:59], v[124:127]
    ds_read_b64_tr_b16 a[162:163], v227 offset:53760
    v_mfma_f32_16x16x32_bf16 v[180:183], a[172:175], a[60:63], v[180:183]
    s_waitcnt lgkmcnt(6)
    v_mfma_f32_16x16x32_bf16 v[16:19], a[176:179], a[48:51], v[16:19]
    ds_read_b64_tr_b16 a[164:165], v227 offset:50208
    v_mfma_f32_16x16x32_bf16 v[72:75], a[176:179], a[52:55], v[72:75]
    v_mfma_f32_16x16x32_bf16 v[128:131], a[176:179], a[56:59], v[128:131]
    ds_read_b64_tr_b16 a[166:167], v227 offset:53792
    v_mfma_f32_16x16x32_bf16 v[184:187], a[176:179], a[60:63], v[184:187]
    s_waitcnt lgkmcnt(6)
    v_mfma_f32_16x16x32_bf16 v[20:23], a[180:183], a[48:51], v[20:23]
    s_add_u32 s61, s62, 7077888
    ds_read_b64_tr_b16 a[168:169], v227 offset:50240
    v_mfma_f32_16x16x32_bf16 v[76:79], a[180:183], a[52:55], v[76:79]
    buffer_load_dword v238, v237, s[64:67], s61 offen
    v_mfma_f32_16x16x32_bf16 v[132:135], a[180:183], a[56:59], v[132:135]
    ds_read_b64_tr_b16 a[170:171], v227 offset:53824
    v_mfma_f32_16x16x32_bf16 v[188:191], a[180:183], a[60:63], v[188:191]
    s_waitcnt lgkmcnt(6)
    v_mfma_f32_16x16x32_bf16 v[24:27], a[184:187], a[48:51], v[24:27]
    ds_read_b64_tr_b16 a[172:173], v227 offset:50272
    v_mfma_f32_16x16x32_bf16 v[80:83], a[184:187], a[52:55], v[80:83]
    buffer_load_dwordx4 v232, s[32:35], s52 offen offset:2048 lds
    v_mfma_f32_16x16x32_bf16 v[136:139], a[184:187], a[56:59], v[136:139]
    ds_read_b64_tr_b16 a[174:175], v227 offset:53856
    v_mfma_f32_16x16x32_bf16 v[192:195], a[184:187], a[60:63], v[192:195]
    s_waitcnt lgkmcnt(6)
    v_mfma_f32_16x16x32_bf16 v[28:31], a[160:163], a[48:51], v[28:31]
    ds_read_b64_tr_b16 a[176:177], v227 offset:50304
    v_mfma_f32_16x16x32_bf16 v[84:87], a[160:163], a[52:55], v[84:87]
    buffer_load_dwordx4 a[136:139], v226, s[40:43], s53 offen offset:0 sc1
    v_mfma_f32_16x16x32_bf16 v[140:143], a[160:163], a[56:59], v[140:143]
    ds_read_b64_tr_b16 a[178:179], v227 offset:53888
    v_mfma_f32_16x16x32_bf16 v[196:199], a[160:163], a[60:63], v[196:199]
    s_waitcnt lgkmcnt(6)
    v_mfma_f32_16x16x32_bf16 v[32:35], a[164:167], a[48:51], v[32:35]
    s_and_b32 s25, s2, 1
    ds_read_b64_tr_b16 a[180:181], v227 offset:50336
    v_mfma_f32_16x16x32_bf16 v[88:91], a[164:167], a[52:55], v[88:91]
    s_lshl_b32 s25, s25, 3
    s_bfe_u32 s68, s2, 0x30003
    s_add_u32 s25, s25, s68
    v_mfma_f32_16x16x32_bf16 v[144:147], a[164:167], a[56:59], v[144:147]
    s_and_b32 s26, s2, 2
    ds_read_b64_tr_b16 a[182:183], v227 offset:53920
    v_mfma_f32_16x16x32_bf16 v[200:203], a[164:167], a[60:63], v[200:203]
    s_waitcnt lgkmcnt(6)
    s_lshl_b32 s26, s26, 1
    s_lshr_b32 s68, s2, 6
    v_mfma_f32_16x16x32_bf16 v[36:39], a[168:171], a[48:51], v[36:39]
    s_add_u32 s26, s26, s68
    ds_read_b64_tr_b16 a[184:185], v227 offset:50368
    v_mfma_f32_16x16x32_bf16 v[92:95], a[168:171], a[52:55], v[92:95]
    buffer_load_dwordx4 v233, s[32:35], s52 offen offset:3072 lds
    v_mfma_f32_16x16x32_bf16 v[148:151], a[168:171], a[56:59], v[148:151]
    s_lshl_b32 s26, s26, 1
    ds_read_b64_tr_b16 a[186:187], v227 offset:53952
    v_mfma_f32_16x16x32_bf16 v[204:207], a[168:171], a[60:63], v[204:207]
    s_waitcnt vmcnt(26) lgkmcnt(6)
    s_barrier
    v_mfma_f32_16x16x32_bf16 v[40:43], a[172:175], a[48:51], v[40:43]
    s_bfe_u32 s68, s2, 0x10002
    ds_read_b64_tr_b16 a[160:161], v228 offset:0
    v_mfma_f32_16x16x32_bf16 v[96:99], a[172:175], a[52:55], v[96:99]
    buffer_load_dwordx4 a[140:143], v226, s[40:43], s53 offen offset:1024 sc1
    v_mfma_f32_16x16x32_bf16 v[152:155], a[172:175], a[56:59], v[152:155]
    s_add_u32 s26, s26, s68
    ds_read_b64_tr_b16 a[162:163], v228 offset:3584
    v_mfma_f32_16x16x32_bf16 v[208:211], a[172:175], a[60:63], v[208:211]
    s_waitcnt lgkmcnt(6)
    s_lshl_b32 s30, s25, 2
    s_add_u32 s30, s30, s24
    v_mfma_f32_16x16x32_bf16 v[44:47], a[176:179], a[48:51], v[44:47]
    s_lshl_b32 s29, s2, 2
    ds_read_b64_tr_b16 a[164:165], v228 offset:32
    v_mfma_f32_16x16x32_bf16 v[100:103], a[176:179], a[52:55], v[100:103]
    s_add_u32 s29, s29, s24
    s_lshl_b32 s29, s29, 12
    s_mov_b32 s64, s22
    v_mfma_f32_16x16x32_bf16 v[156:159], a[176:179], a[56:59], v[156:159]
    s_mov_b32 s65, s23
    ds_read_b64_tr_b16 a[166:167], v228 offset:3616
    v_mfma_f32_16x16x32_bf16 v[212:215], a[176:179], a[60:63], v[212:215]
    s_waitcnt lgkmcnt(6)
    s_mov_b32 s66, 37748864
    s_mov_b32 s101, s29
    v_mfma_f32_16x16x32_bf16 v[48:51], a[180:183], a[48:51], v[48:51]
    s_add_u32 m0, s3, 118784
    ds_read_b64_tr_b16 a[168:169], v228 offset:64
    v_mfma_f32_16x16x32_bf16 v[104:107], a[180:183], a[52:55], v[104:107]
    buffer_load_dwordx4 v234, s[32:35], s52 offen offset:0 lds
    v_mfma_f32_16x16x32_bf16 v[160:163], a[180:183], a[56:59], v[160:163]
    ds_read_b64_tr_b16 a[170:171], v228 offset:3648
    v_mfma_f32_16x16x32_bf16 v[216:219], a[180:183], a[60:63], v[216:219]
    s_waitcnt lgkmcnt(6)
    v_mfma_f32_16x16x32_bf16 v[52:55], a[184:187], a[48:51], v[52:55]
    ds_read_b64_tr_b16 a[172:173], v228 offset:96
    v_mfma_f32_16x16x32_bf16 v[108:111], a[184:187], a[52:55], v[108:111]
    buffer_load_dwordx4 a[144:147], v226, s[36:39], s53 offen offset:2048 sc1
    v_mfma_f32_16x16x32_bf16 v[164:167], a[184:187], a[56:59], v[164:167]
    ds_read_b64_tr_b16 a[174:175], v228 offset:3680
    v_mfma_f32_16x16x32_bf16 v[220:223], a[184:187], a[60:63], v[220:223]
    s_waitcnt lgkmcnt(6)
    v_mfma_f32_16x16x32_bf16 v[0:3], a[160:163], a[64:67], v[0:3]
    ds_read_b64_tr_b16 a[176:177], v228 offset:128
    v_mfma_f32_16x16x32_bf16 v[56:59], a[160:163], a[68:71], v[56:59]
    v_mfma_f32_16x16x32_bf16 v[112:115], a[160:163], a[72:75], v[112:115]
    ds_read_b64_tr_b16 a[178:179], v228 offset:3712
    v_mfma_f32_16x16x32_bf16 v[168:171], a[160:163], a[76:79], v[168:171]
    s_waitcnt lgkmcnt(6)
    v_mfma_f32_16x16x32_bf16 v[4:7], a[164:167], a[64:67], v[4:7]
    ds_read_b64_tr_b16 a[180:181], v228 offset:160
    v_mfma_f32_16x16x32_bf16 v[60:63], a[164:167], a[68:71], v[60:63]
    v_mfma_f32_16x16x32_bf16 v[116:119], a[164:167], a[72:75], v[116:119]
    ds_read_b64_tr_b16 a[182:183], v228 offset:3744
    v_mfma_f32_16x16x32_bf16 v[172:175], a[164:167], a[76:79], v[172:175]
    s_waitcnt lgkmcnt(6)
    v_mfma_f32_16x16x32_bf16 v[8:11], a[168:171], a[64:67], v[8:11]
    ds_read_b64_tr_b16 a[184:185], v228 offset:192
    v_mfma_f32_16x16x32_bf16 v[64:67], a[168:171], a[68:71], v[64:67]
    buffer_load_dwordx4 a[148:151], v226, s[36:39], s53 offen offset:3072 sc1
    v_mfma_f32_16x16x32_bf16 v[120:123], a[168:171], a[72:75], v[120:123]
    ds_read_b64_tr_b16 a[186:187], v228 offset:3776
    v_mfma_f32_16x16x32_bf16 v[176:179], a[168:171], a[76:79], v[176:179]
    s_waitcnt lgkmcnt(6)
    v_mfma_f32_16x16x32_bf16 v[12:15], a[172:175], a[64:67], v[12:15]
    ds_read_b64_tr_b16 a[160:161], v228 offset:14336
    v_mfma_f32_16x16x32_bf16 v[68:71], a[172:175], a[68:71], v[68:71]
    buffer_load_dwordx4 v235, s[32:35], s52 offen offset:1024 lds
    v_mfma_f32_16x16x32_bf16 v[124:127], a[172:175], a[72:75], v[124:127]
    ds_read_b64_tr_b16 a[162:163], v228 offset:17920
    v_mfma_f32_16x16x32_bf16 v[180:183], a[172:175], a[76:79], v[180:183]
    s_waitcnt lgkmcnt(6)
    v_mfma_f32_16x16x32_bf16 v[16:19], a[176:179], a[64:67], v[16:19]
    ds_read_b64_tr_b16 a[164:165], v228 offset:14368
    v_mfma_f32_16x16x32_bf16 v[72:75], a[176:179], a[68:71], v[72:75]
    v_mfma_f32_16x16x32_bf16 v[128:131], a[176:179], a[72:75], v[128:131]
    ds_read_b64_tr_b16 a[166:167], v228 offset:17952
    v_mfma_f32_16x16x32_bf16 v[184:187], a[176:179], a[76:79], v[184:187]
    s_waitcnt lgkmcnt(6)
    v_mfma_f32_16x16x32_bf16 v[20:23], a[180:183], a[64:67], v[20:23]
    ds_read_b64_tr_b16 a[168:169], v228 offset:14400
    v_mfma_f32_16x16x32_bf16 v[76:79], a[180:183], a[68:71], v[76:79]
    buffer_load_dwordx4 a[152:155], v226, s[40:43], s53 offen offset:2048 sc1
    v_mfma_f32_16x16x32_bf16 v[132:135], a[180:183], a[72:75], v[132:135]
    ds_read_b64_tr_b16 a[170:171], v228 offset:17984
    v_mfma_f32_16x16x32_bf16 v[188:191], a[180:183], a[76:79], v[188:191]
    s_waitcnt lgkmcnt(6)
    v_mfma_f32_16x16x32_bf16 v[24:27], a[184:187], a[64:67], v[24:27]
    ds_read_b64_tr_b16 a[172:173], v228 offset:14432
    v_mfma_f32_16x16x32_bf16 v[80:83], a[184:187], a[68:71], v[80:83]
    buffer_load_dwordx4 v236, s[32:35], s52 offen offset:2048 lds
    v_mfma_f32_16x16x32_bf16 v[136:139], a[184:187], a[72:75], v[136:139]
    ds_read_b64_tr_b16 a[174:175], v228 offset:18016
    v_mfma_f32_16x16x32_bf16 v[192:195], a[184:187], a[76:79], v[192:195]
    s_waitcnt lgkmcnt(6)
    v_mfma_f32_16x16x32_bf16 v[28:31], a[160:163], a[64:67], v[28:31]
    s_add_u32 s61, s63, 0
    ds_read_b64_tr_b16 a[176:177], v228 offset:14464
    v_mfma_f32_16x16x32_bf16 v[84:87], a[160:163], a[68:71], v[84:87]
    buffer_load_dword v238, v237, s[96:99], s61 offen
    v_mfma_f32_16x16x32_bf16 v[140:143], a[160:163], a[72:75], v[140:143]
    ds_read_b64_tr_b16 a[178:179], v228 offset:18048
    v_mfma_f32_16x16x32_bf16 v[196:199], a[160:163], a[76:79], v[196:199]
    s_waitcnt lgkmcnt(6)
    v_mfma_f32_16x16x32_bf16 v[32:35], a[164:167], a[64:67], v[32:35]
    ds_read_b64_tr_b16 a[180:181], v228 offset:14496
    v_mfma_f32_16x16x32_bf16 v[88:91], a[164:167], a[68:71], v[88:91]
    v_mfma_f32_16x16x32_bf16 v[144:147], a[164:167], a[72:75], v[144:147]
    ds_read_b64_tr_b16 a[182:183], v228 offset:18080
    v_mfma_f32_16x16x32_bf16 v[200:203], a[164:167], a[76:79], v[200:203]
    s_waitcnt lgkmcnt(6)
    v_mfma_f32_16x16x32_bf16 v[36:39], a[168:171], a[64:67], v[36:39]
    ds_read_b64_tr_b16 a[184:185], v228 offset:14528
    v_mfma_f32_16x16x32_bf16 v[92:95], a[168:171], a[68:71], v[92:95]
    buffer_load_dwordx4 a[156:159], v226, s[40:43], s53 offen offset:3072 sc1
    v_mfma_f32_16x16x32_bf16 v[148:151], a[168:171], a[72:75], v[148:151]
    s_mov_b32 s52, 4587520
    ds_read_b64_tr_b16 a[186:187], v228 offset:18112
    v_mfma_f32_16x16x32_bf16 v[204:207], a[168:171], a[76:79], v[204:207]
    s_waitcnt lgkmcnt(6)
    v_mfma_f32_16x16x32_bf16 v[40:43], a[172:175], a[64:67], v[40:43]
    s_add_u32 m0, s3, 0
    ds_read_b64_tr_b16 a[160:161], v228 offset:7168
    v_mfma_f32_16x16x32_bf16 v[96:99], a[172:175], a[68:71], v[96:99]
    buffer_load_dwordx4 v230, s[32:35], s52 offen offset:0 lds
    v_mfma_f32_16x16x32_bf16 v[152:155], a[172:175], a[72:75], v[152:155]
    ds_read_b64_tr_b16 a[162:163], v228 offset:10752
    v_mfma_f32_16x16x32_bf16 v[208:211], a[172:175], a[76:79], v[208:211]
    s_waitcnt lgkmcnt(6)
    v_mfma_f32_16x16x32_bf16 v[44:47], a[176:179], a[64:67], v[44:47]
    ds_read_b64_tr_b16 a[164:165], v228 offset:7200
    v_mfma_f32_16x16x32_bf16 v[100:103], a[176:179], a[68:71], v[100:103]
    v_mfma_f32_16x16x32_bf16 v[156:159], a[176:179], a[72:75], v[156:159]
    ds_read_b64_tr_b16 a[166:167], v228 offset:10784
    v_mfma_f32_16x16x32_bf16 v[212:215], a[176:179], a[76:79], v[212:215]
    s_waitcnt lgkmcnt(6)
    v_mfma_f32_16x16x32_bf16 v[48:51], a[180:183], a[64:67], v[48:51]
    s_mov_b32 s53, 40960
    ds_read_b64_tr_b16 a[168:169], v228 offset:7232
    v_mfma_f32_16x16x32_bf16 v[104:107], a[180:183], a[68:71], v[104:107]
    buffer_load_dwordx4 a[0:3], v226, s[36:39], s53 offen offset:0 sc1
    v_mfma_f32_16x16x32_bf16 v[160:163], a[180:183], a[72:75], v[160:163]
    ds_read_b64_tr_b16 a[170:171], v228 offset:10816
    v_mfma_f32_16x16x32_bf16 v[216:219], a[180:183], a[76:79], v[216:219]
    s_waitcnt lgkmcnt(6)
    v_mfma_f32_16x16x32_bf16 v[52:55], a[184:187], a[64:67], v[52:55]
    ds_read_b64_tr_b16 a[172:173], v228 offset:7264
    v_mfma_f32_16x16x32_bf16 v[108:111], a[184:187], a[68:71], v[108:111]
    v_mfma_f32_16x16x32_bf16 v[164:167], a[184:187], a[72:75], v[164:167]
    ds_read_b64_tr_b16 a[174:175], v228 offset:10848
    v_mfma_f32_16x16x32_bf16 v[220:223], a[184:187], a[76:79], v[220:223]
    s_waitcnt vmcnt(36) lgkmcnt(6)
    v_mfma_f32_16x16x32_bf16 v[0:3], a[160:163], a[80:83], v[0:3]
    ds_read_b64_tr_b16 a[176:177], v228 offset:7296
    v_mfma_f32_16x16x32_bf16 v[56:59], a[160:163], a[84:87], v[56:59]
    buffer_load_dwordx4 v231, s[32:35], s52 offen offset:1024 lds
    v_mfma_f32_16x16x32_bf16 v[112:115], a[160:163], a[88:91], v[112:115]
    ds_read_b64_tr_b16 a[178:179], v228 offset:10880
    v_mfma_f32_16x16x32_bf16 v[168:171], a[160:163], a[92:95], v[168:171]
    s_waitcnt lgkmcnt(6)
    v_mfma_f32_16x16x32_bf16 v[4:7], a[164:167], a[80:83], v[4:7]
    ds_read_b64_tr_b16 a[180:181], v228 offset:7328
    v_mfma_f32_16x16x32_bf16 v[60:63], a[164:167], a[84:87], v[60:63]
    v_mfma_f32_16x16x32_bf16 v[116:119], a[164:167], a[88:91], v[116:119]
    ds_read_b64_tr_b16 a[182:183], v228 offset:10912
    v_mfma_f32_16x16x32_bf16 v[172:175], a[164:167], a[92:95], v[172:175]
    s_waitcnt lgkmcnt(6)
    v_mfma_f32_16x16x32_bf16 v[8:11], a[168:171], a[80:83], v[8:11]
    ds_read_b64_tr_b16 a[184:185], v228 offset:7360
    v_mfma_f32_16x16x32_bf16 v[64:67], a[168:171], a[84:87], v[64:67]
    buffer_load_dwordx4 a[4:7], v226, s[36:39], s53 offen offset:1024 sc1
    v_mfma_f32_16x16x32_bf16 v[120:123], a[168:171], a[88:91], v[120:123]
    ds_read_b64_tr_b16 a[186:187], v228 offset:10944
    v_mfma_f32_16x16x32_bf16 v[176:179], a[168:171], a[92:95], v[176:179]
    s_waitcnt lgkmcnt(6)
    v_mfma_f32_16x16x32_bf16 v[12:15], a[172:175], a[80:83], v[12:15]
    ds_read_b64_tr_b16 a[160:161], v228 offset:21504
    v_mfma_f32_16x16x32_bf16 v[68:71], a[172:175], a[84:87], v[68:71]
    v_mfma_f32_16x16x32_bf16 v[124:127], a[172:175], a[88:91], v[124:127]
    ds_read_b64_tr_b16 a[162:163], v228 offset:25088
    v_mfma_f32_16x16x32_bf16 v[180:183], a[172:175], a[92:95], v[180:183]
    s_waitcnt lgkmcnt(6)
    v_mfma_f32_16x16x32_bf16 v[16:19], a[176:179], a[80:83], v[16:19]
    ds_read_b64_tr_b16 a[164:165], v228 offset:21536
    v_mfma_f32_16x16x32_bf16 v[72:75], a[176:179], a[84:87], v[72:75]
    buffer_load_dwordx4 v232, s[32:35], s52 offen offset:2048 lds
    v_mfma_f32_16x16x32_bf16 v[128:131], a[176:179], a[88:91], v[128:131]
    ds_read_b64_tr_b16 a[166:167], v228 offset:25120
    v_mfma_f32_16x16x32_bf16 v[184:187], a[176:179], a[92:95], v[184:187]
    s_waitcnt lgkmcnt(6)
    v_mfma_f32_16x16x32_bf16 v[20:23], a[180:183], a[80:83], v[20:23]
    ds_read_b64_tr_b16 a[168:169], v228 offset:21568
    v_mfma_f32_16x16x32_bf16 v[76:79], a[180:183], a[84:87], v[76:79]
    buffer_load_dwordx4 a[8:11], v226, s[40:43], s53 offen offset:0 sc1
    v_mfma_f32_16x16x32_bf16 v[132:135], a[180:183], a[88:91], v[132:135]
    ds_read_b64_tr_b16 a[170:171], v228 offset:25152
    v_mfma_f32_16x16x32_bf16 v[188:191], a[180:183], a[92:95], v[188:191]
    s_waitcnt lgkmcnt(6)
    v_mfma_f32_16x16x32_bf16 v[24:27], a[184:187], a[80:83], v[24:27]
    ds_read_b64_tr_b16 a[172:173], v228 offset:21600
    v_mfma_f32_16x16x32_bf16 v[80:83], a[184:187], a[84:87], v[80:83]
    v_mfma_f32_16x16x32_bf16 v[136:139], a[184:187], a[88:91], v[136:139]
    ds_read_b64_tr_b16 a[174:175], v228 offset:25184
    v_mfma_f32_16x16x32_bf16 v[192:195], a[184:187], a[92:95], v[192:195]
    s_waitcnt lgkmcnt(6)
    v_mfma_f32_16x16x32_bf16 v[28:31], a[160:163], a[80:83], v[28:31]
    ds_read_b64_tr_b16 a[176:177], v228 offset:21632
    v_mfma_f32_16x16x32_bf16 v[84:87], a[160:163], a[84:87], v[84:87]
    v_mfma_f32_16x16x32_bf16 v[140:143], a[160:163], a[88:91], v[140:143]
    ds_read_b64_tr_b16 a[178:179], v228 offset:25216
    v_mfma_f32_16x16x32_bf16 v[196:199], a[160:163], a[92:95], v[196:199]
    s_waitcnt lgkmcnt(6)
    v_mfma_f32_16x16x32_bf16 v[32:35], a[164:167], a[80:83], v[32:35]
    ds_read_b64_tr_b16 a[180:181], v228 offset:21664
    v_mfma_f32_16x16x32_bf16 v[88:91], a[164:167], a[84:87], v[88:91]
    buffer_load_dwordx4 v233, s[32:35], s52 offen offset:3072 lds
    v_mfma_f32_16x16x32_bf16 v[144:147], a[164:167], a[88:91], v[144:147]
    ds_read_b64_tr_b16 a[182:183], v228 offset:25248
    v_mfma_f32_16x16x32_bf16 v[200:203], a[164:167], a[92:95], v[200:203]
    s_waitcnt lgkmcnt(6)
    v_mfma_f32_16x16x32_bf16 v[36:39], a[168:171], a[80:83], v[36:39]
    s_add_u32 s61, s63, 786432
    ds_read_b64_tr_b16 a[184:185], v228 offset:21696
    v_mfma_f32_16x16x32_bf16 v[92:95], a[168:171], a[84:87], v[92:95]
    buffer_load_dword v238, v237, s[96:99], s61 offen
    v_mfma_f32_16x16x32_bf16 v[148:151], a[168:171], a[88:91], v[148:151]
Lpad_11:
    s_cbranch_execz Lback_a
    ds_read_b64_tr_b16 a[186:187], v228 offset:25280
    v_mfma_f32_16x16x32_bf16 v[204:207], a[168:171], a[92:95], v[204:207]
    s_waitcnt vmcnt(26) lgkmcnt(6)
    s_barrier
    v_mfma_f32_16x16x32_bf16 v[40:43], a[172:175], a[80:83], v[40:43]
    ds_read_b64_tr_b16 a[160:161], v228 offset:28672
    v_mfma_f32_16x16x32_bf16 v[96:99], a[172:175], a[84:87], v[96:99]
    buffer_load_dwordx4 a[12:15], v226, s[40:43], s53 offen offset:1024 sc1
    v_mfma_f32_16x16x32_bf16 v[152:155], a[172:175], a[88:91], v[152:155]
    ds_read_b64_tr_b16 a[162:163], v228 offset:32256
    v_mfma_f32_16x16x32_bf16 v[208:211], a[172:175], a[92:95], v[208:211]
    s_waitcnt lgkmcnt(6)
    v_mfma_f32_16x16x32_bf16 v[44:47], a[176:179], a[80:83], v[44:47]
    ds_read_b64_tr_b16 a[164:165], v228 offset:28704
    v_mfma_f32_16x16x32_bf16 v[100:103], a[176:179], a[84:87], v[100:103]
    v_mfma_f32_16x16x32_bf16 v[156:159], a[176:179], a[88:91], v[156:159]
    ds_read_b64_tr_b16 a[166:167], v228 offset:32288
    v_mfma_f32_16x16x32_bf16 v[212:215], a[176:179], a[92:95], v[212:215]
    s_waitcnt lgkmcnt(6)
    v_mfma_f32_16x16x32_bf16 v[48:51], a[180:183], a[80:83], v[48:51]
    s_add_u32 m0, s3, 4096
    ds_read_b64_tr_b16 a[168:169], v228 offset:28736
    v_mfma_f32_16x16x32_bf16 v[104:107], a[180:183], a[84:87], v[104:107]
    buffer_load_dwordx4 v234, s[32:35], s52 offen offset:0 lds
    v_mfma_f32_16x16x32_bf16 v[160:163], a[180:183], a[88:91], v[160:163]
    ds_read_b64_tr_b16 a[170:171], v228 offset:32320
    v_mfma_f32_16x16x32_bf16 v[216:219], a[180:183], a[92:95], v[216:219]
    s_waitcnt lgkmcnt(6)
    v_mfma_f32_16x16x32_bf16 v[52:55], a[184:187], a[80:83], v[52:55]
    ds_read_b64_tr_b16 a[172:173], v228 offset:28768
    v_mfma_f32_16x16x32_bf16 v[108:111], a[184:187], a[84:87], v[108:111]
    buffer_load_dwordx4 a[16:19], v226, s[36:39], s53 offen offset:2048 sc1
    v_mfma_f32_16x16x32_bf16 v[164:167], a[184:187], a[88:91], v[164:167]
    ds_read_b64_tr_b16 a[174:175], v228 offset:32352
    v_mfma_f32_16x16x32_bf16 v[220:223], a[184:187], a[92:95], v[220:223]
    s_waitcnt lgkmcnt(6)
    v_mfma_f32_16x16x32_bf16 v[0:3], a[160:163], a[96:99], v[0:3]
    ds_read_b64_tr_b16 a[176:177], v228 offset:28800
    v_mfma_f32_16x16x32_bf16 v[56:59], a[160:163], a[100:103], v[56:59]
    v_mfma_f32_16x16x32_bf16 v[112:115], a[160:163], a[104:107], v[112:115]
    ds_read_b64_tr_b16 a[178:179], v228 offset:32384
    v_mfma_f32_16x16x32_bf16 v[168:171], a[160:163], a[108:111], v[168:171]
    s_waitcnt lgkmcnt(6)
    v_mfma_f32_16x16x32_bf16 v[4:7], a[164:167], a[96:99], v[4:7]
    ds_read_b64_tr_b16 a[180:181], v228 offset:28832
    v_mfma_f32_16x16x32_bf16 v[60:63], a[164:167], a[100:103], v[60:63]
    v_mfma_f32_16x16x32_bf16 v[116:119], a[164:167], a[104:107], v[116:119]
    ds_read_b64_tr_b16 a[182:183], v228 offset:32416
    v_mfma_f32_16x16x32_bf16 v[172:175], a[164:167], a[108:111], v[172:175]
    s_waitcnt lgkmcnt(6)
    v_mfma_f32_16x16x32_bf16 v[8:11], a[168:171], a[96:99], v[8:11]
    ds_read_b64_tr_b16 a[184:185], v228 offset:28864
    v_mfma_f32_16x16x32_bf16 v[64:67], a[168:171], a[100:103], v[64:67]
    buffer_load_dwordx4 v235, s[32:35], s52 offen offset:1024 lds
    v_mfma_f32_16x16x32_bf16 v[120:123], a[168:171], a[104:107], v[120:123]
    ds_read_b64_tr_b16 a[186:187], v228 offset:32448
    v_mfma_f32_16x16x32_bf16 v[176:179], a[168:171], a[108:111], v[176:179]
    s_waitcnt lgkmcnt(6)
    v_mfma_f32_16x16x32_bf16 v[12:15], a[172:175], a[96:99], v[12:15]
    ds_read_b64_tr_b16 a[160:161], v228 offset:43008
    v_mfma_f32_16x16x32_bf16 v[68:71], a[172:175], a[100:103], v[68:71]
    buffer_load_dwordx4 a[20:23], v226, s[36:39], s53 offen offset:3072 sc1
    v_mfma_f32_16x16x32_bf16 v[124:127], a[172:175], a[104:107], v[124:127]
    ds_read_b64_tr_b16 a[162:163], v228 offset:46592
    v_mfma_f32_16x16x32_bf16 v[180:183], a[172:175], a[108:111], v[180:183]
    s_waitcnt lgkmcnt(6)
    v_mfma_f32_16x16x32_bf16 v[16:19], a[176:179], a[96:99], v[16:19]
    ds_read_b64_tr_b16 a[164:165], v228 offset:43040
    v_mfma_f32_16x16x32_bf16 v[72:75], a[176:179], a[100:103], v[72:75]
    v_mfma_f32_16x16x32_bf16 v[128:131], a[176:179], a[104:107], v[128:131]
    ds_read_b64_tr_b16 a[166:167], v228 offset:46624
    v_mfma_f32_16x16x32_bf16 v[184:187], a[176:179], a[108:111], v[184:187]
    s_waitcnt lgkmcnt(6)
    v_mfma_f32_16x16x32_bf16 v[20:23], a[180:183], a[96:99], v[20:23]
    ds_read_b64_tr_b16 a[168:169], v228 offset:43072
    v_mfma_f32_16x16x32_bf16 v[76:79], a[180:183], a[100:103], v[76:79]
    buffer_load_dwordx4 a[24:27], v226, s[40:43], s53 offen offset:2048 sc1
    v_mfma_f32_16x16x32_bf16 v[132:135], a[180:183], a[104:107], v[132:135]
    ds_read_b64_tr_b16 a[170:171], v228 offset:46656
    v_mfma_f32_16x16x32_bf16 v[188:191], a[180:183], a[108:111], v[188:191]
    s_waitcnt lgkmcnt(6)
    v_mfma_f32_16x16x32_bf16 v[24:27], a[184:187], a[96:99], v[24:27]
    ds_read_b64_tr_b16 a[172:173], v228 offset:43104
    v_mfma_f32_16x16x32_bf16 v[80:83], a[184:187], a[100:103], v[80:83]
    buffer_load_dwordx4 v236, s[32:35], s52 offen offset:2048 lds
    v_mfma_f32_16x16x32_bf16 v[136:139], a[184:187], a[104:107], v[136:139]
    ds_read_b64_tr_b16 a[174:175], v228 offset:46688
    v_mfma_f32_16x16x32_bf16 v[192:195], a[184:187], a[108:111], v[192:195]
    s_waitcnt lgkmcnt(6)
    v_mfma_f32_16x16x32_bf16 v[28:31], a[160:163], a[96:99], v[28:31]
    ds_read_b64_tr_b16 a[176:177], v228 offset:43136
    v_mfma_f32_16x16x32_bf16 v[84:87], a[160:163], a[100:103], v[84:87]
    v_mfma_f32_16x16x32_bf16 v[140:143], a[160:163], a[104:107], v[140:143]
    ds_read_b64_tr_b16 a[178:179], v228 offset:46720
    v_mfma_f32_16x16x32_bf16 v[196:199], a[160:163], a[108:111], v[196:199]
    s_waitcnt lgkmcnt(6)
    v_mfma_f32_16x16x32_bf16 v[32:35], a[164:167], a[96:99], v[32:35]
    ds_read_b64_tr_b16 a[180:181], v228 offset:43168
    v_mfma_f32_16x16x32_bf16 v[88:91], a[164:167], a[100:103], v[88:91]
    v_mfma_f32_16x16x32_bf16 v[144:147], a[164:167], a[104:107], v[144:147]
    ds_read_b64_tr_b16 a[182:183], v228 offset:46752
    v_mfma_f32_16x16x32_bf16 v[200:203], a[164:167], a[108:111], v[200:203]
    s_waitcnt lgkmcnt(6)
    v_mfma_f32_16x16x32_bf16 v[36:39], a[168:171], a[96:99], v[36:39]
    ds_read_b64_tr_b16 a[184:185], v228 offset:43200
    v_mfma_f32_16x16x32_bf16 v[92:95], a[168:171], a[100:103], v[92:95]
    buffer_load_dwordx4 a[28:31], v226, s[40:43], s53 offen offset:3072 sc1
    v_mfma_f32_16x16x32_bf16 v[148:151], a[168:171], a[104:107], v[148:151]
    s_mov_b32 s52, 5046272
    ds_read_b64_tr_b16 a[186:187], v228 offset:46784
    v_mfma_f32_16x16x32_bf16 v[204:207], a[168:171], a[108:111], v[204:207]
    s_waitcnt lgkmcnt(6)
    v_mfma_f32_16x16x32_bf16 v[40:43], a[172:175], a[96:99], v[40:43]
    s_add_u32 m0, s3, 28672
    ds_read_b64_tr_b16 a[160:161], v228 offset:35840
    v_mfma_f32_16x16x32_bf16 v[96:99], a[172:175], a[100:103], v[96:99]
    buffer_load_dwordx4 v230, s[32:35], s52 offen offset:0 lds
    v_mfma_f32_16x16x32_bf16 v[152:155], a[172:175], a[104:107], v[152:155]
    ds_read_b64_tr_b16 a[162:163], v228 offset:39424
    v_mfma_f32_16x16x32_bf16 v[208:211], a[172:175], a[108:111], v[208:211]
    s_waitcnt lgkmcnt(6)
    v_mfma_f32_16x16x32_bf16 v[44:47], a[176:179], a[96:99], v[44:47]
    s_add_u32 s61, s63, 1572864
    ds_read_b64_tr_b16 a[164:165], v228 offset:35872
    v_mfma_f32_16x16x32_bf16 v[100:103], a[176:179], a[100:103], v[100:103]
    buffer_load_dword v238, v237, s[96:99], s61 offen
    v_mfma_f32_16x16x32_bf16 v[156:159], a[176:179], a[104:107], v[156:159]
    ds_read_b64_tr_b16 a[166:167], v228 offset:39456
    v_mfma_f32_16x16x32_bf16 v[212:215], a[176:179], a[108:111], v[212:215]
    s_waitcnt lgkmcnt(6)
    v_mfma_f32_16x16x32_bf16 v[48:51], a[180:183], a[96:99], v[48:51]
    s_mov_b32 s53, 45056
    ds_read_b64_tr_b16 a[168:169], v228 offset:35904
    v_mfma_f32_16x16x32_bf16 v[104:107], a[180:183], a[100:103], v[104:107]
    buffer_load_dwordx4 a[32:35], v226, s[36:39], s53 offen offset:0 sc1
    v_mfma_f32_16x16x32_bf16 v[160:163], a[180:183], a[104:107], v[160:163]
    ds_read_b64_tr_b16 a[170:171], v228 offset:39488
    v_mfma_f32_16x16x32_bf16 v[216:219], a[180:183], a[108:111], v[216:219]
    s_waitcnt lgkmcnt(6)
    v_mfma_f32_16x16x32_bf16 v[52:55], a[184:187], a[96:99], v[52:55]
    ds_read_b64_tr_b16 a[172:173], v228 offset:35936
    v_mfma_f32_16x16x32_bf16 v[108:111], a[184:187], a[100:103], v[108:111]
    buffer_load_dwordx4 v231, s[32:35], s52 offen offset:1024 lds
    v_mfma_f32_16x16x32_bf16 v[164:167], a[184:187], a[104:107], v[164:167]
    ds_read_b64_tr_b16 a[174:175], v228 offset:39520
    v_mfma_f32_16x16x32_bf16 v[220:223], a[184:187], a[108:111], v[220:223]
    s_waitcnt vmcnt(37) lgkmcnt(6)
    v_mfma_f32_16x16x32_bf16 v[0:3], a[160:163], a[112:115], v[0:3]
    ds_read_b64_tr_b16 a[176:177], v228 offset:35968
    v_mfma_f32_16x16x32_bf16 v[56:59], a[160:163], a[116:119], v[56:59]
    v_mfma_f32_16x16x32_bf16 v[112:115], a[160:163], a[120:123], v[112:115]
    ds_read_b64_tr_b16 a[178:179], v228 offset:39552
    v_mfma_f32_16x16x32_bf16 v[168:171], a[160:163], a[124:127], v[168:171]
    s_waitcnt lgkmcnt(6)
    v_mfma_f32_16x16x32_bf16 v[4:7], a[164:167], a[112:115], v[4:7]
    ds_read_b64_tr_b16 a[180:181], v228 offset:36000
    v_mfma_f32_16x16x32_bf16 v[60:63], a[164:167], a[116:119], v[60:63]
    v_mfma_f32_16x16x32_bf16 v[116:119], a[164:167], a[120:123], v[116:119]
    ds_read_b64_tr_b16 a[182:183], v228 offset:39584
    v_mfma_f32_16x16x32_bf16 v[172:175], a[164:167], a[124:127], v[172:175]
    s_waitcnt lgkmcnt(6)
    v_mfma_f32_16x16x32_bf16 v[8:11], a[168:171], a[112:115], v[8:11]
    ds_read_b64_tr_b16 a[184:185], v228 offset:36032
    v_mfma_f32_16x16x32_bf16 v[64:67], a[168:171], a[116:119], v[64:67]
    buffer_load_dwordx4 a[36:39], v226, s[36:39], s53 offen offset:1024 sc1
    v_mfma_f32_16x16x32_bf16 v[120:123], a[168:171], a[120:123], v[120:123]
    ds_read_b64_tr_b16 a[186:187], v228 offset:39616
    v_mfma_f32_16x16x32_bf16 v[176:179], a[168:171], a[124:127], v[176:179]
    s_waitcnt lgkmcnt(6)
    v_mfma_f32_16x16x32_bf16 v[12:15], a[172:175], a[112:115], v[12:15]
    ds_read_b64_tr_b16 a[160:161], v228 offset:50176
    v_mfma_f32_16x16x32_bf16 v[68:71], a[172:175], a[116:119], v[68:71]
    buffer_load_dwordx4 v232, s[32:35], s52 offen offset:2048 lds
    v_mfma_f32_16x16x32_bf16 v[124:127], a[172:175], a[120:123], v[124:127]
    ds_read_b64_tr_b16 a[162:163], v228 offset:53760
    v_mfma_f32_16x16x32_bf16 v[180:183], a[172:175], a[124:127], v[180:183]
    s_waitcnt lgkmcnt(6)
    v_mfma_f32_16x16x32_bf16 v[16:19], a[176:179], a[112:115], v[16:19]
    ds_read_b64_tr_b16 a[164:165], v228 offset:50208
    v_mfma_f32_16x16x32_bf16 v[72:75], a[176:179], a[116:119], v[72:75]
    v_mfma_f32_16x16x32_bf16 v[128:131], a[176:179], a[120:123], v[128:131]
    ds_read_b64_tr_b16 a[166:167], v228 offset:53792
    v_mfma_f32_16x16x32_bf16 v[184:187], a[176:179], a[124:127], v[184:187]
    s_waitcnt lgkmcnt(6)
    v_mfma_f32_16x16x32_bf16 v[20:23], a[180:183], a[112:115], v[20:23]
    ds_read_b64_tr_b16 a[168:169], v228 offset:50240
    v_mfma_f32_16x16x32_bf16 v[76:79], a[180:183], a[116:119], v[76:79]
    buffer_load_dwordx4 a[40:43], v226, s[40:43], s53 offen offset:0 sc1
    v_mfma_f32_16x16x32_bf16 v[132:135], a[180:183], a[120:123], v[132:135]
    ds_read_b64_tr_b16 a[170:171], v228 offset:53824
    v_mfma_f32_16x16x32_bf16 v[188:191], a[180:183], a[124:127], v[188:191]
    s_waitcnt lgkmcnt(6)
    v_mfma_f32_16x16x32_bf16 v[24:27], a[184:187], a[112:115], v[24:27]
    ds_read_b64_tr_b16 a[172:173], v228 offset:50272
    v_mfma_f32_16x16x32_bf16 v[80:83], a[184:187], a[116:119], v[80:83]
    v_mfma_f32_16x16x32_bf16 v[136:139], a[184:187], a[120:123], v[136:139]
    ds_read_b64_tr_b16 a[174:175], v228 offset:53856
    v_mfma_f32_16x16x32_bf16 v[192:195], a[184:187], a[124:127], v[192:195]
    s_waitcnt lgkmcnt(6)
    v_mfma_f32_16x16x32_bf16 v[28:31], a[160:163], a[112:115], v[28:31]
    ds_read_b64_tr_b16 a[176:177], v228 offset:50304
    v_mfma_f32_16x16x32_bf16 v[84:87], a[160:163], a[116:119], v[84:87]
    buffer_load_dwordx4 v233, s[32:35], s52 offen offset:3072 lds
    v_mfma_f32_16x16x32_bf16 v[140:143], a[160:163], a[120:123], v[140:143]
    ds_read_b64_tr_b16 a[178:179], v228 offset:53888
    v_mfma_f32_16x16x32_bf16 v[196:199], a[160:163], a[124:127], v[196:199]
    s_waitcnt lgkmcnt(6)
    v_mfma_f32_16x16x32_bf16 v[32:35], a[164:167], a[112:115], v[32:35]
    ds_read_b64_tr_b16 a[180:181], v228 offset:50336
    v_mfma_f32_16x16x32_bf16 v[88:91], a[164:167], a[116:119], v[88:91]
    v_mfma_f32_16x16x32_bf16 v[144:147], a[164:167], a[120:123], v[144:147]
    ds_read_b64_tr_b16 a[182:183], v228 offset:53920
    v_mfma_f32_16x16x32_bf16 v[200:203], a[164:167], a[124:127], v[200:203]
    s_waitcnt lgkmcnt(6)
    v_mfma_f32_16x16x32_bf16 v[36:39], a[168:171], a[112:115], v[36:39]
    ds_read_b64_tr_b16 a[184:185], v228 offset:50368
    v_mfma_f32_16x16x32_bf16 v[92:95], a[168:171], a[116:119], v[92:95]
    buffer_load_dwordx4 a[44:47], v226, s[40:43], s53 offen offset:1024 sc1
    v_mfma_f32_16x16x32_bf16 v[148:151], a[168:171], a[120:123], v[148:151]
    ds_read_b64_tr_b16 a[186:187], v228 offset:53952
    v_mfma_f32_16x16x32_bf16 v[204:207], a[168:171], a[124:127], v[204:207]
    s_waitcnt vmcnt(27) lgkmcnt(6)
    s_barrier
    v_mfma_f32_16x16x32_bf16 v[40:43], a[172:175], a[112:115], v[40:43]
    ds_read_b64_tr_b16 a[160:161], v229 offset:0
    v_mfma_f32_16x16x32_bf16 v[96:99], a[172:175], a[116:119], v[96:99]
    v_mfma_f32_16x16x32_bf16 v[152:155], a[172:175], a[120:123], v[152:155]
    ds_read_b64_tr_b16 a[162:163], v229 offset:3584
    v_mfma_f32_16x16x32_bf16 v[208:211], a[172:175], a[124:127], v[208:211]
    s_waitcnt lgkmcnt(6)
    v_mfma_f32_16x16x32_bf16 v[44:47], a[176:179], a[112:115], v[44:47]
    s_add_u32 m0, s3, 32768
    ds_read_b64_tr_b16 a[164:165], v229 offset:32
    v_mfma_f32_16x16x32_bf16 v[100:103], a[176:179], a[116:119], v[100:103]
    buffer_load_dwordx4 v234, s[32:35], s52 offen offset:0 lds
    v_mfma_f32_16x16x32_bf16 v[156:159], a[176:179], a[120:123], v[156:159]
    ds_read_b64_tr_b16 a[166:167], v229 offset:3616
    v_mfma_f32_16x16x32_bf16 v[212:215], a[176:179], a[124:127], v[212:215]
    s_waitcnt lgkmcnt(6)
    v_mfma_f32_16x16x32_bf16 v[48:51], a[180:183], a[112:115], v[48:51]
    ds_read_b64_tr_b16 a[168:169], v229 offset:64
    v_mfma_f32_16x16x32_bf16 v[104:107], a[180:183], a[116:119], v[104:107]
    buffer_load_dwordx4 a[48:51], v226, s[36:39], s53 offen offset:2048 sc1
    v_mfma_f32_16x16x32_bf16 v[160:163], a[180:183], a[120:123], v[160:163]
    ds_read_b64_tr_b16 a[170:171], v229 offset:3648
    v_mfma_f32_16x16x32_bf16 v[216:219], a[180:183], a[124:127], v[216:219]
    s_waitcnt lgkmcnt(6)
    v_mfma_f32_16x16x32_bf16 v[52:55], a[184:187], a[112:115], v[52:55]
    ds_read_b64_tr_b16 a[172:173], v229 offset:96
    v_mfma_f32_16x16x32_bf16 v[108:111], a[184:187], a[116:119], v[108:111]
    v_mfma_f32_16x16x32_bf16 v[164:167], a[184:187], a[120:123], v[164:167]
    ds_read_b64_tr_b16 a[174:175], v229 offset:3680
    v_mfma_f32_16x16x32_bf16 v[220:223], a[184:187], a[124:127], v[220:223]
    s_waitcnt lgkmcnt(6)
    v_mfma_f32_16x16x32_bf16 v[0:3], a[160:163], a[128:131], v[0:3]
    s_add_u32 s61, s63, 2359296
    ds_read_b64_tr_b16 a[176:177], v229 offset:128
    v_mfma_f32_16x16x32_bf16 v[56:59], a[160:163], a[132:135], v[56:59]
    buffer_load_dword v238, v237, s[96:99], s61 offen
    v_mfma_f32_16x16x32_bf16 v[112:115], a[160:163], a[136:139], v[112:115]
    ds_read_b64_tr_b16 a[178:179], v229 offset:3712
    v_mfma_f32_16x16x32_bf16 v[168:171], a[160:163], a[140:143], v[168:171]
    s_waitcnt lgkmcnt(6)
    v_mfma_f32_16x16x32_bf16 v[4:7], a[164:167], a[128:131], v[4:7]
    ds_read_b64_tr_b16 a[180:181], v229 offset:160
    v_mfma_f32_16x16x32_bf16 v[60:63], a[164:167], a[132:135], v[60:63]
    buffer_load_dwordx4 v235, s[32:35], s52 offen offset:1024 lds
    v_mfma_f32_16x16x32_bf16 v[116:119], a[164:167], a[136:139], v[116:119]
    ds_read_b64_tr_b16 a[182:183], v229 offset:3744
    v_mfma_f32_16x16x32_bf16 v[172:175], a[164:167], a[140:143], v[172:175]
    s_waitcnt lgkmcnt(6)
    v_mfma_f32_16x16x32_bf16 v[8:11], a[168:171], a[128:131], v[8:11]
    ds_read_b64_tr_b16 a[184:185], v229 offset:192
    v_mfma_f32_16x16x32_bf16 v[64:67], a[168:171], a[132:135], v[64:67]
    buffer_load_dwordx4 a[52:55], v226, s[36:39], s53 offen offset:3072 sc1
    v_mfma_f32_16x16x32_bf16 v[120:123], a[168:171], a[136:139], v[120:123]
    ds_read_b64_tr_b16 a[186:187], v229 offset:3776
    v_mfma_f32_16x16x32_bf16 v[176:179], a[168:171], a[140:143], v[176:179]
    s_waitcnt lgkmcnt(6)
    v_mfma_f32_16x16x32_bf16 v[12:15], a[172:175], a[128:131], v[12:15]
    ds_read_b64_tr_b16 a[160:161], v229 offset:14336
    v_mfma_f32_16x16x32_bf16 v[68:71], a[172:175], a[132:135], v[68:71]
    v_mfma_f32_16x16x32_bf16 v[124:127], a[172:175], a[136:139], v[124:127]
    ds_read_b64_tr_b16 a[162:163], v229 offset:17920
    v_mfma_f32_16x16x32_bf16 v[180:183], a[172:175], a[140:143], v[180:183]
    s_waitcnt lgkmcnt(6)
    v_mfma_f32_16x16x32_bf16 v[16:19], a[176:179], a[128:131], v[16:19]
    ds_read_b64_tr_b16 a[164:165], v229 offset:14368
    v_mfma_f32_16x16x32_bf16 v[72:75], a[176:179], a[132:135], v[72:75]
    v_mfma_f32_16x16x32_bf16 v[128:131], a[176:179], a[136:139], v[128:131]
    ds_read_b64_tr_b16 a[166:167], v229 offset:17952
    v_mfma_f32_16x16x32_bf16 v[184:187], a[176:179], a[140:143], v[184:187]
    s_waitcnt lgkmcnt(6)
    v_mfma_f32_16x16x32_bf16 v[20:23], a[180:183], a[128:131], v[20:23]
    ds_read_b64_tr_b16 a[168:169], v229 offset:14400
    v_mfma_f32_16x16x32_bf16 v[76:79], a[180:183], a[132:135], v[76:79]
    buffer_load_dwordx4 v236, s[32:35], s52 offen offset:2048 lds
    v_mfma_f32_16x16x32_bf16 v[132:135], a[180:183], a[136:139], v[132:135]
    ds_read_b64_tr_b16 a[170:171], v229 offset:17984
    v_mfma_f32_16x16x32_bf16 v[188:191], a[180:183], a[140:143], v[188:191]
    s_waitcnt lgkmcnt(6)
    v_mfma_f32_16x16x32_bf16 v[24:27], a[184:187], a[128:131], v[24:27]
    ds_read_b64_tr_b16 a[172:173], v229 offset:14432
    v_mfma_f32_16x16x32_bf16 v[80:83], a[184:187], a[132:135], v[80:83]
    buffer_load_dwordx4 a[56:59], v226, s[40:43], s53 offen offset:2048 sc1
    v_mfma_f32_16x16x32_bf16 v[136:139], a[184:187], a[136:139], v[136:139]
    ds_read_b64_tr_b16 a[174:175], v229 offset:18016
    v_mfma_f32_16x16x32_bf16 v[192:195], a[184:187], a[140:143], v[192:195]
    s_waitcnt lgkmcnt(6)
    v_mfma_f32_16x16x32_bf16 v[28:31], a[160:163], a[128:131], v[28:31]
    ds_read_b64_tr_b16 a[176:177], v229 offset:14464
    v_mfma_f32_16x16x32_bf16 v[84:87], a[160:163], a[132:135], v[84:87]
    v_mfma_f32_16x16x32_bf16 v[140:143], a[160:163], a[136:139], v[140:143]
    ds_read_b64_tr_b16 a[178:179], v229 offset:18048
    v_mfma_f32_16x16x32_bf16 v[196:199], a[160:163], a[140:143], v[196:199]
    s_waitcnt lgkmcnt(6)
    v_mfma_f32_16x16x32_bf16 v[32:35], a[164:167], a[128:131], v[32:35]
    ds_read_b64_tr_b16 a[180:181], v229 offset:14496
    v_mfma_f32_16x16x32_bf16 v[88:91], a[164:167], a[132:135], v[88:91]
    v_mfma_f32_16x16x32_bf16 v[144:147], a[164:167], a[136:139], v[144:147]
    s_mov_b32 s52, 5505024
    ds_read_b64_tr_b16 a[182:183], v229 offset:18080
    v_mfma_f32_16x16x32_bf16 v[200:203], a[164:167], a[140:143], v[200:203]
    s_waitcnt lgkmcnt(6)
    v_mfma_f32_16x16x32_bf16 v[36:39], a[168:171], a[128:131], v[36:39]
    s_add_u32 m0, s3, 57344
    ds_read_b64_tr_b16 a[184:185], v229 offset:14528
    v_mfma_f32_16x16x32_bf16 v[92:95], a[168:171], a[132:135], v[92:95]
    buffer_load_dwordx4 v230, s[32:35], s52 offen offset:0 lds
    v_mfma_f32_16x16x32_bf16 v[148:151], a[168:171], a[136:139], v[148:151]
    ds_read_b64_tr_b16 a[186:187], v229 offset:18112
    v_mfma_f32_16x16x32_bf16 v[204:207], a[168:171], a[140:143], v[204:207]
    s_waitcnt lgkmcnt(6)
    v_mfma_f32_16x16x32_bf16 v[40:43], a[172:175], a[128:131], v[40:43]
    ds_read_b64_tr_b16 a[160:161], v229 offset:7168
    v_mfma_f32_16x16x32_bf16 v[96:99], a[172:175], a[132:135], v[96:99]
    buffer_load_dwordx4 a[60:63], v226, s[40:43], s53 offen offset:3072 sc1
    v_mfma_f32_16x16x32_bf16 v[152:155], a[172:175], a[136:139], v[152:155]
    ds_read_b64_tr_b16 a[162:163], v229 offset:10752
    v_mfma_f32_16x16x32_bf16 v[208:211], a[172:175], a[140:143], v[208:211]
    s_waitcnt lgkmcnt(6)
    v_mfma_f32_16x16x32_bf16 v[44:47], a[176:179], a[128:131], v[44:47]
    ds_read_b64_tr_b16 a[164:165], v229 offset:7200
    v_mfma_f32_16x16x32_bf16 v[100:103], a[176:179], a[132:135], v[100:103]
    v_mfma_f32_16x16x32_bf16 v[156:159], a[176:179], a[136:139], v[156:159]
    ds_read_b64_tr_b16 a[166:167], v229 offset:10784
    v_mfma_f32_16x16x32_bf16 v[212:215], a[176:179], a[140:143], v[212:215]
    s_waitcnt lgkmcnt(6)
    v_mfma_f32_16x16x32_bf16 v[48:51], a[180:183], a[128:131], v[48:51]
    s_mov_b32 s53, 49152
    ds_read_b64_tr_b16 a[168:169], v229 offset:7232
    v_mfma_f32_16x16x32_bf16 v[104:107], a[180:183], a[132:135], v[104:107]
    buffer_load_dwordx4 a[64:67], v226, s[36:39], s53 offen offset:0 sc1
    v_mfma_f32_16x16x32_bf16 v[160:163], a[180:183], a[136:139], v[160:163]
    ds_read_b64_tr_b16 a[170:171], v229 offset:10816
    v_mfma_f32_16x16x32_bf16 v[216:219], a[180:183], a[140:143], v[216:219]
    s_waitcnt lgkmcnt(6)
    v_mfma_f32_16x16x32_bf16 v[52:55], a[184:187], a[128:131], v[52:55]
    ds_read_b64_tr_b16 a[172:173], v229 offset:7264
    v_mfma_f32_16x16x32_bf16 v[108:111], a[184:187], a[132:135], v[108:111]
    buffer_load_dwordx4 v231, s[32:35], s52 offen offset:1024 lds
    v_mfma_f32_16x16x32_bf16 v[164:167], a[184:187], a[136:139], v[164:167]
    ds_read_b64_tr_b16 a[174:175], v229 offset:10848
    v_mfma_f32_16x16x32_bf16 v[220:223], a[184:187], a[140:143], v[220:223]
    s_waitcnt vmcnt(36) lgkmcnt(6)
    v_mfma_f32_16x16x32_bf16 v[0:3], a[160:163], a[144:147], v[0:3]
    ds_read_b64_tr_b16 a[176:177], v229 offset:7296
    v_mfma_f32_16x16x32_bf16 v[56:59], a[160:163], a[148:151], v[56:59]
    v_mfma_f32_16x16x32_bf16 v[112:115], a[160:163], a[152:155], v[112:115]
    ds_read_b64_tr_b16 a[178:179], v229 offset:10880
    v_mfma_f32_16x16x32_bf16 v[168:171], a[160:163], a[156:159], v[168:171]
    s_waitcnt lgkmcnt(6)
    v_mfma_f32_16x16x32_bf16 v[4:7], a[164:167], a[144:147], v[4:7]
    ds_read_b64_tr_b16 a[180:181], v229 offset:7328
    v_mfma_f32_16x16x32_bf16 v[60:63], a[164:167], a[148:151], v[60:63]
    v_mfma_f32_16x16x32_bf16 v[116:119], a[164:167], a[152:155], v[116:119]
    ds_read_b64_tr_b16 a[182:183], v229 offset:10912
    v_mfma_f32_16x16x32_bf16 v[172:175], a[164:167], a[156:159], v[172:175]
    s_waitcnt lgkmcnt(6)
    v_mfma_f32_16x16x32_bf16 v[8:11], a[168:171], a[144:147], v[8:11]
    s_add_u32 s61, s63, 3145728
    ds_read_b64_tr_b16 a[184:185], v229 offset:7360
    v_mfma_f32_16x16x32_bf16 v[64:67], a[168:171], a[148:151], v[64:67]
    buffer_load_dword v238, v237, s[96:99], s61 offen
    v_mfma_f32_16x16x32_bf16 v[120:123], a[168:171], a[152:155], v[120:123]
    ds_read_b64_tr_b16 a[186:187], v229 offset:10944
    v_mfma_f32_16x16x32_bf16 v[176:179], a[168:171], a[156:159], v[176:179]
    s_waitcnt lgkmcnt(6)
    v_mfma_f32_16x16x32_bf16 v[12:15], a[172:175], a[144:147], v[12:15]
    ds_read_b64_tr_b16 a[160:161], v229 offset:21504
    v_mfma_f32_16x16x32_bf16 v[68:71], a[172:175], a[148:151], v[68:71]
    buffer_load_dwordx4 a[68:71], v226, s[36:39], s53 offen offset:1024 sc1
    v_mfma_f32_16x16x32_bf16 v[124:127], a[172:175], a[152:155], v[124:127]
    ds_read_b64_tr_b16 a[162:163], v229 offset:25088
    v_mfma_f32_16x16x32_bf16 v[180:183], a[172:175], a[156:159], v[180:183]
    s_waitcnt lgkmcnt(6)
    v_mfma_f32_16x16x32_bf16 v[16:19], a[176:179], a[144:147], v[16:19]
    ds_read_b64_tr_b16 a[164:165], v229 offset:21536
    v_mfma_f32_16x16x32_bf16 v[72:75], a[176:179], a[148:151], v[72:75]
    buffer_load_dwordx4 v232, s[32:35], s52 offen offset:2048 lds
    v_mfma_f32_16x16x32_bf16 v[128:131], a[176:179], a[152:155], v[128:131]
    ds_read_b64_tr_b16 a[166:167], v229 offset:25120
    v_mfma_f32_16x16x32_bf16 v[184:187], a[176:179], a[156:159], v[184:187]
    s_waitcnt lgkmcnt(6)
    v_mfma_f32_16x16x32_bf16 v[20:23], a[180:183], a[144:147], v[20:23]
    ds_read_b64_tr_b16 a[168:169], v229 offset:21568
    v_mfma_f32_16x16x32_bf16 v[76:79], a[180:183], a[148:151], v[76:79]
    buffer_load_dwordx4 a[72:75], v226, s[40:43], s53 offen offset:0 sc1
    v_mfma_f32_16x16x32_bf16 v[132:135], a[180:183], a[152:155], v[132:135]
    ds_read_b64_tr_b16 a[170:171], v229 offset:25152
    v_mfma_f32_16x16x32_bf16 v[188:191], a[180:183], a[156:159], v[188:191]
    s_waitcnt lgkmcnt(6)
    v_mfma_f32_16x16x32_bf16 v[24:27], a[184:187], a[144:147], v[24:27]
    ds_read_b64_tr_b16 a[172:173], v229 offset:21600
    v_mfma_f32_16x16x32_bf16 v[80:83], a[184:187], a[148:151], v[80:83]
    buffer_load_dwordx4 v233, s[32:35], s52 offen offset:3072 lds
    v_mfma_f32_16x16x32_bf16 v[136:139], a[184:187], a[152:155], v[136:139]
    ds_read_b64_tr_b16 a[174:175], v229 offset:25184
    v_mfma_f32_16x16x32_bf16 v[192:195], a[184:187], a[156:159], v[192:195]
    s_waitcnt lgkmcnt(6)
    v_mfma_f32_16x16x32_bf16 v[28:31], a[160:163], a[144:147], v[28:31]
    ds_read_b64_tr_b16 a[176:177], v229 offset:21632
    v_mfma_f32_16x16x32_bf16 v[84:87], a[160:163], a[148:151], v[84:87]
    v_mfma_f32_16x16x32_bf16 v[140:143], a[160:163], a[152:155], v[140:143]
    ds_read_b64_tr_b16 a[178:179], v229 offset:25216
    v_mfma_f32_16x16x32_bf16 v[196:199], a[160:163], a[156:159], v[196:199]
    s_waitcnt lgkmcnt(6)
    v_mfma_f32_16x16x32_bf16 v[32:35], a[164:167], a[144:147], v[32:35]
    ds_read_b64_tr_b16 a[180:181], v229 offset:21664
    v_mfma_f32_16x16x32_bf16 v[88:91], a[164:167], a[148:151], v[88:91]
    v_mfma_f32_16x16x32_bf16 v[144:147], a[164:167], a[152:155], v[144:147]
    ds_read_b64_tr_b16 a[182:183], v229 offset:25248
    v_mfma_f32_16x16x32_bf16 v[200:203], a[164:167], a[156:159], v[200:203]
    s_waitcnt lgkmcnt(6)
    v_mfma_f32_16x16x32_bf16 v[36:39], a[168:171], a[144:147], v[36:39]
    ds_read_b64_tr_b16 a[184:185], v229 offset:21696
    v_mfma_f32_16x16x32_bf16 v[92:95], a[168:171], a[148:151], v[92:95]
    buffer_load_dwordx4 a[76:79], v226, s[40:43], s53 offen offset:1024 sc1
    v_mfma_f32_16x16x32_bf16 v[148:151], a[168:171], a[152:155], v[148:151]
    ds_read_b64_tr_b16 a[186:187], v229 offset:25280
    v_mfma_f32_16x16x32_bf16 v[204:207], a[168:171], a[156:159], v[204:207]
    s_waitcnt vmcnt(27) lgkmcnt(6)
    s_barrier
    v_mfma_f32_16x16x32_bf16 v[40:43], a[172:175], a[144:147], v[40:43]
    s_add_u32 m0, s3, 61440
    ds_read_b64_tr_b16 a[160:161], v227 offset:0
    v_mfma_f32_16x16x32_bf16 v[96:99], a[172:175], a[148:151], v[96:99]
    buffer_load_dwordx4 v234, s[32:35], s52 offen offset:0 lds
    v_mfma_f32_16x16x32_bf16 v[152:155], a[172:175], a[152:155], v[152:155]
    ds_read_b64_tr_b16 a[162:163], v227 offset:3584
    v_mfma_f32_16x16x32_bf16 v[208:211], a[172:175], a[156:159], v[208:211]
    s_waitcnt lgkmcnt(6)
    v_mfma_f32_16x16x32_bf16 v[44:47], a[176:179], a[144:147], v[44:47]
    ds_read_b64_tr_b16 a[164:165], v227 offset:32
    v_mfma_f32_16x16x32_bf16 v[100:103], a[176:179], a[148:151], v[100:103]
    v_mfma_f32_16x16x32_bf16 v[156:159], a[176:179], a[152:155], v[156:159]
    ds_read_b64_tr_b16 a[166:167], v227 offset:3616
    v_mfma_f32_16x16x32_bf16 v[212:215], a[176:179], a[156:159], v[212:215]
    s_waitcnt lgkmcnt(6)
    v_mfma_f32_16x16x32_bf16 v[48:51], a[180:183], a[144:147], v[48:51]
    ds_read_b64_tr_b16 a[168:169], v227 offset:64
    v_mfma_f32_16x16x32_bf16 v[104:107], a[180:183], a[148:151], v[104:107]
    buffer_load_dwordx4 a[80:83], v226, s[36:39], s53 offen offset:2048 sc1
    v_mfma_f32_16x16x32_bf16 v[160:163], a[180:183], a[152:155], v[160:163]
    ds_read_b64_tr_b16 a[170:171], v227 offset:3648
    v_mfma_f32_16x16x32_bf16 v[216:219], a[180:183], a[156:159], v[216:219]
    s_waitcnt lgkmcnt(6)
    v_mfma_f32_16x16x32_bf16 v[52:55], a[184:187], a[144:147], v[52:55]
    ds_read_b64_tr_b16 a[172:173], v227 offset:96
    v_mfma_f32_16x16x32_bf16 v[108:111], a[184:187], a[148:151], v[108:111]
    v_mfma_f32_16x16x32_bf16 v[164:167], a[184:187], a[152:155], v[164:167]
    ds_read_b64_tr_b16 a[174:175], v227 offset:3680
    v_mfma_f32_16x16x32_bf16 v[220:223], a[184:187], a[156:159], v[220:223]
    s_waitcnt lgkmcnt(6)
    v_mfma_f32_16x16x32_bf16 v[0:3], a[160:163], a[0:3], v[0:3]
    ds_read_b64_tr_b16 a[176:177], v227 offset:128
    v_mfma_f32_16x16x32_bf16 v[56:59], a[160:163], a[4:7], v[56:59]
    buffer_load_dwordx4 v235, s[32:35], s52 offen offset:1024 lds
    v_mfma_f32_16x16x32_bf16 v[112:115], a[160:163], a[8:11], v[112:115]
    ds_read_b64_tr_b16 a[178:179], v227 offset:3712
    v_mfma_f32_16x16x32_bf16 v[168:171], a[160:163], a[12:15], v[168:171]
    s_waitcnt lgkmcnt(6)
    v_mfma_f32_16x16x32_bf16 v[4:7], a[164:167], a[0:3], v[4:7]
    ds_read_b64_tr_b16 a[180:181], v227 offset:160
    v_mfma_f32_16x16x32_bf16 v[60:63], a[164:167], a[4:7], v[60:63]
    v_mfma_f32_16x16x32_bf16 v[116:119], a[164:167], a[8:11], v[116:119]
    ds_read_b64_tr_b16 a[182:183], v227 offset:3744
    v_mfma_f32_16x16x32_bf16 v[172:175], a[164:167], a[12:15], v[172:175]
    s_waitcnt lgkmcnt(6)
    v_mfma_f32_16x16x32_bf16 v[8:11], a[168:171], a[0:3], v[8:11]
    ds_read_b64_tr_b16 a[184:185], v227 offset:192
    v_mfma_f32_16x16x32_bf16 v[64:67], a[168:171], a[4:7], v[64:67]
    buffer_load_dwordx4 a[84:87], v226, s[36:39], s53 offen offset:3072 sc1
    v_mfma_f32_16x16x32_bf16 v[120:123], a[168:171], a[8:11], v[120:123]
    ds_read_b64_tr_b16 a[186:187], v227 offset:3776
    v_mfma_f32_16x16x32_bf16 v[176:179], a[168:171], a[12:15], v[176:179]
    s_waitcnt lgkmcnt(6)
    v_mfma_f32_16x16x32_bf16 v[12:15], a[172:175], a[0:3], v[12:15]
    ds_read_b64_tr_b16 a[160:161], v227 offset:14336
    v_mfma_f32_16x16x32_bf16 v[68:71], a[172:175], a[4:7], v[68:71]
    v_mfma_f32_16x16x32_bf16 v[124:127], a[172:175], a[8:11], v[124:127]
    ds_read_b64_tr_b16 a[162:163], v227 offset:17920
    v_mfma_f32_16x16x32_bf16 v[180:183], a[172:175], a[12:15], v[180:183]
    s_waitcnt lgkmcnt(6)
    v_mfma_f32_16x16x32_bf16 v[16:19], a[176:179], a[0:3], v[16:19]
    s_add_u32 s61, s63, 3932160
    ds_read_b64_tr_b16 a[164:165], v227 offset:14368
    v_mfma_f32_16x16x32_bf16 v[72:75], a[176:179], a[4:7], v[72:75]
    buffer_load_dword v238, v237, s[96:99], s61 offen
    v_mfma_f32_16x16x32_bf16 v[128:131], a[176:179], a[8:11], v[128:131]
    ds_read_b64_tr_b16 a[166:167], v227 offset:17952
    v_mfma_f32_16x16x32_bf16 v[184:187], a[176:179], a[12:15], v[184:187]
    s_waitcnt lgkmcnt(6)
    v_mfma_f32_16x16x32_bf16 v[20:23], a[180:183], a[0:3], v[20:23]
    ds_read_b64_tr_b16 a[168:169], v227 offset:14400
    v_mfma_f32_16x16x32_bf16 v[76:79], a[180:183], a[4:7], v[76:79]
    buffer_load_dwordx4 v236, s[32:35], s52 offen offset:2048 lds
    v_mfma_f32_16x16x32_bf16 v[132:135], a[180:183], a[8:11], v[132:135]
    ds_read_b64_tr_b16 a[170:171], v227 offset:17984
    v_mfma_f32_16x16x32_bf16 v[188:191], a[180:183], a[12:15], v[188:191]
    s_waitcnt lgkmcnt(6)
    v_mfma_f32_16x16x32_bf16 v[24:27], a[184:187], a[0:3], v[24:27]
    ds_read_b64_tr_b16 a[172:173], v227 offset:14432
    v_mfma_f32_16x16x32_bf16 v[80:83], a[184:187], a[4:7], v[80:83]
    buffer_load_dwordx4 a[88:91], v226, s[40:43], s53 offen offset:2048 sc1
    v_mfma_f32_16x16x32_bf16 v[136:139], a[184:187], a[8:11], v[136:139]
    ds_read_b64_tr_b16 a[174:175], v227 offset:18016
    v_mfma_f32_16x16x32_bf16 v[192:195], a[184:187], a[12:15], v[192:195]
    s_waitcnt lgkmcnt(6)
    v_mfma_f32_16x16x32_bf16 v[28:31], a[160:163], a[0:3], v[28:31]
    ds_read_b64_tr_b16 a[176:177], v227 offset:14464
    v_mfma_f32_16x16x32_bf16 v[84:87], a[160:163], a[4:7], v[84:87]
    v_mfma_f32_16x16x32_bf16 v[140:143], a[160:163], a[8:11], v[140:143]
    s_mov_b32 s52, 5963776
    ds_read_b64_tr_b16 a[178:179], v227 offset:18048
    v_mfma_f32_16x16x32_bf16 v[196:199], a[160:163], a[12:15], v[196:199]
    s_waitcnt lgkmcnt(6)
    v_mfma_f32_16x16x32_bf16 v[32:35], a[164:167], a[0:3], v[32:35]
    s_add_u32 m0, s3, 86016
    ds_read_b64_tr_b16 a[180:181], v227 offset:14496
    v_mfma_f32_16x16x32_bf16 v[88:91], a[164:167], a[4:7], v[88:91]
    buffer_load_dwordx4 v230, s[32:35], s52 offen offset:0 lds
    v_mfma_f32_16x16x32_bf16 v[144:147], a[164:167], a[8:11], v[144:147]
    ds_read_b64_tr_b16 a[182:183], v227 offset:18080
    v_mfma_f32_16x16x32_bf16 v[200:203], a[164:167], a[12:15], v[200:203]
    s_waitcnt lgkmcnt(6)
    v_mfma_f32_16x16x32_bf16 v[36:39], a[168:171], a[0:3], v[36:39]
Lpad_12:
    s_cbranch_execz Lback_a
    ds_read_b64_tr_b16 a[184:185], v227 offset:14528
    v_mfma_f32_16x16x32_bf16 v[92:95], a[168:171], a[4:7], v[92:95]
    buffer_load_dwordx4 a[92:95], v226, s[40:43], s53 offen offset:3072 sc1
    v_mfma_f32_16x16x32_bf16 v[148:151], a[168:171], a[8:11], v[148:151]
    ds_read_b64_tr_b16 a[186:187], v227 offset:18112
    v_mfma_f32_16x16x32_bf16 v[204:207], a[168:171], a[12:15], v[204:207]
    s_waitcnt lgkmcnt(6)
    v_mfma_f32_16x16x32_bf16 v[40:43], a[172:175], a[0:3], v[40:43]
    ds_read_b64_tr_b16 a[160:161], v227 offset:7168
    v_mfma_f32_16x16x32_bf16 v[96:99], a[172:175], a[4:7], v[96:99]
    v_mfma_f32_16x16x32_bf16 v[152:155], a[172:175], a[8:11], v[152:155]
    ds_read_b64_tr_b16 a[162:163], v227 offset:10752
    v_mfma_f32_16x16x32_bf16 v[208:211], a[172:175], a[12:15], v[208:211]
    s_waitcnt lgkmcnt(6)
    v_mfma_f32_16x16x32_bf16 v[44:47], a[176:179], a[0:3], v[44:47]
    ds_read_b64_tr_b16 a[164:165], v227 offset:7200
    v_mfma_f32_16x16x32_bf16 v[100:103], a[176:179], a[4:7], v[100:103]
    v_mfma_f32_16x16x32_bf16 v[156:159], a[176:179], a[8:11], v[156:159]
    ds_read_b64_tr_b16 a[166:167], v227 offset:10784
    v_mfma_f32_16x16x32_bf16 v[212:215], a[176:179], a[12:15], v[212:215]
    s_waitcnt lgkmcnt(6)
    v_mfma_f32_16x16x32_bf16 v[48:51], a[180:183], a[0:3], v[48:51]
    ds_read_b64_tr_b16 a[168:169], v227 offset:7232
    v_mfma_f32_16x16x32_bf16 v[104:107], a[180:183], a[4:7], v[104:107]
    buffer_load_dwordx4 v231, s[32:35], s52 offen offset:1024 lds
    v_mfma_f32_16x16x32_bf16 v[160:163], a[180:183], a[8:11], v[160:163]
    ds_read_b64_tr_b16 a[170:171], v227 offset:10816
    v_mfma_f32_16x16x32_bf16 v[216:219], a[180:183], a[12:15], v[216:219]
    s_waitcnt lgkmcnt(6)
    v_mfma_f32_16x16x32_bf16 v[52:55], a[184:187], a[0:3], v[52:55]
    s_mov_b32 s53, 53248
    ds_read_b64_tr_b16 a[172:173], v227 offset:7264
    v_mfma_f32_16x16x32_bf16 v[108:111], a[184:187], a[4:7], v[108:111]
    buffer_load_dwordx4 a[96:99], v226, s[36:39], s53 offen offset:0 sc1
    v_mfma_f32_16x16x32_bf16 v[164:167], a[184:187], a[8:11], v[164:167]
    ds_read_b64_tr_b16 a[174:175], v227 offset:10848
    v_mfma_f32_16x16x32_bf16 v[220:223], a[184:187], a[12:15], v[220:223]
    s_waitcnt vmcnt(37) lgkmcnt(6)
    v_mfma_f32_16x16x32_bf16 v[0:3], a[160:163], a[16:19], v[0:3]
    ds_read_b64_tr_b16 a[176:177], v227 offset:7296
    v_mfma_f32_16x16x32_bf16 v[56:59], a[160:163], a[20:23], v[56:59]
    v_mfma_f32_16x16x32_bf16 v[112:115], a[160:163], a[24:27], v[112:115]
    ds_read_b64_tr_b16 a[178:179], v227 offset:10880
    v_mfma_f32_16x16x32_bf16 v[168:171], a[160:163], a[28:31], v[168:171]
    s_waitcnt lgkmcnt(6)
    v_mfma_f32_16x16x32_bf16 v[4:7], a[164:167], a[16:19], v[4:7]
    ds_read_b64_tr_b16 a[180:181], v227 offset:7328
    v_mfma_f32_16x16x32_bf16 v[60:63], a[164:167], a[20:23], v[60:63]
    buffer_load_dwordx4 a[100:103], v226, s[36:39], s53 offen offset:1024 sc1
    v_mfma_f32_16x16x32_bf16 v[116:119], a[164:167], a[24:27], v[116:119]
    ds_read_b64_tr_b16 a[182:183], v227 offset:10912
    v_mfma_f32_16x16x32_bf16 v[172:175], a[164:167], a[28:31], v[172:175]
    s_waitcnt lgkmcnt(6)
    v_mfma_f32_16x16x32_bf16 v[8:11], a[168:171], a[16:19], v[8:11]
    ds_read_b64_tr_b16 a[184:185], v227 offset:7360
    v_mfma_f32_16x16x32_bf16 v[64:67], a[168:171], a[20:23], v[64:67]
    buffer_load_dwordx4 v232, s[32:35], s52 offen offset:2048 lds
    v_mfma_f32_16x16x32_bf16 v[120:123], a[168:171], a[24:27], v[120:123]
    ds_read_b64_tr_b16 a[186:187], v227 offset:10944
    v_mfma_f32_16x16x32_bf16 v[176:179], a[168:171], a[28:31], v[176:179]
    s_waitcnt lgkmcnt(6)
    v_mfma_f32_16x16x32_bf16 v[12:15], a[172:175], a[16:19], v[12:15]
    ds_read_b64_tr_b16 a[160:161], v227 offset:21504
    v_mfma_f32_16x16x32_bf16 v[68:71], a[172:175], a[20:23], v[68:71]
    v_mfma_f32_16x16x32_bf16 v[124:127], a[172:175], a[24:27], v[124:127]
    ds_read_b64_tr_b16 a[162:163], v227 offset:25088
    v_mfma_f32_16x16x32_bf16 v[180:183], a[172:175], a[28:31], v[180:183]
    s_waitcnt lgkmcnt(6)
    v_mfma_f32_16x16x32_bf16 v[16:19], a[176:179], a[16:19], v[16:19]
    ds_read_b64_tr_b16 a[164:165], v227 offset:21536
    v_mfma_f32_16x16x32_bf16 v[72:75], a[176:179], a[20:23], v[72:75]
    v_mfma_f32_16x16x32_bf16 v[128:131], a[176:179], a[24:27], v[128:131]
    ds_read_b64_tr_b16 a[166:167], v227 offset:25120
    v_mfma_f32_16x16x32_bf16 v[184:187], a[176:179], a[28:31], v[184:187]
    s_waitcnt lgkmcnt(6)
    v_mfma_f32_16x16x32_bf16 v[20:23], a[180:183], a[16:19], v[20:23]
    ds_read_b64_tr_b16 a[168:169], v227 offset:21568
    v_mfma_f32_16x16x32_bf16 v[76:79], a[180:183], a[20:23], v[76:79]
    buffer_load_dwordx4 a[104:107], v226, s[40:43], s53 offen offset:0 sc1
    v_mfma_f32_16x16x32_bf16 v[132:135], a[180:183], a[24:27], v[132:135]
    ds_read_b64_tr_b16 a[170:171], v227 offset:25152
    v_mfma_f32_16x16x32_bf16 v[188:191], a[180:183], a[28:31], v[188:191]
    s_waitcnt lgkmcnt(6)
    v_mfma_f32_16x16x32_bf16 v[24:27], a[184:187], a[16:19], v[24:27]
    ds_read_b64_tr_b16 a[172:173], v227 offset:21600
    v_mfma_f32_16x16x32_bf16 v[80:83], a[184:187], a[20:23], v[80:83]
    buffer_load_dwordx4 v233, s[32:35], s52 offen offset:3072 lds
    v_mfma_f32_16x16x32_bf16 v[136:139], a[184:187], a[24:27], v[136:139]
    ds_read_b64_tr_b16 a[174:175], v227 offset:25184
    v_mfma_f32_16x16x32_bf16 v[192:195], a[184:187], a[28:31], v[192:195]
    s_waitcnt lgkmcnt(6)
    v_mfma_f32_16x16x32_bf16 v[28:31], a[160:163], a[16:19], v[28:31]
    s_add_u32 s61, s63, 4718592
    ds_read_b64_tr_b16 a[176:177], v227 offset:21632
    v_mfma_f32_16x16x32_bf16 v[84:87], a[160:163], a[20:23], v[84:87]
    buffer_load_dword v238, v237, s[96:99], s61 offen
    v_mfma_f32_16x16x32_bf16 v[140:143], a[160:163], a[24:27], v[140:143]
    ds_read_b64_tr_b16 a[178:179], v227 offset:25216
    v_mfma_f32_16x16x32_bf16 v[196:199], a[160:163], a[28:31], v[196:199]
    s_waitcnt lgkmcnt(6)
    v_mfma_f32_16x16x32_bf16 v[32:35], a[164:167], a[16:19], v[32:35]
    ds_read_b64_tr_b16 a[180:181], v227 offset:21664
    v_mfma_f32_16x16x32_bf16 v[88:91], a[164:167], a[20:23], v[88:91]
    buffer_load_dwordx4 a[108:111], v226, s[40:43], s53 offen offset:1024 sc1
    v_mfma_f32_16x16x32_bf16 v[144:147], a[164:167], a[24:27], v[144:147]
    ds_read_b64_tr_b16 a[182:183], v227 offset:25248
    v_mfma_f32_16x16x32_bf16 v[200:203], a[164:167], a[28:31], v[200:203]
    s_waitcnt lgkmcnt(6)
    v_mfma_f32_16x16x32_bf16 v[36:39], a[168:171], a[16:19], v[36:39]
    s_add_u32 m0, s3, 90112
    ds_read_b64_tr_b16 a[184:185], v227 offset:21696
    v_mfma_f32_16x16x32_bf16 v[92:95], a[168:171], a[20:23], v[92:95]
    buffer_load_dwordx4 v234, s[32:35], s52 offen offset:0 lds
    v_mfma_f32_16x16x32_bf16 v[148:151], a[168:171], a[24:27], v[148:151]
    ds_read_b64_tr_b16 a[186:187], v227 offset:25280
    v_mfma_f32_16x16x32_bf16 v[204:207], a[168:171], a[28:31], v[204:207]
    s_waitcnt vmcnt(29) lgkmcnt(6)
    s_barrier
    v_mfma_f32_16x16x32_bf16 v[40:43], a[172:175], a[16:19], v[40:43]
    ds_read_b64_tr_b16 a[160:161], v227 offset:28672
    v_mfma_f32_16x16x32_bf16 v[96:99], a[172:175], a[20:23], v[96:99]
    v_mfma_f32_16x16x32_bf16 v[152:155], a[172:175], a[24:27], v[152:155]
    ds_read_b64_tr_b16 a[162:163], v227 offset:32256
    v_mfma_f32_16x16x32_bf16 v[208:211], a[172:175], a[28:31], v[208:211]
    s_waitcnt lgkmcnt(6)
    v_mfma_f32_16x16x32_bf16 v[44:47], a[176:179], a[16:19], v[44:47]
    ds_read_b64_tr_b16 a[164:165], v227 offset:28704
    v_mfma_f32_16x16x32_bf16 v[100:103], a[176:179], a[20:23], v[100:103]
    v_mfma_f32_16x16x32_bf16 v[156:159], a[176:179], a[24:27], v[156:159]
    ds_read_b64_tr_b16 a[166:167], v227 offset:32288
    v_mfma_f32_16x16x32_bf16 v[212:215], a[176:179], a[28:31], v[212:215]
    s_waitcnt lgkmcnt(6)
    v_mfma_f32_16x16x32_bf16 v[48:51], a[180:183], a[16:19], v[48:51]
    ds_read_b64_tr_b16 a[168:169], v227 offset:28736
    v_mfma_f32_16x16x32_bf16 v[104:107], a[180:183], a[20:23], v[104:107]
    buffer_load_dwordx4 a[112:115], v226, s[36:39], s53 offen offset:2048 sc1
    v_mfma_f32_16x16x32_bf16 v[160:163], a[180:183], a[24:27], v[160:163]
    ds_read_b64_tr_b16 a[170:171], v227 offset:32320
    v_mfma_f32_16x16x32_bf16 v[216:219], a[180:183], a[28:31], v[216:219]
    s_waitcnt lgkmcnt(6)
    v_mfma_f32_16x16x32_bf16 v[52:55], a[184:187], a[16:19], v[52:55]
    ds_read_b64_tr_b16 a[172:173], v227 offset:28768
    v_mfma_f32_16x16x32_bf16 v[108:111], a[184:187], a[20:23], v[108:111]
    buffer_load_dwordx4 v235, s[32:35], s52 offen offset:1024 lds
    v_mfma_f32_16x16x32_bf16 v[164:167], a[184:187], a[24:27], v[164:167]
    ds_read_b64_tr_b16 a[174:175], v227 offset:32352
    v_mfma_f32_16x16x32_bf16 v[220:223], a[184:187], a[28:31], v[220:223]
    s_waitcnt lgkmcnt(6)
    v_mfma_f32_16x16x32_bf16 v[0:3], a[160:163], a[32:35], v[0:3]
    ds_read_b64_tr_b16 a[176:177], v227 offset:28800
    v_mfma_f32_16x16x32_bf16 v[56:59], a[160:163], a[36:39], v[56:59]
    v_mfma_f32_16x16x32_bf16 v[112:115], a[160:163], a[40:43], v[112:115]
    ds_read_b64_tr_b16 a[178:179], v227 offset:32384
    v_mfma_f32_16x16x32_bf16 v[168:171], a[160:163], a[44:47], v[168:171]
    s_waitcnt lgkmcnt(6)
    v_mfma_f32_16x16x32_bf16 v[4:7], a[164:167], a[32:35], v[4:7]
    ds_read_b64_tr_b16 a[180:181], v227 offset:28832
    v_mfma_f32_16x16x32_bf16 v[60:63], a[164:167], a[36:39], v[60:63]
    buffer_load_dwordx4 a[116:119], v226, s[36:39], s53 offen offset:3072 sc1
    v_mfma_f32_16x16x32_bf16 v[116:119], a[164:167], a[40:43], v[116:119]
    ds_read_b64_tr_b16 a[182:183], v227 offset:32416
    v_mfma_f32_16x16x32_bf16 v[172:175], a[164:167], a[44:47], v[172:175]
    s_waitcnt lgkmcnt(6)
    v_mfma_f32_16x16x32_bf16 v[8:11], a[168:171], a[32:35], v[8:11]
    ds_read_b64_tr_b16 a[184:185], v227 offset:28864
    v_mfma_f32_16x16x32_bf16 v[64:67], a[168:171], a[36:39], v[64:67]
    v_mfma_f32_16x16x32_bf16 v[120:123], a[168:171], a[40:43], v[120:123]
    ds_read_b64_tr_b16 a[186:187], v227 offset:32448
    v_mfma_f32_16x16x32_bf16 v[176:179], a[168:171], a[44:47], v[176:179]
    s_waitcnt lgkmcnt(6)
    v_mfma_f32_16x16x32_bf16 v[12:15], a[172:175], a[32:35], v[12:15]
    ds_read_b64_tr_b16 a[160:161], v227 offset:43008
    v_mfma_f32_16x16x32_bf16 v[68:71], a[172:175], a[36:39], v[68:71]
    buffer_load_dwordx4 v236, s[32:35], s52 offen offset:2048 lds
    v_mfma_f32_16x16x32_bf16 v[124:127], a[172:175], a[40:43], v[124:127]
    ds_read_b64_tr_b16 a[162:163], v227 offset:46592
    v_mfma_f32_16x16x32_bf16 v[180:183], a[172:175], a[44:47], v[180:183]
    s_waitcnt lgkmcnt(6)
    v_mfma_f32_16x16x32_bf16 v[16:19], a[176:179], a[32:35], v[16:19]
    ds_read_b64_tr_b16 a[164:165], v227 offset:43040
    v_mfma_f32_16x16x32_bf16 v[72:75], a[176:179], a[36:39], v[72:75]
    v_mfma_f32_16x16x32_bf16 v[128:131], a[176:179], a[40:43], v[128:131]
    ds_read_b64_tr_b16 a[166:167], v227 offset:46624
    v_mfma_f32_16x16x32_bf16 v[184:187], a[176:179], a[44:47], v[184:187]
    s_waitcnt lgkmcnt(6)
    v_mfma_f32_16x16x32_bf16 v[20:23], a[180:183], a[32:35], v[20:23]
    ds_read_b64_tr_b16 a[168:169], v227 offset:43072
    v_mfma_f32_16x16x32_bf16 v[76:79], a[180:183], a[36:39], v[76:79]
    buffer_load_dwordx4 a[120:123], v226, s[40:43], s53 offen offset:2048 sc1
    v_mfma_f32_16x16x32_bf16 v[132:135], a[180:183], a[40:43], v[132:135]
    ds_read_b64_tr_b16 a[170:171], v227 offset:46656
    v_mfma_f32_16x16x32_bf16 v[188:191], a[180:183], a[44:47], v[188:191]
    s_waitcnt lgkmcnt(6)
    v_mfma_f32_16x16x32_bf16 v[24:27], a[184:187], a[32:35], v[24:27]
    ds_read_b64_tr_b16 a[172:173], v227 offset:43104
    v_mfma_f32_16x16x32_bf16 v[80:83], a[184:187], a[36:39], v[80:83]
    v_mfma_f32_16x16x32_bf16 v[136:139], a[184:187], a[40:43], v[136:139]
    s_mov_b32 s52, 6422528
    ds_read_b64_tr_b16 a[174:175], v227 offset:46688
    v_mfma_f32_16x16x32_bf16 v[192:195], a[184:187], a[44:47], v[192:195]
    s_waitcnt lgkmcnt(6)
    v_mfma_f32_16x16x32_bf16 v[28:31], a[160:163], a[32:35], v[28:31]
    s_add_u32 m0, s3, 114688
    ds_read_b64_tr_b16 a[176:177], v227 offset:43136
    v_mfma_f32_16x16x32_bf16 v[84:87], a[160:163], a[36:39], v[84:87]
    buffer_load_dwordx4 v230, s[32:35], s52 offen offset:0 lds
    v_mfma_f32_16x16x32_bf16 v[140:143], a[160:163], a[40:43], v[140:143]
    ds_read_b64_tr_b16 a[178:179], v227 offset:46720
    v_mfma_f32_16x16x32_bf16 v[196:199], a[160:163], a[44:47], v[196:199]
    s_waitcnt lgkmcnt(6)
    v_mfma_f32_16x16x32_bf16 v[32:35], a[164:167], a[32:35], v[32:35]
    ds_read_b64_tr_b16 a[180:181], v227 offset:43168
    v_mfma_f32_16x16x32_bf16 v[88:91], a[164:167], a[36:39], v[88:91]
    buffer_load_dwordx4 a[124:127], v226, s[40:43], s53 offen offset:3072 sc1
    v_mfma_f32_16x16x32_bf16 v[144:147], a[164:167], a[40:43], v[144:147]
    ds_read_b64_tr_b16 a[182:183], v227 offset:46752
    v_mfma_f32_16x16x32_bf16 v[200:203], a[164:167], a[44:47], v[200:203]
    s_waitcnt lgkmcnt(6)
    v_mfma_f32_16x16x32_bf16 v[36:39], a[168:171], a[32:35], v[36:39]
    s_add_u32 s61, s63, 5505024
    ds_read_b64_tr_b16 a[184:185], v227 offset:43200
    v_mfma_f32_16x16x32_bf16 v[92:95], a[168:171], a[36:39], v[92:95]
    buffer_load_dword v238, v237, s[96:99], s61 offen
    v_mfma_f32_16x16x32_bf16 v[148:151], a[168:171], a[40:43], v[148:151]
    ds_read_b64_tr_b16 a[186:187], v227 offset:46784
    v_mfma_f32_16x16x32_bf16 v[204:207], a[168:171], a[44:47], v[204:207]
    s_waitcnt lgkmcnt(6)
    v_mfma_f32_16x16x32_bf16 v[40:43], a[172:175], a[32:35], v[40:43]
    ds_read_b64_tr_b16 a[160:161], v227 offset:35840
    v_mfma_f32_16x16x32_bf16 v[96:99], a[172:175], a[36:39], v[96:99]
    v_mfma_f32_16x16x32_bf16 v[152:155], a[172:175], a[40:43], v[152:155]
    ds_read_b64_tr_b16 a[162:163], v227 offset:39424
    v_mfma_f32_16x16x32_bf16 v[208:211], a[172:175], a[44:47], v[208:211]
    s_waitcnt lgkmcnt(6)
    v_mfma_f32_16x16x32_bf16 v[44:47], a[176:179], a[32:35], v[44:47]
    ds_read_b64_tr_b16 a[164:165], v227 offset:35872
    v_mfma_f32_16x16x32_bf16 v[100:103], a[176:179], a[36:39], v[100:103]
    buffer_load_dwordx4 v231, s[32:35], s52 offen offset:1024 lds
    v_mfma_f32_16x16x32_bf16 v[156:159], a[176:179], a[40:43], v[156:159]
    ds_read_b64_tr_b16 a[166:167], v227 offset:39456
    v_mfma_f32_16x16x32_bf16 v[212:215], a[176:179], a[44:47], v[212:215]
    s_waitcnt lgkmcnt(6)
    v_mfma_f32_16x16x32_bf16 v[48:51], a[180:183], a[32:35], v[48:51]
    s_mov_b32 s53, 57344
    ds_read_b64_tr_b16 a[168:169], v227 offset:35904
    v_mfma_f32_16x16x32_bf16 v[104:107], a[180:183], a[36:39], v[104:107]
    buffer_load_dwordx4 a[128:131], v226, s[36:39], s53 offen offset:0 sc1
    v_mfma_f32_16x16x32_bf16 v[160:163], a[180:183], a[40:43], v[160:163]
    ds_read_b64_tr_b16 a[170:171], v227 offset:39488
    v_mfma_f32_16x16x32_bf16 v[216:219], a[180:183], a[44:47], v[216:219]
    s_waitcnt lgkmcnt(6)
    v_mfma_f32_16x16x32_bf16 v[52:55], a[184:187], a[32:35], v[52:55]
    ds_read_b64_tr_b16 a[172:173], v227 offset:35936
    v_mfma_f32_16x16x32_bf16 v[108:111], a[184:187], a[36:39], v[108:111]
    v_mfma_f32_16x16x32_bf16 v[164:167], a[184:187], a[40:43], v[164:167]
    ds_read_b64_tr_b16 a[174:175], v227 offset:39520
    v_mfma_f32_16x16x32_bf16 v[220:223], a[184:187], a[44:47], v[220:223]
    s_waitcnt vmcnt(36) lgkmcnt(6)
    v_mfma_f32_16x16x32_bf16 v[0:3], a[160:163], a[48:51], v[0:3]
    ds_read_b64_tr_b16 a[176:177], v227 offset:35968
    v_mfma_f32_16x16x32_bf16 v[56:59], a[160:163], a[52:55], v[56:59]
    v_mfma_f32_16x16x32_bf16 v[112:115], a[160:163], a[56:59], v[112:115]
    ds_read_b64_tr_b16 a[178:179], v227 offset:39552
    v_mfma_f32_16x16x32_bf16 v[168:171], a[160:163], a[60:63], v[168:171]
    s_waitcnt lgkmcnt(6)
    v_mfma_f32_16x16x32_bf16 v[4:7], a[164:167], a[48:51], v[4:7]
    ds_read_b64_tr_b16 a[180:181], v227 offset:36000
    v_mfma_f32_16x16x32_bf16 v[60:63], a[164:167], a[52:55], v[60:63]
    buffer_load_dwordx4 v232, s[32:35], s52 offen offset:2048 lds
    v_mfma_f32_16x16x32_bf16 v[116:119], a[164:167], a[56:59], v[116:119]
    ds_read_b64_tr_b16 a[182:183], v227 offset:39584
    v_mfma_f32_16x16x32_bf16 v[172:175], a[164:167], a[60:63], v[172:175]
    s_waitcnt lgkmcnt(6)
    v_mfma_f32_16x16x32_bf16 v[8:11], a[168:171], a[48:51], v[8:11]
    ds_read_b64_tr_b16 a[184:185], v227 offset:36032
    v_mfma_f32_16x16x32_bf16 v[64:67], a[168:171], a[52:55], v[64:67]
    buffer_load_dwordx4 a[132:135], v226, s[36:39], s53 offen offset:1024 sc1
    v_mfma_f32_16x16x32_bf16 v[120:123], a[168:171], a[56:59], v[120:123]
    ds_read_b64_tr_b16 a[186:187], v227 offset:39616
    v_mfma_f32_16x16x32_bf16 v[176:179], a[168:171], a[60:63], v[176:179]
    s_waitcnt lgkmcnt(6)
    v_mfma_f32_16x16x32_bf16 v[12:15], a[172:175], a[48:51], v[12:15]
    ds_read_b64_tr_b16 a[160:161], v227 offset:50176
    v_mfma_f32_16x16x32_bf16 v[68:71], a[172:175], a[52:55], v[68:71]
    v_mfma_f32_16x16x32_bf16 v[124:127], a[172:175], a[56:59], v[124:127]
    ds_read_b64_tr_b16 a[162:163], v227 offset:53760
    v_mfma_f32_16x16x32_bf16 v[180:183], a[172:175], a[60:63], v[180:183]
    s_waitcnt lgkmcnt(6)
    v_mfma_f32_16x16x32_bf16 v[16:19], a[176:179], a[48:51], v[16:19]
    ds_read_b64_tr_b16 a[164:165], v227 offset:50208
    v_mfma_f32_16x16x32_bf16 v[72:75], a[176:179], a[52:55], v[72:75]
    v_mfma_f32_16x16x32_bf16 v[128:131], a[176:179], a[56:59], v[128:131]
    ds_read_b64_tr_b16 a[166:167], v227 offset:53792
    v_mfma_f32_16x16x32_bf16 v[184:187], a[176:179], a[60:63], v[184:187]
    s_waitcnt lgkmcnt(6)
    v_mfma_f32_16x16x32_bf16 v[20:23], a[180:183], a[48:51], v[20:23]
    ds_read_b64_tr_b16 a[168:169], v227 offset:50240
    v_mfma_f32_16x16x32_bf16 v[76:79], a[180:183], a[52:55], v[76:79]
    buffer_load_dwordx4 v233, s[32:35], s52 offen offset:3072 lds
    v_mfma_f32_16x16x32_bf16 v[132:135], a[180:183], a[56:59], v[132:135]
    ds_read_b64_tr_b16 a[170:171], v227 offset:53824
    v_mfma_f32_16x16x32_bf16 v[188:191], a[180:183], a[60:63], v[188:191]
    s_waitcnt lgkmcnt(6)
    v_mfma_f32_16x16x32_bf16 v[24:27], a[184:187], a[48:51], v[24:27]
    ds_read_b64_tr_b16 a[172:173], v227 offset:50272
    v_mfma_f32_16x16x32_bf16 v[80:83], a[184:187], a[52:55], v[80:83]
    buffer_load_dwordx4 a[136:139], v226, s[40:43], s53 offen offset:0 sc1
    v_mfma_f32_16x16x32_bf16 v[136:139], a[184:187], a[56:59], v[136:139]
    ds_read_b64_tr_b16 a[174:175], v227 offset:53856
    v_mfma_f32_16x16x32_bf16 v[192:195], a[184:187], a[60:63], v[192:195]
    s_waitcnt lgkmcnt(6)
    v_mfma_f32_16x16x32_bf16 v[28:31], a[160:163], a[48:51], v[28:31]
    ds_read_b64_tr_b16 a[176:177], v227 offset:50304
    v_mfma_f32_16x16x32_bf16 v[84:87], a[160:163], a[52:55], v[84:87]
    v_mfma_f32_16x16x32_bf16 v[140:143], a[160:163], a[56:59], v[140:143]
    ds_read_b64_tr_b16 a[178:179], v227 offset:53888
    v_mfma_f32_16x16x32_bf16 v[196:199], a[160:163], a[60:63], v[196:199]
    s_waitcnt lgkmcnt(6)
    v_mfma_f32_16x16x32_bf16 v[32:35], a[164:167], a[48:51], v[32:35]
    ds_read_b64_tr_b16 a[180:181], v227 offset:50336
    v_mfma_f32_16x16x32_bf16 v[88:91], a[164:167], a[52:55], v[88:91]
    buffer_load_dwordx4 a[140:143], v226, s[40:43], s53 offen offset:1024 sc1
    v_mfma_f32_16x16x32_bf16 v[144:147], a[164:167], a[56:59], v[144:147]
    ds_read_b64_tr_b16 a[182:183], v227 offset:53920
    v_mfma_f32_16x16x32_bf16 v[200:203], a[164:167], a[60:63], v[200:203]
    s_waitcnt lgkmcnt(6)
    v_mfma_f32_16x16x32_bf16 v[36:39], a[168:171], a[48:51], v[36:39]
    s_add_u32 m0, s3, 118784
    ds_read_b64_tr_b16 a[184:185], v227 offset:50368
    v_mfma_f32_16x16x32_bf16 v[92:95], a[168:171], a[52:55], v[92:95]
    buffer_load_dwordx4 v234, s[32:35], s52 offen offset:0 lds
    v_mfma_f32_16x16x32_bf16 v[148:151], a[168:171], a[56:59], v[148:151]
    ds_read_b64_tr_b16 a[186:187], v227 offset:53952
    v_mfma_f32_16x16x32_bf16 v[204:207], a[168:171], a[60:63], v[204:207]
    s_waitcnt vmcnt(28) lgkmcnt(6)
    s_barrier
    v_mfma_f32_16x16x32_bf16 v[40:43], a[172:175], a[48:51], v[40:43]
    ds_read_b64_tr_b16 a[160:161], v228 offset:0
    v_mfma_f32_16x16x32_bf16 v[96:99], a[172:175], a[52:55], v[96:99]
    v_mfma_f32_16x16x32_bf16 v[152:155], a[172:175], a[56:59], v[152:155]
    ds_read_b64_tr_b16 a[162:163], v228 offset:3584
    v_mfma_f32_16x16x32_bf16 v[208:211], a[172:175], a[60:63], v[208:211]
    s_waitcnt lgkmcnt(6)
    v_mfma_f32_16x16x32_bf16 v[44:47], a[176:179], a[48:51], v[44:47]
    s_add_u32 s61, s63, 6291456
    ds_read_b64_tr_b16 a[164:165], v228 offset:32
    v_mfma_f32_16x16x32_bf16 v[100:103], a[176:179], a[52:55], v[100:103]
    buffer_load_dword v238, v237, s[96:99], s61 offen
    v_mfma_f32_16x16x32_bf16 v[156:159], a[176:179], a[56:59], v[156:159]
    ds_read_b64_tr_b16 a[166:167], v228 offset:3616
    v_mfma_f32_16x16x32_bf16 v[212:215], a[176:179], a[60:63], v[212:215]
    s_waitcnt lgkmcnt(6)
    v_mfma_f32_16x16x32_bf16 v[48:51], a[180:183], a[48:51], v[48:51]
    ds_read_b64_tr_b16 a[168:169], v228 offset:64
    v_mfma_f32_16x16x32_bf16 v[104:107], a[180:183], a[52:55], v[104:107]
    buffer_load_dwordx4 a[144:147], v226, s[36:39], s53 offen offset:2048 sc1
    v_mfma_f32_16x16x32_bf16 v[160:163], a[180:183], a[56:59], v[160:163]
    ds_read_b64_tr_b16 a[170:171], v228 offset:3648
    v_mfma_f32_16x16x32_bf16 v[216:219], a[180:183], a[60:63], v[216:219]
    s_waitcnt lgkmcnt(6)
    v_mfma_f32_16x16x32_bf16 v[52:55], a[184:187], a[48:51], v[52:55]
    ds_read_b64_tr_b16 a[172:173], v228 offset:96
    v_mfma_f32_16x16x32_bf16 v[108:111], a[184:187], a[52:55], v[108:111]
    buffer_load_dwordx4 v235, s[32:35], s52 offen offset:1024 lds
    v_mfma_f32_16x16x32_bf16 v[164:167], a[184:187], a[56:59], v[164:167]
    ds_read_b64_tr_b16 a[174:175], v228 offset:3680
    v_mfma_f32_16x16x32_bf16 v[220:223], a[184:187], a[60:63], v[220:223]
    s_waitcnt lgkmcnt(6)
    v_mfma_f32_16x16x32_bf16 v[0:3], a[160:163], a[64:67], v[0:3]
    ds_read_b64_tr_b16 a[176:177], v228 offset:128
    v_mfma_f32_16x16x32_bf16 v[56:59], a[160:163], a[68:71], v[56:59]
    v_mfma_f32_16x16x32_bf16 v[112:115], a[160:163], a[72:75], v[112:115]
    ds_read_b64_tr_b16 a[178:179], v228 offset:3712
    v_mfma_f32_16x16x32_bf16 v[168:171], a[160:163], a[76:79], v[168:171]
    s_waitcnt lgkmcnt(6)
    v_mfma_f32_16x16x32_bf16 v[4:7], a[164:167], a[64:67], v[4:7]
    ds_read_b64_tr_b16 a[180:181], v228 offset:160
    v_mfma_f32_16x16x32_bf16 v[60:63], a[164:167], a[68:71], v[60:63]
    buffer_load_dwordx4 a[148:151], v226, s[36:39], s53 offen offset:3072 sc1
    v_mfma_f32_16x16x32_bf16 v[116:119], a[164:167], a[72:75], v[116:119]
    ds_read_b64_tr_b16 a[182:183], v228 offset:3744
    v_mfma_f32_16x16x32_bf16 v[172:175], a[164:167], a[76:79], v[172:175]
    s_waitcnt lgkmcnt(6)
    v_mfma_f32_16x16x32_bf16 v[8:11], a[168:171], a[64:67], v[8:11]
    ds_read_b64_tr_b16 a[184:185], v228 offset:192
    v_mfma_f32_16x16x32_bf16 v[64:67], a[168:171], a[68:71], v[64:67]
    buffer_load_dwordx4 v236, s[32:35], s52 offen offset:2048 lds
    v_mfma_f32_16x16x32_bf16 v[120:123], a[168:171], a[72:75], v[120:123]
    ds_read_b64_tr_b16 a[186:187], v228 offset:3776
    v_mfma_f32_16x16x32_bf16 v[176:179], a[168:171], a[76:79], v[176:179]
    s_waitcnt lgkmcnt(6)
    v_mfma_f32_16x16x32_bf16 v[12:15], a[172:175], a[64:67], v[12:15]
    ds_read_b64_tr_b16 a[160:161], v228 offset:14336
    v_mfma_f32_16x16x32_bf16 v[68:71], a[172:175], a[68:71], v[68:71]
    v_mfma_f32_16x16x32_bf16 v[124:127], a[172:175], a[72:75], v[124:127]
    ds_read_b64_tr_b16 a[162:163], v228 offset:17920
    v_mfma_f32_16x16x32_bf16 v[180:183], a[172:175], a[76:79], v[180:183]
    s_waitcnt lgkmcnt(6)
    v_mfma_f32_16x16x32_bf16 v[16:19], a[176:179], a[64:67], v[16:19]
    ds_read_b64_tr_b16 a[164:165], v228 offset:14368
    v_mfma_f32_16x16x32_bf16 v[72:75], a[176:179], a[68:71], v[72:75]
    v_mfma_f32_16x16x32_bf16 v[128:131], a[176:179], a[72:75], v[128:131]
    ds_read_b64_tr_b16 a[166:167], v228 offset:17952
    v_mfma_f32_16x16x32_bf16 v[184:187], a[176:179], a[76:79], v[184:187]
    s_waitcnt lgkmcnt(6)
    v_mfma_f32_16x16x32_bf16 v[20:23], a[180:183], a[64:67], v[20:23]
    ds_read_b64_tr_b16 a[168:169], v228 offset:14400
    v_mfma_f32_16x16x32_bf16 v[76:79], a[180:183], a[68:71], v[76:79]
    buffer_load_dwordx4 a[152:155], v226, s[40:43], s53 offen offset:2048 sc1
    v_mfma_f32_16x16x32_bf16 v[132:135], a[180:183], a[72:75], v[132:135]
    s_mov_b32 s52, 6881280
    ds_read_b64_tr_b16 a[170:171], v228 offset:17984
    v_mfma_f32_16x16x32_bf16 v[188:191], a[180:183], a[76:79], v[188:191]
    s_waitcnt lgkmcnt(6)
    v_mfma_f32_16x16x32_bf16 v[24:27], a[184:187], a[64:67], v[24:27]
    s_add_u32 m0, s3, 0
    ds_read_b64_tr_b16 a[172:173], v228 offset:14432
    v_mfma_f32_16x16x32_bf16 v[80:83], a[184:187], a[68:71], v[80:83]
    buffer_load_dwordx4 v230, s[32:35], s52 offen offset:0 lds
    v_mfma_f32_16x16x32_bf16 v[136:139], a[184:187], a[72:75], v[136:139]
    ds_read_b64_tr_b16 a[174:175], v228 offset:18016
    v_mfma_f32_16x16x32_bf16 v[192:195], a[184:187], a[76:79], v[192:195]
    s_waitcnt lgkmcnt(6)
    v_mfma_f32_16x16x32_bf16 v[28:31], a[160:163], a[64:67], v[28:31]
    ds_read_b64_tr_b16 a[176:177], v228 offset:14464
    v_mfma_f32_16x16x32_bf16 v[84:87], a[160:163], a[68:71], v[84:87]
    v_mfma_f32_16x16x32_bf16 v[140:143], a[160:163], a[72:75], v[140:143]
    ds_read_b64_tr_b16 a[178:179], v228 offset:18048
    v_mfma_f32_16x16x32_bf16 v[196:199], a[160:163], a[76:79], v[196:199]
    s_waitcnt lgkmcnt(6)
    v_mfma_f32_16x16x32_bf16 v[32:35], a[164:167], a[64:67], v[32:35]
    ds_read_b64_tr_b16 a[180:181], v228 offset:14496
    v_mfma_f32_16x16x32_bf16 v[88:91], a[164:167], a[68:71], v[88:91]
    buffer_load_dwordx4 a[156:159], v226, s[40:43], s53 offen offset:3072 sc1
    v_mfma_f32_16x16x32_bf16 v[144:147], a[164:167], a[72:75], v[144:147]
    ds_read_b64_tr_b16 a[182:183], v228 offset:18080
    v_mfma_f32_16x16x32_bf16 v[200:203], a[164:167], a[76:79], v[200:203]
    s_waitcnt lgkmcnt(6)
    v_mfma_f32_16x16x32_bf16 v[36:39], a[168:171], a[64:67], v[36:39]
    ds_read_b64_tr_b16 a[184:185], v228 offset:14528
    v_mfma_f32_16x16x32_bf16 v[92:95], a[168:171], a[68:71], v[92:95]
    v_mfma_f32_16x16x32_bf16 v[148:151], a[168:171], a[72:75], v[148:151]
    ds_read_b64_tr_b16 a[186:187], v228 offset:18112
    v_mfma_f32_16x16x32_bf16 v[204:207], a[168:171], a[76:79], v[204:207]
    s_waitcnt lgkmcnt(6)
    v_mfma_f32_16x16x32_bf16 v[40:43], a[172:175], a[64:67], v[40:43]
    ds_read_b64_tr_b16 a[160:161], v228 offset:7168
    v_mfma_f32_16x16x32_bf16 v[96:99], a[172:175], a[68:71], v[96:99]
    buffer_load_dwordx4 v231, s[32:35], s52 offen offset:1024 lds
    v_mfma_f32_16x16x32_bf16 v[152:155], a[172:175], a[72:75], v[152:155]
    ds_read_b64_tr_b16 a[162:163], v228 offset:10752
    v_mfma_f32_16x16x32_bf16 v[208:211], a[172:175], a[76:79], v[208:211]
    s_waitcnt lgkmcnt(6)
    v_mfma_f32_16x16x32_bf16 v[44:47], a[176:179], a[64:67], v[44:47]
    ds_read_b64_tr_b16 a[164:165], v228 offset:7200
    v_mfma_f32_16x16x32_bf16 v[100:103], a[176:179], a[68:71], v[100:103]
    v_mfma_f32_16x16x32_bf16 v[156:159], a[176:179], a[72:75], v[156:159]
    ds_read_b64_tr_b16 a[166:167], v228 offset:10784
    v_mfma_f32_16x16x32_bf16 v[212:215], a[176:179], a[76:79], v[212:215]
    s_waitcnt lgkmcnt(6)
    v_mfma_f32_16x16x32_bf16 v[48:51], a[180:183], a[64:67], v[48:51]
    s_mov_b32 s53, 61440
    ds_read_b64_tr_b16 a[168:169], v228 offset:7232
    v_mfma_f32_16x16x32_bf16 v[104:107], a[180:183], a[68:71], v[104:107]
    buffer_load_dwordx4 a[0:3], v226, s[36:39], s53 offen offset:0 sc1
    v_mfma_f32_16x16x32_bf16 v[160:163], a[180:183], a[72:75], v[160:163]
    ds_read_b64_tr_b16 a[170:171], v228 offset:10816
    v_mfma_f32_16x16x32_bf16 v[216:219], a[180:183], a[76:79], v[216:219]
    s_waitcnt lgkmcnt(6)
    v_mfma_f32_16x16x32_bf16 v[52:55], a[184:187], a[64:67], v[52:55]
    ds_read_b64_tr_b16 a[172:173], v228 offset:7264
    v_mfma_f32_16x16x32_bf16 v[108:111], a[184:187], a[68:71], v[108:111]
    v_mfma_f32_16x16x32_bf16 v[164:167], a[184:187], a[72:75], v[164:167]
    ds_read_b64_tr_b16 a[174:175], v228 offset:10848
    v_mfma_f32_16x16x32_bf16 v[220:223], a[184:187], a[76:79], v[220:223]
    s_waitcnt vmcnt(35) lgkmcnt(6)
    v_mfma_f32_16x16x32_bf16 v[0:3], a[160:163], a[80:83], v[0:3]
    s_add_u32 s61, s63, 7077888
    ds_read_b64_tr_b16 a[176:177], v228 offset:7296
    v_mfma_f32_16x16x32_bf16 v[56:59], a[160:163], a[84:87], v[56:59]
    buffer_load_dword v238, v237, s[96:99], s61 offen
    v_mfma_f32_16x16x32_bf16 v[112:115], a[160:163], a[88:91], v[112:115]
    ds_read_b64_tr_b16 a[178:179], v228 offset:10880
    v_mfma_f32_16x16x32_bf16 v[168:171], a[160:163], a[92:95], v[168:171]
    s_waitcnt lgkmcnt(6)
    v_mfma_f32_16x16x32_bf16 v[4:7], a[164:167], a[80:83], v[4:7]
    ds_read_b64_tr_b16 a[180:181], v228 offset:7328
    v_mfma_f32_16x16x32_bf16 v[60:63], a[164:167], a[84:87], v[60:63]
    buffer_load_dwordx4 v232, s[32:35], s52 offen offset:2048 lds
    v_mfma_f32_16x16x32_bf16 v[116:119], a[164:167], a[88:91], v[116:119]
    ds_read_b64_tr_b16 a[182:183], v228 offset:10912
    v_mfma_f32_16x16x32_bf16 v[172:175], a[164:167], a[92:95], v[172:175]
    s_waitcnt lgkmcnt(6)
    v_mfma_f32_16x16x32_bf16 v[8:11], a[168:171], a[80:83], v[8:11]
    ds_read_b64_tr_b16 a[184:185], v228 offset:7360
    v_mfma_f32_16x16x32_bf16 v[64:67], a[168:171], a[84:87], v[64:67]
    buffer_load_dwordx4 a[4:7], v226, s[36:39], s53 offen offset:1024 sc1
    v_mfma_f32_16x16x32_bf16 v[120:123], a[168:171], a[88:91], v[120:123]
    ds_read_b64_tr_b16 a[186:187], v228 offset:10944
    v_mfma_f32_16x16x32_bf16 v[176:179], a[168:171], a[92:95], v[176:179]
    s_waitcnt lgkmcnt(6)
    v_mfma_f32_16x16x32_bf16 v[12:15], a[172:175], a[80:83], v[12:15]
    ds_read_b64_tr_b16 a[160:161], v228 offset:21504
    v_mfma_f32_16x16x32_bf16 v[68:71], a[172:175], a[84:87], v[68:71]
    v_mfma_f32_16x16x32_bf16 v[124:127], a[172:175], a[88:91], v[124:127]
    ds_read_b64_tr_b16 a[162:163], v228 offset:25088
    v_mfma_f32_16x16x32_bf16 v[180:183], a[172:175], a[92:95], v[180:183]
    s_waitcnt lgkmcnt(6)
    v_mfma_f32_16x16x32_bf16 v[16:19], a[176:179], a[80:83], v[16:19]
    ds_read_b64_tr_b16 a[164:165], v228 offset:21536
    v_mfma_f32_16x16x32_bf16 v[72:75], a[176:179], a[84:87], v[72:75]
    buffer_load_dwordx4 v233, s[32:35], s52 offen offset:3072 lds
    v_mfma_f32_16x16x32_bf16 v[128:131], a[176:179], a[88:91], v[128:131]
    ds_read_b64_tr_b16 a[166:167], v228 offset:25120
    v_mfma_f32_16x16x32_bf16 v[184:187], a[176:179], a[92:95], v[184:187]
    s_waitcnt lgkmcnt(6)
    v_mfma_f32_16x16x32_bf16 v[20:23], a[180:183], a[80:83], v[20:23]
    ds_read_b64_tr_b16 a[168:169], v228 offset:21568
    v_mfma_f32_16x16x32_bf16 v[76:79], a[180:183], a[84:87], v[76:79]
    buffer_load_dwordx4 a[8:11], v226, s[40:43], s53 offen offset:0 sc1
    v_mfma_f32_16x16x32_bf16 v[132:135], a[180:183], a[88:91], v[132:135]
    ds_read_b64_tr_b16 a[170:171], v228 offset:25152
    v_mfma_f32_16x16x32_bf16 v[188:191], a[180:183], a[92:95], v[188:191]
    s_waitcnt lgkmcnt(6)
    v_mfma_f32_16x16x32_bf16 v[24:27], a[184:187], a[80:83], v[24:27]
    ds_read_b64_tr_b16 a[172:173], v228 offset:21600
    v_mfma_f32_16x16x32_bf16 v[80:83], a[184:187], a[84:87], v[80:83]
    v_mfma_f32_16x16x32_bf16 v[136:139], a[184:187], a[88:91], v[136:139]
    ds_read_b64_tr_b16 a[174:175], v228 offset:25184
    v_mfma_f32_16x16x32_bf16 v[192:195], a[184:187], a[92:95], v[192:195]
    s_waitcnt lgkmcnt(6)
    v_mfma_f32_16x16x32_bf16 v[28:31], a[160:163], a[80:83], v[28:31]
    ds_read_b64_tr_b16 a[176:177], v228 offset:21632
    v_mfma_f32_16x16x32_bf16 v[84:87], a[160:163], a[84:87], v[84:87]
    v_mfma_f32_16x16x32_bf16 v[140:143], a[160:163], a[88:91], v[140:143]
    ds_read_b64_tr_b16 a[178:179], v228 offset:25216
    v_mfma_f32_16x16x32_bf16 v[196:199], a[160:163], a[92:95], v[196:199]
    s_waitcnt lgkmcnt(6)
    v_mfma_f32_16x16x32_bf16 v[32:35], a[164:167], a[80:83], v[32:35]
    s_add_u32 m0, s3, 4096
    ds_read_b64_tr_b16 a[180:181], v228 offset:21664
    v_mfma_f32_16x16x32_bf16 v[88:91], a[164:167], a[84:87], v[88:91]
    buffer_load_dwordx4 v234, s[32:35], s52 offen offset:0 lds
    v_mfma_f32_16x16x32_bf16 v[144:147], a[164:167], a[88:91], v[144:147]
    ds_read_b64_tr_b16 a[182:183], v228 offset:25248
    v_mfma_f32_16x16x32_bf16 v[200:203], a[164:167], a[92:95], v[200:203]
    s_waitcnt lgkmcnt(6)
    v_mfma_f32_16x16x32_bf16 v[36:39], a[168:171], a[80:83], v[36:39]
Lpad_13:
    s_cbranch_execz Lback_a
    ds_read_b64_tr_b16 a[184:185], v228 offset:21696
    v_mfma_f32_16x16x32_bf16 v[92:95], a[168:171], a[84:87], v[92:95]
    buffer_load_dwordx4 a[12:15], v226, s[40:43], s53 offen offset:1024 sc1
    v_mfma_f32_16x16x32_bf16 v[148:151], a[168:171], a[88:91], v[148:151]
    ds_read_b64_tr_b16 a[186:187], v228 offset:25280
    v_mfma_f32_16x16x32_bf16 v[204:207], a[168:171], a[92:95], v[204:207]
    s_waitcnt vmcnt(29) lgkmcnt(6)
    s_barrier
    v_mfma_f32_16x16x32_bf16 v[40:43], a[172:175], a[80:83], v[40:43]
    ds_read_b64_tr_b16 a[160:161], v228 offset:28672
    v_mfma_f32_16x16x32_bf16 v[96:99], a[172:175], a[84:87], v[96:99]
    v_mfma_f32_16x16x32_bf16 v[152:155], a[172:175], a[88:91], v[152:155]
    ds_read_b64_tr_b16 a[162:163], v228 offset:32256
    v_mfma_f32_16x16x32_bf16 v[208:211], a[172:175], a[92:95], v[208:211]
    s_waitcnt lgkmcnt(6)
    v_mfma_f32_16x16x32_bf16 v[44:47], a[176:179], a[80:83], v[44:47]
    ds_read_b64_tr_b16 a[164:165], v228 offset:28704
    v_mfma_f32_16x16x32_bf16 v[100:103], a[176:179], a[84:87], v[100:103]
    v_mfma_f32_16x16x32_bf16 v[156:159], a[176:179], a[88:91], v[156:159]
    ds_read_b64_tr_b16 a[166:167], v228 offset:32288
    v_mfma_f32_16x16x32_bf16 v[212:215], a[176:179], a[92:95], v[212:215]
    s_waitcnt lgkmcnt(6)
    v_mfma_f32_16x16x32_bf16 v[48:51], a[180:183], a[80:83], v[48:51]
    ds_read_b64_tr_b16 a[168:169], v228 offset:28736
    v_mfma_f32_16x16x32_bf16 v[104:107], a[180:183], a[84:87], v[104:107]
    buffer_load_dwordx4 a[16:19], v226, s[36:39], s53 offen offset:2048 sc1
    v_mfma_f32_16x16x32_bf16 v[160:163], a[180:183], a[88:91], v[160:163]
    ds_read_b64_tr_b16 a[170:171], v228 offset:32320
    v_mfma_f32_16x16x32_bf16 v[216:219], a[180:183], a[92:95], v[216:219]
    s_waitcnt lgkmcnt(6)
    v_mfma_f32_16x16x32_bf16 v[52:55], a[184:187], a[80:83], v[52:55]
    ds_read_b64_tr_b16 a[172:173], v228 offset:28768
    v_mfma_f32_16x16x32_bf16 v[108:111], a[184:187], a[84:87], v[108:111]
    buffer_load_dwordx4 v235, s[32:35], s52 offen offset:1024 lds
    v_mfma_f32_16x16x32_bf16 v[164:167], a[184:187], a[88:91], v[164:167]
    ds_read_b64_tr_b16 a[174:175], v228 offset:32352
    v_mfma_f32_16x16x32_bf16 v[220:223], a[184:187], a[92:95], v[220:223]
    s_waitcnt lgkmcnt(6)
    v_mfma_f32_16x16x32_bf16 v[0:3], a[160:163], a[96:99], v[0:3]
    ds_read_b64_tr_b16 a[176:177], v228 offset:28800
    v_mfma_f32_16x16x32_bf16 v[56:59], a[160:163], a[100:103], v[56:59]
    v_mfma_f32_16x16x32_bf16 v[112:115], a[160:163], a[104:107], v[112:115]
    ds_read_b64_tr_b16 a[178:179], v228 offset:32384
    v_mfma_f32_16x16x32_bf16 v[168:171], a[160:163], a[108:111], v[168:171]
    s_waitcnt lgkmcnt(6)
    v_mfma_f32_16x16x32_bf16 v[4:7], a[164:167], a[96:99], v[4:7]
    ds_read_b64_tr_b16 a[180:181], v228 offset:28832
    v_mfma_f32_16x16x32_bf16 v[60:63], a[164:167], a[100:103], v[60:63]
    buffer_load_dwordx4 a[20:23], v226, s[36:39], s53 offen offset:3072 sc1
    v_mfma_f32_16x16x32_bf16 v[116:119], a[164:167], a[104:107], v[116:119]
    ds_read_b64_tr_b16 a[182:183], v228 offset:32416
    v_mfma_f32_16x16x32_bf16 v[172:175], a[164:167], a[108:111], v[172:175]
    s_waitcnt lgkmcnt(6)
    v_mfma_f32_16x16x32_bf16 v[8:11], a[168:171], a[96:99], v[8:11]
    ds_read_b64_tr_b16 a[184:185], v228 offset:28864
    v_mfma_f32_16x16x32_bf16 v[64:67], a[168:171], a[100:103], v[64:67]
    buffer_load_dwordx4 v236, s[32:35], s52 offen offset:2048 lds
    v_mfma_f32_16x16x32_bf16 v[120:123], a[168:171], a[104:107], v[120:123]
    ds_read_b64_tr_b16 a[186:187], v228 offset:32448
    v_mfma_f32_16x16x32_bf16 v[176:179], a[168:171], a[108:111], v[176:179]
    s_waitcnt lgkmcnt(6)
    v_mfma_f32_16x16x32_bf16 v[12:15], a[172:175], a[96:99], v[12:15]
    ds_read_b64_tr_b16 a[160:161], v228 offset:43008
    v_lshrrev_b32 v252, 3, v225
    v_mfma_f32_16x16x32_bf16 v[68:71], a[172:175], a[100:103], v[68:71]
    v_mul_u32_u24 v230, 2048, v252
    v_lshrrev_b32 v252, 3, v225
    v_mfma_f32_16x16x32_bf16 v[124:127], a[172:175], a[104:107], v[124:127]
    ds_read_b64_tr_b16 a[162:163], v228 offset:46592
    v_and_b32 v252, 6, v252
    v_mfma_f32_16x16x32_bf16 v[180:183], a[172:175], a[108:111], v[180:183]
    s_waitcnt lgkmcnt(6)
    v_and_b32 v253, 7, v225
    v_xor_b32 v252, v252, v253
    v_mfma_f32_16x16x32_bf16 v[16:19], a[176:179], a[96:99], v[16:19]
    ds_read_b64_tr_b16 a[164:165], v228 offset:43040
    v_lshl_add_u32 v230, v252, 4, v230
    v_mfma_f32_16x16x32_bf16 v[72:75], a[176:179], a[100:103], v[72:75]
    s_lshl_b32 s68, s24, 15
    s_and_b32 s69, s26, 1
    s_lshl_b32 s69, s69, 7
    v_mfma_f32_16x16x32_bf16 v[128:131], a[176:179], a[104:107], v[128:131]
    s_add_u32 s68, s68, s69
    ds_read_b64_tr_b16 a[166:167], v228 offset:46624
    v_add_u32 v230, s68, v230
    v_mfma_f32_16x16x32_bf16 v[184:187], a[176:179], a[108:111], v[184:187]
    s_waitcnt lgkmcnt(6)
    v_add_u32 v231, 15360, v230
    v_xor_b32 v232, 128, v230
    v_mfma_f32_16x16x32_bf16 v[20:23], a[180:183], a[96:99], v[20:23]
    ds_read_b64_tr_b16 a[168:169], v228 offset:43072
    v_xor_b32 v233, 128, v231
    v_mfma_f32_16x16x32_bf16 v[76:79], a[180:183], a[100:103], v[76:79]
    buffer_load_dwordx4 a[24:27], v226, s[40:43], s53 offen offset:2048 sc1
    v_mfma_f32_16x16x32_bf16 v[132:135], a[180:183], a[104:107], v[132:135]
    s_lshl_b32 s29, s24, 12
    ds_read_b64_tr_b16 a[170:171], v228 offset:46656
    v_mfma_f32_16x16x32_bf16 v[188:191], a[180:183], a[108:111], v[188:191]
    s_waitcnt lgkmcnt(6)
    s_mul_i32 s69, s69, 28672
    s_lshr_b32 s68, s26, 1
    v_mfma_f32_16x16x32_bf16 v[24:27], a[184:187], a[96:99], v[24:27]
    s_lshl_b32 s68, s68, 8
    ds_read_b64_tr_b16 a[172:173], v228 offset:43104
    v_mfma_f32_16x16x32_bf16 v[80:83], a[184:187], a[100:103], v[80:83]
    s_add_u32 s69, s69, s68
    s_sub_u32 s34, 7340032, s69
    s_mov_b32 s98, s34
    v_mfma_f32_16x16x32_bf16 v[136:139], a[184:187], a[104:107], v[136:139]
    s_and_b32 s68, s26, 7
    ds_read_b64_tr_b16 a[174:175], v228 offset:46688
    v_mfma_f32_16x16x32_bf16 v[192:195], a[184:187], a[108:111], v[192:195]
    s_waitcnt lgkmcnt(6)
    s_add_u32 s32, s22, 67108992
    s_addc_u32 s33, s23, 0
    s_cmp_eq_u32 s68, 9
    s_cselect_b32 s32, s32, s16
    s_cselect_b32 s33, s33, s17
    s_add_u32 s32, s32, s69
    s_addc_u32 s33, s33, 0
    s_add_u32 s96, s22, 67108992
    s_addc_u32 s97, s23, 0
    s_cmp_eq_u32 s68, 9
    s_cselect_b32 s96, s96, s16
    s_cselect_b32 s97, s97, s17
    s_add_u32 s96, s96, s69
    s_addc_u32 s97, s97, 0
    v_mfma_f32_16x16x32_bf16 v[28:31], a[160:163], a[96:99], v[28:31]
    ds_read_b64_tr_b16 a[176:177], v228 offset:43136
    v_mfma_f32_16x16x32_bf16 v[84:87], a[160:163], a[100:103], v[84:87]
    v_mfma_f32_16x16x32_bf16 v[140:143], a[160:163], a[104:107], v[140:143]
    ds_read_b64_tr_b16 a[178:179], v228 offset:46720
    v_mfma_f32_16x16x32_bf16 v[196:199], a[160:163], a[108:111], v[196:199]
    s_waitcnt lgkmcnt(6)
    v_mfma_f32_16x16x32_bf16 v[32:35], a[164:167], a[96:99], v[32:35]
    ds_read_b64_tr_b16 a[180:181], v228 offset:43168
    v_mfma_f32_16x16x32_bf16 v[88:91], a[164:167], a[100:103], v[88:91]
    buffer_load_dwordx4 a[28:31], v226, s[40:43], s53 offen offset:3072 sc1
    v_mfma_f32_16x16x32_bf16 v[144:147], a[164:167], a[104:107], v[144:147]
    ds_read_b64_tr_b16 a[182:183], v228 offset:46752
    v_mfma_f32_16x16x32_bf16 v[200:203], a[164:167], a[108:111], v[200:203]
    s_waitcnt lgkmcnt(6)
    v_mfma_f32_16x16x32_bf16 v[36:39], a[168:171], a[96:99], v[36:39]
    ds_read_b64_tr_b16 a[184:185], v228 offset:43200
    v_mfma_f32_16x16x32_bf16 v[92:95], a[168:171], a[100:103], v[92:95]
    v_mfma_f32_16x16x32_bf16 v[148:151], a[168:171], a[104:107], v[148:151]
    ds_read_b64_tr_b16 a[186:187], v228 offset:46784
    v_mfma_f32_16x16x32_bf16 v[204:207], a[168:171], a[108:111], v[204:207]
    s_waitcnt lgkmcnt(6)
    v_mfma_f32_16x16x32_bf16 v[40:43], a[172:175], a[96:99], v[40:43]
    ds_read_b64_tr_b16 a[160:161], v228 offset:35840
    v_mfma_f32_16x16x32_bf16 v[96:99], a[172:175], a[100:103], v[96:99]
    v_mfma_f32_16x16x32_bf16 v[152:155], a[172:175], a[104:107], v[152:155]
    ds_read_b64_tr_b16 a[162:163], v228 offset:39424
    v_mfma_f32_16x16x32_bf16 v[208:211], a[172:175], a[108:111], v[208:211]
    s_waitcnt lgkmcnt(6)
    v_mfma_f32_16x16x32_bf16 v[44:47], a[176:179], a[96:99], v[44:47]
    ds_read_b64_tr_b16 a[164:165], v228 offset:35872
    v_mfma_f32_16x16x32_bf16 v[100:103], a[176:179], a[100:103], v[100:103]
    v_mfma_f32_16x16x32_bf16 v[156:159], a[176:179], a[104:107], v[156:159]
    ds_read_b64_tr_b16 a[166:167], v228 offset:39456
    v_mfma_f32_16x16x32_bf16 v[212:215], a[176:179], a[108:111], v[212:215]
    s_waitcnt lgkmcnt(6)
    v_mfma_f32_16x16x32_bf16 v[48:51], a[180:183], a[96:99], v[48:51]
    ds_read_b64_tr_b16 a[168:169], v228 offset:35904
    v_mfma_f32_16x16x32_bf16 v[104:107], a[180:183], a[100:103], v[104:107]
    v_mfma_f32_16x16x32_bf16 v[160:163], a[180:183], a[104:107], v[160:163]
    ds_read_b64_tr_b16 a[170:171], v228 offset:39488
    v_mfma_f32_16x16x32_bf16 v[216:219], a[180:183], a[108:111], v[216:219]
    s_waitcnt lgkmcnt(6)
    v_mfma_f32_16x16x32_bf16 v[52:55], a[184:187], a[96:99], v[52:55]
    ds_read_b64_tr_b16 a[172:173], v228 offset:35936
    v_mfma_f32_16x16x32_bf16 v[108:111], a[184:187], a[100:103], v[108:111]
    v_mfma_f32_16x16x32_bf16 v[164:167], a[184:187], a[104:107], v[164:167]
    ds_read_b64_tr_b16 a[174:175], v228 offset:39520
    v_mfma_f32_16x16x32_bf16 v[220:223], a[184:187], a[108:111], v[220:223]
    s_waitcnt vmcnt(32) lgkmcnt(6)
    v_mfma_f32_16x16x32_bf16 v[0:3], a[160:163], a[112:115], v[0:3]
    ds_read_b64_tr_b16 a[176:177], v228 offset:35968
    v_mfma_f32_16x16x32_bf16 v[56:59], a[160:163], a[116:119], v[56:59]
    v_mfma_f32_16x16x32_bf16 v[112:115], a[160:163], a[120:123], v[112:115]
    ds_read_b64_tr_b16 a[178:179], v228 offset:39552
    v_mfma_f32_16x16x32_bf16 v[168:171], a[160:163], a[124:127], v[168:171]
    s_waitcnt lgkmcnt(6)
    v_mfma_f32_16x16x32_bf16 v[4:7], a[164:167], a[112:115], v[4:7]
    ds_read_b64_tr_b16 a[180:181], v228 offset:36000
    v_mfma_f32_16x16x32_bf16 v[60:63], a[164:167], a[116:119], v[60:63]
    v_mfma_f32_16x16x32_bf16 v[116:119], a[164:167], a[120:123], v[116:119]
    ds_read_b64_tr_b16 a[182:183], v228 offset:39584
    v_mfma_f32_16x16x32_bf16 v[172:175], a[164:167], a[124:127], v[172:175]
    s_waitcnt lgkmcnt(6)
    v_mfma_f32_16x16x32_bf16 v[8:11], a[168:171], a[112:115], v[8:11]
    ds_read_b64_tr_b16 a[184:185], v228 offset:36032
    v_mfma_f32_16x16x32_bf16 v[64:67], a[168:171], a[116:119], v[64:67]
    v_mfma_f32_16x16x32_bf16 v[120:123], a[168:171], a[120:123], v[120:123]
    ds_read_b64_tr_b16 a[186:187], v228 offset:39616
    v_mfma_f32_16x16x32_bf16 v[176:179], a[168:171], a[124:127], v[176:179]
    s_waitcnt lgkmcnt(6)
    v_mfma_f32_16x16x32_bf16 v[12:15], a[172:175], a[112:115], v[12:15]
    ds_read_b64_tr_b16 a[160:161], v228 offset:50176
    v_mfma_f32_16x16x32_bf16 v[68:71], a[172:175], a[116:119], v[68:71]
    v_mfma_f32_16x16x32_bf16 v[124:127], a[172:175], a[120:123], v[124:127]
    ds_read_b64_tr_b16 a[162:163], v228 offset:53760
    v_mfma_f32_16x16x32_bf16 v[180:183], a[172:175], a[124:127], v[180:183]
    s_waitcnt lgkmcnt(6)
    v_mfma_f32_16x16x32_bf16 v[16:19], a[176:179], a[112:115], v[16:19]
    ds_read_b64_tr_b16 a[164:165], v228 offset:50208
    v_mfma_f32_16x16x32_bf16 v[72:75], a[176:179], a[116:119], v[72:75]
    v_mfma_f32_16x16x32_bf16 v[128:131], a[176:179], a[120:123], v[128:131]
    ds_read_b64_tr_b16 a[166:167], v228 offset:53792
    v_mfma_f32_16x16x32_bf16 v[184:187], a[176:179], a[124:127], v[184:187]
    s_waitcnt lgkmcnt(6)
    v_mfma_f32_16x16x32_bf16 v[20:23], a[180:183], a[112:115], v[20:23]
    ds_read_b64_tr_b16 a[168:169], v228 offset:50240
    v_mfma_f32_16x16x32_bf16 v[76:79], a[180:183], a[116:119], v[76:79]
    v_mfma_f32_16x16x32_bf16 v[132:135], a[180:183], a[120:123], v[132:135]
    ds_read_b64_tr_b16 a[170:171], v228 offset:53824
    v_mfma_f32_16x16x32_bf16 v[188:191], a[180:183], a[124:127], v[188:191]
    s_waitcnt lgkmcnt(6)
    v_mfma_f32_16x16x32_bf16 v[24:27], a[184:187], a[112:115], v[24:27]
    ds_read_b64_tr_b16 a[172:173], v228 offset:50272
    v_mfma_f32_16x16x32_bf16 v[80:83], a[184:187], a[116:119], v[80:83]
    v_mfma_f32_16x16x32_bf16 v[136:139], a[184:187], a[120:123], v[136:139]
    ds_read_b64_tr_b16 a[174:175], v228 offset:53856
    v_mfma_f32_16x16x32_bf16 v[192:195], a[184:187], a[124:127], v[192:195]
    s_waitcnt lgkmcnt(6)
    v_mfma_f32_16x16x32_bf16 v[28:31], a[160:163], a[112:115], v[28:31]
    ds_read_b64_tr_b16 a[176:177], v228 offset:50304
    v_mfma_f32_16x16x32_bf16 v[84:87], a[160:163], a[116:119], v[84:87]
    v_mfma_f32_16x16x32_bf16 v[140:143], a[160:163], a[120:123], v[140:143]
    ds_read_b64_tr_b16 a[178:179], v228 offset:53888
    v_mfma_f32_16x16x32_bf16 v[196:199], a[160:163], a[124:127], v[196:199]
    s_waitcnt lgkmcnt(6)
    v_mfma_f32_16x16x32_bf16 v[32:35], a[164:167], a[112:115], v[32:35]
    ds_read_b64_tr_b16 a[180:181], v228 offset:50336
    v_mfma_f32_16x16x32_bf16 v[88:91], a[164:167], a[116:119], v[88:91]
    v_mfma_f32_16x16x32_bf16 v[144:147], a[164:167], a[120:123], v[144:147]
    ds_read_b64_tr_b16 a[182:183], v228 offset:53920
    v_mfma_f32_16x16x32_bf16 v[200:203], a[164:167], a[124:127], v[200:203]
    s_waitcnt lgkmcnt(6)
    v_mfma_f32_16x16x32_bf16 v[36:39], a[168:171], a[112:115], v[36:39]
    ds_read_b64_tr_b16 a[184:185], v228 offset:50368
    v_mfma_f32_16x16x32_bf16 v[92:95], a[168:171], a[116:119], v[92:95]
    v_mfma_f32_16x16x32_bf16 v[148:151], a[168:171], a[120:123], v[148:151]
    ds_read_b64_tr_b16 a[186:187], v228 offset:53952
    v_mfma_f32_16x16x32_bf16 v[204:207], a[168:171], a[124:127], v[204:207]
    s_waitcnt vmcnt(2) lgkmcnt(6)
    s_barrier
    v_mfma_f32_16x16x32_bf16 v[40:43], a[172:175], a[112:115], v[40:43]
    ds_read_b64_tr_b16 a[160:161], v229 offset:0
    v_mfma_f32_16x16x32_bf16 v[96:99], a[172:175], a[116:119], v[96:99]
    v_mfma_f32_16x16x32_bf16 v[152:155], a[172:175], a[120:123], v[152:155]
    ds_read_b64_tr_b16 a[162:163], v229 offset:3584
    v_mfma_f32_16x16x32_bf16 v[208:211], a[172:175], a[124:127], v[208:211]
    s_waitcnt lgkmcnt(6)
    v_mfma_f32_16x16x32_bf16 v[44:47], a[176:179], a[112:115], v[44:47]
    ds_read_b64_tr_b16 a[164:165], v229 offset:7168
    v_mfma_f32_16x16x32_bf16 v[100:103], a[176:179], a[116:119], v[100:103]
    v_mfma_f32_16x16x32_bf16 v[156:159], a[176:179], a[120:123], v[156:159]
    ds_read_b64_tr_b16 a[166:167], v229 offset:10752
    v_mfma_f32_16x16x32_bf16 v[212:215], a[176:179], a[124:127], v[212:215]
    s_waitcnt lgkmcnt(6)
    v_mfma_f32_16x16x32_bf16 v[48:51], a[180:183], a[112:115], v[48:51]
    ds_read_b64_tr_b16 a[168:169], v227 offset:0
    v_mfma_f32_16x16x32_bf16 v[104:107], a[180:183], a[116:119], v[104:107]
    v_mfma_f32_16x16x32_bf16 v[160:163], a[180:183], a[120:123], v[160:163]
    ds_read_b64_tr_b16 a[170:171], v227 offset:3584
    v_mfma_f32_16x16x32_bf16 v[216:219], a[180:183], a[124:127], v[216:219]
    s_waitcnt lgkmcnt(6)
    v_mfma_f32_16x16x32_bf16 v[52:55], a[184:187], a[112:115], v[52:55]
    ds_read_b64_tr_b16 a[172:173], v227 offset:7168
    v_mfma_f32_16x16x32_bf16 v[108:111], a[184:187], a[116:119], v[108:111]
    v_mfma_f32_16x16x32_bf16 v[164:167], a[184:187], a[120:123], v[164:167]
    ds_read_b64_tr_b16 a[174:175], v227 offset:10752
    v_mfma_f32_16x16x32_bf16 v[220:223], a[184:187], a[124:127], v[220:223]
    s_waitcnt lgkmcnt(6)
    v_mfma_f32_16x16x32_bf16 v[0:3], a[160:163], a[128:131], v[0:3]
    ds_read_b64_tr_b16 a[176:177], v229 offset:14336
    v_mfma_f32_16x16x32_bf16 v[56:59], a[160:163], a[132:135], v[56:59]
    v_mfma_f32_16x16x32_bf16 v[112:115], a[160:163], a[136:139], v[112:115]
    s_mov_b32 s52, 0
    ds_read_b64_tr_b16 a[178:179], v229 offset:17920
    v_mfma_f32_16x16x32_bf16 v[168:171], a[160:163], a[140:143], v[168:171]
    s_waitcnt lgkmcnt(6)
    v_mfma_f32_16x16x32_bf16 v[0:3], a[164:167], a[144:147], v[0:3]
    s_add_u32 m0, s29, 32768
    ds_read_b64_tr_b16 a[180:181], v229 offset:21504
    v_mfma_f32_16x16x32_bf16 v[56:59], a[164:167], a[148:151], v[56:59]
    buffer_load_dwordx4 v230, s[32:35], s52 offen offset:0 lds
    v_mfma_f32_16x16x32_bf16 v[112:115], a[164:167], a[152:155], v[112:115]
    ds_read_b64_tr_b16 a[182:183], v229 offset:25088
    v_mfma_f32_16x16x32_bf16 v[168:171], a[164:167], a[156:159], v[168:171]
    s_waitcnt lgkmcnt(6)
    v_mfma_f32_16x16x32_bf16 v[0:3], a[168:171], a[0:3], v[0:3]
    ds_read_b64_tr_b16 a[184:185], v227 offset:14336
    v_mfma_f32_16x16x32_bf16 v[56:59], a[168:171], a[4:7], v[56:59]
    v_mfma_f32_16x16x32_bf16 v[112:115], a[168:171], a[8:11], v[112:115]
    ds_read_b64_tr_b16 a[186:187], v227 offset:17920
    v_mfma_f32_16x16x32_bf16 v[168:171], a[168:171], a[12:15], v[168:171]
    s_waitcnt vmcnt(1) lgkmcnt(6)
    v_mfma_f32_16x16x32_bf16 v[0:3], a[172:175], a[16:19], v[0:3]
    ds_read_b64_tr_b16 a[160:161], v227 offset:21504
    v_mfma_f32_16x16x32_bf16 v[56:59], a[172:175], a[20:23], v[56:59]
    buffer_load_dwordx4 v231, s[32:35], s52 offen offset:1024 lds
    v_mfma_f32_16x16x32_bf16 v[112:115], a[172:175], a[24:27], v[112:115]
    ds_read_b64_tr_b16 a[162:163], v227 offset:25088
    v_mfma_f32_16x16x32_bf16 v[168:171], a[172:175], a[28:31], v[168:171]
    s_waitcnt lgkmcnt(6)
    v_mfma_f32_16x16x32_bf16 v[28:31], a[176:179], a[128:131], v[28:31]
    ds_read_b64_tr_b16 a[164:165], v229 offset:32
    v_mfma_f32_16x16x32_bf16 v[84:87], a[176:179], a[132:135], v[84:87]
    v_mfma_f32_16x16x32_bf16 v[140:143], a[176:179], a[136:139], v[140:143]
    ds_read_b64_tr_b16 a[166:167], v229 offset:3616
    v_mfma_f32_16x16x32_bf16 v[196:199], a[176:179], a[140:143], v[196:199]
    s_waitcnt lgkmcnt(6)
    v_mfma_f32_16x16x32_bf16 v[28:31], a[180:183], a[144:147], v[28:31]
    s_add_u32 m0, s29, 34816
    ds_read_b64_tr_b16 a[168:169], v229 offset:7200
    v_mfma_f32_16x16x32_bf16 v[84:87], a[180:183], a[148:151], v[84:87]
    buffer_load_dwordx4 v232, s[96:99], s52 offen offset:0 lds
    v_mfma_f32_16x16x32_bf16 v[140:143], a[180:183], a[152:155], v[140:143]
    ds_read_b64_tr_b16 a[170:171], v229 offset:10784
    v_mul_f32 v0, v240, v0
    v_mul_f32 v1, v240, v1
    v_mul_f32 v2, v240, v2
    v_mul_f32 v3, v240, v3
    v_mfma_f32_16x16x32_bf16 v[196:199], a[180:183], a[156:159], v[196:199]
    s_waitcnt lgkmcnt(6)
    v_mul_f32 v56, v241, v56
    v_mul_f32 v57, v241, v57
    v_mul_f32 v58, v241, v58
    v_mul_f32 v59, v241, v59
    v_mul_f32 v112, v242, v112
    v_mfma_f32_16x16x32_bf16 v[28:31], a[184:187], a[0:3], v[28:31]
    ds_read_b64_tr_b16 a[172:173], v227 offset:32
    v_mul_f32 v113, v242, v113
    v_mul_f32 v114, v242, v114
    v_mul_f32 v115, v242, v115
    v_mul_f32 v168, v243, v168
    v_mfma_f32_16x16x32_bf16 v[84:87], a[184:187], a[4:7], v[84:87]
    v_mul_f32 v169, v243, v169
    v_mul_f32 v170, v243, v170
    v_mul_f32 v171, v243, v171
    v_exp_f32 v0, v0
    v_mfma_f32_16x16x32_bf16 v[140:143], a[184:187], a[8:11], v[140:143]
    ds_read_b64_tr_b16 a[174:175], v227 offset:3616
    v_exp_f32 v1, v1
    v_exp_f32 v2, v2
    v_mfma_f32_16x16x32_bf16 v[196:199], a[184:187], a[12:15], v[196:199]
    s_waitcnt lgkmcnt(6)
    v_exp_f32 v3, v3
    v_exp_f32 v56, v56
    v_mfma_f32_16x16x32_bf16 v[28:31], a[160:163], a[16:19], v[28:31]
    ds_read_b64_tr_b16 a[176:177], v227 offset:7200
    v_exp_f32 v57, v57
    v_exp_f32 v58, v58
    v_mfma_f32_16x16x32_bf16 v[84:87], a[160:163], a[20:23], v[84:87]
    buffer_load_dwordx4 v233, s[96:99], s52 offen offset:1024 lds
    v_mfma_f32_16x16x32_bf16 v[140:143], a[160:163], a[24:27], v[140:143]
    ds_read_b64_tr_b16 a[178:179], v227 offset:10784
    v_exp_f32 v59, v59
    v_exp_f32 v112, v112
    v_mfma_f32_16x16x32_bf16 v[196:199], a[160:163], a[28:31], v[196:199]
    s_waitcnt lgkmcnt(6)
    v_exp_f32 v113, v113
    v_exp_f32 v114, v114
    v_mfma_f32_16x16x32_bf16 v[4:7], a[164:167], a[128:131], v[4:7]
    ds_read_b64_tr_b16 a[180:181], v229 offset:14368
    v_exp_f32 v115, v115
    v_exp_f32 v168, v168
    v_mfma_f32_16x16x32_bf16 v[60:63], a[164:167], a[132:135], v[60:63]
    v_exp_f32 v169, v169
    v_exp_f32 v170, v170
    v_mfma_f32_16x16x32_bf16 v[116:119], a[164:167], a[136:139], v[116:119]
    s_mov_b32 s52, 131072
    ds_read_b64_tr_b16 a[182:183], v229 offset:17952
    v_exp_f32 v171, v171
    v_add_f32 v0, 1.0, v0
    v_add_f32 v1, 1.0, v1
    v_mfma_f32_16x16x32_bf16 v[172:175], a[164:167], a[140:143], v[172:175]
    s_waitcnt lgkmcnt(6)
    v_add_f32 v2, 1.0, v2
    v_add_f32 v3, 1.0, v3
    v_add_f32 v56, 1.0, v56
    v_add_f32 v57, 1.0, v57
    v_add_f32 v58, 1.0, v58
    v_mfma_f32_16x16x32_bf16 v[4:7], a[168:171], a[144:147], v[4:7]
    s_add_u32 m0, s29, 49152
    ds_read_b64_tr_b16 a[184:185], v229 offset:21536
    v_add_f32 v59, 1.0, v59
    v_add_f32 v112, 1.0, v112
    v_add_f32 v113, 1.0, v113
    v_add_f32 v114, 1.0, v114
    v_mfma_f32_16x16x32_bf16 v[60:63], a[168:171], a[148:151], v[60:63]
    buffer_load_dwordx4 v230, s[32:35], s52 offen offset:0 lds
    v_mfma_f32_16x16x32_bf16 v[116:119], a[168:171], a[152:155], v[116:119]
    ds_read_b64_tr_b16 a[186:187], v229 offset:25120
    v_add_f32 v115, 1.0, v115
    v_add_f32 v168, 1.0, v168
    v_add_f32 v169, 1.0, v169
    v_add_f32 v170, 1.0, v170
    v_mfma_f32_16x16x32_bf16 v[172:175], a[168:171], a[156:159], v[172:175]
    s_waitcnt lgkmcnt(6)
    v_add_f32 v171, 1.0, v171
    v_rcp_f32 v0, v0
    v_rcp_f32 v1, v1
    v_mfma_f32_16x16x32_bf16 v[4:7], a[172:175], a[0:3], v[4:7]
    ds_read_b64_tr_b16 a[160:161], v227 offset:14368
    v_rcp_f32 v2, v2
    v_rcp_f32 v3, v3
    v_mfma_f32_16x16x32_bf16 v[60:63], a[172:175], a[4:7], v[60:63]
    v_rcp_f32 v56, v56
    v_rcp_f32 v57, v57
    v_mfma_f32_16x16x32_bf16 v[116:119], a[172:175], a[8:11], v[116:119]
    ds_read_b64_tr_b16 a[162:163], v227 offset:17952
    v_rcp_f32 v58, v58
    v_rcp_f32 v59, v59
    v_mfma_f32_16x16x32_bf16 v[172:175], a[172:175], a[12:15], v[172:175]
    s_waitcnt lgkmcnt(6)
    v_rcp_f32 v112, v112
    v_rcp_f32 v113, v113
    v_mfma_f32_16x16x32_bf16 v[4:7], a[176:179], a[16:19], v[4:7]
    ds_read_b64_tr_b16 a[164:165], v227 offset:21536
    v_rcp_f32 v114, v114
    v_rcp_f32 v115, v115
    v_mfma_f32_16x16x32_bf16 v[60:63], a[176:179], a[20:23], v[60:63]
    buffer_load_dwordx4 v231, s[32:35], s52 offen offset:1024 lds
    v_mfma_f32_16x16x32_bf16 v[116:119], a[176:179], a[24:27], v[116:119]
    ds_read_b64_tr_b16 a[166:167], v227 offset:25120
    v_rcp_f32 v168, v168
    v_rcp_f32 v169, v169
    v_mfma_f32_16x16x32_bf16 v[172:175], a[176:179], a[28:31], v[172:175]
    s_waitcnt lgkmcnt(6)
    v_rcp_f32 v170, v170
    v_rcp_f32 v171, v171
    v_mul_f32 v0, v0, v28
    v_mfma_f32_16x16x32_bf16 v[32:35], a[180:183], a[128:131], v[32:35]
    ds_read_b64_tr_b16 a[168:169], v229 offset:64
    v_mul_f32 v1, v1, v29
    v_mul_f32 v2, v2, v30
    v_mul_f32 v3, v3, v31
    v_mul_f32 v56, v56, v84
    v_mfma_f32_16x16x32_bf16 v[88:91], a[180:183], a[132:135], v[88:91]
    v_mul_f32 v57, v57, v85
    v_mul_f32 v58, v58, v86
    v_mul_f32 v59, v59, v87
    v_mul_f32 v112, v112, v140
    v_mul_f32 v113, v113, v141
    v_mfma_f32_16x16x32_bf16 v[144:147], a[180:183], a[136:139], v[144:147]
    ds_read_b64_tr_b16 a[170:171], v229 offset:3648
    v_mul_f32 v114, v114, v142
    v_mul_f32 v115, v115, v143
    v_mul_f32 v168, v168, v196
    v_mul_f32 v169, v169, v197
    v_mfma_f32_16x16x32_bf16 v[200:203], a[180:183], a[140:143], v[200:203]
    s_waitcnt lgkmcnt(6)
    v_mul_f32 v170, v170, v198
    v_mul_f32 v171, v171, v199
    v_cvt_pk_bf16_f32 v28, v0, v1
    v_cvt_pk_bf16_f32 v29, v2, v3
    v_cvt_pk_bf16_f32 v84, v56, v57
    v_mfma_f32_16x16x32_bf16 v[32:35], a[184:187], a[144:147], v[32:35]
    s_add_u32 m0, s29, 51200
    ds_read_b64_tr_b16 a[172:173], v229 offset:7232
    v_cvt_pk_bf16_f32 v85, v58, v59
    v_cvt_pk_bf16_f32 v140, v112, v113
    v_cvt_pk_bf16_f32 v141, v114, v115
    v_cvt_pk_bf16_f32 v196, v168, v169
    v_mfma_f32_16x16x32_bf16 v[88:91], a[184:187], a[148:151], v[88:91]
    buffer_load_dwordx4 v232, s[96:99], s52 offen offset:0 lds
    v_mfma_f32_16x16x32_bf16 v[144:147], a[184:187], a[152:155], v[144:147]
    ds_read_b64_tr_b16 a[174:175], v229 offset:10816
    v_cvt_pk_bf16_f32 v197, v170, v171
    v_mul_f32 v4, v240, v4
    v_mul_f32 v5, v240, v5
    v_mul_f32 v6, v240, v6
    v_mfma_f32_16x16x32_bf16 v[200:203], a[184:187], a[156:159], v[200:203]
    s_waitcnt lgkmcnt(6)
    v_mul_f32 v7, v240, v7
    v_mul_f32 v60, v241, v60
    v_mul_f32 v61, v241, v61
    v_mul_f32 v62, v241, v62
    v_mul_f32 v63, v241, v63
    v_mfma_f32_16x16x32_bf16 v[32:35], a[160:163], a[0:3], v[32:35]
    ds_read_b64_tr_b16 a[176:177], v227 offset:64
    v_mul_f32 v116, v242, v116
    v_mul_f32 v117, v242, v117
    v_mul_f32 v118, v242, v118
    v_mul_f32 v119, v242, v119
    v_mfma_f32_16x16x32_bf16 v[88:91], a[160:163], a[4:7], v[88:91]
    v_mul_f32 v172, v243, v172
    v_mul_f32 v173, v243, v173
    v_mul_f32 v174, v243, v174
    v_mul_f32 v175, v243, v175
    v_mfma_f32_16x16x32_bf16 v[144:147], a[160:163], a[8:11], v[144:147]
    ds_read_b64_tr_b16 a[178:179], v227 offset:3648
    v_exp_f32 v4, v4
    v_exp_f32 v5, v5
    v_mfma_f32_16x16x32_bf16 v[200:203], a[160:163], a[12:15], v[200:203]
    s_waitcnt lgkmcnt(6)
    v_exp_f32 v6, v6
    v_exp_f32 v7, v7
    v_mfma_f32_16x16x32_bf16 v[32:35], a[164:167], a[16:19], v[32:35]
    ds_read_b64_tr_b16 a[180:181], v227 offset:7232
    v_exp_f32 v60, v60
    v_exp_f32 v61, v61
    v_mfma_f32_16x16x32_bf16 v[88:91], a[164:167], a[20:23], v[88:91]
    buffer_load_dwordx4 v233, s[96:99], s52 offen offset:1024 lds
    v_mfma_f32_16x16x32_bf16 v[144:147], a[164:167], a[24:27], v[144:147]
    ds_read_b64_tr_b16 a[182:183], v227 offset:10816
    v_exp_f32 v62, v62
    v_exp_f32 v63, v63
    v_mfma_f32_16x16x32_bf16 v[200:203], a[164:167], a[28:31], v[200:203]
    s_waitcnt lgkmcnt(6)
    v_exp_f32 v116, v116
    v_exp_f32 v117, v117
    v_mfma_f32_16x16x32_bf16 v[8:11], a[168:171], a[128:131], v[8:11]
    ds_read_b64_tr_b16 a[184:185], v229 offset:14400
    v_exp_f32 v118, v118
    v_exp_f32 v119, v119
    v_mfma_f32_16x16x32_bf16 v[64:67], a[168:171], a[132:135], v[64:67]
    v_exp_f32 v172, v172
    v_exp_f32 v173, v173
    v_mfma_f32_16x16x32_bf16 v[120:123], a[168:171], a[136:139], v[120:123]
    s_mov_b32 s52, 262144
    ds_read_b64_tr_b16 a[186:187], v229 offset:17984
    v_exp_f32 v174, v174
    v_exp_f32 v175, v175
    v_mfma_f32_16x16x32_bf16 v[176:179], a[168:171], a[140:143], v[176:179]
    s_waitcnt lgkmcnt(6)
    v_add_f32 v4, 1.0, v4
    v_add_f32 v5, 1.0, v5
    v_add_f32 v6, 1.0, v6
    v_add_f32 v7, 1.0, v7
    v_add_f32 v60, 1.0, v60
    v_mfma_f32_16x16x32_bf16 v[8:11], a[172:175], a[144:147], v[8:11]
    s_add_u32 m0, s29, 65536
    ds_read_b64_tr_b16 a[160:161], v229 offset:21568
    v_add_f32 v61, 1.0, v61
    v_add_f32 v62, 1.0, v62
    v_add_f32 v63, 1.0, v63
    v_add_f32 v116, 1.0, v116
    v_mfma_f32_16x16x32_bf16 v[64:67], a[172:175], a[148:151], v[64:67]
    buffer_load_dwordx4 v230, s[32:35], s52 offen offset:0 lds
    v_mfma_f32_16x16x32_bf16 v[120:123], a[172:175], a[152:155], v[120:123]
    ds_read_b64_tr_b16 a[162:163], v229 offset:25152
    v_add_f32 v117, 1.0, v117
    v_add_f32 v118, 1.0, v118
    v_add_f32 v119, 1.0, v119
    v_add_f32 v172, 1.0, v172
    v_mfma_f32_16x16x32_bf16 v[176:179], a[172:175], a[156:159], v[176:179]
    s_waitcnt lgkmcnt(6)
    v_add_f32 v173, 1.0, v173
    v_add_f32 v174, 1.0, v174
    v_add_f32 v175, 1.0, v175
    v_rcp_f32 v4, v4
    v_mfma_f32_16x16x32_bf16 v[8:11], a[176:179], a[0:3], v[8:11]
    ds_read_b64_tr_b16 a[164:165], v227 offset:14400
    v_rcp_f32 v5, v5
    v_rcp_f32 v6, v6
    v_mfma_f32_16x16x32_bf16 v[64:67], a[176:179], a[4:7], v[64:67]
    v_rcp_f32 v7, v7
    v_rcp_f32 v60, v60
    v_mfma_f32_16x16x32_bf16 v[120:123], a[176:179], a[8:11], v[120:123]
    ds_read_b64_tr_b16 a[166:167], v227 offset:17984
    v_rcp_f32 v61, v61
    v_rcp_f32 v62, v62
    v_mfma_f32_16x16x32_bf16 v[176:179], a[176:179], a[12:15], v[176:179]
    s_waitcnt lgkmcnt(6)
    v_rcp_f32 v63, v63
    v_rcp_f32 v116, v116
    v_mfma_f32_16x16x32_bf16 v[8:11], a[180:183], a[16:19], v[8:11]
    ds_read_b64_tr_b16 a[168:169], v227 offset:21568
    v_rcp_f32 v117, v117
    v_rcp_f32 v118, v118
    v_mfma_f32_16x16x32_bf16 v[64:67], a[180:183], a[20:23], v[64:67]
    buffer_load_dwordx4 v231, s[32:35], s52 offen offset:1024 lds
    v_mfma_f32_16x16x32_bf16 v[120:123], a[180:183], a[24:27], v[120:123]
    ds_read_b64_tr_b16 a[170:171], v227 offset:25152
    v_rcp_f32 v119, v119
    v_rcp_f32 v172, v172
    v_mfma_f32_16x16x32_bf16 v[176:179], a[180:183], a[28:31], v[176:179]
    s_waitcnt lgkmcnt(6)
    v_rcp_f32 v173, v173
    v_rcp_f32 v174, v174
    v_mfma_f32_16x16x32_bf16 v[36:39], a[184:187], a[128:131], v[36:39]
    ds_read_b64_tr_b16 a[172:173], v229 offset:96
    v_rcp_f32 v175, v175
    v_mul_f32 v4, v4, v32
    v_mul_f32 v5, v5, v33
    v_mfma_f32_16x16x32_bf16 v[92:95], a[184:187], a[132:135], v[92:95]
    v_mul_f32 v6, v6, v34
    v_mul_f32 v7, v7, v35
    v_mul_f32 v60, v60, v88
    v_mul_f32 v61, v61, v89
    v_mul_f32 v62, v62, v90
    v_mfma_f32_16x16x32_bf16 v[148:151], a[184:187], a[136:139], v[148:151]
    ds_read_b64_tr_b16 a[174:175], v229 offset:3680
    v_mul_f32 v63, v63, v91
    v_mul_f32 v116, v116, v144
    v_mul_f32 v117, v117, v145
    v_mul_f32 v118, v118, v146
    v_mfma_f32_16x16x32_bf16 v[204:207], a[184:187], a[140:143], v[204:207]
    s_waitcnt lgkmcnt(6)
    v_mul_f32 v119, v119, v147
    v_mul_f32 v172, v172, v200
    v_mul_f32 v173, v173, v201
    v_mul_f32 v174, v174, v202
    v_mul_f32 v175, v175, v203
    v_mfma_f32_16x16x32_bf16 v[36:39], a[160:163], a[144:147], v[36:39]
    s_add_u32 m0, s29, 67584
    ds_read_b64_tr_b16 a[176:177], v229 offset:7264
    v_cvt_pk_bf16_f32 v30, v4, v5
    v_cvt_pk_bf16_f32 v31, v6, v7
    v_mfma_f32_16x16x32_bf16 v[92:95], a[160:163], a[148:151], v[92:95]
    buffer_load_dwordx4 v232, s[96:99], s52 offen offset:0 lds
    v_mfma_f32_16x16x32_bf16 v[148:151], a[160:163], a[152:155], v[148:151]
    s_add_u32 s28, s54, 0
    ds_read_b64_tr_b16 a[178:179], v229 offset:10848
    buffer_store_dwordx4 v[28:31], v226, s[56:59], s28 offen offset:0 sc1
    v_cvt_pk_bf16_f32 v86, v60, v61
    v_cvt_pk_bf16_f32 v87, v62, v63
    v_mfma_f32_16x16x32_bf16 v[204:207], a[160:163], a[156:159], v[204:207]
    s_waitcnt lgkmcnt(6)
    buffer_store_dwordx4 v[84:87], v226, s[56:59], s28 offen offset:1024 sc1
    v_cvt_pk_bf16_f32 v142, v116, v117
    v_cvt_pk_bf16_f32 v143, v118, v119
    v_mfma_f32_16x16x32_bf16 v[36:39], a[164:167], a[0:3], v[36:39]
    s_add_u32 s28, s54, 229376
    ds_read_b64_tr_b16 a[180:181], v227 offset:96
    buffer_store_dwordx4 v[140:143], v226, s[56:59], s28 offen offset:0 sc1
    v_cvt_pk_bf16_f32 v198, v172, v173
    v_cvt_pk_bf16_f32 v199, v174, v175
    v_mfma_f32_16x16x32_bf16 v[92:95], a[164:167], a[4:7], v[92:95]
    buffer_store_dwordx4 v[196:199], v226, s[56:59], s28 offen offset:1024 sc1
    v_mul_f32 v8, v240, v8
    v_mul_f32 v9, v240, v9
    v_mul_f32 v10, v240, v10
    v_mfma_f32_16x16x32_bf16 v[148:151], a[164:167], a[8:11], v[148:151]
Lpad_14:
    s_cbranch_execz Lback_a
    ds_read_b64_tr_b16 a[182:183], v227 offset:3680
    v_mul_f32 v11, v240, v11
    v_mul_f32 v64, v241, v64
    v_mul_f32 v65, v241, v65
    v_mul_f32 v66, v241, v66
    v_mfma_f32_16x16x32_bf16 v[204:207], a[164:167], a[12:15], v[204:207]
    s_waitcnt lgkmcnt(6)
    v_mul_f32 v67, v241, v67
    v_mul_f32 v120, v242, v120
    v_mul_f32 v121, v242, v121
    v_mul_f32 v122, v242, v122
    v_mul_f32 v123, v242, v123
    v_mfma_f32_16x16x32_bf16 v[36:39], a[168:171], a[16:19], v[36:39]
    ds_read_b64_tr_b16 a[184:185], v227 offset:7264
    v_mul_f32 v176, v243, v176
    v_mul_f32 v177, v243, v177
    v_mul_f32 v178, v243, v178
    v_mul_f32 v179, v243, v179
    v_mfma_f32_16x16x32_bf16 v[92:95], a[168:171], a[20:23], v[92:95]
    buffer_load_dwordx4 v233, s[96:99], s52 offen offset:1024 lds
    v_mfma_f32_16x16x32_bf16 v[148:151], a[168:171], a[24:27], v[148:151]
    ds_read_b64_tr_b16 a[186:187], v227 offset:10848
    v_exp_f32 v8, v8
    v_exp_f32 v9, v9
    v_mfma_f32_16x16x32_bf16 v[204:207], a[168:171], a[28:31], v[204:207]
    s_waitcnt lgkmcnt(6)
    v_exp_f32 v10, v10
    v_exp_f32 v11, v11
    v_mfma_f32_16x16x32_bf16 v[12:15], a[172:175], a[128:131], v[12:15]
    ds_read_b64_tr_b16 a[160:161], v229 offset:14432
    v_exp_f32 v64, v64
    v_exp_f32 v65, v65
    v_mfma_f32_16x16x32_bf16 v[68:71], a[172:175], a[132:135], v[68:71]
    v_exp_f32 v66, v66
    v_exp_f32 v67, v67
    v_mfma_f32_16x16x32_bf16 v[124:127], a[172:175], a[136:139], v[124:127]
    s_mov_b32 s52, 393216
    ds_read_b64_tr_b16 a[162:163], v229 offset:18016
    v_exp_f32 v120, v120
    v_exp_f32 v121, v121
    v_mfma_f32_16x16x32_bf16 v[180:183], a[172:175], a[140:143], v[180:183]
    s_waitcnt lgkmcnt(6)
    v_exp_f32 v122, v122
    v_exp_f32 v123, v123
    v_mfma_f32_16x16x32_bf16 v[12:15], a[176:179], a[144:147], v[12:15]
    s_add_u32 m0, s29, 147456
    ds_read_b64_tr_b16 a[164:165], v229 offset:21600
    v_exp_f32 v176, v176
    v_exp_f32 v177, v177
    v_mfma_f32_16x16x32_bf16 v[68:71], a[176:179], a[148:151], v[68:71]
    buffer_load_dwordx4 v230, s[32:35], s52 offen offset:0 lds
    v_mfma_f32_16x16x32_bf16 v[124:127], a[176:179], a[152:155], v[124:127]
    ds_read_b64_tr_b16 a[166:167], v229 offset:25184
    v_exp_f32 v178, v178
    v_exp_f32 v179, v179
    v_mfma_f32_16x16x32_bf16 v[180:183], a[176:179], a[156:159], v[180:183]
    s_waitcnt lgkmcnt(6)
    v_add_f32 v8, 1.0, v8
    v_add_f32 v9, 1.0, v9
    v_add_f32 v10, 1.0, v10
    v_add_f32 v11, 1.0, v11
    v_add_f32 v64, 1.0, v64
    v_mfma_f32_16x16x32_bf16 v[12:15], a[180:183], a[0:3], v[12:15]
    ds_read_b64_tr_b16 a[168:169], v227 offset:14432
    v_add_f32 v65, 1.0, v65
    v_add_f32 v66, 1.0, v66
    v_add_f32 v67, 1.0, v67
    v_add_f32 v120, 1.0, v120
    v_mfma_f32_16x16x32_bf16 v[68:71], a[180:183], a[4:7], v[68:71]
    v_add_f32 v121, 1.0, v121
    v_add_f32 v122, 1.0, v122
    v_add_f32 v123, 1.0, v123
    v_add_f32 v176, 1.0, v176
    v_add_f32 v177, 1.0, v177
    v_mfma_f32_16x16x32_bf16 v[124:127], a[180:183], a[8:11], v[124:127]
    ds_read_b64_tr_b16 a[170:171], v227 offset:18016
    v_add_f32 v178, 1.0, v178
    v_add_f32 v179, 1.0, v179
    v_rcp_f32 v8, v8
    v_mfma_f32_16x16x32_bf16 v[180:183], a[180:183], a[12:15], v[180:183]
    s_waitcnt lgkmcnt(6)
    v_rcp_f32 v9, v9
    v_rcp_f32 v10, v10
    v_mfma_f32_16x16x32_bf16 v[12:15], a[184:187], a[16:19], v[12:15]
    ds_read_b64_tr_b16 a[172:173], v227 offset:21600
    v_rcp_f32 v11, v11
    v_rcp_f32 v64, v64
    v_mfma_f32_16x16x32_bf16 v[68:71], a[184:187], a[20:23], v[68:71]
    buffer_load_dwordx4 v231, s[32:35], s52 offen offset:1024 lds
    v_mfma_f32_16x16x32_bf16 v[124:127], a[184:187], a[24:27], v[124:127]
    ds_read_b64_tr_b16 a[174:175], v227 offset:25184
    v_rcp_f32 v65, v65
    v_rcp_f32 v66, v66
    v_mfma_f32_16x16x32_bf16 v[180:183], a[184:187], a[28:31], v[180:183]
    s_waitcnt lgkmcnt(6)
    v_rcp_f32 v67, v67
    v_rcp_f32 v120, v120
    v_mfma_f32_16x16x32_bf16 v[40:43], a[160:163], a[128:131], v[40:43]
    ds_read_b64_tr_b16 a[176:177], v229 offset:128
    v_rcp_f32 v121, v121
    v_rcp_f32 v122, v122
    v_mfma_f32_16x16x32_bf16 v[96:99], a[160:163], a[132:135], v[96:99]
    v_rcp_f32 v123, v123
    v_rcp_f32 v176, v176
    v_mfma_f32_16x16x32_bf16 v[152:155], a[160:163], a[136:139], v[152:155]
    ds_read_b64_tr_b16 a[178:179], v229 offset:3712
    v_rcp_f32 v177, v177
    v_rcp_f32 v178, v178
    v_mfma_f32_16x16x32_bf16 v[208:211], a[160:163], a[140:143], v[208:211]
    s_waitcnt lgkmcnt(6)
    v_rcp_f32 v179, v179
    v_mul_f32 v8, v8, v36
    v_mul_f32 v9, v9, v37
    v_mul_f32 v10, v10, v38
    v_mfma_f32_16x16x32_bf16 v[40:43], a[164:167], a[144:147], v[40:43]
    s_add_u32 m0, s29, 149504
    ds_read_b64_tr_b16 a[180:181], v229 offset:7296
    v_mul_f32 v11, v11, v39
    v_mul_f32 v64, v64, v92
    v_mul_f32 v65, v65, v93
    v_mul_f32 v66, v66, v94
    v_mfma_f32_16x16x32_bf16 v[96:99], a[164:167], a[148:151], v[96:99]
    buffer_load_dwordx4 v232, s[96:99], s52 offen offset:0 lds
    v_mfma_f32_16x16x32_bf16 v[152:155], a[164:167], a[152:155], v[152:155]
    ds_read_b64_tr_b16 a[182:183], v229 offset:10880
    v_mul_f32 v67, v67, v95
    v_mul_f32 v120, v120, v148
    v_mul_f32 v121, v121, v149
    v_mul_f32 v122, v122, v150
    v_mfma_f32_16x16x32_bf16 v[208:211], a[164:167], a[156:159], v[208:211]
    s_waitcnt lgkmcnt(6)
    v_mul_f32 v123, v123, v151
    v_mul_f32 v176, v176, v204
    v_mul_f32 v177, v177, v205
    v_mul_f32 v178, v178, v206
    v_mul_f32 v179, v179, v207
    v_mfma_f32_16x16x32_bf16 v[40:43], a[168:171], a[0:3], v[40:43]
    ds_read_b64_tr_b16 a[184:185], v227 offset:128
    v_cvt_pk_bf16_f32 v36, v8, v9
    v_cvt_pk_bf16_f32 v37, v10, v11
    v_cvt_pk_bf16_f32 v92, v64, v65
    v_cvt_pk_bf16_f32 v93, v66, v67
    v_mfma_f32_16x16x32_bf16 v[96:99], a[168:171], a[4:7], v[96:99]
    v_cvt_pk_bf16_f32 v148, v120, v121
    v_cvt_pk_bf16_f32 v149, v122, v123
    v_cvt_pk_bf16_f32 v204, v176, v177
    v_cvt_pk_bf16_f32 v205, v178, v179
    v_mul_f32 v12, v240, v12
    v_mfma_f32_16x16x32_bf16 v[152:155], a[168:171], a[8:11], v[152:155]
    ds_read_b64_tr_b16 a[186:187], v227 offset:3712
    v_mul_f32 v13, v240, v13
    v_mul_f32 v14, v240, v14
    v_mul_f32 v15, v240, v15
    v_mul_f32 v68, v241, v68
    v_mfma_f32_16x16x32_bf16 v[208:211], a[168:171], a[12:15], v[208:211]
    s_waitcnt lgkmcnt(6)
    v_mul_f32 v69, v241, v69
    v_mul_f32 v70, v241, v70
    v_mul_f32 v71, v241, v71
    v_mul_f32 v124, v242, v124
    v_mul_f32 v125, v242, v125
    v_mfma_f32_16x16x32_bf16 v[40:43], a[172:175], a[16:19], v[40:43]
    ds_read_b64_tr_b16 a[160:161], v227 offset:7296
    v_mul_f32 v126, v242, v126
    v_mul_f32 v127, v242, v127
    v_mul_f32 v180, v243, v180
    v_mul_f32 v181, v243, v181
    v_mfma_f32_16x16x32_bf16 v[96:99], a[172:175], a[20:23], v[96:99]
    buffer_load_dwordx4 v233, s[96:99], s52 offen offset:1024 lds
    v_mfma_f32_16x16x32_bf16 v[152:155], a[172:175], a[24:27], v[152:155]
    ds_read_b64_tr_b16 a[162:163], v227 offset:10880
    v_mul_f32 v182, v243, v182
    v_mul_f32 v183, v243, v183
    v_exp_f32 v12, v12
    v_mfma_f32_16x16x32_bf16 v[208:211], a[172:175], a[28:31], v[208:211]
    s_waitcnt lgkmcnt(6)
    s_barrier
    v_exp_f32 v13, v13
    v_exp_f32 v14, v14
    v_mfma_f32_16x16x32_bf16 v[16:19], a[176:179], a[128:131], v[16:19]
    ds_read_b64_tr_b16 a[164:165], v229 offset:14464
    v_exp_f32 v15, v15
    v_exp_f32 v68, v68
    v_mfma_f32_16x16x32_bf16 v[72:75], a[176:179], a[132:135], v[72:75]
    v_exp_f32 v69, v69
    v_exp_f32 v70, v70
    v_mfma_f32_16x16x32_bf16 v[128:131], a[176:179], a[136:139], v[128:131]
    s_mov_b32 s52, 524288
    ds_read_b64_tr_b16 a[166:167], v229 offset:18048
    v_exp_f32 v71, v71
    v_exp_f32 v124, v124
    v_mfma_f32_16x16x32_bf16 v[184:187], a[176:179], a[140:143], v[184:187]
    s_waitcnt lgkmcnt(6)
    v_exp_f32 v125, v125
    v_exp_f32 v126, v126
    v_mfma_f32_16x16x32_bf16 v[16:19], a[180:183], a[144:147], v[16:19]
    s_add_u32 m0, s29, 81920
    ds_read_b64_tr_b16 a[168:169], v229 offset:21632
    v_exp_f32 v127, v127
    v_exp_f32 v180, v180
    v_mfma_f32_16x16x32_bf16 v[72:75], a[180:183], a[148:151], v[72:75]
    buffer_load_dwordx4 v230, s[32:35], s52 offen offset:0 lds
    v_mfma_f32_16x16x32_bf16 v[128:131], a[180:183], a[152:155], v[128:131]
    ds_read_b64_tr_b16 a[170:171], v229 offset:25216
    v_exp_f32 v181, v181
    v_exp_f32 v182, v182
    v_mfma_f32_16x16x32_bf16 v[184:187], a[180:183], a[156:159], v[184:187]
    s_waitcnt lgkmcnt(6)
    v_exp_f32 v183, v183
    v_add_f32 v12, 1.0, v12
    v_add_f32 v13, 1.0, v13
    v_add_f32 v14, 1.0, v14
    v_mfma_f32_16x16x32_bf16 v[16:19], a[184:187], a[0:3], v[16:19]
    ds_read_b64_tr_b16 a[172:173], v227 offset:14464
    v_add_f32 v15, 1.0, v15
    v_add_f32 v68, 1.0, v68
    v_add_f32 v69, 1.0, v69
    v_add_f32 v70, 1.0, v70
    v_mfma_f32_16x16x32_bf16 v[72:75], a[184:187], a[4:7], v[72:75]
    v_add_f32 v71, 1.0, v71
    v_add_f32 v124, 1.0, v124
    v_add_f32 v125, 1.0, v125
    v_add_f32 v126, 1.0, v126
    v_add_f32 v127, 1.0, v127
    v_mfma_f32_16x16x32_bf16 v[128:131], a[184:187], a[8:11], v[128:131]
    ds_read_b64_tr_b16 a[174:175], v227 offset:18048
    v_add_f32 v180, 1.0, v180
    v_add_f32 v181, 1.0, v181
    v_add_f32 v182, 1.0, v182
    v_add_f32 v183, 1.0, v183
    v_mfma_f32_16x16x32_bf16 v[184:187], a[184:187], a[12:15], v[184:187]
    s_waitcnt lgkmcnt(6)
    v_rcp_f32 v12, v12
    v_rcp_f32 v13, v13
    v_mfma_f32_16x16x32_bf16 v[16:19], a[160:163], a[16:19], v[16:19]
    ds_read_b64_tr_b16 a[176:177], v227 offset:21632
    v_rcp_f32 v14, v14
    v_rcp_f32 v15, v15
    v_mfma_f32_16x16x32_bf16 v[72:75], a[160:163], a[20:23], v[72:75]
    buffer_load_dwordx4 v231, s[32:35], s52 offen offset:1024 lds
    v_mfma_f32_16x16x32_bf16 v[128:131], a[160:163], a[24:27], v[128:131]
    ds_read_b64_tr_b16 a[178:179], v227 offset:25216
    v_rcp_f32 v68, v68
    v_rcp_f32 v69, v69
    v_mfma_f32_16x16x32_bf16 v[184:187], a[160:163], a[28:31], v[184:187]
    s_waitcnt lgkmcnt(6)
    v_rcp_f32 v70, v70
    v_rcp_f32 v71, v71
    v_mfma_f32_16x16x32_bf16 v[44:47], a[164:167], a[128:131], v[44:47]
    ds_read_b64_tr_b16 a[180:181], v229 offset:160
    v_rcp_f32 v124, v124
    v_rcp_f32 v125, v125
    v_mfma_f32_16x16x32_bf16 v[100:103], a[164:167], a[132:135], v[100:103]
    v_rcp_f32 v126, v126
    v_rcp_f32 v127, v127
    v_mfma_f32_16x16x32_bf16 v[156:159], a[164:167], a[136:139], v[156:159]
    ds_read_b64_tr_b16 a[182:183], v229 offset:3744
    v_rcp_f32 v180, v180
    v_rcp_f32 v181, v181
    v_mfma_f32_16x16x32_bf16 v[212:215], a[164:167], a[140:143], v[212:215]
    s_waitcnt lgkmcnt(6)
    v_rcp_f32 v182, v182
    v_rcp_f32 v183, v183
    v_mul_f32 v12, v12, v40
    v_mfma_f32_16x16x32_bf16 v[44:47], a[168:171], a[144:147], v[44:47]
    s_add_u32 m0, s29, 83968
    ds_read_b64_tr_b16 a[184:185], v229 offset:7328
    v_mul_f32 v13, v13, v41
    v_mul_f32 v14, v14, v42
    v_mul_f32 v15, v15, v43
    v_mul_f32 v68, v68, v96
    v_mfma_f32_16x16x32_bf16 v[100:103], a[168:171], a[148:151], v[100:103]
    buffer_load_dwordx4 v232, s[96:99], s52 offen offset:0 lds
    v_mfma_f32_16x16x32_bf16 v[156:159], a[168:171], a[152:155], v[156:159]
    ds_read_b64_tr_b16 a[186:187], v229 offset:10912
    v_mul_f32 v69, v69, v97
    v_mul_f32 v70, v70, v98
    v_mul_f32 v71, v71, v99
    v_mul_f32 v124, v124, v152
    v_mfma_f32_16x16x32_bf16 v[212:215], a[168:171], a[156:159], v[212:215]
    s_waitcnt lgkmcnt(6)
    v_mul_f32 v125, v125, v153
    v_mul_f32 v126, v126, v154
    v_mul_f32 v127, v127, v155
    v_mul_f32 v180, v180, v208
    v_mul_f32 v181, v181, v209
    v_mfma_f32_16x16x32_bf16 v[44:47], a[172:175], a[0:3], v[44:47]
    ds_read_b64_tr_b16 a[160:161], v227 offset:160
    v_mul_f32 v182, v182, v210
    v_mul_f32 v183, v183, v211
    v_cvt_pk_bf16_f32 v38, v12, v13
    v_cvt_pk_bf16_f32 v39, v14, v15
    v_mfma_f32_16x16x32_bf16 v[100:103], a[172:175], a[4:7], v[100:103]
    s_add_u32 s28, s54, 2048
    buffer_store_dwordx4 v[36:39], v226, s[56:59], s28 offen offset:0 sc1
    v_cvt_pk_bf16_f32 v94, v68, v69
    v_cvt_pk_bf16_f32 v95, v70, v71
    v_mfma_f32_16x16x32_bf16 v[156:159], a[172:175], a[8:11], v[156:159]
    ds_read_b64_tr_b16 a[162:163], v227 offset:3744
    buffer_store_dwordx4 v[92:95], v226, s[56:59], s28 offen offset:1024 sc1
    v_cvt_pk_bf16_f32 v150, v124, v125
    v_cvt_pk_bf16_f32 v151, v126, v127
    v_mfma_f32_16x16x32_bf16 v[212:215], a[172:175], a[12:15], v[212:215]
    s_waitcnt lgkmcnt(6)
    s_add_u32 s28, s54, 231424
    buffer_store_dwordx4 v[148:151], v226, s[56:59], s28 offen offset:0 sc1
    v_cvt_pk_bf16_f32 v206, v180, v181
    v_cvt_pk_bf16_f32 v207, v182, v183
    v_mfma_f32_16x16x32_bf16 v[44:47], a[176:179], a[16:19], v[44:47]
    ds_read_b64_tr_b16 a[164:165], v227 offset:7328
    buffer_store_dwordx4 v[204:207], v226, s[56:59], s28 offen offset:1024 sc1
    v_mul_f32 v16, v240, v16
    v_mul_f32 v17, v240, v17
    v_mfma_f32_16x16x32_bf16 v[100:103], a[176:179], a[20:23], v[100:103]
    buffer_load_dwordx4 v233, s[96:99], s52 offen offset:1024 lds
    v_mfma_f32_16x16x32_bf16 v[156:159], a[176:179], a[24:27], v[156:159]
    ds_read_b64_tr_b16 a[166:167], v227 offset:10912
    v_mul_f32 v18, v240, v18
    v_mul_f32 v19, v240, v19
    v_mul_f32 v72, v241, v72
    v_mul_f32 v73, v241, v73
    v_mfma_f32_16x16x32_bf16 v[212:215], a[176:179], a[28:31], v[212:215]
    s_waitcnt lgkmcnt(6)
    v_mul_f32 v74, v241, v74
    v_mul_f32 v75, v241, v75
    v_mul_f32 v128, v242, v128
    v_mul_f32 v129, v242, v129
    v_mul_f32 v130, v242, v130
    v_mfma_f32_16x16x32_bf16 v[20:23], a[180:183], a[128:131], v[20:23]
    ds_read_b64_tr_b16 a[168:169], v229 offset:14496
    v_mul_f32 v131, v242, v131
    v_mul_f32 v184, v243, v184
    v_mul_f32 v185, v243, v185
    v_mul_f32 v186, v243, v186
    v_mfma_f32_16x16x32_bf16 v[76:79], a[180:183], a[132:135], v[76:79]
    v_mul_f32 v187, v243, v187
    v_exp_f32 v16, v16
    v_exp_f32 v17, v17
    v_mfma_f32_16x16x32_bf16 v[132:135], a[180:183], a[136:139], v[132:135]
    s_mov_b32 s52, 655360
    ds_read_b64_tr_b16 a[170:171], v229 offset:18080
    v_exp_f32 v18, v18
    v_exp_f32 v19, v19
    v_mfma_f32_16x16x32_bf16 v[188:191], a[180:183], a[140:143], v[188:191]
    s_waitcnt lgkmcnt(6)
    v_exp_f32 v72, v72
    v_exp_f32 v73, v73
    v_mfma_f32_16x16x32_bf16 v[20:23], a[184:187], a[144:147], v[20:23]
    s_add_u32 m0, s29, 98304
    ds_read_b64_tr_b16 a[172:173], v229 offset:21664
    v_exp_f32 v74, v74
    v_exp_f32 v75, v75
    v_mfma_f32_16x16x32_bf16 v[76:79], a[184:187], a[148:151], v[76:79]
    buffer_load_dwordx4 v230, s[32:35], s52 offen offset:0 lds
    v_mfma_f32_16x16x32_bf16 v[132:135], a[184:187], a[152:155], v[132:135]
    ds_read_b64_tr_b16 a[174:175], v229 offset:25248
    v_exp_f32 v128, v128
    v_exp_f32 v129, v129
    v_mfma_f32_16x16x32_bf16 v[188:191], a[184:187], a[156:159], v[188:191]
    s_waitcnt lgkmcnt(6)
    v_exp_f32 v130, v130
    v_exp_f32 v131, v131
    v_mfma_f32_16x16x32_bf16 v[20:23], a[160:163], a[0:3], v[20:23]
    ds_read_b64_tr_b16 a[176:177], v227 offset:14496
    v_exp_f32 v184, v184
    v_exp_f32 v185, v185
    v_mfma_f32_16x16x32_bf16 v[76:79], a[160:163], a[4:7], v[76:79]
    v_exp_f32 v186, v186
    v_exp_f32 v187, v187
    v_add_f32 v16, 1.0, v16
    v_mfma_f32_16x16x32_bf16 v[132:135], a[160:163], a[8:11], v[132:135]
    ds_read_b64_tr_b16 a[178:179], v227 offset:18080
    v_add_f32 v17, 1.0, v17
    v_add_f32 v18, 1.0, v18
    v_add_f32 v19, 1.0, v19
    v_add_f32 v72, 1.0, v72
    v_mfma_f32_16x16x32_bf16 v[188:191], a[160:163], a[12:15], v[188:191]
    s_waitcnt lgkmcnt(6)
    v_add_f32 v73, 1.0, v73
    v_add_f32 v74, 1.0, v74
    v_add_f32 v75, 1.0, v75
    v_add_f32 v128, 1.0, v128
    v_add_f32 v129, 1.0, v129
    v_mfma_f32_16x16x32_bf16 v[20:23], a[164:167], a[16:19], v[20:23]
    ds_read_b64_tr_b16 a[180:181], v227 offset:21664
    v_add_f32 v130, 1.0, v130
    v_add_f32 v131, 1.0, v131
    v_add_f32 v184, 1.0, v184
    v_add_f32 v185, 1.0, v185
    v_mfma_f32_16x16x32_bf16 v[76:79], a[164:167], a[20:23], v[76:79]
    buffer_load_dwordx4 v231, s[32:35], s52 offen offset:1024 lds
    v_mfma_f32_16x16x32_bf16 v[132:135], a[164:167], a[24:27], v[132:135]
    ds_read_b64_tr_b16 a[182:183], v227 offset:25248
    v_add_f32 v186, 1.0, v186
    v_add_f32 v187, 1.0, v187
    v_rcp_f32 v16, v16
    v_mfma_f32_16x16x32_bf16 v[188:191], a[164:167], a[28:31], v[188:191]
    s_waitcnt lgkmcnt(6)
    v_rcp_f32 v17, v17
    v_rcp_f32 v18, v18
    v_mfma_f32_16x16x32_bf16 v[48:51], a[168:171], a[128:131], v[48:51]
    ds_read_b64_tr_b16 a[184:185], v229 offset:192
    v_rcp_f32 v19, v19
    v_rcp_f32 v72, v72
    v_mfma_f32_16x16x32_bf16 v[104:107], a[168:171], a[132:135], v[104:107]
    v_rcp_f32 v73, v73
    v_rcp_f32 v74, v74
    v_mfma_f32_16x16x32_bf16 v[160:163], a[168:171], a[136:139], v[160:163]
    ds_read_b64_tr_b16 a[186:187], v229 offset:3776
    v_rcp_f32 v75, v75
    v_rcp_f32 v128, v128
    v_mfma_f32_16x16x32_bf16 v[216:219], a[168:171], a[140:143], v[216:219]
    s_waitcnt lgkmcnt(6)
    v_rcp_f32 v129, v129
    v_rcp_f32 v130, v130
    v_mfma_f32_16x16x32_bf16 v[48:51], a[172:175], a[144:147], v[48:51]
    s_add_u32 m0, s29, 100352
    ds_read_b64_tr_b16 a[160:161], v229 offset:7360
    v_rcp_f32 v131, v131
    v_rcp_f32 v184, v184
    v_mfma_f32_16x16x32_bf16 v[104:107], a[172:175], a[148:151], v[104:107]
    buffer_load_dwordx4 v232, s[96:99], s52 offen offset:0 lds
    v_mfma_f32_16x16x32_bf16 v[160:163], a[172:175], a[152:155], v[160:163]
    ds_read_b64_tr_b16 a[162:163], v229 offset:10944
    v_rcp_f32 v185, v185
    v_rcp_f32 v186, v186
    v_mfma_f32_16x16x32_bf16 v[216:219], a[172:175], a[156:159], v[216:219]
    s_waitcnt lgkmcnt(6)
    v_rcp_f32 v187, v187
    v_mul_f32 v16, v16, v44
    v_mul_f32 v17, v17, v45
    v_mul_f32 v18, v18, v46
    v_mfma_f32_16x16x32_bf16 v[48:51], a[176:179], a[0:3], v[48:51]
    ds_read_b64_tr_b16 a[164:165], v227 offset:192
    v_mul_f32 v19, v19, v47
    v_mul_f32 v72, v72, v100
    v_mul_f32 v73, v73, v101
    v_mul_f32 v74, v74, v102
    v_mfma_f32_16x16x32_bf16 v[104:107], a[176:179], a[4:7], v[104:107]
    v_mul_f32 v75, v75, v103
    v_mul_f32 v128, v128, v156
    v_mul_f32 v129, v129, v157
    v_mul_f32 v130, v130, v158
    v_mul_f32 v131, v131, v159
    v_mfma_f32_16x16x32_bf16 v[160:163], a[176:179], a[8:11], v[160:163]
    ds_read_b64_tr_b16 a[166:167], v227 offset:3776
    v_mul_f32 v184, v184, v212
    v_mul_f32 v185, v185, v213
    v_mul_f32 v186, v186, v214
    v_mul_f32 v187, v187, v215
    v_mfma_f32_16x16x32_bf16 v[216:219], a[176:179], a[12:15], v[216:219]
    s_waitcnt lgkmcnt(6)
    v_cvt_pk_bf16_f32 v44, v16, v17
    v_cvt_pk_bf16_f32 v45, v18, v19
    v_cvt_pk_bf16_f32 v100, v72, v73
    v_cvt_pk_bf16_f32 v101, v74, v75
    v_cvt_pk_bf16_f32 v156, v128, v129
    v_mfma_f32_16x16x32_bf16 v[48:51], a[180:183], a[16:19], v[48:51]
    ds_read_b64_tr_b16 a[168:169], v227 offset:7360
    v_cvt_pk_bf16_f32 v157, v130, v131
    v_cvt_pk_bf16_f32 v212, v184, v185
    v_cvt_pk_bf16_f32 v213, v186, v187
    v_mul_f32 v20, v240, v20
    v_mfma_f32_16x16x32_bf16 v[104:107], a[180:183], a[20:23], v[104:107]
    buffer_load_dwordx4 v233, s[96:99], s52 offen offset:1024 lds
    v_mfma_f32_16x16x32_bf16 v[160:163], a[180:183], a[24:27], v[160:163]
    ds_read_b64_tr_b16 a[170:171], v227 offset:10944
    v_mul_f32 v21, v240, v21
    v_mul_f32 v22, v240, v22
    v_mul_f32 v23, v240, v23
    v_mul_f32 v76, v241, v76
    v_mfma_f32_16x16x32_bf16 v[216:219], a[180:183], a[28:31], v[216:219]
    s_waitcnt lgkmcnt(6)
    v_mul_f32 v77, v241, v77
    v_mul_f32 v78, v241, v78
    v_mul_f32 v79, v241, v79
    v_mul_f32 v132, v242, v132
    v_mul_f32 v133, v242, v133
    v_mfma_f32_16x16x32_bf16 v[24:27], a[184:187], a[128:131], v[24:27]
    ds_read_b64_tr_b16 a[172:173], v229 offset:14528
    v_mul_f32 v134, v242, v134
    v_mul_f32 v135, v242, v135
    v_mul_f32 v188, v243, v188
    v_mul_f32 v189, v243, v189
    v_mfma_f32_16x16x32_bf16 v[80:83], a[184:187], a[132:135], v[80:83]
    v_mul_f32 v190, v243, v190
    v_mul_f32 v191, v243, v191
    v_exp_f32 v20, v20
    v_mfma_f32_16x16x32_bf16 v[136:139], a[184:187], a[136:139], v[136:139]
    ds_read_b64_tr_b16 a[174:175], v229 offset:18112
    v_exp_f32 v21, v21
    v_exp_f32 v22, v22
    v_mfma_f32_16x16x32_bf16 v[192:195], a[184:187], a[140:143], v[192:195]
    s_waitcnt lgkmcnt(6)
    v_exp_f32 v23, v23
    v_exp_f32 v76, v76
    v_mfma_f32_16x16x32_bf16 v[24:27], a[160:163], a[144:147], v[24:27]
    ds_read_b64_tr_b16 a[176:177], v229 offset:21696
    v_exp_f32 v77, v77
    v_exp_f32 v78, v78
    v_mfma_f32_16x16x32_bf16 v[80:83], a[160:163], a[148:151], v[80:83]
    v_exp_f32 v79, v79
    v_exp_f32 v132, v132
    v_mfma_f32_16x16x32_bf16 v[136:139], a[160:163], a[152:155], v[136:139]
    ds_read_b64_tr_b16 a[178:179], v229 offset:25280
    v_exp_f32 v133, v133
    v_exp_f32 v134, v134
    v_mfma_f32_16x16x32_bf16 v[192:195], a[160:163], a[156:159], v[192:195]
    s_waitcnt lgkmcnt(6)
    v_exp_f32 v135, v135
    v_exp_f32 v188, v188
    v_mfma_f32_16x16x32_bf16 v[24:27], a[164:167], a[0:3], v[24:27]
    ds_read_b64_tr_b16 a[180:181], v227 offset:14528
    v_exp_f32 v189, v189
    v_exp_f32 v190, v190
    v_mfma_f32_16x16x32_bf16 v[80:83], a[164:167], a[4:7], v[80:83]
    v_exp_f32 v191, v191
    v_add_f32 v20, 1.0, v20
    v_add_f32 v21, 1.0, v21
    v_add_f32 v22, 1.0, v22
    v_mfma_f32_16x16x32_bf16 v[136:139], a[164:167], a[8:11], v[136:139]
    ds_read_b64_tr_b16 a[182:183], v227 offset:18112
    v_add_f32 v23, 1.0, v23
    v_add_f32 v76, 1.0, v76
    v_add_f32 v77, 1.0, v77
    v_add_f32 v78, 1.0, v78
    v_mfma_f32_16x16x32_bf16 v[192:195], a[164:167], a[12:15], v[192:195]
    s_waitcnt lgkmcnt(6)
    v_add_f32 v79, 1.0, v79
    v_add_f32 v132, 1.0, v132
    v_add_f32 v133, 1.0, v133
    v_add_f32 v134, 1.0, v134
    v_add_f32 v135, 1.0, v135
    v_mfma_f32_16x16x32_bf16 v[24:27], a[168:171], a[16:19], v[24:27]
    ds_read_b64_tr_b16 a[184:185], v227 offset:21696
    v_add_f32 v188, 1.0, v188
    v_add_f32 v189, 1.0, v189
    v_add_f32 v190, 1.0, v190
    v_add_f32 v191, 1.0, v191
    v_mfma_f32_16x16x32_bf16 v[80:83], a[168:171], a[20:23], v[80:83]
    v_rcp_f32 v20, v20
    v_rcp_f32 v21, v21
    v_mfma_f32_16x16x32_bf16 v[136:139], a[168:171], a[24:27], v[136:139]
    ds_read_b64_tr_b16 a[186:187], v227 offset:25280
    v_rcp_f32 v22, v22
    v_rcp_f32 v23, v23
    v_mfma_f32_16x16x32_bf16 v[192:195], a[168:171], a[28:31], v[192:195]
    s_waitcnt lgkmcnt(6)
    v_rcp_f32 v76, v76
    v_rcp_f32 v77, v77
    v_mfma_f32_16x16x32_bf16 v[52:55], a[172:175], a[128:131], v[52:55]
    v_rcp_f32 v78, v78
    v_rcp_f32 v79, v79
    v_mfma_f32_16x16x32_bf16 v[108:111], a[172:175], a[132:135], v[108:111]
    v_rcp_f32 v132, v132
    v_rcp_f32 v133, v133
    v_mfma_f32_16x16x32_bf16 v[164:167], a[172:175], a[136:139], v[164:167]
    v_rcp_f32 v134, v134
    v_rcp_f32 v135, v135
    v_mfma_f32_16x16x32_bf16 v[220:223], a[172:175], a[140:143], v[220:223]
    s_waitcnt lgkmcnt(4)
    v_rcp_f32 v188, v188
    v_rcp_f32 v189, v189
    v_mfma_f32_16x16x32_bf16 v[52:55], a[176:179], a[144:147], v[52:55]
    v_rcp_f32 v190, v190
    v_rcp_f32 v191, v191
    v_mul_f32 v20, v20, v48
    v_mfma_f32_16x16x32_bf16 v[108:111], a[176:179], a[148:151], v[108:111]
    v_mul_f32 v21, v21, v49
    v_mul_f32 v22, v22, v50
    v_mul_f32 v23, v23, v51
    v_mul_f32 v76, v76, v104
    v_mul_f32 v77, v77, v105
    v_mfma_f32_16x16x32_bf16 v[164:167], a[176:179], a[152:155], v[164:167]
    v_mul_f32 v78, v78, v106
    v_mul_f32 v79, v79, v107
    v_mul_f32 v132, v132, v160
    v_mul_f32 v133, v133, v161
    v_mul_f32 v134, v134, v162
    v_mfma_f32_16x16x32_bf16 v[220:223], a[176:179], a[156:159], v[220:223]
    s_waitcnt lgkmcnt(2)
    v_mul_f32 v135, v135, v163
    v_mul_f32 v188, v188, v216
    v_mul_f32 v189, v189, v217
    v_mul_f32 v190, v190, v218
    v_mul_f32 v191, v191, v219
    v_mfma_f32_16x16x32_bf16 v[52:55], a[180:183], a[0:3], v[52:55]
    v_cvt_pk_bf16_f32 v46, v20, v21
    v_cvt_pk_bf16_f32 v47, v22, v23
    v_mfma_f32_16x16x32_bf16 v[108:111], a[180:183], a[4:7], v[108:111]
    s_add_u32 s28, s54, 4096
    buffer_store_dwordx4 v[44:47], v226, s[56:59], s28 offen offset:0 sc1
    v_cvt_pk_bf16_f32 v102, v76, v77
    v_cvt_pk_bf16_f32 v103, v78, v79
    v_mfma_f32_16x16x32_bf16 v[164:167], a[180:183], a[8:11], v[164:167]
    buffer_store_dwordx4 v[100:103], v226, s[56:59], s28 offen offset:1024 sc1
    v_cvt_pk_bf16_f32 v158, v132, v133
    v_cvt_pk_bf16_f32 v159, v134, v135
    v_mfma_f32_16x16x32_bf16 v[220:223], a[180:183], a[12:15], v[220:223]
    s_waitcnt lgkmcnt(0)
    s_add_u32 s28, s54, 233472
    buffer_store_dwordx4 v[156:159], v226, s[56:59], s28 offen offset:0 sc1
    v_cvt_pk_bf16_f32 v214, v188, v189
    v_cvt_pk_bf16_f32 v215, v190, v191
    v_mfma_f32_16x16x32_bf16 v[52:55], a[184:187], a[16:19], v[52:55]
    buffer_store_dwordx4 v[212:215], v226, s[56:59], s28 offen offset:1024 sc1
    v_mul_f32 v24, v240, v24
    v_mul_f32 v25, v240, v25
    v_mul_f32 v26, v240, v26
    v_mfma_f32_16x16x32_bf16 v[108:111], a[184:187], a[20:23], v[108:111]
    v_mul_f32 v27, v240, v27
    v_mul_f32 v80, v241, v80
    v_mul_f32 v81, v241, v81
    v_mul_f32 v82, v241, v82
    v_mul_f32 v83, v241, v83
    v_mfma_f32_16x16x32_bf16 v[164:167], a[184:187], a[24:27], v[164:167]
    v_mul_f32 v136, v242, v136
    v_mul_f32 v137, v242, v137
    v_mul_f32 v138, v242, v138
    v_mul_f32 v139, v242, v139
    v_mul_f32 v192, v243, v192
    v_mfma_f32_16x16x32_bf16 v[220:223], a[184:187], a[28:31], v[220:223]
    v_mul_f32 v193, v243, v193
    v_mul_f32 v194, v243, v194
    v_mul_f32 v195, v243, v195
    v_exp_f32 v24, v24
    s_barrier
    s_mov_b32 s52, 786432
    s_add_u32 m0, s29, 0
    s_nop 0
    buffer_load_dwordx4 v230, s[32:35], s52 offen offset:0 lds
    buffer_load_dwordx4 v231, s[32:35], s52 offen offset:1024 lds
    s_add_u32 m0, s29, 2048
    s_nop 0
    buffer_load_dwordx4 v232, s[96:99], s52 offen offset:0 lds
    buffer_load_dwordx4 v233, s[96:99], s52 offen offset:1024 lds
    v_exp_f32 v25, v25
    v_exp_f32 v26, v26
    v_exp_f32 v27, v27
    v_exp_f32 v80, v80
    v_exp_f32 v81, v81
    v_exp_f32 v82, v82
    v_exp_f32 v83, v83
    v_exp_f32 v136, v136
    v_exp_f32 v137, v137
    v_exp_f32 v138, v138
    v_exp_f32 v139, v139
    v_exp_f32 v192, v192
    v_exp_f32 v193, v193
    v_exp_f32 v194, v194
    v_exp_f32 v195, v195
    v_add_f32 v24, 1.0, v24
    v_add_f32 v25, 1.0, v25
    v_add_f32 v26, 1.0, v26
    v_add_f32 v27, 1.0, v27
    v_add_f32 v80, 1.0, v80
    v_add_f32 v81, 1.0, v81
    v_add_f32 v82, 1.0, v82
    v_add_f32 v83, 1.0, v83
    v_add_f32 v136, 1.0, v136
    v_add_f32 v137, 1.0, v137
    v_add_f32 v138, 1.0, v138
    v_add_f32 v139, 1.0, v139
    v_add_f32 v192, 1.0, v192
    v_add_f32 v193, 1.0, v193
    v_add_f32 v194, 1.0, v194
    v_add_f32 v195, 1.0, v195
    v_rcp_f32 v24, v24
    v_rcp_f32 v25, v25
    v_rcp_f32 v26, v26
    v_rcp_f32 v27, v27
    v_rcp_f32 v80, v80
    v_rcp_f32 v81, v81
    v_rcp_f32 v82, v82
    v_rcp_f32 v83, v83
    v_rcp_f32 v136, v136
    v_rcp_f32 v137, v137
    v_rcp_f32 v138, v138
    v_rcp_f32 v139, v139
    v_rcp_f32 v192, v192
    v_rcp_f32 v193, v193
    v_rcp_f32 v194, v194
    v_rcp_f32 v195, v195
    s_nop 7
    v_pk_mul_f32 v[24:25], v[24:25], v[52:53]
    v_pk_mul_f32 v[26:27], v[26:27], v[54:55]
    v_pk_mul_f32 v[80:81], v[80:81], v[108:109]
    v_pk_mul_f32 v[82:83], v[82:83], v[110:111]
    v_pk_mul_f32 v[136:137], v[136:137], v[164:165]
    v_pk_mul_f32 v[138:139], v[138:139], v[166:167]
    v_pk_mul_f32 v[192:193], v[192:193], v[220:221]
    v_pk_mul_f32 v[194:195], v[194:195], v[222:223]
    v_cvt_pk_bf16_f32 v52, v24, v25
    v_cvt_pk_bf16_f32 v53, v26, v27
    s_add_u32 s28, s55, 0
    buffer_store_dwordx2 v[52:53], v239, s[56:59], s28 offen offset:0 sc1
    v_cvt_pk_bf16_f32 v108, v80, v81
    v_cvt_pk_bf16_f32 v109, v82, v83
    buffer_store_dwordx2 v[108:109], v239, s[56:59], s28 offen offset:1024 sc1
    v_cvt_pk_bf16_f32 v164, v136, v137
    v_cvt_pk_bf16_f32 v165, v138, v139
    s_add_u32 s28, s55, 229376
    buffer_store_dwordx2 v[164:165], v239, s[56:59], s28 offen offset:0 sc1
    v_cvt_pk_bf16_f32 v220, v192, v193
    v_cvt_pk_bf16_f32 v221, v194, v195
    buffer_store_dwordx2 v[220:221], v239, s[56:59], s28 offen offset:1024 sc1
    s_lshr_b32 s0, s94, 4
    s_lshl_b32 s0, s0, 10
    s_add_u32 s0, s0, s31
    s_add_u32 s0, s0, 1024
    s_mov_b32 s52, 917504
    s_add_u32 m0, s29, 16384
    s_nop 0
    buffer_load_dwordx4 v230, s[32:35], s52 offen offset:0 lds
    buffer_load_dwordx4 v231, s[32:35], s52 offen offset:1024 lds
    s_add_u32 m0, s29, 18432
    s_nop 0
    buffer_load_dwordx4 v232, s[96:99], s52 offen offset:0 lds
    buffer_load_dwordx4 v233, s[96:99], s52 offen offset:1024 lds
    s_and_b32 s28, s26, 1
    s_xor_b32 s100, s101, 65536
    s_mul_i32 s27, s30, 229376
    s_mul_i32 s54, s28, 114688
Lpad_15:
    s_cbranch_execz Lpad_18
    s_add_u32 s27, s27, s54
    s_add_u32 s27, s27, 16777216
    s_add_u32 s36, s22, s27
    s_addc_u32 s37, s23, 0
    s_mov_b32 s38, 33669248
    s_mov_b32 s39, 0x20000
    s_lshl_b32 s54, s30, 16
    s_lshl_b32 s27, s26, 12
    s_add_u32 s27, s27, s54
    s_add_u32 s27, s27, 12582912
    s_add_u32 s40, s22, s27
    s_addc_u32 s41, s23, 0
    s_mov_b32 s42, 33558656
    s_mov_b32 s43, 0x20000
    s_lshl_b32 s27, s26, 7
    s_add_u32 s27, s54, s27
    s_add_u32 s56, s18, s27
    s_addc_u32 s57, s19, 0
    s_mov_b32 s58, 63616
    s_mov_b32 s59, 0x20000
    s_lshr_b32 s31, s25, 1
    s_lshl_b32 s27, s28, 3
    s_add_u32 s31, s31, s27
    s_lshl_b32 s31, s31, 7
    s_add_u32 s31, s31, 789504
    s_mov_b32 s61, 32768
    s_mov_b32 s60, 0xffff0000
    s_lshl_b32 s62, s30, 7
    s_add_u32 s63, s62, 278528
    s_lshl_b32 s27, s28, 13
    s_add_u32 s62, s62, s27
    s_add_u32 s62, s62, 294912
    v_and_b32 v252, 15, v225
    v_lshlrev_b32 v235, 2, v252
    v_lshlrev_b32 v237, 11, v252
    v_bfe_u32 v253, v225, 4, 1
    v_lshl_add_u32 v252, v253, 5, v237
    v_lshrrev_b32 v253, 5, v225
    v_lshl_add_u32 v234, v253, 4, v252
    v_lshrrev_b32 v252, 2, v225
    v_lshlrev_b32 v252, 7, v252
    v_and_b32 v253, 3, v225
    v_lshl_add_u32 v252, v253, 3, v252
    v_bfe_u32 v253, v225, 3, 2
    v_lshl_add_u32 v240, v253, 5, v252
    v_xor_b32 v241, 32, v240
    v_xor_b32 v242, 64, v240
    v_xor_b32 v243, 96, v240
    v_add_u32 v244, 0x10000, v240
    v_add_u32 v245, 0x10000, v241
    v_add_u32 v246, 0x10000, v242
    v_add_u32 v247, 0x10000, v243
    v_add_u32 v248, 0x10000, v244
    v_add_u32 v249, 0x10000, v245
    v_add_u32 v250, 0x10000, v246
    v_add_u32 v251, 0x10000, v247
    s_mov_b32 s52, 1048576
    s_add_u32 m0, s29, 114688
    s_nop 0
    buffer_load_dwordx4 v230, s[32:35], s52 offen offset:0 lds
    buffer_load_dwordx4 v231, s[32:35], s52 offen offset:1024 lds
    s_lshl_b32 s27, s24, 6
    v_add_lshl_u32 v252, v225, s27, 22
    v_mov_b32 v253, 1
    s_waitcnt vmcnt(6)
    s_barrier
    buffer_atomic_add v253, v252, s[44:47], s0 offen sc1
    s_add_u32 m0, s29, 116736
    s_nop 0
    buffer_load_dwordx4 v232, s[96:99], s52 offen offset:0 lds
    buffer_load_dwordx4 v233, s[96:99], s52 offen offset:1024 lds
    s_mov_b32 s52, 1179648
    s_add_u32 m0, s29, 131072
    s_nop 0
    buffer_load_dwordx4 v230, s[32:35], s52 offen offset:0 lds
    buffer_load_dwordx4 v231, s[32:35], s52 offen offset:1024 lds
    s_add_u32 m0, s29, 133120
    s_nop 0
    buffer_load_dwordx4 v232, s[96:99], s52 offen offset:0 lds
    buffer_load_dwordx4 v233, s[96:99], s52 offen offset:1024 lds
    s_mov_b64 exec, 0
    s_cmp_eq_u32 s24, 1
    s_cbranch_scc1 Lpad_15
    s_cmp_eq_u32 s24, 2
    s_cbranch_scc1 Lpad_16
    s_cmp_eq_u32 s24, 3
    s_cbranch_scc1 Lpad_17
Lback_d2:
    s_mov_b64 exec, -1
    s_cmp_lg_u32 s24, 0
    s_cbranch_scc1 Lnopoll_14
    v_mov_b32 v255, 0
    buffer_atomic_or v255, v252, s[44:47], s31 offen sc0 sc1
    s_waitcnt vmcnt(0)
    v_cmp_gt_u32 vcc, 16, v255
    s_mov_b32 s27, 0x80000
    s_and_b64 vcc, vcc, 1
    s_cbranch_scc0 Lok_15
Lspin_16:
    s_sleep 2
    v_mov_b32 v255, 0
    buffer_atomic_or v255, v252, s[44:47], s31 offen sc0 sc1
    s_waitcnt vmcnt(0)
    v_cmp_gt_u32 vcc, 16, v255
    s_sub_u32 s27, s27, 1
    s_cbranch_scc1 Lok_15
    s_and_b64 vcc, vcc, 1
    s_cbranch_scc1 Lspin_16
Lok_15:
Lnopoll_14:
    s_waitcnt vmcnt(0)
    s_barrier
    s_mov_b32 s53, 0
    buffer_load_dwordx4 a[0:3], v226, s[36:39], s53 offen offset:0 sc1
    buffer_load_dwordx4 a[4:7], v226, s[36:39], s53 offen offset:1024 sc1
    buffer_load_dwordx4 a[8:11], v226, s[36:39], s53 offen offset:2048 sc1
    buffer_load_dwordx4 a[12:15], v226, s[36:39], s53 offen offset:3072 sc1
    s_mov_b32 s53, 4096
    buffer_load_dwordx4 a[16:19], v226, s[36:39], s53 offen offset:0 sc1
    buffer_load_dwordx4 a[20:23], v226, s[36:39], s53 offen offset:1024 sc1
    buffer_load_dwordx2 a[24:25], v239, s[36:39], s53 offen offset:2048 sc1
    buffer_load_dwordx2 a[26:27], v239, s[36:39], s53 offen offset:2560 sc1
    buffer_load_dwordx2 a[28:29], v239, s[36:39], s53 offen offset:3072 sc1
    buffer_load_dwordx2 a[30:31], v239, s[36:39], s53 offen offset:3584 sc1
    ds_read_b64_tr_b16 v[96:97], v240 offset:32768
    ds_read_b64_tr_b16 v[98:99], v240 offset:36864
    ds_read_b64_tr_b16 v[100:101], v241 offset:32768
    ds_read_b64_tr_b16 v[102:103], v241 offset:36864
    ds_read_b64_tr_b16 v[104:105], v242 offset:32768
    ds_read_b64_tr_b16 v[106:107], v242 offset:36864
    ds_read_b64_tr_b16 v[108:109], v243 offset:32768
    ds_read_b64_tr_b16 v[110:111], v243 offset:36864
    ds_read_b64_tr_b16 v[112:113], v240 offset:34816
    ds_read_b64_tr_b16 v[114:115], v240 offset:38912
    ds_read_b64_tr_b16 v[116:117], v241 offset:34816
    ds_read_b64_tr_b16 v[118:119], v241 offset:38912
    s_waitcnt vmcnt(8) lgkmcnt(8)
    v_mfma_f32_16x16x32_bf16 v[0:3], v[96:99], a[0:3], 0
    s_mov_b32 s53, 8192
    ds_read_b64_tr_b16 v[120:121], v242 offset:34816
    ds_read_b64_tr_b16 v[122:123], v242 offset:38912
    v_mfma_f32_16x16x32_bf16 v[16:19], v[96:99], a[4:7], 0
    buffer_load_dwordx4 a[32:35], v226, s[36:39], s53 offen offset:0 sc1
    v_mfma_f32_16x16x32_bf16 v[4:7], v[100:103], a[0:3], 0
    ds_read_b64_tr_b16 v[124:125], v243 offset:34816
    ds_read_b64_tr_b16 v[126:127], v243 offset:38912
    v_mfma_f32_16x16x32_bf16 v[20:23], v[100:103], a[4:7], 0
    s_waitcnt lgkmcnt(8)
    v_mfma_f32_16x16x32_bf16 v[8:11], v[104:107], a[0:3], 0
    ds_read_b64_tr_b16 v[96:97], v240 offset:40960
    ds_read_b64_tr_b16 v[98:99], v240 offset:45056
    v_mfma_f32_16x16x32_bf16 v[24:27], v[104:107], a[4:7], 0
    buffer_load_dwordx4 a[36:39], v226, s[36:39], s53 offen offset:1024 sc1
    v_mfma_f32_16x16x32_bf16 v[12:15], v[108:111], a[0:3], 0
    ds_read_b64_tr_b16 v[100:101], v241 offset:40960
    ds_read_b64_tr_b16 v[102:103], v241 offset:45056
    v_mfma_f32_16x16x32_bf16 v[28:31], v[108:111], a[4:7], 0
    s_waitcnt lgkmcnt(8)
    v_mfma_f32_16x16x32_bf16 v[32:35], v[112:115], a[0:3], 0
    ds_read_b64_tr_b16 v[104:105], v242 offset:40960
    ds_read_b64_tr_b16 v[106:107], v242 offset:45056
    v_mfma_f32_16x16x32_bf16 v[48:51], v[112:115], a[4:7], 0
    buffer_load_dwordx4 a[40:43], v226, s[36:39], s53 offen offset:2048 sc1
    v_mfma_f32_16x16x32_bf16 v[36:39], v[116:119], a[0:3], 0
    ds_read_b64_tr_b16 v[108:109], v243 offset:40960
    ds_read_b64_tr_b16 v[110:111], v243 offset:45056
    v_mfma_f32_16x16x32_bf16 v[52:55], v[116:119], a[4:7], 0
    s_waitcnt lgkmcnt(8)
    v_mfma_f32_16x16x32_bf16 v[40:43], v[120:123], a[0:3], 0
    ds_read_b64_tr_b16 v[112:113], v240 offset:43008
    ds_read_b64_tr_b16 v[114:115], v240 offset:47104
    v_mfma_f32_16x16x32_bf16 v[56:59], v[120:123], a[4:7], 0
    buffer_load_dwordx4 a[44:47], v226, s[36:39], s53 offen offset:3072 sc1
    v_mfma_f32_16x16x32_bf16 v[44:47], v[124:127], a[0:3], 0
    ds_read_b64_tr_b16 v[116:117], v241 offset:43008
    ds_read_b64_tr_b16 v[118:119], v241 offset:47104
    v_mfma_f32_16x16x32_bf16 v[60:63], v[124:127], a[4:7], 0
    s_waitcnt vmcnt(10) lgkmcnt(8)
    v_mfma_f32_16x16x32_bf16 v[0:3], v[96:99], a[8:11], v[0:3]
    s_mov_b32 s53, 12288
    ds_read_b64_tr_b16 v[120:121], v242 offset:43008
    ds_read_b64_tr_b16 v[122:123], v242 offset:47104
    v_mfma_f32_16x16x32_bf16 v[16:19], v[96:99], a[12:15], v[16:19]
    buffer_load_dwordx4 a[48:51], v226, s[36:39], s53 offen offset:0 sc1
    v_mfma_f32_16x16x32_bf16 v[4:7], v[100:103], a[8:11], v[4:7]
    ds_read_b64_tr_b16 v[124:125], v243 offset:43008
    ds_read_b64_tr_b16 v[126:127], v243 offset:47104
    v_mfma_f32_16x16x32_bf16 v[20:23], v[100:103], a[12:15], v[20:23]
    s_waitcnt lgkmcnt(8)
    v_mfma_f32_16x16x32_bf16 v[8:11], v[104:107], a[8:11], v[8:11]
    ds_read_b64_tr_b16 v[96:97], v240 offset:49152
    ds_read_b64_tr_b16 v[98:99], v240 offset:53248
    v_mfma_f32_16x16x32_bf16 v[24:27], v[104:107], a[12:15], v[24:27]
    buffer_load_dwordx4 a[52:55], v226, s[36:39], s53 offen offset:1024 sc1
    v_mfma_f32_16x16x32_bf16 v[12:15], v[108:111], a[8:11], v[12:15]
    ds_read_b64_tr_b16 v[100:101], v241 offset:49152
    ds_read_b64_tr_b16 v[102:103], v241 offset:53248
    v_mfma_f32_16x16x32_bf16 v[28:31], v[108:111], a[12:15], v[28:31]
    s_waitcnt lgkmcnt(8)
    v_mfma_f32_16x16x32_bf16 v[32:35], v[112:115], a[8:11], v[32:35]
    ds_read_b64_tr_b16 v[104:105], v242 offset:49152
    ds_read_b64_tr_b16 v[106:107], v242 offset:53248
    v_mfma_f32_16x16x32_bf16 v[48:51], v[112:115], a[12:15], v[48:51]
    buffer_load_dwordx4 a[56:59], v226, s[36:39], s53 offen offset:2048 sc1
    v_mfma_f32_16x16x32_bf16 v[36:39], v[116:119], a[8:11], v[36:39]
    ds_read_b64_tr_b16 v[108:109], v243 offset:49152
    ds_read_b64_tr_b16 v[110:111], v243 offset:53248
    v_mfma_f32_16x16x32_bf16 v[52:55], v[116:119], a[12:15], v[52:55]
    s_waitcnt lgkmcnt(8)
    v_mfma_f32_16x16x32_bf16 v[40:43], v[120:123], a[8:11], v[40:43]
    ds_read_b64_tr_b16 v[112:113], v240 offset:51200
    ds_read_b64_tr_b16 v[114:115], v240 offset:55296
    v_mfma_f32_16x16x32_bf16 v[56:59], v[120:123], a[12:15], v[56:59]
    buffer_load_dwordx4 a[60:63], v226, s[36:39], s53 offen offset:3072 sc1
    v_mfma_f32_16x16x32_bf16 v[44:47], v[124:127], a[8:11], v[44:47]
    ds_read_b64_tr_b16 v[116:117], v241 offset:51200
    ds_read_b64_tr_b16 v[118:119], v241 offset:55296
    v_mfma_f32_16x16x32_bf16 v[60:63], v[124:127], a[12:15], v[60:63]
    s_waitcnt vmcnt(12) lgkmcnt(8)
    v_mfma_f32_16x16x32_bf16 v[0:3], v[96:99], a[16:19], v[0:3]
    ds_read_b64_tr_b16 v[120:121], v242 offset:51200
    ds_read_b64_tr_b16 v[122:123], v242 offset:55296
    v_mfma_f32_16x16x32_bf16 v[16:19], v[96:99], a[20:23], v[16:19]
    v_mfma_f32_16x16x32_bf16 v[4:7], v[100:103], a[16:19], v[4:7]
    ds_read_b64_tr_b16 v[124:125], v243 offset:51200
    ds_read_b64_tr_b16 v[126:127], v243 offset:55296
    v_mfma_f32_16x16x32_bf16 v[20:23], v[100:103], a[20:23], v[20:23]
    s_waitcnt lgkmcnt(8)
    v_mfma_f32_16x16x32_bf16 v[8:11], v[104:107], a[16:19], v[8:11]
    s_mov_b32 s53, 16384
    ds_read_b64_tr_b16 v[96:97], v240 offset:57344
    ds_read_b64_tr_b16 v[98:99], v240 offset:61440
    v_mfma_f32_16x16x32_bf16 v[24:27], v[104:107], a[20:23], v[24:27]
    buffer_load_dwordx4 a[64:67], v226, s[36:39], s53 offen offset:0 sc1
    v_mfma_f32_16x16x32_bf16 v[12:15], v[108:111], a[16:19], v[12:15]
    ds_read_b64_tr_b16 v[100:101], v241 offset:57344
    ds_read_b64_tr_b16 v[102:103], v241 offset:61440
    v_mfma_f32_16x16x32_bf16 v[28:31], v[108:111], a[20:23], v[28:31]
    s_waitcnt lgkmcnt(8)
    v_mfma_f32_16x16x32_bf16 v[32:35], v[112:115], a[16:19], v[32:35]
    ds_read_b64_tr_b16 v[104:105], v242 offset:57344
    ds_read_b64_tr_b16 v[106:107], v242 offset:61440
    v_mfma_f32_16x16x32_bf16 v[48:51], v[112:115], a[20:23], v[48:51]
    v_mfma_f32_16x16x32_bf16 v[36:39], v[116:119], a[16:19], v[36:39]
    ds_read_b64_tr_b16 v[108:109], v243 offset:57344
    ds_read_b64_tr_b16 v[110:111], v243 offset:61440
    v_mfma_f32_16x16x32_bf16 v[52:55], v[116:119], a[20:23], v[52:55]
    s_waitcnt lgkmcnt(8)
    v_mfma_f32_16x16x32_bf16 v[40:43], v[120:123], a[16:19], v[40:43]
    ds_read_b64_tr_b16 v[112:113], v240 offset:59392
    ds_read_b64_tr_b16 v[114:115], v240 offset:63488
    v_mfma_f32_16x16x32_bf16 v[56:59], v[120:123], a[20:23], v[56:59]
    buffer_load_dwordx4 a[68:71], v226, s[36:39], s53 offen offset:1024 sc1
    v_mfma_f32_16x16x32_bf16 v[44:47], v[124:127], a[16:19], v[44:47]
    ds_read_b64_tr_b16 v[116:117], v241 offset:59392
    ds_read_b64_tr_b16 v[118:119], v241 offset:63488
    v_mfma_f32_16x16x32_bf16 v[60:63], v[124:127], a[20:23], v[60:63]
    s_waitcnt vmcnt(10) lgkmcnt(8)
    v_mfma_f32_16x16x32_bf16 v[0:3], v[96:99], a[24:27], v[0:3]
    ds_read_b64_tr_b16 v[120:121], v242 offset:59392
    ds_read_b64_tr_b16 v[122:123], v242 offset:63488
    v_mfma_f32_16x16x32_bf16 v[16:19], v[96:99], a[28:31], v[16:19]
    v_mfma_f32_16x16x32_bf16 v[4:7], v[100:103], a[24:27], v[4:7]
    s_mov_b32 s52, 1310720
    ds_read_b64_tr_b16 v[124:125], v243 offset:59392
    ds_read_b64_tr_b16 v[126:127], v243 offset:63488
    v_mfma_f32_16x16x32_bf16 v[20:23], v[100:103], a[28:31], v[20:23]
    s_waitcnt lgkmcnt(8)
    s_barrier
    v_mfma_f32_16x16x32_bf16 v[8:11], v[104:107], a[24:27], v[8:11]
    s_add_u32 m0, s29, 32768
    ds_read_b64_tr_b16 v[96:97], v244 offset:0
    ds_read_b64_tr_b16 v[98:99], v244 offset:4096
    v_mfma_f32_16x16x32_bf16 v[24:27], v[104:107], a[28:31], v[24:27]
    buffer_load_dwordx4 v230, s[32:35], s52 offen offset:0 lds
    v_mfma_f32_16x16x32_bf16 v[12:15], v[108:111], a[24:27], v[12:15]
    ds_read_b64_tr_b16 v[100:101], v245 offset:0
    ds_read_b64_tr_b16 v[102:103], v245 offset:4096
    v_mfma_f32_16x16x32_bf16 v[28:31], v[108:111], a[28:31], v[28:31]
    s_waitcnt lgkmcnt(8)
    v_mfma_f32_16x16x32_bf16 v[32:35], v[112:115], a[24:27], v[32:35]
    ds_read_b64_tr_b16 v[104:105], v246 offset:0
    ds_read_b64_tr_b16 v[106:107], v246 offset:4096
    v_mfma_f32_16x16x32_bf16 v[48:51], v[112:115], a[28:31], v[48:51]
    buffer_load_dwordx4 v231, s[32:35], s52 offen offset:1024 lds
    v_mfma_f32_16x16x32_bf16 v[36:39], v[116:119], a[24:27], v[36:39]
    ds_read_b64_tr_b16 v[108:109], v247 offset:0
    ds_read_b64_tr_b16 v[110:111], v247 offset:4096
    v_mfma_f32_16x16x32_bf16 v[52:55], v[116:119], a[28:31], v[52:55]
    s_waitcnt lgkmcnt(8)
    v_mfma_f32_16x16x32_bf16 v[40:43], v[120:123], a[24:27], v[40:43]
    s_add_u32 m0, s29, 34816
    ds_read_b64_tr_b16 v[112:113], v244 offset:2048
    ds_read_b64_tr_b16 v[114:115], v244 offset:6144
    v_mfma_f32_16x16x32_bf16 v[56:59], v[120:123], a[28:31], v[56:59]
    buffer_load_dwordx4 v232, s[96:99], s52 offen offset:0 lds
    v_mfma_f32_16x16x32_bf16 v[44:47], v[124:127], a[24:27], v[44:47]
    ds_read_b64_tr_b16 v[116:117], v245 offset:2048
    ds_read_b64_tr_b16 v[118:119], v245 offset:6144
    v_mfma_f32_16x16x32_bf16 v[60:63], v[124:127], a[28:31], v[60:63]
    s_waitcnt vmcnt(11) lgkmcnt(8)
    v_mfma_f32_16x16x32_bf16 v[0:3], v[96:99], a[32:35], v[0:3]
    ds_read_b64_tr_b16 v[120:121], v246 offset:2048
    ds_read_b64_tr_b16 v[122:123], v246 offset:6144
    v_mfma_f32_16x16x32_bf16 v[16:19], v[96:99], a[36:39], v[16:19]
    buffer_load_dwordx4 a[72:75], v226, s[36:39], s53 offen offset:2048 sc1
    v_mfma_f32_16x16x32_bf16 v[4:7], v[100:103], a[32:35], v[4:7]
    ds_read_b64_tr_b16 v[124:125], v247 offset:2048
    ds_read_b64_tr_b16 v[126:127], v247 offset:6144
    v_mfma_f32_16x16x32_bf16 v[20:23], v[100:103], a[36:39], v[20:23]
    s_waitcnt lgkmcnt(8)
    v_mfma_f32_16x16x32_bf16 v[8:11], v[104:107], a[32:35], v[8:11]
    ds_read_b64_tr_b16 v[96:97], v244 offset:8192
    ds_read_b64_tr_b16 v[98:99], v244 offset:12288
    v_mfma_f32_16x16x32_bf16 v[24:27], v[104:107], a[36:39], v[24:27]
    buffer_load_dwordx4 v233, s[96:99], s52 offen offset:1024 lds
    v_mfma_f32_16x16x32_bf16 v[12:15], v[108:111], a[32:35], v[12:15]
    ds_read_b64_tr_b16 v[100:101], v245 offset:8192
    ds_read_b64_tr_b16 v[102:103], v245 offset:12288
    v_mfma_f32_16x16x32_bf16 v[28:31], v[108:111], a[36:39], v[28:31]
    s_waitcnt lgkmcnt(8)
    v_mfma_f32_16x16x32_bf16 v[32:35], v[112:115], a[32:35], v[32:35]
    ds_read_b64_tr_b16 v[104:105], v246 offset:8192
    ds_read_b64_tr_b16 v[106:107], v246 offset:12288
    v_mfma_f32_16x16x32_bf16 v[48:51], v[112:115], a[36:39], v[48:51]
    buffer_load_dwordx4 a[76:79], v226, s[36:39], s53 offen offset:3072 sc1
    v_mfma_f32_16x16x32_bf16 v[36:39], v[116:119], a[32:35], v[36:39]
    ds_read_b64_tr_b16 v[108:109], v247 offset:8192
    ds_read_b64_tr_b16 v[110:111], v247 offset:12288
    v_mfma_f32_16x16x32_bf16 v[52:55], v[116:119], a[36:39], v[52:55]
    s_waitcnt lgkmcnt(8)
    v_mfma_f32_16x16x32_bf16 v[40:43], v[120:123], a[32:35], v[40:43]
    s_mov_b32 s53, 20480
    ds_read_b64_tr_b16 v[112:113], v244 offset:10240
    ds_read_b64_tr_b16 v[114:115], v244 offset:14336
    v_mfma_f32_16x16x32_bf16 v[56:59], v[120:123], a[36:39], v[56:59]
    buffer_load_dwordx2 a[80:81], v239, s[36:39], s53 offen offset:0 sc1
    buffer_load_dwordx2 a[82:83], v239, s[36:39], s53 offen offset:512 sc1
    v_mfma_f32_16x16x32_bf16 v[44:47], v[124:127], a[32:35], v[44:47]
    ds_read_b64_tr_b16 v[116:117], v245 offset:10240
    ds_read_b64_tr_b16 v[118:119], v245 offset:14336
    v_mfma_f32_16x16x32_bf16 v[60:63], v[124:127], a[36:39], v[60:63]
    s_waitcnt vmcnt(14) lgkmcnt(8)
    v_mfma_f32_16x16x32_bf16 v[0:3], v[96:99], a[40:43], v[0:3]
    ds_read_b64_tr_b16 v[120:121], v246 offset:10240
    ds_read_b64_tr_b16 v[122:123], v246 offset:14336
    v_mfma_f32_16x16x32_bf16 v[16:19], v[96:99], a[44:47], v[16:19]
    buffer_load_dwordx2 a[84:85], v239, s[36:39], s53 offen offset:1024 sc1
    buffer_load_dwordx2 a[86:87], v239, s[36:39], s53 offen offset:1536 sc1
    v_mfma_f32_16x16x32_bf16 v[4:7], v[100:103], a[40:43], v[4:7]
    ds_read_b64_tr_b16 v[124:125], v247 offset:10240
    ds_read_b64_tr_b16 v[126:127], v247 offset:14336
    v_mfma_f32_16x16x32_bf16 v[20:23], v[100:103], a[44:47], v[20:23]
    s_waitcnt lgkmcnt(8)
    v_mfma_f32_16x16x32_bf16 v[8:11], v[104:107], a[40:43], v[8:11]
    ds_read_b64_tr_b16 v[96:97], v248 offset:16384
    ds_read_b64_tr_b16 v[98:99], v248 offset:20480
    v_mfma_f32_16x16x32_bf16 v[24:27], v[104:107], a[44:47], v[24:27]
    buffer_load_dwordx4 a[88:91], v226, s[36:39], s53 offen offset:2048 sc1
    v_mfma_f32_16x16x32_bf16 v[12:15], v[108:111], a[40:43], v[12:15]
    ds_read_b64_tr_b16 v[100:101], v249 offset:16384
    ds_read_b64_tr_b16 v[102:103], v249 offset:20480
    v_mfma_f32_16x16x32_bf16 v[28:31], v[108:111], a[44:47], v[28:31]
    s_waitcnt lgkmcnt(8)
    v_mfma_f32_16x16x32_bf16 v[32:35], v[112:115], a[40:43], v[32:35]
    ds_read_b64_tr_b16 v[104:105], v250 offset:16384
    ds_read_b64_tr_b16 v[106:107], v250 offset:20480
    v_mfma_f32_16x16x32_bf16 v[48:51], v[112:115], a[44:47], v[48:51]
    v_mfma_f32_16x16x32_bf16 v[36:39], v[116:119], a[40:43], v[36:39]
    ds_read_b64_tr_b16 v[108:109], v251 offset:16384
    ds_read_b64_tr_b16 v[110:111], v251 offset:20480
    v_mfma_f32_16x16x32_bf16 v[52:55], v[116:119], a[44:47], v[52:55]
    s_waitcnt lgkmcnt(8)
    v_mfma_f32_16x16x32_bf16 v[40:43], v[120:123], a[40:43], v[40:43]
    ds_read_b64_tr_b16 v[112:113], v248 offset:18432
    ds_read_b64_tr_b16 v[114:115], v248 offset:22528
    v_mfma_f32_16x16x32_bf16 v[56:59], v[120:123], a[44:47], v[56:59]
    buffer_load_dwordx4 a[92:95], v226, s[36:39], s53 offen offset:3072 sc1
    v_mfma_f32_16x16x32_bf16 v[44:47], v[124:127], a[40:43], v[44:47]
    ds_read_b64_tr_b16 v[116:117], v249 offset:18432
    ds_read_b64_tr_b16 v[118:119], v249 offset:22528
    v_mfma_f32_16x16x32_bf16 v[60:63], v[124:127], a[44:47], v[60:63]
    s_waitcnt vmcnt(16) lgkmcnt(8)
    v_mfma_f32_16x16x32_bf16 v[0:3], v[96:99], a[48:51], v[0:3]
    ds_read_b64_tr_b16 v[120:121], v250 offset:18432
    ds_read_b64_tr_b16 v[122:123], v250 offset:22528
    v_mfma_f32_16x16x32_bf16 v[16:19], v[96:99], a[52:55], v[16:19]
    v_mfma_f32_16x16x32_bf16 v[4:7], v[100:103], a[48:51], v[4:7]
    ds_read_b64_tr_b16 v[124:125], v251 offset:18432
    ds_read_b64_tr_b16 v[126:127], v251 offset:22528
    v_mfma_f32_16x16x32_bf16 v[20:23], v[100:103], a[52:55], v[20:23]
    s_waitcnt lgkmcnt(8)
    v_mfma_f32_16x16x32_bf16 v[8:11], v[104:107], a[48:51], v[8:11]
    s_mov_b32 s53, 24576
    ds_read_b64_tr_b16 v[96:97], v248 offset:24576
    ds_read_b64_tr_b16 v[98:99], v248 offset:28672
    v_mfma_f32_16x16x32_bf16 v[24:27], v[104:107], a[52:55], v[24:27]
    buffer_load_dwordx4 a[96:99], v226, s[36:39], s53 offen offset:0 sc1
    v_mfma_f32_16x16x32_bf16 v[12:15], v[108:111], a[48:51], v[12:15]
    ds_read_b64_tr_b16 v[100:101], v249 offset:24576
    ds_read_b64_tr_b16 v[102:103], v249 offset:28672
    v_mfma_f32_16x16x32_bf16 v[28:31], v[108:111], a[52:55], v[28:31]
    s_waitcnt lgkmcnt(8)
    v_mfma_f32_16x16x32_bf16 v[32:35], v[112:115], a[48:51], v[32:35]
    ds_read_b64_tr_b16 v[104:105], v250 offset:24576
    ds_read_b64_tr_b16 v[106:107], v250 offset:28672
    v_mfma_f32_16x16x32_bf16 v[48:51], v[112:115], a[52:55], v[48:51]
    v_mfma_f32_16x16x32_bf16 v[36:39], v[116:119], a[48:51], v[36:39]
    ds_read_b64_tr_b16 v[108:109], v251 offset:24576
    ds_read_b64_tr_b16 v[110:111], v251 offset:28672
    v_mfma_f32_16x16x32_bf16 v[52:55], v[116:119], a[52:55], v[52:55]
    s_waitcnt lgkmcnt(8)
    v_mfma_f32_16x16x32_bf16 v[40:43], v[120:123], a[48:51], v[40:43]
    ds_read_b64_tr_b16 v[112:113], v248 offset:26624
    ds_read_b64_tr_b16 v[114:115], v248 offset:30720
    v_mfma_f32_16x16x32_bf16 v[56:59], v[120:123], a[52:55], v[56:59]
    buffer_load_dwordx4 a[100:103], v226, s[36:39], s53 offen offset:1024 sc1
    v_mfma_f32_16x16x32_bf16 v[44:47], v[124:127], a[48:51], v[44:47]
    ds_read_b64_tr_b16 v[116:117], v249 offset:26624
    ds_read_b64_tr_b16 v[118:119], v249 offset:30720
    v_mfma_f32_16x16x32_bf16 v[60:63], v[124:127], a[52:55], v[60:63]
    s_waitcnt vmcnt(16) lgkmcnt(8)
    v_mfma_f32_16x16x32_bf16 v[0:3], v[96:99], a[56:59], v[0:3]
    ds_read_b64_tr_b16 v[120:121], v250 offset:26624
    ds_read_b64_tr_b16 v[122:123], v250 offset:30720
    v_mfma_f32_16x16x32_bf16 v[16:19], v[96:99], a[60:63], v[16:19]
    v_mfma_f32_16x16x32_bf16 v[4:7], v[100:103], a[56:59], v[4:7]
    s_mov_b32 s52, 1441792
    ds_read_b64_tr_b16 v[124:125], v251 offset:26624
    ds_read_b64_tr_b16 v[126:127], v251 offset:30720
    v_mfma_f32_16x16x32_bf16 v[20:23], v[100:103], a[60:63], v[20:23]
    s_waitcnt lgkmcnt(8)
    s_barrier
    v_mfma_f32_16x16x32_bf16 v[8:11], v[104:107], a[56:59], v[8:11]
    s_add_u32 m0, s29, 49152
    ds_read_b64_tr_b16 v[96:97], v244 offset:16384
    ds_read_b64_tr_b16 v[98:99], v244 offset:20480
    v_mfma_f32_16x16x32_bf16 v[24:27], v[104:107], a[60:63], v[24:27]
    buffer_load_dwordx4 v230, s[32:35], s52 offen offset:0 lds
    v_mfma_f32_16x16x32_bf16 v[12:15], v[108:111], a[56:59], v[12:15]
    ds_read_b64_tr_b16 v[100:101], v245 offset:16384
    ds_read_b64_tr_b16 v[102:103], v245 offset:20480
    v_mfma_f32_16x16x32_bf16 v[28:31], v[108:111], a[60:63], v[28:31]
    s_waitcnt lgkmcnt(8)
    v_mfma_f32_16x16x32_bf16 v[32:35], v[112:115], a[56:59], v[32:35]
    ds_read_b64_tr_b16 v[104:105], v246 offset:16384
    ds_read_b64_tr_b16 v[106:107], v246 offset:20480
    v_mfma_f32_16x16x32_bf16 v[48:51], v[112:115], a[60:63], v[48:51]
    buffer_load_dwordx4 v231, s[32:35], s52 offen offset:1024 lds
    v_mfma_f32_16x16x32_bf16 v[36:39], v[116:119], a[56:59], v[36:39]
    ds_read_b64_tr_b16 v[108:109], v247 offset:16384
    ds_read_b64_tr_b16 v[110:111], v247 offset:20480
    v_mfma_f32_16x16x32_bf16 v[52:55], v[116:119], a[60:63], v[52:55]
    s_waitcnt lgkmcnt(8)
    v_mfma_f32_16x16x32_bf16 v[40:43], v[120:123], a[56:59], v[40:43]
    s_add_u32 m0, s29, 51200
    ds_read_b64_tr_b16 v[112:113], v244 offset:18432
    ds_read_b64_tr_b16 v[114:115], v244 offset:22528
    v_mfma_f32_16x16x32_bf16 v[56:59], v[120:123], a[60:63], v[56:59]
    buffer_load_dwordx4 v232, s[96:99], s52 offen offset:0 lds
    v_mfma_f32_16x16x32_bf16 v[44:47], v[124:127], a[56:59], v[44:47]
    ds_read_b64_tr_b16 v[116:117], v245 offset:18432
    ds_read_b64_tr_b16 v[118:119], v245 offset:22528
    v_mfma_f32_16x16x32_bf16 v[60:63], v[124:127], a[60:63], v[60:63]
    s_waitcnt vmcnt(17) lgkmcnt(8)
    v_mfma_f32_16x16x32_bf16 v[0:3], v[96:99], a[64:67], v[0:3]
    ds_read_b64_tr_b16 v[120:121], v246 offset:18432
    ds_read_b64_tr_b16 v[122:123], v246 offset:22528
    v_mfma_f32_16x16x32_bf16 v[16:19], v[96:99], a[68:71], v[16:19]
    buffer_load_dwordx4 v233, s[96:99], s52 offen offset:1024 lds
    v_mfma_f32_16x16x32_bf16 v[4:7], v[100:103], a[64:67], v[4:7]
    s_mov_b32 s52, 1572864
    ds_read_b64_tr_b16 v[124:125], v247 offset:18432
    ds_read_b64_tr_b16 v[126:127], v247 offset:22528
    v_mfma_f32_16x16x32_bf16 v[20:23], v[100:103], a[68:71], v[20:23]
    s_waitcnt lgkmcnt(8)
    v_mfma_f32_16x16x32_bf16 v[8:11], v[104:107], a[64:67], v[8:11]
    s_add_u32 m0, s29, 65536
    ds_read_b64_tr_b16 v[96:97], v244 offset:24576
    ds_read_b64_tr_b16 v[98:99], v244 offset:28672
    v_mfma_f32_16x16x32_bf16 v[24:27], v[104:107], a[68:71], v[24:27]
    buffer_load_dwordx4 v230, s[32:35], s52 offen offset:0 lds
    v_mfma_f32_16x16x32_bf16 v[12:15], v[108:111], a[64:67], v[12:15]
    ds_read_b64_tr_b16 v[100:101], v245 offset:24576
    ds_read_b64_tr_b16 v[102:103], v245 offset:28672
    v_mfma_f32_16x16x32_bf16 v[28:31], v[108:111], a[68:71], v[28:31]
    s_waitcnt lgkmcnt(8)
    v_mfma_f32_16x16x32_bf16 v[32:35], v[112:115], a[64:67], v[32:35]
    ds_read_b64_tr_b16 v[104:105], v246 offset:24576
    ds_read_b64_tr_b16 v[106:107], v246 offset:28672
    v_mfma_f32_16x16x32_bf16 v[48:51], v[112:115], a[68:71], v[48:51]
    buffer_load_dwordx4 a[104:107], v226, s[36:39], s53 offen offset:2048 sc1
    v_mfma_f32_16x16x32_bf16 v[36:39], v[116:119], a[64:67], v[36:39]
    ds_read_b64_tr_b16 v[108:109], v247 offset:24576
    ds_read_b64_tr_b16 v[110:111], v247 offset:28672
    v_mfma_f32_16x16x32_bf16 v[52:55], v[116:119], a[68:71], v[52:55]
    s_waitcnt lgkmcnt(8)
    v_mfma_f32_16x16x32_bf16 v[40:43], v[120:123], a[64:67], v[40:43]
    ds_read_b64_tr_b16 v[112:113], v244 offset:26624
    ds_read_b64_tr_b16 v[114:115], v244 offset:30720
    v_mfma_f32_16x16x32_bf16 v[56:59], v[120:123], a[68:71], v[56:59]
    buffer_load_dwordx4 v231, s[32:35], s52 offen offset:1024 lds
    v_mfma_f32_16x16x32_bf16 v[44:47], v[124:127], a[64:67], v[44:47]
    ds_read_b64_tr_b16 v[116:117], v245 offset:26624
    ds_read_b64_tr_b16 v[118:119], v245 offset:30720
    v_mfma_f32_16x16x32_bf16 v[60:63], v[124:127], a[68:71], v[60:63]
    s_waitcnt vmcnt(15) lgkmcnt(8)
    v_mfma_f32_16x16x32_bf16 v[0:3], v[96:99], a[72:75], v[0:3]
    ds_read_b64_tr_b16 v[120:121], v246 offset:26624
    ds_read_b64_tr_b16 v[122:123], v246 offset:30720
    v_mfma_f32_16x16x32_bf16 v[16:19], v[96:99], a[76:79], v[16:19]
    buffer_load_dwordx4 a[108:111], v226, s[36:39], s53 offen offset:3072 sc1
    v_mfma_f32_16x16x32_bf16 v[4:7], v[100:103], a[72:75], v[4:7]
    ds_read_b64_tr_b16 v[124:125], v247 offset:26624
    ds_read_b64_tr_b16 v[126:127], v247 offset:30720
    v_mfma_f32_16x16x32_bf16 v[20:23], v[100:103], a[76:79], v[20:23]
    s_waitcnt lgkmcnt(8)
    v_mfma_f32_16x16x32_bf16 v[8:11], v[104:107], a[72:75], v[8:11]
    s_add_u32 m0, s29, 67584
    ds_read_b64_tr_b16 v[96:97], v244 offset:32768
    ds_read_b64_tr_b16 v[98:99], v244 offset:36864
    v_mfma_f32_16x16x32_bf16 v[24:27], v[104:107], a[76:79], v[24:27]
    buffer_load_dwordx4 v232, s[96:99], s52 offen offset:0 lds
    v_mfma_f32_16x16x32_bf16 v[12:15], v[108:111], a[72:75], v[12:15]
    ds_read_b64_tr_b16 v[100:101], v245 offset:32768
    ds_read_b64_tr_b16 v[102:103], v245 offset:36864
    v_mfma_f32_16x16x32_bf16 v[28:31], v[108:111], a[76:79], v[28:31]
    s_waitcnt lgkmcnt(8)
    v_mfma_f32_16x16x32_bf16 v[32:35], v[112:115], a[72:75], v[32:35]
    s_mov_b32 s53, 28672
    ds_read_b64_tr_b16 v[104:105], v246 offset:32768
    ds_read_b64_tr_b16 v[106:107], v246 offset:36864
    v_mfma_f32_16x16x32_bf16 v[48:51], v[112:115], a[76:79], v[48:51]
    buffer_load_dwordx4 a[112:115], v226, s[36:39], s53 offen offset:0 sc1
    v_mfma_f32_16x16x32_bf16 v[36:39], v[116:119], a[72:75], v[36:39]
    ds_read_b64_tr_b16 v[108:109], v247 offset:32768
    ds_read_b64_tr_b16 v[110:111], v247 offset:36864
    v_mfma_f32_16x16x32_bf16 v[52:55], v[116:119], a[76:79], v[52:55]
    s_waitcnt lgkmcnt(8)
    v_mfma_f32_16x16x32_bf16 v[40:43], v[120:123], a[72:75], v[40:43]
    ds_read_b64_tr_b16 v[112:113], v244 offset:34816
    ds_read_b64_tr_b16 v[114:115], v244 offset:38912
    v_mfma_f32_16x16x32_bf16 v[56:59], v[120:123], a[76:79], v[56:59]
    buffer_load_dwordx4 v233, s[96:99], s52 offen offset:1024 lds
    v_mfma_f32_16x16x32_bf16 v[44:47], v[124:127], a[72:75], v[44:47]
    ds_read_b64_tr_b16 v[116:117], v245 offset:34816
    ds_read_b64_tr_b16 v[118:119], v245 offset:38912
    v_mfma_f32_16x16x32_bf16 v[60:63], v[124:127], a[76:79], v[60:63]
    s_waitcnt vmcnt(15) lgkmcnt(8)
    v_mfma_f32_16x16x32_bf16 v[0:3], v[96:99], a[80:83], v[0:3]
    ds_read_b64_tr_b16 v[120:121], v246 offset:34816
    ds_read_b64_tr_b16 v[122:123], v246 offset:38912
    v_mfma_f32_16x16x32_bf16 v[16:19], v[96:99], a[84:87], v[16:19]
    buffer_load_dwordx4 a[116:119], v226, s[36:39], s53 offen offset:1024 sc1
    v_mfma_f32_16x16x32_bf16 v[4:7], v[100:103], a[80:83], v[4:7]
    ds_read_b64_tr_b16 v[124:125], v247 offset:34816
    ds_read_b64_tr_b16 v[126:127], v247 offset:38912
    v_mfma_f32_16x16x32_bf16 v[20:23], v[100:103], a[84:87], v[20:23]
    s_waitcnt lgkmcnt(8)
    v_mfma_f32_16x16x32_bf16 v[8:11], v[104:107], a[80:83], v[8:11]
    ds_read_b64_tr_b16 v[96:97], v244 offset:40960
    ds_read_b64_tr_b16 v[98:99], v244 offset:45056
    v_mfma_f32_16x16x32_bf16 v[24:27], v[104:107], a[84:87], v[24:27]
    buffer_load_dwordx4 a[120:123], v226, s[36:39], s53 offen offset:2048 sc1
    v_mfma_f32_16x16x32_bf16 v[12:15], v[108:111], a[80:83], v[12:15]
    ds_read_b64_tr_b16 v[100:101], v245 offset:40960
    ds_read_b64_tr_b16 v[102:103], v245 offset:45056
    v_mfma_f32_16x16x32_bf16 v[28:31], v[108:111], a[84:87], v[28:31]
    s_waitcnt lgkmcnt(8)
    v_mfma_f32_16x16x32_bf16 v[32:35], v[112:115], a[80:83], v[32:35]
Lpad_16:
    s_cbranch_execz Lpad_19
    ds_read_b64_tr_b16 v[104:105], v246 offset:40960
    ds_read_b64_tr_b16 v[106:107], v246 offset:45056
    v_mfma_f32_16x16x32_bf16 v[48:51], v[112:115], a[84:87], v[48:51]
    buffer_load_dwordx4 a[124:127], v226, s[36:39], s53 offen offset:3072 sc1
    v_mfma_f32_16x16x32_bf16 v[36:39], v[116:119], a[80:83], v[36:39]
    ds_read_b64_tr_b16 v[108:109], v247 offset:40960
    ds_read_b64_tr_b16 v[110:111], v247 offset:45056
    v_mfma_f32_16x16x32_bf16 v[52:55], v[116:119], a[84:87], v[52:55]
    s_waitcnt lgkmcnt(8)
    v_mfma_f32_16x16x32_bf16 v[40:43], v[120:123], a[80:83], v[40:43]
    s_mov_b32 s53, 32768
    ds_read_b64_tr_b16 v[112:113], v244 offset:43008
    ds_read_b64_tr_b16 v[114:115], v244 offset:47104
    v_mfma_f32_16x16x32_bf16 v[56:59], v[120:123], a[84:87], v[56:59]
    buffer_load_dwordx4 a[128:131], v226, s[36:39], s53 offen offset:0 sc1
    v_mfma_f32_16x16x32_bf16 v[44:47], v[124:127], a[80:83], v[44:47]
    ds_read_b64_tr_b16 v[116:117], v245 offset:43008
    ds_read_b64_tr_b16 v[118:119], v245 offset:47104
    v_mfma_f32_16x16x32_bf16 v[60:63], v[124:127], a[84:87], v[60:63]
    s_waitcnt vmcnt(17) lgkmcnt(8)
    v_mfma_f32_16x16x32_bf16 v[0:3], v[96:99], a[88:91], v[0:3]
    ds_read_b64_tr_b16 v[120:121], v246 offset:43008
    ds_read_b64_tr_b16 v[122:123], v246 offset:47104
    v_mfma_f32_16x16x32_bf16 v[16:19], v[96:99], a[92:95], v[16:19]
    buffer_load_dwordx4 a[132:135], v226, s[36:39], s53 offen offset:1024 sc1
    v_mfma_f32_16x16x32_bf16 v[4:7], v[100:103], a[88:91], v[4:7]
    s_mov_b32 s52, 1703936
    ds_read_b64_tr_b16 v[124:125], v247 offset:43008
    ds_read_b64_tr_b16 v[126:127], v247 offset:47104
    v_mfma_f32_16x16x32_bf16 v[20:23], v[100:103], a[92:95], v[20:23]
    s_waitcnt lgkmcnt(8)
    s_barrier
    v_mfma_f32_16x16x32_bf16 v[8:11], v[104:107], a[88:91], v[8:11]
    s_add_u32 m0, s29, 147456
    ds_read_b64_tr_b16 v[96:97], v240 offset:0
    ds_read_b64_tr_b16 v[98:99], v240 offset:4096
    v_mfma_f32_16x16x32_bf16 v[24:27], v[104:107], a[92:95], v[24:27]
    buffer_load_dwordx4 v230, s[32:35], s52 offen offset:0 lds
    v_mfma_f32_16x16x32_bf16 v[12:15], v[108:111], a[88:91], v[12:15]
    ds_read_b64_tr_b16 v[100:101], v241 offset:0
    ds_read_b64_tr_b16 v[102:103], v241 offset:4096
    v_mfma_f32_16x16x32_bf16 v[28:31], v[108:111], a[92:95], v[28:31]
    s_waitcnt lgkmcnt(8)
    v_mfma_f32_16x16x32_bf16 v[32:35], v[112:115], a[88:91], v[32:35]
    ds_read_b64_tr_b16 v[104:105], v242 offset:0
    ds_read_b64_tr_b16 v[106:107], v242 offset:4096
    v_mfma_f32_16x16x32_bf16 v[48:51], v[112:115], a[92:95], v[48:51]
    buffer_load_dwordx4 v231, s[32:35], s52 offen offset:1024 lds
    v_mfma_f32_16x16x32_bf16 v[36:39], v[116:119], a[88:91], v[36:39]
    ds_read_b64_tr_b16 v[108:109], v243 offset:0
    ds_read_b64_tr_b16 v[110:111], v243 offset:4096
    v_mfma_f32_16x16x32_bf16 v[52:55], v[116:119], a[92:95], v[52:55]
    s_waitcnt lgkmcnt(8)
    v_mfma_f32_16x16x32_bf16 v[40:43], v[120:123], a[88:91], v[40:43]
    s_add_u32 m0, s29, 149504
    ds_read_b64_tr_b16 v[112:113], v240 offset:2048
    ds_read_b64_tr_b16 v[114:115], v240 offset:6144
    v_mfma_f32_16x16x32_bf16 v[56:59], v[120:123], a[92:95], v[56:59]
    buffer_load_dwordx4 v232, s[96:99], s52 offen offset:0 lds
    v_mfma_f32_16x16x32_bf16 v[44:47], v[124:127], a[88:91], v[44:47]
    ds_read_b64_tr_b16 v[116:117], v241 offset:2048
    ds_read_b64_tr_b16 v[118:119], v241 offset:6144
    v_mfma_f32_16x16x32_bf16 v[60:63], v[124:127], a[92:95], v[60:63]
    s_waitcnt vmcnt(19) lgkmcnt(8)
    v_mfma_f32_16x16x32_bf16 v[0:3], v[96:99], a[96:99], v[0:3]
    ds_read_b64_tr_b16 v[120:121], v242 offset:2048
    ds_read_b64_tr_b16 v[122:123], v242 offset:6144
    v_mfma_f32_16x16x32_bf16 v[16:19], v[96:99], a[100:103], v[16:19]
    buffer_load_dwordx2 a[136:137], v239, s[36:39], s53 offen offset:2048 sc1
    buffer_load_dwordx2 a[138:139], v239, s[36:39], s53 offen offset:2560 sc1
    v_mfma_f32_16x16x32_bf16 v[4:7], v[100:103], a[96:99], v[4:7]
    ds_read_b64_tr_b16 v[124:125], v243 offset:2048
    ds_read_b64_tr_b16 v[126:127], v243 offset:6144
    v_mfma_f32_16x16x32_bf16 v[20:23], v[100:103], a[100:103], v[20:23]
    s_waitcnt lgkmcnt(8)
    v_mfma_f32_16x16x32_bf16 v[8:11], v[104:107], a[96:99], v[8:11]
    ds_read_b64_tr_b16 v[96:97], v240 offset:8192
    ds_read_b64_tr_b16 v[98:99], v240 offset:12288
    v_mfma_f32_16x16x32_bf16 v[24:27], v[104:107], a[100:103], v[24:27]
    buffer_load_dwordx4 v233, s[96:99], s52 offen offset:1024 lds
    v_mfma_f32_16x16x32_bf16 v[12:15], v[108:111], a[96:99], v[12:15]
    ds_read_b64_tr_b16 v[100:101], v241 offset:8192
    ds_read_b64_tr_b16 v[102:103], v241 offset:12288
    v_mfma_f32_16x16x32_bf16 v[28:31], v[108:111], a[100:103], v[28:31]
    s_waitcnt lgkmcnt(8)
    v_mfma_f32_16x16x32_bf16 v[32:35], v[112:115], a[96:99], v[32:35]
    ds_read_b64_tr_b16 v[104:105], v242 offset:8192
    ds_read_b64_tr_b16 v[106:107], v242 offset:12288
    v_mfma_f32_16x16x32_bf16 v[48:51], v[112:115], a[100:103], v[48:51]
    buffer_load_dwordx2 a[140:141], v239, s[36:39], s53 offen offset:3072 sc1
    buffer_load_dwordx2 a[142:143], v239, s[36:39], s53 offen offset:3584 sc1
    v_mfma_f32_16x16x32_bf16 v[36:39], v[116:119], a[96:99], v[36:39]
    s_mov_b32 s52, 1835008
    ds_read_b64_tr_b16 v[108:109], v243 offset:8192
    ds_read_b64_tr_b16 v[110:111], v243 offset:12288
    v_mfma_f32_16x16x32_bf16 v[52:55], v[116:119], a[100:103], v[52:55]
    s_waitcnt lgkmcnt(8)
    v_mfma_f32_16x16x32_bf16 v[40:43], v[120:123], a[96:99], v[40:43]
    s_add_u32 m0, s29, 81920
    ds_read_b64_tr_b16 v[112:113], v240 offset:10240
    ds_read_b64_tr_b16 v[114:115], v240 offset:14336
    v_mfma_f32_16x16x32_bf16 v[56:59], v[120:123], a[100:103], v[56:59]
    buffer_load_dwordx4 v230, s[32:35], s52 offen offset:0 lds
    v_mfma_f32_16x16x32_bf16 v[44:47], v[124:127], a[96:99], v[44:47]
    ds_read_b64_tr_b16 v[116:117], v241 offset:10240
    ds_read_b64_tr_b16 v[118:119], v241 offset:14336
    v_mfma_f32_16x16x32_bf16 v[60:63], v[124:127], a[100:103], v[60:63]
    s_waitcnt vmcnt(17) lgkmcnt(8)
    v_mfma_f32_16x16x32_bf16 v[0:3], v[96:99], a[104:107], v[0:3]
    s_mov_b32 s53, 36864
    ds_read_b64_tr_b16 v[120:121], v242 offset:10240
    ds_read_b64_tr_b16 v[122:123], v242 offset:14336
    v_mfma_f32_16x16x32_bf16 v[16:19], v[96:99], a[108:111], v[16:19]
    buffer_load_dwordx4 a[144:147], v226, s[36:39], s53 offen offset:0 sc1
    v_mfma_f32_16x16x32_bf16 v[4:7], v[100:103], a[104:107], v[4:7]
    ds_read_b64_tr_b16 v[124:125], v243 offset:10240
    ds_read_b64_tr_b16 v[126:127], v243 offset:14336
    v_mfma_f32_16x16x32_bf16 v[20:23], v[100:103], a[108:111], v[20:23]
    s_waitcnt lgkmcnt(8)
    v_mfma_f32_16x16x32_bf16 v[8:11], v[104:107], a[104:107], v[8:11]
    ds_read_b64_tr_b16 v[96:97], v240 offset:16384
    ds_read_b64_tr_b16 v[98:99], v240 offset:20480
    v_mfma_f32_16x16x32_bf16 v[24:27], v[104:107], a[108:111], v[24:27]
    buffer_load_dwordx4 v231, s[32:35], s52 offen offset:1024 lds
    v_mfma_f32_16x16x32_bf16 v[12:15], v[108:111], a[104:107], v[12:15]
    ds_read_b64_tr_b16 v[100:101], v241 offset:16384
    ds_read_b64_tr_b16 v[102:103], v241 offset:20480
    v_mfma_f32_16x16x32_bf16 v[28:31], v[108:111], a[108:111], v[28:31]
    s_waitcnt lgkmcnt(8)
    v_mfma_f32_16x16x32_bf16 v[32:35], v[112:115], a[104:107], v[32:35]
    ds_read_b64_tr_b16 v[104:105], v242 offset:16384
    ds_read_b64_tr_b16 v[106:107], v242 offset:20480
    v_mfma_f32_16x16x32_bf16 v[48:51], v[112:115], a[108:111], v[48:51]
    buffer_load_dwordx4 a[148:151], v226, s[36:39], s53 offen offset:1024 sc1
    v_mfma_f32_16x16x32_bf16 v[36:39], v[116:119], a[104:107], v[36:39]
    ds_read_b64_tr_b16 v[108:109], v243 offset:16384
    ds_read_b64_tr_b16 v[110:111], v243 offset:20480
    v_mfma_f32_16x16x32_bf16 v[52:55], v[116:119], a[108:111], v[52:55]
    s_waitcnt lgkmcnt(8)
    v_mfma_f32_16x16x32_bf16 v[40:43], v[120:123], a[104:107], v[40:43]
    s_add_u32 m0, s29, 83968
    ds_read_b64_tr_b16 v[112:113], v240 offset:18432
    ds_read_b64_tr_b16 v[114:115], v240 offset:22528
    v_mfma_f32_16x16x32_bf16 v[56:59], v[120:123], a[108:111], v[56:59]
    buffer_load_dwordx4 v232, s[96:99], s52 offen offset:0 lds
    v_mfma_f32_16x16x32_bf16 v[44:47], v[124:127], a[104:107], v[44:47]
    ds_read_b64_tr_b16 v[116:117], v241 offset:18432
    ds_read_b64_tr_b16 v[118:119], v241 offset:22528
    v_mfma_f32_16x16x32_bf16 v[60:63], v[124:127], a[108:111], v[60:63]
    s_waitcnt vmcnt(17) lgkmcnt(8)
    v_mfma_f32_16x16x32_bf16 v[0:3], v[96:99], a[112:115], v[0:3]
    ds_read_b64_tr_b16 v[120:121], v242 offset:18432
    ds_read_b64_tr_b16 v[122:123], v242 offset:22528
    v_mfma_f32_16x16x32_bf16 v[16:19], v[96:99], a[116:119], v[16:19]
    buffer_load_dwordx4 a[152:155], v226, s[36:39], s53 offen offset:2048 sc1
    v_mfma_f32_16x16x32_bf16 v[4:7], v[100:103], a[112:115], v[4:7]
    ds_read_b64_tr_b16 v[124:125], v243 offset:18432
    ds_read_b64_tr_b16 v[126:127], v243 offset:22528
    v_mfma_f32_16x16x32_bf16 v[20:23], v[100:103], a[116:119], v[20:23]
    s_waitcnt lgkmcnt(8)
    v_mfma_f32_16x16x32_bf16 v[8:11], v[104:107], a[112:115], v[8:11]
    ds_read_b64_tr_b16 v[96:97], v240 offset:24576
    ds_read_b64_tr_b16 v[98:99], v240 offset:28672
    v_mfma_f32_16x16x32_bf16 v[24:27], v[104:107], a[116:119], v[24:27]
    buffer_load_dwordx4 a[156:159], v226, s[36:39], s53 offen offset:3072 sc1
    v_mfma_f32_16x16x32_bf16 v[12:15], v[108:111], a[112:115], v[12:15]
    ds_read_b64_tr_b16 v[100:101], v241 offset:24576
    ds_read_b64_tr_b16 v[102:103], v241 offset:28672
    v_mfma_f32_16x16x32_bf16 v[28:31], v[108:111], a[116:119], v[28:31]
    s_waitcnt lgkmcnt(8)
    v_mfma_f32_16x16x32_bf16 v[32:35], v[112:115], a[112:115], v[32:35]
    ds_read_b64_tr_b16 v[104:105], v242 offset:24576
    ds_read_b64_tr_b16 v[106:107], v242 offset:28672
    v_mfma_f32_16x16x32_bf16 v[48:51], v[112:115], a[116:119], v[48:51]
    buffer_load_dwordx4 v233, s[96:99], s52 offen offset:1024 lds
    v_mfma_f32_16x16x32_bf16 v[36:39], v[116:119], a[112:115], v[36:39]
    ds_read_b64_tr_b16 v[108:109], v243 offset:24576
    ds_read_b64_tr_b16 v[110:111], v243 offset:28672
    v_mfma_f32_16x16x32_bf16 v[52:55], v[116:119], a[116:119], v[52:55]
    s_waitcnt lgkmcnt(8)
    v_mfma_f32_16x16x32_bf16 v[40:43], v[120:123], a[112:115], v[40:43]
    s_mov_b32 s53, 40960
    ds_read_b64_tr_b16 v[112:113], v240 offset:26624
    ds_read_b64_tr_b16 v[114:115], v240 offset:30720
    v_mfma_f32_16x16x32_bf16 v[56:59], v[120:123], a[116:119], v[56:59]
    buffer_load_dwordx4 a[160:163], v226, s[36:39], s53 offen offset:0 sc1
    v_mfma_f32_16x16x32_bf16 v[44:47], v[124:127], a[112:115], v[44:47]
    ds_read_b64_tr_b16 v[116:117], v241 offset:26624
    ds_read_b64_tr_b16 v[118:119], v241 offset:30720
    v_mfma_f32_16x16x32_bf16 v[60:63], v[124:127], a[116:119], v[60:63]
    s_waitcnt vmcnt(19) lgkmcnt(8)
    v_mfma_f32_16x16x32_bf16 v[0:3], v[96:99], a[120:123], v[0:3]
    ds_read_b64_tr_b16 v[120:121], v242 offset:26624
    ds_read_b64_tr_b16 v[122:123], v242 offset:30720
    v_mfma_f32_16x16x32_bf16 v[16:19], v[96:99], a[124:127], v[16:19]
    buffer_load_dwordx4 a[164:167], v226, s[36:39], s53 offen offset:1024 sc1
    v_mfma_f32_16x16x32_bf16 v[4:7], v[100:103], a[120:123], v[4:7]
    s_mov_b32 s52, 1966080
    ds_read_b64_tr_b16 v[124:125], v243 offset:26624
    ds_read_b64_tr_b16 v[126:127], v243 offset:30720
    v_mfma_f32_16x16x32_bf16 v[20:23], v[100:103], a[124:127], v[20:23]
    s_waitcnt lgkmcnt(8)
    s_barrier
    v_mfma_f32_16x16x32_bf16 v[8:11], v[104:107], a[120:123], v[8:11]
    s_add_u32 m0, s29, 98304
    ds_read_b64_tr_b16 v[96:97], v244 offset:49152
    ds_read_b64_tr_b16 v[98:99], v244 offset:53248
    v_mfma_f32_16x16x32_bf16 v[24:27], v[104:107], a[124:127], v[24:27]
    buffer_load_dwordx4 v230, s[32:35], s52 offen offset:0 lds
    v_mfma_f32_16x16x32_bf16 v[12:15], v[108:111], a[120:123], v[12:15]
    ds_read_b64_tr_b16 v[100:101], v245 offset:49152
    ds_read_b64_tr_b16 v[102:103], v245 offset:53248
    v_mfma_f32_16x16x32_bf16 v[28:31], v[108:111], a[124:127], v[28:31]
    s_waitcnt lgkmcnt(8)
    v_mfma_f32_16x16x32_bf16 v[32:35], v[112:115], a[120:123], v[32:35]
    ds_read_b64_tr_b16 v[104:105], v246 offset:49152
    ds_read_b64_tr_b16 v[106:107], v246 offset:53248
    v_mfma_f32_16x16x32_bf16 v[48:51], v[112:115], a[124:127], v[48:51]
    buffer_load_dwordx4 v231, s[32:35], s52 offen offset:1024 lds
    v_mfma_f32_16x16x32_bf16 v[36:39], v[116:119], a[120:123], v[36:39]
    ds_read_b64_tr_b16 v[108:109], v247 offset:49152
    ds_read_b64_tr_b16 v[110:111], v247 offset:53248
    v_mfma_f32_16x16x32_bf16 v[52:55], v[116:119], a[124:127], v[52:55]
    s_waitcnt lgkmcnt(8)
    v_mfma_f32_16x16x32_bf16 v[40:43], v[120:123], a[120:123], v[40:43]
    ds_read_b64_tr_b16 v[112:113], v244 offset:51200
    ds_read_b64_tr_b16 v[114:115], v244 offset:55296
    v_mfma_f32_16x16x32_bf16 v[56:59], v[120:123], a[124:127], v[56:59]
    buffer_load_dwordx4 a[168:171], v226, s[36:39], s53 offen offset:2048 sc1
    v_mfma_f32_16x16x32_bf16 v[44:47], v[124:127], a[120:123], v[44:47]
    ds_read_b64_tr_b16 v[116:117], v245 offset:51200
    ds_read_b64_tr_b16 v[118:119], v245 offset:55296
    v_mfma_f32_16x16x32_bf16 v[60:63], v[124:127], a[124:127], v[60:63]
    s_waitcnt vmcnt(21) lgkmcnt(8)
    v_mfma_f32_16x16x32_bf16 v[0:3], v[96:99], a[128:131], v[0:3]
    ds_read_b64_tr_b16 v[120:121], v246 offset:51200
    ds_read_b64_tr_b16 v[122:123], v246 offset:55296
    v_mfma_f32_16x16x32_bf16 v[16:19], v[96:99], a[132:135], v[16:19]
    buffer_load_dwordx4 a[172:175], v226, s[36:39], s53 offen offset:3072 sc1
    v_mfma_f32_16x16x32_bf16 v[4:7], v[100:103], a[128:131], v[4:7]
    ds_read_b64_tr_b16 v[124:125], v247 offset:51200
    ds_read_b64_tr_b16 v[126:127], v247 offset:55296
    v_mfma_f32_16x16x32_bf16 v[20:23], v[100:103], a[132:135], v[20:23]
    s_waitcnt lgkmcnt(8)
    v_mfma_f32_16x16x32_bf16 v[8:11], v[104:107], a[128:131], v[8:11]
    s_add_u32 m0, s29, 100352
    ds_read_b64_tr_b16 v[96:97], v244 offset:57344
    ds_read_b64_tr_b16 v[98:99], v244 offset:61440
    v_mfma_f32_16x16x32_bf16 v[24:27], v[104:107], a[132:135], v[24:27]
    buffer_load_dwordx4 v232, s[96:99], s52 offen offset:0 lds
    v_mfma_f32_16x16x32_bf16 v[12:15], v[108:111], a[128:131], v[12:15]
    ds_read_b64_tr_b16 v[100:101], v245 offset:57344
    ds_read_b64_tr_b16 v[102:103], v245 offset:61440
    v_mfma_f32_16x16x32_bf16 v[28:31], v[108:111], a[132:135], v[28:31]
    s_waitcnt lgkmcnt(8)
    v_mfma_f32_16x16x32_bf16 v[32:35], v[112:115], a[128:131], v[32:35]
    s_mov_b32 s53, 45056
    ds_read_b64_tr_b16 v[104:105], v246 offset:57344
    ds_read_b64_tr_b16 v[106:107], v246 offset:61440
    v_mfma_f32_16x16x32_bf16 v[48:51], v[112:115], a[132:135], v[48:51]
    buffer_load_dwordx4 a[176:179], v226, s[36:39], s53 offen offset:0 sc1
    v_mfma_f32_16x16x32_bf16 v[36:39], v[116:119], a[128:131], v[36:39]
    ds_read_b64_tr_b16 v[108:109], v247 offset:57344
    ds_read_b64_tr_b16 v[110:111], v247 offset:61440
    v_mfma_f32_16x16x32_bf16 v[52:55], v[116:119], a[132:135], v[52:55]
    s_waitcnt lgkmcnt(8)
    v_mfma_f32_16x16x32_bf16 v[40:43], v[120:123], a[128:131], v[40:43]
    ds_read_b64_tr_b16 v[112:113], v244 offset:59392
    ds_read_b64_tr_b16 v[114:115], v244 offset:63488
    v_mfma_f32_16x16x32_bf16 v[56:59], v[120:123], a[132:135], v[56:59]
    buffer_load_dwordx4 v233, s[96:99], s52 offen offset:1024 lds
    v_mfma_f32_16x16x32_bf16 v[44:47], v[124:127], a[128:131], v[44:47]
    ds_read_b64_tr_b16 v[116:117], v245 offset:59392
    ds_read_b64_tr_b16 v[118:119], v245 offset:63488
    v_mfma_f32_16x16x32_bf16 v[60:63], v[124:127], a[132:135], v[60:63]
    s_waitcnt vmcnt(17) lgkmcnt(8)
    v_mfma_f32_16x16x32_bf16 v[0:3], v[96:99], a[136:139], v[0:3]
    ds_read_b64_tr_b16 v[120:121], v246 offset:59392
    ds_read_b64_tr_b16 v[122:123], v246 offset:63488
    v_mfma_f32_16x16x32_bf16 v[16:19], v[96:99], a[140:143], v[16:19]
    buffer_load_dwordx4 a[180:183], v226, s[36:39], s53 offen offset:1024 sc1
    v_mfma_f32_16x16x32_bf16 v[4:7], v[100:103], a[136:139], v[4:7]
    s_mov_b32 s52, 2097152
    ds_read_b64_tr_b16 v[124:125], v247 offset:59392
    ds_read_b64_tr_b16 v[126:127], v247 offset:63488
    v_mfma_f32_16x16x32_bf16 v[20:23], v[100:103], a[140:143], v[20:23]
    s_waitcnt lgkmcnt(8)
    v_mfma_f32_16x16x32_bf16 v[8:11], v[104:107], a[136:139], v[8:11]
    s_add_u32 m0, s29, 0
    ds_read_b64_tr_b16 v[96:97], v248 offset:0
    ds_read_b64_tr_b16 v[98:99], v248 offset:4096
    v_mfma_f32_16x16x32_bf16 v[24:27], v[104:107], a[140:143], v[24:27]
    buffer_load_dwordx4 v230, s[32:35], s52 offen offset:0 lds
    v_mfma_f32_16x16x32_bf16 v[12:15], v[108:111], a[136:139], v[12:15]
    ds_read_b64_tr_b16 v[100:101], v249 offset:0
    ds_read_b64_tr_b16 v[102:103], v249 offset:4096
    v_mfma_f32_16x16x32_bf16 v[28:31], v[108:111], a[140:143], v[28:31]
    s_waitcnt lgkmcnt(8)
    v_mfma_f32_16x16x32_bf16 v[32:35], v[112:115], a[136:139], v[32:35]
    ds_read_b64_tr_b16 v[104:105], v250 offset:0
    ds_read_b64_tr_b16 v[106:107], v250 offset:4096
    v_mfma_f32_16x16x32_bf16 v[48:51], v[112:115], a[140:143], v[48:51]
    buffer_load_dwordx4 a[184:187], v226, s[36:39], s53 offen offset:2048 sc1
    v_mfma_f32_16x16x32_bf16 v[36:39], v[116:119], a[136:139], v[36:39]
    ds_read_b64_tr_b16 v[108:109], v251 offset:0
    ds_read_b64_tr_b16 v[110:111], v251 offset:4096
    v_mfma_f32_16x16x32_bf16 v[52:55], v[116:119], a[140:143], v[52:55]
    s_waitcnt lgkmcnt(8)
    v_mfma_f32_16x16x32_bf16 v[40:43], v[120:123], a[136:139], v[40:43]
    ds_read_b64_tr_b16 v[112:113], v248 offset:2048
    ds_read_b64_tr_b16 v[114:115], v248 offset:6144
    v_mfma_f32_16x16x32_bf16 v[56:59], v[120:123], a[140:143], v[56:59]
    buffer_load_dwordx4 v231, s[32:35], s52 offen offset:1024 lds
    v_mfma_f32_16x16x32_bf16 v[44:47], v[124:127], a[136:139], v[44:47]
    ds_read_b64_tr_b16 v[116:117], v249 offset:2048
    ds_read_b64_tr_b16 v[118:119], v249 offset:6144
    v_mfma_f32_16x16x32_bf16 v[60:63], v[124:127], a[140:143], v[60:63]
    s_waitcnt vmcnt(17) lgkmcnt(8)
    v_mfma_f32_16x16x32_bf16 v[0:3], v[96:99], a[144:147], v[0:3]
    ds_read_b64_tr_b16 v[120:121], v250 offset:2048
    ds_read_b64_tr_b16 v[122:123], v250 offset:6144
    v_mfma_f32_16x16x32_bf16 v[16:19], v[96:99], a[148:151], v[16:19]
    buffer_load_dwordx4 a[188:191], v226, s[36:39], s53 offen offset:3072 sc1
    v_mfma_f32_16x16x32_bf16 v[4:7], v[100:103], a[144:147], v[4:7]
    ds_read_b64_tr_b16 v[124:125], v251 offset:2048
    ds_read_b64_tr_b16 v[126:127], v251 offset:6144
    v_mfma_f32_16x16x32_bf16 v[20:23], v[100:103], a[148:151], v[20:23]
    s_waitcnt lgkmcnt(8)
    v_mfma_f32_16x16x32_bf16 v[8:11], v[104:107], a[144:147], v[8:11]
    s_mov_b32 s53, 49152
    ds_read_b64_tr_b16 v[96:97], v248 offset:8192
    ds_read_b64_tr_b16 v[98:99], v248 offset:12288
    v_mfma_f32_16x16x32_bf16 v[24:27], v[104:107], a[148:151], v[24:27]
    buffer_load_dwordx2 a[192:193], v239, s[36:39], s53 offen offset:0 sc1
    buffer_load_dwordx2 a[194:195], v239, s[36:39], s53 offen offset:512 sc1
    v_mfma_f32_16x16x32_bf16 v[12:15], v[108:111], a[144:147], v[12:15]
    ds_read_b64_tr_b16 v[100:101], v249 offset:8192
    ds_read_b64_tr_b16 v[102:103], v249 offset:12288
    v_mfma_f32_16x16x32_bf16 v[28:31], v[108:111], a[148:151], v[28:31]
    s_waitcnt lgkmcnt(8)
    v_mfma_f32_16x16x32_bf16 v[32:35], v[112:115], a[144:147], v[32:35]
    s_add_u32 m0, s29, 2048
    ds_read_b64_tr_b16 v[104:105], v250 offset:8192
    ds_read_b64_tr_b16 v[106:107], v250 offset:12288
    v_mfma_f32_16x16x32_bf16 v[48:51], v[112:115], a[148:151], v[48:51]
    buffer_load_dwordx4 v232, s[96:99], s52 offen offset:0 lds
    v_mfma_f32_16x16x32_bf16 v[36:39], v[116:119], a[144:147], v[36:39]
    ds_read_b64_tr_b16 v[108:109], v251 offset:8192
    ds_read_b64_tr_b16 v[110:111], v251 offset:12288
    v_mfma_f32_16x16x32_bf16 v[52:55], v[116:119], a[148:151], v[52:55]
    s_waitcnt lgkmcnt(8)
    v_mfma_f32_16x16x32_bf16 v[40:43], v[120:123], a[144:147], v[40:43]
    ds_read_b64_tr_b16 v[112:113], v248 offset:10240
    ds_read_b64_tr_b16 v[114:115], v248 offset:14336
    v_mfma_f32_16x16x32_bf16 v[56:59], v[120:123], a[148:151], v[56:59]
    buffer_load_dwordx2 a[196:197], v239, s[36:39], s53 offen offset:1024 sc1
    buffer_load_dwordx2 a[198:199], v239, s[36:39], s53 offen offset:1536 sc1
    v_mfma_f32_16x16x32_bf16 v[44:47], v[124:127], a[144:147], v[44:47]
    ds_read_b64_tr_b16 v[116:117], v249 offset:10240
    ds_read_b64_tr_b16 v[118:119], v249 offset:14336
    v_mfma_f32_16x16x32_bf16 v[60:63], v[124:127], a[148:151], v[60:63]
    s_waitcnt vmcnt(20) lgkmcnt(8)
    v_mfma_f32_16x16x32_bf16 v[0:3], v[96:99], a[152:155], v[0:3]
    ds_read_b64_tr_b16 v[120:121], v250 offset:10240
    ds_read_b64_tr_b16 v[122:123], v250 offset:14336
    v_mfma_f32_16x16x32_bf16 v[16:19], v[96:99], a[156:159], v[16:19]
    buffer_load_dwordx4 v233, s[96:99], s52 offen offset:1024 lds
    v_mfma_f32_16x16x32_bf16 v[4:7], v[100:103], a[152:155], v[4:7]
    ds_read_b64_tr_b16 v[124:125], v251 offset:10240
    ds_read_b64_tr_b16 v[126:127], v251 offset:14336
    v_mfma_f32_16x16x32_bf16 v[20:23], v[100:103], a[156:159], v[20:23]
    s_waitcnt lgkmcnt(8)
    s_barrier
    v_mfma_f32_16x16x32_bf16 v[8:11], v[104:107], a[152:155], v[8:11]
    ds_read_b64_tr_b16 v[96:97], v240 offset:32768
    ds_read_b64_tr_b16 v[98:99], v240 offset:36864
    v_mfma_f32_16x16x32_bf16 v[24:27], v[104:107], a[156:159], v[24:27]
    buffer_load_dwordx4 a[200:203], v226, s[36:39], s53 offen offset:2048 sc1
    v_mfma_f32_16x16x32_bf16 v[12:15], v[108:111], a[152:155], v[12:15]
    s_mov_b32 s52, 2228224
    ds_read_b64_tr_b16 v[100:101], v241 offset:32768
    ds_read_b64_tr_b16 v[102:103], v241 offset:36864
    v_mfma_f32_16x16x32_bf16 v[28:31], v[108:111], a[156:159], v[28:31]
    s_waitcnt lgkmcnt(8)
    v_mfma_f32_16x16x32_bf16 v[32:35], v[112:115], a[152:155], v[32:35]
    s_add_u32 m0, s29, 16384
    ds_read_b64_tr_b16 v[104:105], v242 offset:32768
    ds_read_b64_tr_b16 v[106:107], v242 offset:36864
    v_mfma_f32_16x16x32_bf16 v[48:51], v[112:115], a[156:159], v[48:51]
    buffer_load_dwordx4 v230, s[32:35], s52 offen offset:0 lds
    v_mfma_f32_16x16x32_bf16 v[36:39], v[116:119], a[152:155], v[36:39]
    ds_read_b64_tr_b16 v[108:109], v243 offset:32768
    ds_read_b64_tr_b16 v[110:111], v243 offset:36864
    v_mfma_f32_16x16x32_bf16 v[52:55], v[116:119], a[156:159], v[52:55]
    s_waitcnt lgkmcnt(8)
    v_mfma_f32_16x16x32_bf16 v[40:43], v[120:123], a[152:155], v[40:43]
    ds_read_b64_tr_b16 v[112:113], v240 offset:34816
    ds_read_b64_tr_b16 v[114:115], v240 offset:38912
    v_mfma_f32_16x16x32_bf16 v[56:59], v[120:123], a[156:159], v[56:59]
    buffer_load_dwordx4 a[204:207], v226, s[36:39], s53 offen offset:3072 sc1
    v_mfma_f32_16x16x32_bf16 v[44:47], v[124:127], a[152:155], v[44:47]
    ds_read_b64_tr_b16 v[116:117], v241 offset:34816
    ds_read_b64_tr_b16 v[118:119], v241 offset:38912
    v_mfma_f32_16x16x32_bf16 v[60:63], v[124:127], a[156:159], v[60:63]
    s_waitcnt vmcnt(21) lgkmcnt(8)
    v_mfma_f32_16x16x32_bf16 v[0:3], v[96:99], a[160:163], v[0:3]
    ds_read_b64_tr_b16 v[120:121], v242 offset:34816
    ds_read_b64_tr_b16 v[122:123], v242 offset:38912
    v_mfma_f32_16x16x32_bf16 v[16:19], v[96:99], a[164:167], v[16:19]
    v_mfma_f32_16x16x32_bf16 v[4:7], v[100:103], a[160:163], v[4:7]
    ds_read_b64_tr_b16 v[124:125], v243 offset:34816
    ds_read_b64_tr_b16 v[126:127], v243 offset:38912
    v_mfma_f32_16x16x32_bf16 v[20:23], v[100:103], a[164:167], v[20:23]
    s_waitcnt lgkmcnt(8)
    v_mfma_f32_16x16x32_bf16 v[8:11], v[104:107], a[160:163], v[8:11]
    s_mov_b32 s53, 53248
    ds_read_b64_tr_b16 v[96:97], v240 offset:40960
    ds_read_b64_tr_b16 v[98:99], v240 offset:45056
    v_mfma_f32_16x16x32_bf16 v[24:27], v[104:107], a[164:167], v[24:27]
    buffer_load_dwordx4 a[208:211], v226, s[36:39], s53 offen offset:0 sc1
    v_mfma_f32_16x16x32_bf16 v[12:15], v[108:111], a[160:163], v[12:15]
    ds_read_b64_tr_b16 v[100:101], v241 offset:40960
    ds_read_b64_tr_b16 v[102:103], v241 offset:45056
    v_mfma_f32_16x16x32_bf16 v[28:31], v[108:111], a[164:167], v[28:31]
    s_waitcnt lgkmcnt(8)
    v_mfma_f32_16x16x32_bf16 v[32:35], v[112:115], a[160:163], v[32:35]
    ds_read_b64_tr_b16 v[104:105], v242 offset:40960
    ds_read_b64_tr_b16 v[106:107], v242 offset:45056
    v_mfma_f32_16x16x32_bf16 v[48:51], v[112:115], a[164:167], v[48:51]
    buffer_load_dwordx4 v231, s[32:35], s52 offen offset:1024 lds
    v_mfma_f32_16x16x32_bf16 v[36:39], v[116:119], a[160:163], v[36:39]
    ds_read_b64_tr_b16 v[108:109], v243 offset:40960
    ds_read_b64_tr_b16 v[110:111], v243 offset:45056
    v_mfma_f32_16x16x32_bf16 v[52:55], v[116:119], a[164:167], v[52:55]
    s_waitcnt lgkmcnt(8)
    v_mfma_f32_16x16x32_bf16 v[40:43], v[120:123], a[160:163], v[40:43]
    ds_read_b64_tr_b16 v[112:113], v240 offset:43008
    ds_read_b64_tr_b16 v[114:115], v240 offset:47104
    v_mfma_f32_16x16x32_bf16 v[56:59], v[120:123], a[164:167], v[56:59]
    buffer_load_dwordx4 a[212:215], v226, s[36:39], s53 offen offset:1024 sc1
    v_mfma_f32_16x16x32_bf16 v[44:47], v[124:127], a[160:163], v[44:47]
    ds_read_b64_tr_b16 v[116:117], v241 offset:43008
    ds_read_b64_tr_b16 v[118:119], v241 offset:47104
    v_mfma_f32_16x16x32_bf16 v[60:63], v[124:127], a[164:167], v[60:63]
    s_waitcnt vmcnt(20) lgkmcnt(8)
    v_mfma_f32_16x16x32_bf16 v[0:3], v[96:99], a[168:171], v[0:3]
    s_add_u32 m0, s29, 18432
    ds_read_b64_tr_b16 v[120:121], v242 offset:43008
    ds_read_b64_tr_b16 v[122:123], v242 offset:47104
    v_mfma_f32_16x16x32_bf16 v[16:19], v[96:99], a[172:175], v[16:19]
    buffer_load_dwordx4 v232, s[96:99], s52 offen offset:0 lds
    v_mfma_f32_16x16x32_bf16 v[4:7], v[100:103], a[168:171], v[4:7]
    ds_read_b64_tr_b16 v[124:125], v243 offset:43008
    ds_read_b64_tr_b16 v[126:127], v243 offset:47104
    v_mfma_f32_16x16x32_bf16 v[20:23], v[100:103], a[172:175], v[20:23]
    s_waitcnt lgkmcnt(8)
    v_mfma_f32_16x16x32_bf16 v[8:11], v[104:107], a[168:171], v[8:11]
    ds_read_b64_tr_b16 v[96:97], v240 offset:49152
    ds_read_b64_tr_b16 v[98:99], v240 offset:53248
    v_mfma_f32_16x16x32_bf16 v[24:27], v[104:107], a[172:175], v[24:27]
    buffer_load_dwordx4 a[216:219], v226, s[36:39], s53 offen offset:2048 sc1
    v_mfma_f32_16x16x32_bf16 v[12:15], v[108:111], a[168:171], v[12:15]
    ds_read_b64_tr_b16 v[100:101], v241 offset:49152
    ds_read_b64_tr_b16 v[102:103], v241 offset:53248
    v_mfma_f32_16x16x32_bf16 v[28:31], v[108:111], a[172:175], v[28:31]
    s_waitcnt lgkmcnt(8)
    v_mfma_f32_16x16x32_bf16 v[32:35], v[112:115], a[168:171], v[32:35]
    ds_read_b64_tr_b16 v[104:105], v242 offset:49152
    ds_read_b64_tr_b16 v[106:107], v242 offset:53248
    v_mfma_f32_16x16x32_bf16 v[48:51], v[112:115], a[172:175], v[48:51]
    buffer_load_dwordx4 v233, s[96:99], s52 offen offset:1024 lds
    v_mfma_f32_16x16x32_bf16 v[36:39], v[116:119], a[168:171], v[36:39]
    ds_read_b64_tr_b16 v[108:109], v243 offset:49152
    ds_read_b64_tr_b16 v[110:111], v243 offset:53248
    v_mfma_f32_16x16x32_bf16 v[52:55], v[116:119], a[172:175], v[52:55]
    s_waitcnt lgkmcnt(8)
    v_mfma_f32_16x16x32_bf16 v[40:43], v[120:123], a[168:171], v[40:43]
    ds_read_b64_tr_b16 v[112:113], v240 offset:51200
    ds_read_b64_tr_b16 v[114:115], v240 offset:55296
    v_mfma_f32_16x16x32_bf16 v[56:59], v[120:123], a[172:175], v[56:59]
    buffer_load_dwordx4 a[220:223], v226, s[36:39], s53 offen offset:3072 sc1
    v_mfma_f32_16x16x32_bf16 v[44:47], v[124:127], a[168:171], v[44:47]
    ds_read_b64_tr_b16 v[116:117], v241 offset:51200
    ds_read_b64_tr_b16 v[118:119], v241 offset:55296
    v_mfma_f32_16x16x32_bf16 v[60:63], v[124:127], a[172:175], v[60:63]
    s_waitcnt vmcnt(20) lgkmcnt(8)
    v_mfma_f32_16x16x32_bf16 v[0:3], v[96:99], a[176:179], v[0:3]
    ds_read_b64_tr_b16 v[120:121], v242 offset:51200
    ds_read_b64_tr_b16 v[122:123], v242 offset:55296
    v_mfma_f32_16x16x32_bf16 v[16:19], v[96:99], a[180:183], v[16:19]
    v_mfma_f32_16x16x32_bf16 v[4:7], v[100:103], a[176:179], v[4:7]
    s_mov_b32 s52, 2359296
    ds_read_b64_tr_b16 v[124:125], v243 offset:51200
    ds_read_b64_tr_b16 v[126:127], v243 offset:55296
    v_mfma_f32_16x16x32_bf16 v[20:23], v[100:103], a[180:183], v[20:23]
    s_waitcnt lgkmcnt(8)
    v_mfma_f32_16x16x32_bf16 v[8:11], v[104:107], a[176:179], v[8:11]
    s_add_u32 m0, s29, 114688
    ds_read_b64_tr_b16 v[96:97], v240 offset:57344
    ds_read_b64_tr_b16 v[98:99], v240 offset:61440
    v_mfma_f32_16x16x32_bf16 v[24:27], v[104:107], a[180:183], v[24:27]
    buffer_load_dwordx4 v230, s[32:35], s52 offen offset:0 lds
    v_mfma_f32_16x16x32_bf16 v[12:15], v[108:111], a[176:179], v[12:15]
    ds_read_b64_tr_b16 v[100:101], v241 offset:57344
    ds_read_b64_tr_b16 v[102:103], v241 offset:61440
    v_mfma_f32_16x16x32_bf16 v[28:31], v[108:111], a[180:183], v[28:31]
    s_waitcnt lgkmcnt(8)
    v_mfma_f32_16x16x32_bf16 v[32:35], v[112:115], a[176:179], v[32:35]
    s_mov_b32 s53, 57344
    ds_read_b64_tr_b16 v[104:105], v242 offset:57344
    ds_read_b64_tr_b16 v[106:107], v242 offset:61440
    v_mfma_f32_16x16x32_bf16 v[48:51], v[112:115], a[180:183], v[48:51]
    buffer_load_dwordx4 a[224:227], v226, s[36:39], s53 offen offset:0 sc1
    v_mfma_f32_16x16x32_bf16 v[36:39], v[116:119], a[176:179], v[36:39]
    ds_read_b64_tr_b16 v[108:109], v243 offset:57344
    ds_read_b64_tr_b16 v[110:111], v243 offset:61440
    v_mfma_f32_16x16x32_bf16 v[52:55], v[116:119], a[180:183], v[52:55]
    s_waitcnt lgkmcnt(8)
    v_mfma_f32_16x16x32_bf16 v[40:43], v[120:123], a[176:179], v[40:43]
    ds_read_b64_tr_b16 v[112:113], v240 offset:59392
    ds_read_b64_tr_b16 v[114:115], v240 offset:63488
    v_mfma_f32_16x16x32_bf16 v[56:59], v[120:123], a[180:183], v[56:59]
    buffer_load_dwordx4 a[228:231], v226, s[36:39], s53 offen offset:1024 sc1
    v_mfma_f32_16x16x32_bf16 v[44:47], v[124:127], a[176:179], v[44:47]
    ds_read_b64_tr_b16 v[116:117], v241 offset:59392
    ds_read_b64_tr_b16 v[118:119], v241 offset:63488
    v_mfma_f32_16x16x32_bf16 v[60:63], v[124:127], a[180:183], v[60:63]
    s_waitcnt vmcnt(19) lgkmcnt(8)
    v_mfma_f32_16x16x32_bf16 v[0:3], v[96:99], a[184:187], v[0:3]
    ds_read_b64_tr_b16 v[120:121], v242 offset:59392
    ds_read_b64_tr_b16 v[122:123], v242 offset:63488
    v_mfma_f32_16x16x32_bf16 v[16:19], v[96:99], a[188:191], v[16:19]
    buffer_load_dwordx4 v231, s[32:35], s52 offen offset:1024 lds
    v_mfma_f32_16x16x32_bf16 v[4:7], v[100:103], a[184:187], v[4:7]
    ds_read_b64_tr_b16 v[124:125], v243 offset:59392
    ds_read_b64_tr_b16 v[126:127], v243 offset:63488
    v_mfma_f32_16x16x32_bf16 v[20:23], v[100:103], a[188:191], v[20:23]
    s_waitcnt lgkmcnt(8)
    s_barrier
    v_mfma_f32_16x16x32_bf16 v[8:11], v[104:107], a[184:187], v[8:11]
Lpad_17:
    s_cbranch_execz Lback_d2
    ds_read_b64_tr_b16 v[96:97], v244 offset:0
    ds_read_b64_tr_b16 v[98:99], v244 offset:4096
    v_mfma_f32_16x16x32_bf16 v[24:27], v[104:107], a[188:191], v[24:27]
    buffer_load_dwordx4 a[232:235], v226, s[36:39], s53 offen offset:2048 sc1
    v_mfma_f32_16x16x32_bf16 v[12:15], v[108:111], a[184:187], v[12:15]
    ds_read_b64_tr_b16 v[100:101], v245 offset:0
    ds_read_b64_tr_b16 v[102:103], v245 offset:4096
    v_mfma_f32_16x16x32_bf16 v[28:31], v[108:111], a[188:191], v[28:31]
    s_waitcnt lgkmcnt(8)
    v_mfma_f32_16x16x32_bf16 v[32:35], v[112:115], a[184:187], v[32:35]
    s_add_u32 m0, s29, 116736
    ds_read_b64_tr_b16 v[104:105], v246 offset:0
    ds_read_b64_tr_b16 v[106:107], v246 offset:4096
    v_mfma_f32_16x16x32_bf16 v[48:51], v[112:115], a[188:191], v[48:51]
    buffer_load_dwordx4 v232, s[96:99], s52 offen offset:0 lds
    v_mfma_f32_16x16x32_bf16 v[36:39], v[116:119], a[184:187], v[36:39]
    ds_read_b64_tr_b16 v[108:109], v247 offset:0
    ds_read_b64_tr_b16 v[110:111], v247 offset:4096
    v_mfma_f32_16x16x32_bf16 v[52:55], v[116:119], a[188:191], v[52:55]
    s_waitcnt lgkmcnt(8)
    v_mfma_f32_16x16x32_bf16 v[40:43], v[120:123], a[184:187], v[40:43]
    ds_read_b64_tr_b16 v[112:113], v244 offset:2048
    ds_read_b64_tr_b16 v[114:115], v244 offset:6144
    v_mfma_f32_16x16x32_bf16 v[56:59], v[120:123], a[188:191], v[56:59]
    buffer_load_dwordx4 a[236:239], v226, s[36:39], s53 offen offset:3072 sc1
    v_mfma_f32_16x16x32_bf16 v[44:47], v[124:127], a[184:187], v[44:47]
    ds_read_b64_tr_b16 v[116:117], v245 offset:2048
    ds_read_b64_tr_b16 v[118:119], v245 offset:6144
    v_mfma_f32_16x16x32_bf16 v[60:63], v[124:127], a[188:191], v[60:63]
    s_waitcnt vmcnt(18) lgkmcnt(8)
    v_mfma_f32_16x16x32_bf16 v[0:3], v[96:99], a[192:195], v[0:3]
    ds_read_b64_tr_b16 v[120:121], v246 offset:2048
    ds_read_b64_tr_b16 v[122:123], v246 offset:6144
    v_mfma_f32_16x16x32_bf16 v[16:19], v[96:99], a[196:199], v[16:19]
    buffer_load_dwordx4 v233, s[96:99], s52 offen offset:1024 lds
    v_mfma_f32_16x16x32_bf16 v[4:7], v[100:103], a[192:195], v[4:7]
    ds_read_b64_tr_b16 v[124:125], v247 offset:2048
    ds_read_b64_tr_b16 v[126:127], v247 offset:6144
    v_mfma_f32_16x16x32_bf16 v[20:23], v[100:103], a[196:199], v[20:23]
    s_waitcnt lgkmcnt(8)
    v_mfma_f32_16x16x32_bf16 v[8:11], v[104:107], a[192:195], v[8:11]
    s_mov_b32 s53, 61440
    ds_read_b64_tr_b16 v[96:97], v244 offset:8192
    ds_read_b64_tr_b16 v[98:99], v244 offset:12288
    v_mfma_f32_16x16x32_bf16 v[24:27], v[104:107], a[196:199], v[24:27]
    buffer_load_dwordx4 a[240:243], v226, s[36:39], s53 offen offset:0 sc1
    v_mfma_f32_16x16x32_bf16 v[12:15], v[108:111], a[192:195], v[12:15]
    ds_read_b64_tr_b16 v[100:101], v245 offset:8192
    ds_read_b64_tr_b16 v[102:103], v245 offset:12288
    v_mfma_f32_16x16x32_bf16 v[28:31], v[108:111], a[196:199], v[28:31]
    s_waitcnt lgkmcnt(8)
    v_mfma_f32_16x16x32_bf16 v[32:35], v[112:115], a[192:195], v[32:35]
    ds_read_b64_tr_b16 v[104:105], v246 offset:8192
    ds_read_b64_tr_b16 v[106:107], v246 offset:12288
    v_mfma_f32_16x16x32_bf16 v[48:51], v[112:115], a[196:199], v[48:51]
    v_mfma_f32_16x16x32_bf16 v[36:39], v[116:119], a[192:195], v[36:39]
    ds_read_b64_tr_b16 v[108:109], v247 offset:8192
    ds_read_b64_tr_b16 v[110:111], v247 offset:12288
    v_mfma_f32_16x16x32_bf16 v[52:55], v[116:119], a[196:199], v[52:55]
    s_waitcnt lgkmcnt(8)
    v_mfma_f32_16x16x32_bf16 v[40:43], v[120:123], a[192:195], v[40:43]
    ds_read_b64_tr_b16 v[112:113], v244 offset:10240
    ds_read_b64_tr_b16 v[114:115], v244 offset:14336
    v_mfma_f32_16x16x32_bf16 v[56:59], v[120:123], a[196:199], v[56:59]
    buffer_load_dwordx4 a[244:247], v226, s[36:39], s53 offen offset:1024 sc1
    v_mfma_f32_16x16x32_bf16 v[44:47], v[124:127], a[192:195], v[44:47]
    s_mov_b32 s52, 2490368
    ds_read_b64_tr_b16 v[116:117], v245 offset:10240
    ds_read_b64_tr_b16 v[118:119], v245 offset:14336
    v_mfma_f32_16x16x32_bf16 v[60:63], v[124:127], a[196:199], v[60:63]
    s_waitcnt vmcnt(17) lgkmcnt(8)
    v_mfma_f32_16x16x32_bf16 v[0:3], v[96:99], a[200:203], v[0:3]
    s_add_u32 m0, s29, 131072
    ds_read_b64_tr_b16 v[120:121], v246 offset:10240
    ds_read_b64_tr_b16 v[122:123], v246 offset:14336
    v_mfma_f32_16x16x32_bf16 v[16:19], v[96:99], a[204:207], v[16:19]
    buffer_load_dwordx4 v230, s[32:35], s52 offen offset:0 lds
    v_mfma_f32_16x16x32_bf16 v[4:7], v[100:103], a[200:203], v[4:7]
    ds_read_b64_tr_b16 v[124:125], v247 offset:10240
    ds_read_b64_tr_b16 v[126:127], v247 offset:14336
    v_mfma_f32_16x16x32_bf16 v[20:23], v[100:103], a[204:207], v[20:23]
    s_waitcnt lgkmcnt(8)
    v_mfma_f32_16x16x32_bf16 v[8:11], v[104:107], a[200:203], v[8:11]
    ds_read_b64_tr_b16 v[96:97], v248 offset:16384
    ds_read_b64_tr_b16 v[98:99], v248 offset:20480
    v_mfma_f32_16x16x32_bf16 v[24:27], v[104:107], a[204:207], v[24:27]
    buffer_load_dwordx2 a[248:249], v239, s[36:39], s53 offen offset:2048 sc1
    buffer_load_dwordx2 a[250:251], v239, s[36:39], s53 offen offset:2560 sc1
    v_mfma_f32_16x16x32_bf16 v[12:15], v[108:111], a[200:203], v[12:15]
    ds_read_b64_tr_b16 v[100:101], v249 offset:16384
    ds_read_b64_tr_b16 v[102:103], v249 offset:20480
    v_mfma_f32_16x16x32_bf16 v[28:31], v[108:111], a[204:207], v[28:31]
    s_waitcnt lgkmcnt(8)
    v_mfma_f32_16x16x32_bf16 v[32:35], v[112:115], a[200:203], v[32:35]
    ds_read_b64_tr_b16 v[104:105], v250 offset:16384
    ds_read_b64_tr_b16 v[106:107], v250 offset:20480
    v_mfma_f32_16x16x32_bf16 v[48:51], v[112:115], a[204:207], v[48:51]
    buffer_load_dwordx4 v231, s[32:35], s52 offen offset:1024 lds
    v_mfma_f32_16x16x32_bf16 v[36:39], v[116:119], a[200:203], v[36:39]
    ds_read_b64_tr_b16 v[108:109], v251 offset:16384
    ds_read_b64_tr_b16 v[110:111], v251 offset:20480
    v_mfma_f32_16x16x32_bf16 v[52:55], v[116:119], a[204:207], v[52:55]
    s_waitcnt lgkmcnt(8)
    v_mfma_f32_16x16x32_bf16 v[40:43], v[120:123], a[200:203], v[40:43]
    ds_read_b64_tr_b16 v[112:113], v248 offset:18432
    ds_read_b64_tr_b16 v[114:115], v248 offset:22528
    v_mfma_f32_16x16x32_bf16 v[56:59], v[120:123], a[204:207], v[56:59]
    buffer_load_dwordx2 a[252:253], v239, s[36:39], s53 offen offset:3072 sc1
    buffer_load_dwordx2 a[254:255], v239, s[36:39], s53 offen offset:3584 sc1
    v_mfma_f32_16x16x32_bf16 v[44:47], v[124:127], a[200:203], v[44:47]
    ds_read_b64_tr_b16 v[116:117], v249 offset:18432
    ds_read_b64_tr_b16 v[118:119], v249 offset:22528
    v_mfma_f32_16x16x32_bf16 v[60:63], v[124:127], a[204:207], v[60:63]
    s_waitcnt vmcnt(20) lgkmcnt(8)
    v_mfma_f32_16x16x32_bf16 v[0:3], v[96:99], a[208:211], v[0:3]
    s_add_u32 m0, s29, 133120
    ds_read_b64_tr_b16 v[120:121], v250 offset:18432
    ds_read_b64_tr_b16 v[122:123], v250 offset:22528
    v_mfma_f32_16x16x32_bf16 v[16:19], v[96:99], a[212:215], v[16:19]
    buffer_load_dwordx4 v232, s[96:99], s52 offen offset:0 lds
    v_mfma_f32_16x16x32_bf16 v[4:7], v[100:103], a[208:211], v[4:7]
    ds_read_b64_tr_b16 v[124:125], v251 offset:18432
    ds_read_b64_tr_b16 v[126:127], v251 offset:22528
    v_mfma_f32_16x16x32_bf16 v[20:23], v[100:103], a[212:215], v[20:23]
    s_waitcnt lgkmcnt(8)
    v_mfma_f32_16x16x32_bf16 v[8:11], v[104:107], a[208:211], v[8:11]
    s_mov_b32 s53, 65536
    ds_read_b64_tr_b16 v[96:97], v248 offset:24576
    ds_read_b64_tr_b16 v[98:99], v248 offset:28672
    v_mfma_f32_16x16x32_bf16 v[24:27], v[104:107], a[212:215], v[24:27]
    buffer_load_dwordx4 a[0:3], v226, s[36:39], s53 offen offset:0 sc1
    v_mfma_f32_16x16x32_bf16 v[12:15], v[108:111], a[208:211], v[12:15]
    ds_read_b64_tr_b16 v[100:101], v249 offset:24576
    ds_read_b64_tr_b16 v[102:103], v249 offset:28672
    v_mfma_f32_16x16x32_bf16 v[28:31], v[108:111], a[212:215], v[28:31]
    s_waitcnt lgkmcnt(8)
    v_mfma_f32_16x16x32_bf16 v[32:35], v[112:115], a[208:211], v[32:35]
    ds_read_b64_tr_b16 v[104:105], v250 offset:24576
    ds_read_b64_tr_b16 v[106:107], v250 offset:28672
    v_mfma_f32_16x16x32_bf16 v[48:51], v[112:115], a[212:215], v[48:51]
    buffer_load_dwordx4 v233, s[96:99], s52 offen offset:1024 lds
    v_mfma_f32_16x16x32_bf16 v[36:39], v[116:119], a[208:211], v[36:39]
    ds_read_b64_tr_b16 v[108:109], v251 offset:24576
    ds_read_b64_tr_b16 v[110:111], v251 offset:28672
    v_mfma_f32_16x16x32_bf16 v[52:55], v[116:119], a[212:215], v[52:55]
    s_waitcnt lgkmcnt(8)
    v_mfma_f32_16x16x32_bf16 v[40:43], v[120:123], a[208:211], v[40:43]
    ds_read_b64_tr_b16 v[112:113], v248 offset:26624
    ds_read_b64_tr_b16 v[114:115], v248 offset:30720
    v_mfma_f32_16x16x32_bf16 v[56:59], v[120:123], a[212:215], v[56:59]
    buffer_load_dwordx4 a[4:7], v226, s[36:39], s53 offen offset:1024 sc1
    v_mfma_f32_16x16x32_bf16 v[44:47], v[124:127], a[208:211], v[44:47]
    ds_read_b64_tr_b16 v[116:117], v249 offset:26624
    ds_read_b64_tr_b16 v[118:119], v249 offset:30720
    v_mfma_f32_16x16x32_bf16 v[60:63], v[124:127], a[212:215], v[60:63]
    s_waitcnt vmcnt(20) lgkmcnt(8)
    v_mfma_f32_16x16x32_bf16 v[0:3], v[96:99], a[216:219], v[0:3]
    ds_read_b64_tr_b16 v[120:121], v250 offset:26624
    ds_read_b64_tr_b16 v[122:123], v250 offset:30720
    v_mfma_f32_16x16x32_bf16 v[16:19], v[96:99], a[220:223], v[16:19]
    buffer_load_dwordx4 a[8:11], v226, s[36:39], s53 offen offset:2048 sc1
    v_mfma_f32_16x16x32_bf16 v[4:7], v[100:103], a[216:219], v[4:7]
    s_mov_b32 s52, 2621440
    ds_read_b64_tr_b16 v[124:125], v251 offset:26624
    ds_read_b64_tr_b16 v[126:127], v251 offset:30720
    v_mfma_f32_16x16x32_bf16 v[20:23], v[100:103], a[220:223], v[20:23]
    s_waitcnt lgkmcnt(8)
    s_barrier
    v_mfma_f32_16x16x32_bf16 v[8:11], v[104:107], a[216:219], v[8:11]
    s_add_u32 m0, s29, 32768
    ds_read_b64_tr_b16 v[96:97], v244 offset:16384
    ds_read_b64_tr_b16 v[98:99], v244 offset:20480
    v_mfma_f32_16x16x32_bf16 v[24:27], v[104:107], a[220:223], v[24:27]
    buffer_load_dwordx4 v230, s[32:35], s52 offen offset:0 lds
    v_mfma_f32_16x16x32_bf16 v[12:15], v[108:111], a[216:219], v[12:15]
    ds_read_b64_tr_b16 v[100:101], v245 offset:16384
    ds_read_b64_tr_b16 v[102:103], v245 offset:20480
    v_mfma_f32_16x16x32_bf16 v[28:31], v[108:111], a[220:223], v[28:31]
    s_waitcnt lgkmcnt(8)
    v_mfma_f32_16x16x32_bf16 v[32:35], v[112:115], a[216:219], v[32:35]
    ds_read_b64_tr_b16 v[104:105], v246 offset:16384
    ds_read_b64_tr_b16 v[106:107], v246 offset:20480
    v_mfma_f32_16x16x32_bf16 v[48:51], v[112:115], a[220:223], v[48:51]
    buffer_load_dwordx4 a[12:15], v226, s[36:39], s53 offen offset:3072 sc1
    v_mfma_f32_16x16x32_bf16 v[36:39], v[116:119], a[216:219], v[36:39]
    ds_read_b64_tr_b16 v[108:109], v247 offset:16384
    ds_read_b64_tr_b16 v[110:111], v247 offset:20480
    v_mfma_f32_16x16x32_bf16 v[52:55], v[116:119], a[220:223], v[52:55]
    s_waitcnt lgkmcnt(8)
    v_mfma_f32_16x16x32_bf16 v[40:43], v[120:123], a[216:219], v[40:43]
    ds_read_b64_tr_b16 v[112:113], v244 offset:18432
    ds_read_b64_tr_b16 v[114:115], v244 offset:22528
    v_mfma_f32_16x16x32_bf16 v[56:59], v[120:123], a[220:223], v[56:59]
    v_mfma_f32_16x16x32_bf16 v[44:47], v[124:127], a[216:219], v[44:47]
    ds_read_b64_tr_b16 v[116:117], v245 offset:18432
    ds_read_b64_tr_b16 v[118:119], v245 offset:22528
    v_mfma_f32_16x16x32_bf16 v[60:63], v[124:127], a[220:223], v[60:63]
    s_waitcnt vmcnt(20) lgkmcnt(8)
    v_mfma_f32_16x16x32_bf16 v[0:3], v[96:99], a[224:227], v[0:3]
    ds_read_b64_tr_b16 v[120:121], v246 offset:18432
    ds_read_b64_tr_b16 v[122:123], v246 offset:22528
    v_mfma_f32_16x16x32_bf16 v[16:19], v[96:99], a[228:231], v[16:19]
    buffer_load_dwordx4 v231, s[32:35], s52 offen offset:1024 lds
    v_mfma_f32_16x16x32_bf16 v[4:7], v[100:103], a[224:227], v[4:7]
    ds_read_b64_tr_b16 v[124:125], v247 offset:18432
    ds_read_b64_tr_b16 v[126:127], v247 offset:22528
    v_mfma_f32_16x16x32_bf16 v[20:23], v[100:103], a[228:231], v[20:23]
    s_waitcnt lgkmcnt(8)
    v_mfma_f32_16x16x32_bf16 v[8:11], v[104:107], a[224:227], v[8:11]
    s_mov_b32 s53, 69632
    ds_read_b64_tr_b16 v[96:97], v244 offset:24576
    ds_read_b64_tr_b16 v[98:99], v244 offset:28672
    v_mfma_f32_16x16x32_bf16 v[24:27], v[104:107], a[228:231], v[24:27]
    buffer_load_dwordx4 a[16:19], v226, s[36:39], s53 offen offset:0 sc1
    v_mfma_f32_16x16x32_bf16 v[12:15], v[108:111], a[224:227], v[12:15]
    ds_read_b64_tr_b16 v[100:101], v245 offset:24576
    ds_read_b64_tr_b16 v[102:103], v245 offset:28672
    v_mfma_f32_16x16x32_bf16 v[28:31], v[108:111], a[228:231], v[28:31]
    s_waitcnt lgkmcnt(8)
    v_mfma_f32_16x16x32_bf16 v[32:35], v[112:115], a[224:227], v[32:35]
    s_add_u32 m0, s29, 34816
    ds_read_b64_tr_b16 v[104:105], v246 offset:24576
    ds_read_b64_tr_b16 v[106:107], v246 offset:28672
    v_mfma_f32_16x16x32_bf16 v[48:51], v[112:115], a[228:231], v[48:51]
    buffer_load_dwordx4 v232, s[96:99], s52 offen offset:0 lds
    v_mfma_f32_16x16x32_bf16 v[36:39], v[116:119], a[224:227], v[36:39]
    ds_read_b64_tr_b16 v[108:109], v247 offset:24576
    ds_read_b64_tr_b16 v[110:111], v247 offset:28672
    v_mfma_f32_16x16x32_bf16 v[52:55], v[116:119], a[228:231], v[52:55]
    s_waitcnt lgkmcnt(8)
    v_mfma_f32_16x16x32_bf16 v[40:43], v[120:123], a[224:227], v[40:43]
    ds_read_b64_tr_b16 v[112:113], v244 offset:26624
    ds_read_b64_tr_b16 v[114:115], v244 offset:30720
    v_mfma_f32_16x16x32_bf16 v[56:59], v[120:123], a[228:231], v[56:59]
    buffer_load_dwordx4 a[20:23], v226, s[36:39], s53 offen offset:1024 sc1
    v_mfma_f32_16x16x32_bf16 v[44:47], v[124:127], a[224:227], v[44:47]
    ds_read_b64_tr_b16 v[116:117], v245 offset:26624
    ds_read_b64_tr_b16 v[118:119], v245 offset:30720
    v_mfma_f32_16x16x32_bf16 v[60:63], v[124:127], a[228:231], v[60:63]
    s_waitcnt vmcnt(20) lgkmcnt(8)
    v_mfma_f32_16x16x32_bf16 v[0:3], v[96:99], a[232:235], v[0:3]
    ds_read_b64_tr_b16 v[120:121], v246 offset:26624
    ds_read_b64_tr_b16 v[122:123], v246 offset:30720
    v_mfma_f32_16x16x32_bf16 v[16:19], v[96:99], a[236:239], v[16:19]
    buffer_load_dwordx4 a[24:27], v226, s[36:39], s53 offen offset:2048 sc1
    v_mfma_f32_16x16x32_bf16 v[4:7], v[100:103], a[232:235], v[4:7]
    ds_read_b64_tr_b16 v[124:125], v247 offset:26624
    ds_read_b64_tr_b16 v[126:127], v247 offset:30720
    v_mfma_f32_16x16x32_bf16 v[20:23], v[100:103], a[236:239], v[20:23]
    s_waitcnt lgkmcnt(8)
    v_mfma_f32_16x16x32_bf16 v[8:11], v[104:107], a[232:235], v[8:11]
    ds_read_b64_tr_b16 v[96:97], v244 offset:32768
    ds_read_b64_tr_b16 v[98:99], v244 offset:36864
    v_mfma_f32_16x16x32_bf16 v[24:27], v[104:107], a[236:239], v[24:27]
    buffer_load_dwordx4 v233, s[96:99], s52 offen offset:1024 lds
    v_mfma_f32_16x16x32_bf16 v[12:15], v[108:111], a[232:235], v[12:15]
    ds_read_b64_tr_b16 v[100:101], v245 offset:32768
    ds_read_b64_tr_b16 v[102:103], v245 offset:36864
    v_mfma_f32_16x16x32_bf16 v[28:31], v[108:111], a[236:239], v[28:31]
    s_waitcnt lgkmcnt(8)
    v_mfma_f32_16x16x32_bf16 v[32:35], v[112:115], a[232:235], v[32:35]
    ds_read_b64_tr_b16 v[104:105], v246 offset:32768
    ds_read_b64_tr_b16 v[106:107], v246 offset:36864
    v_mfma_f32_16x16x32_bf16 v[48:51], v[112:115], a[236:239], v[48:51]
    buffer_load_dwordx4 a[28:31], v226, s[36:39], s53 offen offset:3072 sc1
    v_mfma_f32_16x16x32_bf16 v[36:39], v[116:119], a[232:235], v[36:39]
    s_mov_b32 s52, 2752512
    ds_read_b64_tr_b16 v[108:109], v247 offset:32768
    ds_read_b64_tr_b16 v[110:111], v247 offset:36864
    v_mfma_f32_16x16x32_bf16 v[52:55], v[116:119], a[236:239], v[52:55]
    s_waitcnt lgkmcnt(8)
    v_mfma_f32_16x16x32_bf16 v[40:43], v[120:123], a[232:235], v[40:43]
    s_add_u32 m0, s29, 49152
    ds_read_b64_tr_b16 v[112:113], v244 offset:34816
    ds_read_b64_tr_b16 v[114:115], v244 offset:38912
    v_mfma_f32_16x16x32_bf16 v[56:59], v[120:123], a[236:239], v[56:59]
    buffer_load_dwordx4 v230, s[32:35], s52 offen offset:0 lds
    v_mfma_f32_16x16x32_bf16 v[44:47], v[124:127], a[232:235], v[44:47]
    ds_read_b64_tr_b16 v[116:117], v245 offset:34816
    ds_read_b64_tr_b16 v[118:119], v245 offset:38912
    v_mfma_f32_16x16x32_bf16 v[60:63], v[124:127], a[236:239], v[60:63]
    s_waitcnt vmcnt(21) lgkmcnt(8)
    v_mfma_f32_16x16x32_bf16 v[0:3], v[96:99], a[240:243], v[0:3]
    s_mov_b32 s53, 73728
    ds_read_b64_tr_b16 v[120:121], v246 offset:34816
    ds_read_b64_tr_b16 v[122:123], v246 offset:38912
    v_mfma_f32_16x16x32_bf16 v[16:19], v[96:99], a[244:247], v[16:19]
    buffer_load_dwordx4 a[32:35], v226, s[36:39], s53 offen offset:0 sc1
    v_mfma_f32_16x16x32_bf16 v[4:7], v[100:103], a[240:243], v[4:7]
    ds_read_b64_tr_b16 v[124:125], v247 offset:34816
    ds_read_b64_tr_b16 v[126:127], v247 offset:38912
    v_mfma_f32_16x16x32_bf16 v[20:23], v[100:103], a[244:247], v[20:23]
    s_waitcnt lgkmcnt(8)
    v_mfma_f32_16x16x32_bf16 v[8:11], v[104:107], a[240:243], v[8:11]
    ds_read_b64_tr_b16 v[96:97], v244 offset:40960
    ds_read_b64_tr_b16 v[98:99], v244 offset:45056
    v_mfma_f32_16x16x32_bf16 v[24:27], v[104:107], a[244:247], v[24:27]
    v_mfma_f32_16x16x32_bf16 v[12:15], v[108:111], a[240:243], v[12:15]
    ds_read_b64_tr_b16 v[100:101], v245 offset:40960
    ds_read_b64_tr_b16 v[102:103], v245 offset:45056
    v_mfma_f32_16x16x32_bf16 v[28:31], v[108:111], a[244:247], v[28:31]
    s_waitcnt lgkmcnt(8)
    v_mfma_f32_16x16x32_bf16 v[32:35], v[112:115], a[240:243], v[32:35]
    ds_read_b64_tr_b16 v[104:105], v246 offset:40960
    ds_read_b64_tr_b16 v[106:107], v246 offset:45056
    v_mfma_f32_16x16x32_bf16 v[48:51], v[112:115], a[244:247], v[48:51]
    buffer_load_dwordx4 v231, s[32:35], s52 offen offset:1024 lds
    v_mfma_f32_16x16x32_bf16 v[36:39], v[116:119], a[240:243], v[36:39]
    ds_read_b64_tr_b16 v[108:109], v247 offset:40960
    ds_read_b64_tr_b16 v[110:111], v247 offset:45056
    v_mfma_f32_16x16x32_bf16 v[52:55], v[116:119], a[244:247], v[52:55]
    s_waitcnt lgkmcnt(8)
    v_mfma_f32_16x16x32_bf16 v[40:43], v[120:123], a[240:243], v[40:43]
    ds_read_b64_tr_b16 v[112:113], v244 offset:43008
    ds_read_b64_tr_b16 v[114:115], v244 offset:47104
    v_mfma_f32_16x16x32_bf16 v[56:59], v[120:123], a[244:247], v[56:59]
    buffer_load_dwordx4 a[36:39], v226, s[36:39], s53 offen offset:1024 sc1
    v_mfma_f32_16x16x32_bf16 v[44:47], v[124:127], a[240:243], v[44:47]
    ds_read_b64_tr_b16 v[116:117], v245 offset:43008
    ds_read_b64_tr_b16 v[118:119], v245 offset:47104
    v_mfma_f32_16x16x32_bf16 v[60:63], v[124:127], a[244:247], v[60:63]
    s_waitcnt vmcnt(18) lgkmcnt(8)
    v_mfma_f32_16x16x32_bf16 v[0:3], v[96:99], a[248:251], v[0:3]
    ds_read_b64_tr_b16 v[120:121], v246 offset:43008
    ds_read_b64_tr_b16 v[122:123], v246 offset:47104
    v_mfma_f32_16x16x32_bf16 v[16:19], v[96:99], a[252:255], v[16:19]
    buffer_load_dwordx4 a[40:43], v226, s[36:39], s53 offen offset:2048 sc1
    v_mfma_f32_16x16x32_bf16 v[4:7], v[100:103], a[248:251], v[4:7]
    ds_read_b64_tr_b16 v[124:125], v247 offset:43008
    ds_read_b64_tr_b16 v[126:127], v247 offset:47104
    v_mfma_f32_16x16x32_bf16 v[20:23], v[100:103], a[252:255], v[20:23]
    s_waitcnt lgkmcnt(8)
    s_barrier
    v_mfma_f32_16x16x32_bf16 v[8:11], v[104:107], a[248:251], v[8:11]
    s_add_u32 m0, s29, 51200
    ds_read_b64_tr_b16 v[96:97], v240 offset:0
    ds_read_b64_tr_b16 v[98:99], v240 offset:4096
    v_mfma_f32_16x16x32_bf16 v[24:27], v[104:107], a[252:255], v[24:27]
    buffer_load_dwordx4 v232, s[96:99], s52 offen offset:0 lds
    v_mfma_f32_16x16x32_bf16 v[12:15], v[108:111], a[248:251], v[12:15]
    ds_read_b64_tr_b16 v[100:101], v241 offset:0
    ds_read_b64_tr_b16 v[102:103], v241 offset:4096
    v_mfma_f32_16x16x32_bf16 v[28:31], v[108:111], a[252:255], v[28:31]
    s_waitcnt lgkmcnt(8)
    v_mfma_f32_16x16x32_bf16 v[32:35], v[112:115], a[248:251], v[32:35]
    ds_read_b64_tr_b16 v[104:105], v242 offset:0
    ds_read_b64_tr_b16 v[106:107], v242 offset:4096
    v_mfma_f32_16x16x32_bf16 v[48:51], v[112:115], a[252:255], v[48:51]
    buffer_load_dwordx4 a[44:47], v226, s[36:39], s53 offen offset:3072 sc1
    v_mfma_f32_16x16x32_bf16 v[36:39], v[116:119], a[248:251], v[36:39]
    ds_read_b64_tr_b16 v[108:109], v243 offset:0
    ds_read_b64_tr_b16 v[110:111], v243 offset:4096
    v_mfma_f32_16x16x32_bf16 v[52:55], v[116:119], a[252:255], v[52:55]
    s_waitcnt lgkmcnt(8)
    v_mfma_f32_16x16x32_bf16 v[40:43], v[120:123], a[248:251], v[40:43]
    ds_read_b64_tr_b16 v[112:113], v240 offset:2048
    ds_read_b64_tr_b16 v[114:115], v240 offset:6144
    v_mfma_f32_16x16x32_bf16 v[56:59], v[120:123], a[252:255], v[56:59]
    buffer_load_dwordx4 v233, s[96:99], s52 offen offset:1024 lds
    v_mfma_f32_16x16x32_bf16 v[44:47], v[124:127], a[248:251], v[44:47]
    ds_read_b64_tr_b16 v[116:117], v241 offset:2048
    ds_read_b64_tr_b16 v[118:119], v241 offset:6144
    v_mfma_f32_16x16x32_bf16 v[60:63], v[124:127], a[252:255], v[60:63]
    s_waitcnt vmcnt(18) lgkmcnt(8)
    v_mfma_f32_16x16x32_bf16 v[0:3], v[96:99], a[0:3], v[0:3]
    s_mov_b32 s53, 77824
    ds_read_b64_tr_b16 v[120:121], v242 offset:2048
    ds_read_b64_tr_b16 v[122:123], v242 offset:6144
    v_mfma_f32_16x16x32_bf16 v[16:19], v[96:99], a[4:7], v[16:19]
    buffer_load_dwordx2 a[48:49], v239, s[36:39], s53 offen offset:0 sc1
    buffer_load_dwordx2 a[50:51], v239, s[36:39], s53 offen offset:512 sc1
    v_mfma_f32_16x16x32_bf16 v[4:7], v[100:103], a[0:3], v[4:7]
    s_mov_b32 s52, 2883584
    ds_read_b64_tr_b16 v[124:125], v243 offset:2048
    ds_read_b64_tr_b16 v[126:127], v243 offset:6144
    v_mfma_f32_16x16x32_bf16 v[20:23], v[100:103], a[4:7], v[20:23]
    s_waitcnt lgkmcnt(8)
    v_mfma_f32_16x16x32_bf16 v[8:11], v[104:107], a[0:3], v[8:11]
    s_add_u32 m0, s29, 65536
    ds_read_b64_tr_b16 v[96:97], v240 offset:8192
    ds_read_b64_tr_b16 v[98:99], v240 offset:12288
    v_mfma_f32_16x16x32_bf16 v[24:27], v[104:107], a[4:7], v[24:27]
    buffer_load_dwordx4 v230, s[32:35], s52 offen offset:0 lds
    v_mfma_f32_16x16x32_bf16 v[12:15], v[108:111], a[0:3], v[12:15]
    ds_read_b64_tr_b16 v[100:101], v241 offset:8192
    ds_read_b64_tr_b16 v[102:103], v241 offset:12288
    v_mfma_f32_16x16x32_bf16 v[28:31], v[108:111], a[4:7], v[28:31]
    s_waitcnt lgkmcnt(8)
    v_mfma_f32_16x16x32_bf16 v[32:35], v[112:115], a[0:3], v[32:35]
    ds_read_b64_tr_b16 v[104:105], v242 offset:8192
    ds_read_b64_tr_b16 v[106:107], v242 offset:12288
    v_mfma_f32_16x16x32_bf16 v[48:51], v[112:115], a[4:7], v[48:51]
    buffer_load_dwordx2 a[52:53], v239, s[36:39], s53 offen offset:1024 sc1
    buffer_load_dwordx2 a[54:55], v239, s[36:39], s53 offen offset:1536 sc1
    v_mfma_f32_16x16x32_bf16 v[36:39], v[116:119], a[0:3], v[36:39]
    ds_read_b64_tr_b16 v[108:109], v243 offset:8192
    ds_read_b64_tr_b16 v[110:111], v243 offset:12288
    v_mfma_f32_16x16x32_bf16 v[52:55], v[116:119], a[4:7], v[52:55]
    s_waitcnt lgkmcnt(8)
    v_mfma_f32_16x16x32_bf16 v[40:43], v[120:123], a[0:3], v[40:43]
    ds_read_b64_tr_b16 v[112:113], v240 offset:10240
    ds_read_b64_tr_b16 v[114:115], v240 offset:14336
    v_mfma_f32_16x16x32_bf16 v[56:59], v[120:123], a[4:7], v[56:59]
    v_mfma_f32_16x16x32_bf16 v[44:47], v[124:127], a[0:3], v[44:47]
    ds_read_b64_tr_b16 v[116:117], v241 offset:10240
    ds_read_b64_tr_b16 v[118:119], v241 offset:14336
    v_mfma_f32_16x16x32_bf16 v[60:63], v[124:127], a[4:7], v[60:63]
    s_waitcnt vmcnt(20) lgkmcnt(8)
    v_mfma_f32_16x16x32_bf16 v[0:3], v[96:99], a[8:11], v[0:3]
    ds_read_b64_tr_b16 v[120:121], v242 offset:10240
    ds_read_b64_tr_b16 v[122:123], v242 offset:14336
    v_mfma_f32_16x16x32_bf16 v[16:19], v[96:99], a[12:15], v[16:19]
    buffer_load_dwordx4 v231, s[32:35], s52 offen offset:1024 lds
    v_mfma_f32_16x16x32_bf16 v[4:7], v[100:103], a[8:11], v[4:7]
    ds_read_b64_tr_b16 v[124:125], v243 offset:10240
    ds_read_b64_tr_b16 v[126:127], v243 offset:14336
    v_mfma_f32_16x16x32_bf16 v[20:23], v[100:103], a[12:15], v[20:23]
    s_waitcnt lgkmcnt(8)
    v_mfma_f32_16x16x32_bf16 v[8:11], v[104:107], a[8:11], v[8:11]
    ds_read_b64_tr_b16 v[96:97], v240 offset:16384
    ds_read_b64_tr_b16 v[98:99], v240 offset:20480
    v_mfma_f32_16x16x32_bf16 v[24:27], v[104:107], a[12:15], v[24:27]
    buffer_load_dwordx4 a[56:59], v226, s[36:39], s53 offen offset:2048 sc1
    v_mfma_f32_16x16x32_bf16 v[12:15], v[108:111], a[8:11], v[12:15]
    ds_read_b64_tr_b16 v[100:101], v241 offset:16384
    ds_read_b64_tr_b16 v[102:103], v241 offset:20480
    v_mfma_f32_16x16x32_bf16 v[28:31], v[108:111], a[12:15], v[28:31]
    s_waitcnt lgkmcnt(8)
    v_mfma_f32_16x16x32_bf16 v[32:35], v[112:115], a[8:11], v[32:35]
    ds_read_b64_tr_b16 v[104:105], v242 offset:16384
    ds_read_b64_tr_b16 v[106:107], v242 offset:20480
    v_mfma_f32_16x16x32_bf16 v[48:51], v[112:115], a[12:15], v[48:51]
    buffer_load_dwordx4 a[60:63], v226, s[36:39], s53 offen offset:3072 sc1
    v_mfma_f32_16x16x32_bf16 v[36:39], v[116:119], a[8:11], v[36:39]
    ds_read_b64_tr_b16 v[108:109], v243 offset:16384
    ds_read_b64_tr_b16 v[110:111], v243 offset:20480
    v_mfma_f32_16x16x32_bf16 v[52:55], v[116:119], a[12:15], v[52:55]
    s_waitcnt lgkmcnt(8)
    v_mfma_f32_16x16x32_bf16 v[40:43], v[120:123], a[8:11], v[40:43]
    s_add_u32 m0, s29, 67584
    ds_read_b64_tr_b16 v[112:113], v240 offset:18432
    ds_read_b64_tr_b16 v[114:115], v240 offset:22528
    v_mfma_f32_16x16x32_bf16 v[56:59], v[120:123], a[12:15], v[56:59]
    buffer_load_dwordx4 v232, s[96:99], s52 offen offset:0 lds
    v_mfma_f32_16x16x32_bf16 v[44:47], v[124:127], a[8:11], v[44:47]
    ds_read_b64_tr_b16 v[116:117], v241 offset:18432
    ds_read_b64_tr_b16 v[118:119], v241 offset:22528
    v_mfma_f32_16x16x32_bf16 v[60:63], v[124:127], a[12:15], v[60:63]
    s_waitcnt vmcnt(20) lgkmcnt(8)
    v_mfma_f32_16x16x32_bf16 v[0:3], v[96:99], a[16:19], v[0:3]
    s_mov_b32 s53, 81920
    ds_read_b64_tr_b16 v[120:121], v242 offset:18432
    ds_read_b64_tr_b16 v[122:123], v242 offset:22528
    v_mfma_f32_16x16x32_bf16 v[16:19], v[96:99], a[20:23], v[16:19]
    buffer_load_dwordx4 a[64:67], v226, s[36:39], s53 offen offset:0 sc1
    v_mfma_f32_16x16x32_bf16 v[4:7], v[100:103], a[16:19], v[4:7]
    ds_read_b64_tr_b16 v[124:125], v243 offset:18432
    ds_read_b64_tr_b16 v[126:127], v243 offset:22528
    v_mfma_f32_16x16x32_bf16 v[20:23], v[100:103], a[20:23], v[20:23]
    s_waitcnt lgkmcnt(8)
    v_mfma_f32_16x16x32_bf16 v[8:11], v[104:107], a[16:19], v[8:11]
    ds_read_b64_tr_b16 v[96:97], v240 offset:24576
    ds_read_b64_tr_b16 v[98:99], v240 offset:28672
    v_mfma_f32_16x16x32_bf16 v[24:27], v[104:107], a[20:23], v[24:27]
    buffer_load_dwordx4 v233, s[96:99], s52 offen offset:1024 lds
    v_mfma_f32_16x16x32_bf16 v[12:15], v[108:111], a[16:19], v[12:15]
    ds_read_b64_tr_b16 v[100:101], v241 offset:24576
    ds_read_b64_tr_b16 v[102:103], v241 offset:28672
    v_mfma_f32_16x16x32_bf16 v[28:31], v[108:111], a[20:23], v[28:31]
    s_waitcnt lgkmcnt(8)
    v_mfma_f32_16x16x32_bf16 v[32:35], v[112:115], a[16:19], v[32:35]
    ds_read_b64_tr_b16 v[104:105], v242 offset:24576
    ds_read_b64_tr_b16 v[106:107], v242 offset:28672
    v_mfma_f32_16x16x32_bf16 v[48:51], v[112:115], a[20:23], v[48:51]
    buffer_load_dwordx4 a[68:71], v226, s[36:39], s53 offen offset:1024 sc1
    v_mfma_f32_16x16x32_bf16 v[36:39], v[116:119], a[16:19], v[36:39]
    ds_read_b64_tr_b16 v[108:109], v243 offset:24576
    ds_read_b64_tr_b16 v[110:111], v243 offset:28672
    v_mfma_f32_16x16x32_bf16 v[52:55], v[116:119], a[20:23], v[52:55]
    s_waitcnt lgkmcnt(8)
    v_mfma_f32_16x16x32_bf16 v[40:43], v[120:123], a[16:19], v[40:43]
    ds_read_b64_tr_b16 v[112:113], v240 offset:26624
    ds_read_b64_tr_b16 v[114:115], v240 offset:30720
    v_mfma_f32_16x16x32_bf16 v[56:59], v[120:123], a[20:23], v[56:59]
    v_mfma_f32_16x16x32_bf16 v[44:47], v[124:127], a[16:19], v[44:47]
    s_mov_b32 s52, 3014656
    ds_read_b64_tr_b16 v[116:117], v241 offset:26624
    ds_read_b64_tr_b16 v[118:119], v241 offset:30720
    v_mfma_f32_16x16x32_bf16 v[60:63], v[124:127], a[20:23], v[60:63]
    s_waitcnt vmcnt(20) lgkmcnt(8)
    v_mfma_f32_16x16x32_bf16 v[0:3], v[96:99], a[24:27], v[0:3]
    s_add_u32 m0, s29, 147456
    ds_read_b64_tr_b16 v[120:121], v242 offset:26624
    ds_read_b64_tr_b16 v[122:123], v242 offset:30720
    v_mfma_f32_16x16x32_bf16 v[16:19], v[96:99], a[28:31], v[16:19]
    buffer_load_dwordx4 v230, s[32:35], s52 offen offset:0 lds
    v_mfma_f32_16x16x32_bf16 v[4:7], v[100:103], a[24:27], v[4:7]
    ds_read_b64_tr_b16 v[124:125], v243 offset:26624
    ds_read_b64_tr_b16 v[126:127], v243 offset:30720
    v_mfma_f32_16x16x32_bf16 v[20:23], v[100:103], a[28:31], v[20:23]
    s_waitcnt lgkmcnt(8)
    s_barrier
    v_mfma_f32_16x16x32_bf16 v[8:11], v[104:107], a[24:27], v[8:11]
    ds_read_b64_tr_b16 v[96:97], v244 offset:49152
    ds_read_b64_tr_b16 v[98:99], v244 offset:53248
    v_mfma_f32_16x16x32_bf16 v[24:27], v[104:107], a[28:31], v[24:27]
    buffer_load_dwordx4 a[72:75], v226, s[36:39], s53 offen offset:2048 sc1
    v_mfma_f32_16x16x32_bf16 v[12:15], v[108:111], a[24:27], v[12:15]
    ds_read_b64_tr_b16 v[100:101], v245 offset:49152
    ds_read_b64_tr_b16 v[102:103], v245 offset:53248
    v_mfma_f32_16x16x32_bf16 v[28:31], v[108:111], a[28:31], v[28:31]
    s_waitcnt lgkmcnt(8)
    v_mfma_f32_16x16x32_bf16 v[32:35], v[112:115], a[24:27], v[32:35]
    ds_read_b64_tr_b16 v[104:105], v246 offset:49152
    ds_read_b64_tr_b16 v[106:107], v246 offset:53248
    v_mfma_f32_16x16x32_bf16 v[48:51], v[112:115], a[28:31], v[48:51]
    buffer_load_dwordx4 a[76:79], v226, s[36:39], s53 offen offset:3072 sc1
    v_mfma_f32_16x16x32_bf16 v[36:39], v[116:119], a[24:27], v[36:39]
    ds_read_b64_tr_b16 v[108:109], v247 offset:49152
    ds_read_b64_tr_b16 v[110:111], v247 offset:53248
    v_mfma_f32_16x16x32_bf16 v[52:55], v[116:119], a[28:31], v[52:55]
    s_waitcnt lgkmcnt(8)
    v_mfma_f32_16x16x32_bf16 v[40:43], v[120:123], a[24:27], v[40:43]
    ds_read_b64_tr_b16 v[112:113], v244 offset:51200
    ds_read_b64_tr_b16 v[114:115], v244 offset:55296
    v_mfma_f32_16x16x32_bf16 v[56:59], v[120:123], a[28:31], v[56:59]
    buffer_load_dwordx4 v231, s[32:35], s52 offen offset:1024 lds
    v_mfma_f32_16x16x32_bf16 v[44:47], v[124:127], a[24:27], v[44:47]
    ds_read_b64_tr_b16 v[116:117], v245 offset:51200
    ds_read_b64_tr_b16 v[118:119], v245 offset:55296
    v_mfma_f32_16x16x32_bf16 v[60:63], v[124:127], a[28:31], v[60:63]
    s_waitcnt vmcnt(20) lgkmcnt(8)
    v_mfma_f32_16x16x32_bf16 v[0:3], v[96:99], a[32:35], v[0:3]
    s_mov_b32 s53, 86016
    ds_read_b64_tr_b16 v[120:121], v246 offset:51200
    ds_read_b64_tr_b16 v[122:123], v246 offset:55296
    v_mfma_f32_16x16x32_bf16 v[16:19], v[96:99], a[36:39], v[16:19]
    buffer_load_dwordx4 a[80:83], v226, s[36:39], s53 offen offset:0 sc1
    v_mfma_f32_16x16x32_bf16 v[4:7], v[100:103], a[32:35], v[4:7]
Lpad_18:
    s_cbranch_execz Lback_d2
    ds_read_b64_tr_b16 v[124:125], v247 offset:51200
    ds_read_b64_tr_b16 v[126:127], v247 offset:55296
    v_mfma_f32_16x16x32_bf16 v[20:23], v[100:103], a[36:39], v[20:23]
    s_waitcnt lgkmcnt(8)
    v_mfma_f32_16x16x32_bf16 v[8:11], v[104:107], a[32:35], v[8:11]
    s_add_u32 m0, s29, 149504
    ds_read_b64_tr_b16 v[96:97], v244 offset:57344
    ds_read_b64_tr_b16 v[98:99], v244 offset:61440
    v_mfma_f32_16x16x32_bf16 v[24:27], v[104:107], a[36:39], v[24:27]
    buffer_load_dwordx4 v232, s[96:99], s52 offen offset:0 lds
    v_mfma_f32_16x16x32_bf16 v[12:15], v[108:111], a[32:35], v[12:15]
    ds_read_b64_tr_b16 v[100:101], v245 offset:57344
    ds_read_b64_tr_b16 v[102:103], v245 offset:61440
    v_mfma_f32_16x16x32_bf16 v[28:31], v[108:111], a[36:39], v[28:31]
    s_waitcnt lgkmcnt(8)
    v_mfma_f32_16x16x32_bf16 v[32:35], v[112:115], a[32:35], v[32:35]
    ds_read_b64_tr_b16 v[104:105], v246 offset:57344
    ds_read_b64_tr_b16 v[106:107], v246 offset:61440
    v_mfma_f32_16x16x32_bf16 v[48:51], v[112:115], a[36:39], v[48:51]
    buffer_load_dwordx4 a[84:87], v226, s[36:39], s53 offen offset:1024 sc1
    v_mfma_f32_16x16x32_bf16 v[36:39], v[116:119], a[32:35], v[36:39]
    ds_read_b64_tr_b16 v[108:109], v247 offset:57344
    ds_read_b64_tr_b16 v[110:111], v247 offset:61440
    v_mfma_f32_16x16x32_bf16 v[52:55], v[116:119], a[36:39], v[52:55]
    s_waitcnt lgkmcnt(8)
    v_mfma_f32_16x16x32_bf16 v[40:43], v[120:123], a[32:35], v[40:43]
    ds_read_b64_tr_b16 v[112:113], v244 offset:59392
    ds_read_b64_tr_b16 v[114:115], v244 offset:63488
    v_mfma_f32_16x16x32_bf16 v[56:59], v[120:123], a[36:39], v[56:59]
    buffer_load_dwordx4 v233, s[96:99], s52 offen offset:1024 lds
    v_mfma_f32_16x16x32_bf16 v[44:47], v[124:127], a[32:35], v[44:47]
    ds_read_b64_tr_b16 v[116:117], v245 offset:59392
    ds_read_b64_tr_b16 v[118:119], v245 offset:63488
    v_mfma_f32_16x16x32_bf16 v[60:63], v[124:127], a[36:39], v[60:63]
    s_waitcnt vmcnt(21) lgkmcnt(8)
    v_mfma_f32_16x16x32_bf16 v[0:3], v[96:99], a[40:43], v[0:3]
    ds_read_b64_tr_b16 v[120:121], v246 offset:59392
    ds_read_b64_tr_b16 v[122:123], v246 offset:63488
    v_mfma_f32_16x16x32_bf16 v[16:19], v[96:99], a[44:47], v[16:19]
    buffer_load_dwordx4 a[88:91], v226, s[36:39], s53 offen offset:2048 sc1
    v_mfma_f32_16x16x32_bf16 v[4:7], v[100:103], a[40:43], v[4:7]
    ds_read_b64_tr_b16 v[124:125], v247 offset:59392
    ds_read_b64_tr_b16 v[126:127], v247 offset:63488
    v_mfma_f32_16x16x32_bf16 v[20:23], v[100:103], a[44:47], v[20:23]
    s_waitcnt lgkmcnt(8)
    v_mfma_f32_16x16x32_bf16 v[8:11], v[104:107], a[40:43], v[8:11]
    ds_read_b64_tr_b16 v[96:97], v248 offset:0
    ds_read_b64_tr_b16 v[98:99], v248 offset:4096
    v_mfma_f32_16x16x32_bf16 v[24:27], v[104:107], a[44:47], v[24:27]
    v_mfma_f32_16x16x32_bf16 v[12:15], v[108:111], a[40:43], v[12:15]
    s_mov_b32 s52, 3145728
    ds_read_b64_tr_b16 v[100:101], v249 offset:0
    ds_read_b64_tr_b16 v[102:103], v249 offset:4096
    v_mfma_f32_16x16x32_bf16 v[28:31], v[108:111], a[44:47], v[28:31]
    s_waitcnt lgkmcnt(8)
    v_mfma_f32_16x16x32_bf16 v[32:35], v[112:115], a[40:43], v[32:35]
    s_add_u32 m0, s29, 81920
    ds_read_b64_tr_b16 v[104:105], v250 offset:0
    ds_read_b64_tr_b16 v[106:107], v250 offset:4096
    v_mfma_f32_16x16x32_bf16 v[48:51], v[112:115], a[44:47], v[48:51]
    buffer_load_dwordx4 v230, s[32:35], s52 offen offset:0 lds
    v_mfma_f32_16x16x32_bf16 v[36:39], v[116:119], a[40:43], v[36:39]
    ds_read_b64_tr_b16 v[108:109], v251 offset:0
    ds_read_b64_tr_b16 v[110:111], v251 offset:4096
    v_mfma_f32_16x16x32_bf16 v[52:55], v[116:119], a[44:47], v[52:55]
    s_waitcnt lgkmcnt(8)
    v_mfma_f32_16x16x32_bf16 v[40:43], v[120:123], a[40:43], v[40:43]
    ds_read_b64_tr_b16 v[112:113], v248 offset:2048
    ds_read_b64_tr_b16 v[114:115], v248 offset:6144
    v_mfma_f32_16x16x32_bf16 v[56:59], v[120:123], a[44:47], v[56:59]
    buffer_load_dwordx4 a[92:95], v226, s[36:39], s53 offen offset:3072 sc1
    v_mfma_f32_16x16x32_bf16 v[44:47], v[124:127], a[40:43], v[44:47]
    ds_read_b64_tr_b16 v[116:117], v249 offset:2048
    ds_read_b64_tr_b16 v[118:119], v249 offset:6144
    v_mfma_f32_16x16x32_bf16 v[60:63], v[124:127], a[44:47], v[60:63]
    s_waitcnt vmcnt(18) lgkmcnt(8)
    v_mfma_f32_16x16x32_bf16 v[0:3], v[96:99], a[48:51], v[0:3]
    s_mov_b32 s53, 90112
    ds_read_b64_tr_b16 v[120:121], v250 offset:2048
    ds_read_b64_tr_b16 v[122:123], v250 offset:6144
    v_mfma_f32_16x16x32_bf16 v[16:19], v[96:99], a[52:55], v[16:19]
    buffer_load_dwordx4 a[96:99], v226, s[36:39], s53 offen offset:0 sc1
    v_mfma_f32_16x16x32_bf16 v[4:7], v[100:103], a[48:51], v[4:7]
    ds_read_b64_tr_b16 v[124:125], v251 offset:2048
    ds_read_b64_tr_b16 v[126:127], v251 offset:6144
    v_mfma_f32_16x16x32_bf16 v[20:23], v[100:103], a[52:55], v[20:23]
    s_waitcnt lgkmcnt(8)
    v_mfma_f32_16x16x32_bf16 v[8:11], v[104:107], a[48:51], v[8:11]
    ds_read_b64_tr_b16 v[96:97], v248 offset:8192
    ds_read_b64_tr_b16 v[98:99], v248 offset:12288
    v_mfma_f32_16x16x32_bf16 v[24:27], v[104:107], a[52:55], v[24:27]
    buffer_load_dwordx4 v231, s[32:35], s52 offen offset:1024 lds
    v_mfma_f32_16x16x32_bf16 v[12:15], v[108:111], a[48:51], v[12:15]
    ds_read_b64_tr_b16 v[100:101], v249 offset:8192
    ds_read_b64_tr_b16 v[102:103], v249 offset:12288
    v_mfma_f32_16x16x32_bf16 v[28:31], v[108:111], a[52:55], v[28:31]
    s_waitcnt lgkmcnt(8)
    v_mfma_f32_16x16x32_bf16 v[32:35], v[112:115], a[48:51], v[32:35]
    ds_read_b64_tr_b16 v[104:105], v250 offset:8192
    ds_read_b64_tr_b16 v[106:107], v250 offset:12288
    v_mfma_f32_16x16x32_bf16 v[48:51], v[112:115], a[52:55], v[48:51]
    buffer_load_dwordx4 a[100:103], v226, s[36:39], s53 offen offset:1024 sc1
    v_mfma_f32_16x16x32_bf16 v[36:39], v[116:119], a[48:51], v[36:39]
    ds_read_b64_tr_b16 v[108:109], v251 offset:8192
    ds_read_b64_tr_b16 v[110:111], v251 offset:12288
    v_mfma_f32_16x16x32_bf16 v[52:55], v[116:119], a[52:55], v[52:55]
    s_waitcnt lgkmcnt(8)
    v_mfma_f32_16x16x32_bf16 v[40:43], v[120:123], a[48:51], v[40:43]
    s_add_u32 m0, s29, 83968
    ds_read_b64_tr_b16 v[112:113], v248 offset:10240
    ds_read_b64_tr_b16 v[114:115], v248 offset:14336
    v_mfma_f32_16x16x32_bf16 v[56:59], v[120:123], a[52:55], v[56:59]
    buffer_load_dwordx4 v232, s[96:99], s52 offen offset:0 lds
    v_mfma_f32_16x16x32_bf16 v[44:47], v[124:127], a[48:51], v[44:47]
    ds_read_b64_tr_b16 v[116:117], v249 offset:10240
    ds_read_b64_tr_b16 v[118:119], v249 offset:14336
    v_mfma_f32_16x16x32_bf16 v[60:63], v[124:127], a[52:55], v[60:63]
    s_waitcnt vmcnt(19) lgkmcnt(8)
    v_mfma_f32_16x16x32_bf16 v[0:3], v[96:99], a[56:59], v[0:3]
    ds_read_b64_tr_b16 v[120:121], v250 offset:10240
    ds_read_b64_tr_b16 v[122:123], v250 offset:14336
    v_mfma_f32_16x16x32_bf16 v[16:19], v[96:99], a[60:63], v[16:19]
    buffer_load_dwordx2 a[104:105], v239, s[36:39], s53 offen offset:2048 sc1
    buffer_load_dwordx2 a[106:107], v239, s[36:39], s53 offen offset:2560 sc1
    v_mfma_f32_16x16x32_bf16 v[4:7], v[100:103], a[56:59], v[4:7]
    ds_read_b64_tr_b16 v[124:125], v251 offset:10240
    ds_read_b64_tr_b16 v[126:127], v251 offset:14336
    v_mfma_f32_16x16x32_bf16 v[20:23], v[100:103], a[60:63], v[20:23]
    s_waitcnt lgkmcnt(8)
    s_barrier
    v_mfma_f32_16x16x32_bf16 v[8:11], v[104:107], a[56:59], v[8:11]
    ds_read_b64_tr_b16 v[96:97], v240 offset:32768
    ds_read_b64_tr_b16 v[98:99], v240 offset:36864
    v_mfma_f32_16x16x32_bf16 v[24:27], v[104:107], a[60:63], v[24:27]
    v_mfma_f32_16x16x32_bf16 v[12:15], v[108:111], a[56:59], v[12:15]
    ds_read_b64_tr_b16 v[100:101], v241 offset:32768
    ds_read_b64_tr_b16 v[102:103], v241 offset:36864
    v_mfma_f32_16x16x32_bf16 v[28:31], v[108:111], a[60:63], v[28:31]
    s_waitcnt lgkmcnt(8)
    v_mfma_f32_16x16x32_bf16 v[32:35], v[112:115], a[56:59], v[32:35]
    ds_read_b64_tr_b16 v[104:105], v242 offset:32768
    ds_read_b64_tr_b16 v[106:107], v242 offset:36864
    v_mfma_f32_16x16x32_bf16 v[48:51], v[112:115], a[60:63], v[48:51]
    buffer_load_dwordx4 v233, s[96:99], s52 offen offset:1024 lds
    v_mfma_f32_16x16x32_bf16 v[36:39], v[116:119], a[56:59], v[36:39]
    ds_read_b64_tr_b16 v[108:109], v243 offset:32768
    ds_read_b64_tr_b16 v[110:111], v243 offset:36864
    v_mfma_f32_16x16x32_bf16 v[52:55], v[116:119], a[60:63], v[52:55]
    s_waitcnt lgkmcnt(8)
    v_mfma_f32_16x16x32_bf16 v[40:43], v[120:123], a[56:59], v[40:43]
    ds_read_b64_tr_b16 v[112:113], v240 offset:34816
    ds_read_b64_tr_b16 v[114:115], v240 offset:38912
    v_mfma_f32_16x16x32_bf16 v[56:59], v[120:123], a[60:63], v[56:59]
    buffer_load_dwordx2 a[108:109], v239, s[36:39], s53 offen offset:3072 sc1
    buffer_load_dwordx2 a[110:111], v239, s[36:39], s53 offen offset:3584 sc1
    v_mfma_f32_16x16x32_bf16 v[44:47], v[124:127], a[56:59], v[44:47]
    ds_read_b64_tr_b16 v[116:117], v241 offset:34816
    ds_read_b64_tr_b16 v[118:119], v241 offset:38912
    v_mfma_f32_16x16x32_bf16 v[60:63], v[124:127], a[60:63], v[60:63]
    s_waitcnt vmcnt(20) lgkmcnt(8)
    v_mfma_f32_16x16x32_bf16 v[0:3], v[96:99], a[64:67], v[0:3]
    s_mov_b32 s53, 94208
    ds_read_b64_tr_b16 v[120:121], v242 offset:34816
    ds_read_b64_tr_b16 v[122:123], v242 offset:38912
    v_mfma_f32_16x16x32_bf16 v[16:19], v[96:99], a[68:71], v[16:19]
    buffer_load_dwordx4 a[112:115], v226, s[36:39], s53 offen offset:0 sc1
    v_mfma_f32_16x16x32_bf16 v[4:7], v[100:103], a[64:67], v[4:7]
    s_mov_b32 s52, 3276800
    ds_read_b64_tr_b16 v[124:125], v243 offset:34816
    ds_read_b64_tr_b16 v[126:127], v243 offset:38912
    v_mfma_f32_16x16x32_bf16 v[20:23], v[100:103], a[68:71], v[20:23]
    s_waitcnt lgkmcnt(8)
    v_mfma_f32_16x16x32_bf16 v[8:11], v[104:107], a[64:67], v[8:11]
    s_add_u32 m0, s29, 98304
    ds_read_b64_tr_b16 v[96:97], v240 offset:40960
    ds_read_b64_tr_b16 v[98:99], v240 offset:45056
    v_mfma_f32_16x16x32_bf16 v[24:27], v[104:107], a[68:71], v[24:27]
    buffer_load_dwordx4 v230, s[32:35], s52 offen offset:0 lds
    v_mfma_f32_16x16x32_bf16 v[12:15], v[108:111], a[64:67], v[12:15]
    ds_read_b64_tr_b16 v[100:101], v241 offset:40960
    ds_read_b64_tr_b16 v[102:103], v241 offset:45056
    v_mfma_f32_16x16x32_bf16 v[28:31], v[108:111], a[68:71], v[28:31]
    s_waitcnt lgkmcnt(8)
    v_mfma_f32_16x16x32_bf16 v[32:35], v[112:115], a[64:67], v[32:35]
    ds_read_b64_tr_b16 v[104:105], v242 offset:40960
    ds_read_b64_tr_b16 v[106:107], v242 offset:45056
    v_mfma_f32_16x16x32_bf16 v[48:51], v[112:115], a[68:71], v[48:51]
    buffer_load_dwordx4 a[116:119], v226, s[36:39], s53 offen offset:1024 sc1
    v_mfma_f32_16x16x32_bf16 v[36:39], v[116:119], a[64:67], v[36:39]
    ds_read_b64_tr_b16 v[108:109], v243 offset:40960
    ds_read_b64_tr_b16 v[110:111], v243 offset:45056
    v_mfma_f32_16x16x32_bf16 v[52:55], v[116:119], a[68:71], v[52:55]
    s_waitcnt lgkmcnt(8)
    v_mfma_f32_16x16x32_bf16 v[40:43], v[120:123], a[64:67], v[40:43]
    ds_read_b64_tr_b16 v[112:113], v240 offset:43008
    ds_read_b64_tr_b16 v[114:115], v240 offset:47104
    v_mfma_f32_16x16x32_bf16 v[56:59], v[120:123], a[68:71], v[56:59]
    buffer_load_dwordx4 v231, s[32:35], s52 offen offset:1024 lds
    v_mfma_f32_16x16x32_bf16 v[44:47], v[124:127], a[64:67], v[44:47]
    ds_read_b64_tr_b16 v[116:117], v241 offset:43008
    ds_read_b64_tr_b16 v[118:119], v241 offset:47104
    v_mfma_f32_16x16x32_bf16 v[60:63], v[124:127], a[68:71], v[60:63]
    s_waitcnt vmcnt(21) lgkmcnt(8)
    v_mfma_f32_16x16x32_bf16 v[0:3], v[96:99], a[72:75], v[0:3]
    ds_read_b64_tr_b16 v[120:121], v242 offset:43008
    ds_read_b64_tr_b16 v[122:123], v242 offset:47104
    v_mfma_f32_16x16x32_bf16 v[16:19], v[96:99], a[76:79], v[16:19]
    buffer_load_dwordx4 a[120:123], v226, s[36:39], s53 offen offset:2048 sc1
    v_mfma_f32_16x16x32_bf16 v[4:7], v[100:103], a[72:75], v[4:7]
    ds_read_b64_tr_b16 v[124:125], v243 offset:43008
    ds_read_b64_tr_b16 v[126:127], v243 offset:47104
    v_mfma_f32_16x16x32_bf16 v[20:23], v[100:103], a[76:79], v[20:23]
    s_waitcnt lgkmcnt(8)
    v_mfma_f32_16x16x32_bf16 v[8:11], v[104:107], a[72:75], v[8:11]
    s_add_u32 m0, s29, 100352
    ds_read_b64_tr_b16 v[96:97], v240 offset:49152
    ds_read_b64_tr_b16 v[98:99], v240 offset:53248
    v_mfma_f32_16x16x32_bf16 v[24:27], v[104:107], a[76:79], v[24:27]
    buffer_load_dwordx4 v232, s[96:99], s52 offen offset:0 lds
    v_mfma_f32_16x16x32_bf16 v[12:15], v[108:111], a[72:75], v[12:15]
    ds_read_b64_tr_b16 v[100:101], v241 offset:49152
    ds_read_b64_tr_b16 v[102:103], v241 offset:53248
    v_mfma_f32_16x16x32_bf16 v[28:31], v[108:111], a[76:79], v[28:31]
    s_waitcnt lgkmcnt(8)
    v_mfma_f32_16x16x32_bf16 v[32:35], v[112:115], a[72:75], v[32:35]
    ds_read_b64_tr_b16 v[104:105], v242 offset:49152
    ds_read_b64_tr_b16 v[106:107], v242 offset:53248
    v_mfma_f32_16x16x32_bf16 v[48:51], v[112:115], a[76:79], v[48:51]
    buffer_load_dwordx4 a[124:127], v226, s[36:39], s53 offen offset:3072 sc1
    v_mfma_f32_16x16x32_bf16 v[36:39], v[116:119], a[72:75], v[36:39]
    ds_read_b64_tr_b16 v[108:109], v243 offset:49152
    ds_read_b64_tr_b16 v[110:111], v243 offset:53248
    v_mfma_f32_16x16x32_bf16 v[52:55], v[116:119], a[76:79], v[52:55]
    s_waitcnt lgkmcnt(8)
    v_mfma_f32_16x16x32_bf16 v[40:43], v[120:123], a[72:75], v[40:43]
    ds_read_b64_tr_b16 v[112:113], v240 offset:51200
    ds_read_b64_tr_b16 v[114:115], v240 offset:55296
    v_mfma_f32_16x16x32_bf16 v[56:59], v[120:123], a[76:79], v[56:59]
    v_mfma_f32_16x16x32_bf16 v[44:47], v[124:127], a[72:75], v[44:47]
    ds_read_b64_tr_b16 v[116:117], v241 offset:51200
    ds_read_b64_tr_b16 v[118:119], v241 offset:55296
    v_mfma_f32_16x16x32_bf16 v[60:63], v[124:127], a[76:79], v[60:63]
    s_waitcnt vmcnt(20) lgkmcnt(8)
    v_mfma_f32_16x16x32_bf16 v[0:3], v[96:99], a[80:83], v[0:3]
    ds_read_b64_tr_b16 v[120:121], v242 offset:51200
    ds_read_b64_tr_b16 v[122:123], v242 offset:55296
    v_mfma_f32_16x16x32_bf16 v[16:19], v[96:99], a[84:87], v[16:19]
    buffer_load_dwordx4 v233, s[96:99], s52 offen offset:1024 lds
    v_mfma_f32_16x16x32_bf16 v[4:7], v[100:103], a[80:83], v[4:7]
    ds_read_b64_tr_b16 v[124:125], v243 offset:51200
    ds_read_b64_tr_b16 v[126:127], v243 offset:55296
    v_mfma_f32_16x16x32_bf16 v[20:23], v[100:103], a[84:87], v[20:23]
    s_waitcnt lgkmcnt(8)
    v_mfma_f32_16x16x32_bf16 v[8:11], v[104:107], a[80:83], v[8:11]
    s_mov_b32 s53, 98304
    ds_read_b64_tr_b16 v[96:97], v240 offset:57344
    ds_read_b64_tr_b16 v[98:99], v240 offset:61440
    v_mfma_f32_16x16x32_bf16 v[24:27], v[104:107], a[84:87], v[24:27]
    buffer_load_dwordx4 a[128:131], v226, s[36:39], s53 offen offset:0 sc1
    v_mfma_f32_16x16x32_bf16 v[12:15], v[108:111], a[80:83], v[12:15]
    ds_read_b64_tr_b16 v[100:101], v241 offset:57344
    ds_read_b64_tr_b16 v[102:103], v241 offset:61440
    v_mfma_f32_16x16x32_bf16 v[28:31], v[108:111], a[84:87], v[28:31]
    s_waitcnt lgkmcnt(8)
    v_mfma_f32_16x16x32_bf16 v[32:35], v[112:115], a[80:83], v[32:35]
    ds_read_b64_tr_b16 v[104:105], v242 offset:57344
    ds_read_b64_tr_b16 v[106:107], v242 offset:61440
    v_mfma_f32_16x16x32_bf16 v[48:51], v[112:115], a[84:87], v[48:51]
    buffer_load_dwordx4 a[132:135], v226, s[36:39], s53 offen offset:1024 sc1
    v_mfma_f32_16x16x32_bf16 v[36:39], v[116:119], a[80:83], v[36:39]
    s_mov_b32 s52, 3407872
    ds_read_b64_tr_b16 v[108:109], v243 offset:57344
    ds_read_b64_tr_b16 v[110:111], v243 offset:61440
    v_mfma_f32_16x16x32_bf16 v[52:55], v[116:119], a[84:87], v[52:55]
    s_waitcnt lgkmcnt(8)
    v_mfma_f32_16x16x32_bf16 v[40:43], v[120:123], a[80:83], v[40:43]
    s_add_u32 m0, s29, 0
    ds_read_b64_tr_b16 v[112:113], v240 offset:59392
    ds_read_b64_tr_b16 v[114:115], v240 offset:63488
    v_mfma_f32_16x16x32_bf16 v[56:59], v[120:123], a[84:87], v[56:59]
    buffer_load_dwordx4 v230, s[32:35], s52 offen offset:0 lds
    v_mfma_f32_16x16x32_bf16 v[44:47], v[124:127], a[80:83], v[44:47]
    ds_read_b64_tr_b16 v[116:117], v241 offset:59392
    ds_read_b64_tr_b16 v[118:119], v241 offset:63488
    v_mfma_f32_16x16x32_bf16 v[60:63], v[124:127], a[84:87], v[60:63]
    s_waitcnt vmcnt(20) lgkmcnt(8)
    v_mfma_f32_16x16x32_bf16 v[0:3], v[96:99], a[88:91], v[0:3]
    ds_read_b64_tr_b16 v[120:121], v242 offset:59392
    ds_read_b64_tr_b16 v[122:123], v242 offset:63488
    v_mfma_f32_16x16x32_bf16 v[16:19], v[96:99], a[92:95], v[16:19]
    buffer_load_dwordx4 a[136:139], v226, s[36:39], s53 offen offset:2048 sc1
    v_mfma_f32_16x16x32_bf16 v[4:7], v[100:103], a[88:91], v[4:7]
    ds_read_b64_tr_b16 v[124:125], v243 offset:59392
    ds_read_b64_tr_b16 v[126:127], v243 offset:63488
    v_mfma_f32_16x16x32_bf16 v[20:23], v[100:103], a[92:95], v[20:23]
    s_waitcnt lgkmcnt(8)
    s_barrier
    v_mfma_f32_16x16x32_bf16 v[8:11], v[104:107], a[88:91], v[8:11]
    ds_read_b64_tr_b16 v[96:97], v244 offset:0
    ds_read_b64_tr_b16 v[98:99], v244 offset:4096
    v_mfma_f32_16x16x32_bf16 v[24:27], v[104:107], a[92:95], v[24:27]
    buffer_load_dwordx4 v231, s[32:35], s52 offen offset:1024 lds
    v_mfma_f32_16x16x32_bf16 v[12:15], v[108:111], a[88:91], v[12:15]
    ds_read_b64_tr_b16 v[100:101], v245 offset:0
    ds_read_b64_tr_b16 v[102:103], v245 offset:4096
    v_mfma_f32_16x16x32_bf16 v[28:31], v[108:111], a[92:95], v[28:31]
    s_waitcnt lgkmcnt(8)
    v_mfma_f32_16x16x32_bf16 v[32:35], v[112:115], a[88:91], v[32:35]
    ds_read_b64_tr_b16 v[104:105], v246 offset:0
    ds_read_b64_tr_b16 v[106:107], v246 offset:4096
    v_mfma_f32_16x16x32_bf16 v[48:51], v[112:115], a[92:95], v[48:51]
    buffer_load_dwordx4 a[140:143], v226, s[36:39], s53 offen offset:3072 sc1
    v_mfma_f32_16x16x32_bf16 v[36:39], v[116:119], a[88:91], v[36:39]
    ds_read_b64_tr_b16 v[108:109], v247 offset:0
    ds_read_b64_tr_b16 v[110:111], v247 offset:4096
    v_mfma_f32_16x16x32_bf16 v[52:55], v[116:119], a[92:95], v[52:55]
    s_waitcnt lgkmcnt(8)
    v_mfma_f32_16x16x32_bf16 v[40:43], v[120:123], a[88:91], v[40:43]
    s_add_u32 m0, s29, 2048
    ds_read_b64_tr_b16 v[112:113], v244 offset:2048
    ds_read_b64_tr_b16 v[114:115], v244 offset:6144
    v_mfma_f32_16x16x32_bf16 v[56:59], v[120:123], a[92:95], v[56:59]
    buffer_load_dwordx4 v232, s[96:99], s52 offen offset:0 lds
    v_mfma_f32_16x16x32_bf16 v[44:47], v[124:127], a[88:91], v[44:47]
    ds_read_b64_tr_b16 v[116:117], v245 offset:2048
    ds_read_b64_tr_b16 v[118:119], v245 offset:6144
    v_mfma_f32_16x16x32_bf16 v[60:63], v[124:127], a[92:95], v[60:63]
    s_waitcnt vmcnt(21) lgkmcnt(8)
    v_mfma_f32_16x16x32_bf16 v[0:3], v[96:99], a[96:99], v[0:3]
    s_mov_b32 s53, 102400
    ds_read_b64_tr_b16 v[120:121], v246 offset:2048
    ds_read_b64_tr_b16 v[122:123], v246 offset:6144
    v_mfma_f32_16x16x32_bf16 v[16:19], v[96:99], a[100:103], v[16:19]
    buffer_load_dwordx4 a[144:147], v226, s[36:39], s53 offen offset:0 sc1
    v_mfma_f32_16x16x32_bf16 v[4:7], v[100:103], a[96:99], v[4:7]
    ds_read_b64_tr_b16 v[124:125], v247 offset:2048
    ds_read_b64_tr_b16 v[126:127], v247 offset:6144
    v_mfma_f32_16x16x32_bf16 v[20:23], v[100:103], a[100:103], v[20:23]
    s_waitcnt lgkmcnt(8)
    v_mfma_f32_16x16x32_bf16 v[8:11], v[104:107], a[96:99], v[8:11]
    ds_read_b64_tr_b16 v[96:97], v244 offset:8192
    ds_read_b64_tr_b16 v[98:99], v244 offset:12288
    v_mfma_f32_16x16x32_bf16 v[24:27], v[104:107], a[100:103], v[24:27]
    v_mfma_f32_16x16x32_bf16 v[12:15], v[108:111], a[96:99], v[12:15]
    ds_read_b64_tr_b16 v[100:101], v245 offset:8192
    ds_read_b64_tr_b16 v[102:103], v245 offset:12288
    v_mfma_f32_16x16x32_bf16 v[28:31], v[108:111], a[100:103], v[28:31]
    s_waitcnt lgkmcnt(8)
    v_mfma_f32_16x16x32_bf16 v[32:35], v[112:115], a[96:99], v[32:35]
    ds_read_b64_tr_b16 v[104:105], v246 offset:8192
    ds_read_b64_tr_b16 v[106:107], v246 offset:12288
    v_mfma_f32_16x16x32_bf16 v[48:51], v[112:115], a[100:103], v[48:51]
    buffer_load_dwordx4 a[148:151], v226, s[36:39], s53 offen offset:1024 sc1
    v_mfma_f32_16x16x32_bf16 v[36:39], v[116:119], a[96:99], v[36:39]
    ds_read_b64_tr_b16 v[108:109], v247 offset:8192
    ds_read_b64_tr_b16 v[110:111], v247 offset:12288
    v_mfma_f32_16x16x32_bf16 v[52:55], v[116:119], a[100:103], v[52:55]
    s_waitcnt lgkmcnt(8)
    v_mfma_f32_16x16x32_bf16 v[40:43], v[120:123], a[96:99], v[40:43]
    ds_read_b64_tr_b16 v[112:113], v244 offset:10240
    ds_read_b64_tr_b16 v[114:115], v244 offset:14336
    v_mfma_f32_16x16x32_bf16 v[56:59], v[120:123], a[100:103], v[56:59]
    buffer_load_dwordx4 v233, s[96:99], s52 offen offset:1024 lds
    v_mfma_f32_16x16x32_bf16 v[44:47], v[124:127], a[96:99], v[44:47]
    ds_read_b64_tr_b16 v[116:117], v245 offset:10240
    ds_read_b64_tr_b16 v[118:119], v245 offset:14336
    v_mfma_f32_16x16x32_bf16 v[60:63], v[124:127], a[100:103], v[60:63]
    s_waitcnt vmcnt(18) lgkmcnt(8)
    v_mfma_f32_16x16x32_bf16 v[0:3], v[96:99], a[104:107], v[0:3]
    ds_read_b64_tr_b16 v[120:121], v246 offset:10240
    ds_read_b64_tr_b16 v[122:123], v246 offset:14336
    v_mfma_f32_16x16x32_bf16 v[16:19], v[96:99], a[108:111], v[16:19]
    buffer_load_dwordx4 a[152:155], v226, s[36:39], s53 offen offset:2048 sc1
    v_mfma_f32_16x16x32_bf16 v[4:7], v[100:103], a[104:107], v[4:7]
    s_mov_b32 s52, 3538944
    ds_read_b64_tr_b16 v[124:125], v247 offset:10240
    ds_read_b64_tr_b16 v[126:127], v247 offset:14336
    v_mfma_f32_16x16x32_bf16 v[20:23], v[100:103], a[108:111], v[20:23]
    s_waitcnt lgkmcnt(8)
    v_mfma_f32_16x16x32_bf16 v[8:11], v[104:107], a[104:107], v[8:11]
    s_add_u32 m0, s29, 16384
    ds_read_b64_tr_b16 v[96:97], v248 offset:16384
    ds_read_b64_tr_b16 v[98:99], v248 offset:20480
    v_mfma_f32_16x16x32_bf16 v[24:27], v[104:107], a[108:111], v[24:27]
    buffer_load_dwordx4 v230, s[32:35], s52 offen offset:0 lds
    v_mfma_f32_16x16x32_bf16 v[12:15], v[108:111], a[104:107], v[12:15]
    ds_read_b64_tr_b16 v[100:101], v249 offset:16384
    ds_read_b64_tr_b16 v[102:103], v249 offset:20480
    v_mfma_f32_16x16x32_bf16 v[28:31], v[108:111], a[108:111], v[28:31]
    s_waitcnt lgkmcnt(8)
    v_mfma_f32_16x16x32_bf16 v[32:35], v[112:115], a[104:107], v[32:35]
    ds_read_b64_tr_b16 v[104:105], v250 offset:16384
    ds_read_b64_tr_b16 v[106:107], v250 offset:20480
    v_mfma_f32_16x16x32_bf16 v[48:51], v[112:115], a[108:111], v[48:51]
    buffer_load_dwordx4 a[156:159], v226, s[36:39], s53 offen offset:3072 sc1
    v_mfma_f32_16x16x32_bf16 v[36:39], v[116:119], a[104:107], v[36:39]
    ds_read_b64_tr_b16 v[108:109], v251 offset:16384
    ds_read_b64_tr_b16 v[110:111], v251 offset:20480
    v_mfma_f32_16x16x32_bf16 v[52:55], v[116:119], a[108:111], v[52:55]
    s_waitcnt lgkmcnt(8)
    v_mfma_f32_16x16x32_bf16 v[40:43], v[120:123], a[104:107], v[40:43]
    ds_read_b64_tr_b16 v[112:113], v248 offset:18432
    ds_read_b64_tr_b16 v[114:115], v248 offset:22528
    v_mfma_f32_16x16x32_bf16 v[56:59], v[120:123], a[108:111], v[56:59]
    buffer_load_dwordx4 v231, s[32:35], s52 offen offset:1024 lds
    v_mfma_f32_16x16x32_bf16 v[44:47], v[124:127], a[104:107], v[44:47]
    ds_read_b64_tr_b16 v[116:117], v249 offset:18432
    ds_read_b64_tr_b16 v[118:119], v249 offset:22528
    v_mfma_f32_16x16x32_bf16 v[60:63], v[124:127], a[108:111], v[60:63]
    s_waitcnt vmcnt(19) lgkmcnt(8)
    v_mfma_f32_16x16x32_bf16 v[0:3], v[96:99], a[112:115], v[0:3]
    s_mov_b32 s53, 106496
    ds_read_b64_tr_b16 v[120:121], v250 offset:18432
    ds_read_b64_tr_b16 v[122:123], v250 offset:22528
    v_mfma_f32_16x16x32_bf16 v[16:19], v[96:99], a[116:119], v[16:19]
    buffer_load_dwordx2 a[160:161], v239, s[36:39], s53 offen offset:0 sc1
    buffer_load_dwordx2 a[162:163], v239, s[36:39], s53 offen offset:512 sc1
    v_mfma_f32_16x16x32_bf16 v[4:7], v[100:103], a[112:115], v[4:7]
    ds_read_b64_tr_b16 v[124:125], v251 offset:18432
    ds_read_b64_tr_b16 v[126:127], v251 offset:22528
    v_mfma_f32_16x16x32_bf16 v[20:23], v[100:103], a[116:119], v[20:23]
    s_waitcnt lgkmcnt(8)
    v_mfma_f32_16x16x32_bf16 v[8:11], v[104:107], a[112:115], v[8:11]
    ds_read_b64_tr_b16 v[96:97], v248 offset:24576
    ds_read_b64_tr_b16 v[98:99], v248 offset:28672
    v_mfma_f32_16x16x32_bf16 v[24:27], v[104:107], a[116:119], v[24:27]
    v_mfma_f32_16x16x32_bf16 v[12:15], v[108:111], a[112:115], v[12:15]
    ds_read_b64_tr_b16 v[100:101], v249 offset:24576
    ds_read_b64_tr_b16 v[102:103], v249 offset:28672
    v_mfma_f32_16x16x32_bf16 v[28:31], v[108:111], a[116:119], v[28:31]
    s_waitcnt lgkmcnt(8)
    v_mfma_f32_16x16x32_bf16 v[32:35], v[112:115], a[112:115], v[32:35]
    ds_read_b64_tr_b16 v[104:105], v250 offset:24576
    ds_read_b64_tr_b16 v[106:107], v250 offset:28672
    v_mfma_f32_16x16x32_bf16 v[48:51], v[112:115], a[116:119], v[48:51]
    buffer_load_dwordx2 a[164:165], v239, s[36:39], s53 offen offset:1024 sc1
    buffer_load_dwordx2 a[166:167], v239, s[36:39], s53 offen offset:1536 sc1
    v_mfma_f32_16x16x32_bf16 v[36:39], v[116:119], a[112:115], v[36:39]
    ds_read_b64_tr_b16 v[108:109], v251 offset:24576
    ds_read_b64_tr_b16 v[110:111], v251 offset:28672
    v_mfma_f32_16x16x32_bf16 v[52:55], v[116:119], a[116:119], v[52:55]
    s_waitcnt lgkmcnt(8)
    v_mfma_f32_16x16x32_bf16 v[40:43], v[120:123], a[112:115], v[40:43]
    s_add_u32 m0, s29, 18432
    ds_read_b64_tr_b16 v[112:113], v248 offset:26624
    ds_read_b64_tr_b16 v[114:115], v248 offset:30720
    v_mfma_f32_16x16x32_bf16 v[56:59], v[120:123], a[116:119], v[56:59]
    buffer_load_dwordx4 v232, s[96:99], s52 offen offset:0 lds
    v_mfma_f32_16x16x32_bf16 v[44:47], v[124:127], a[112:115], v[44:47]
    ds_read_b64_tr_b16 v[116:117], v249 offset:26624
    ds_read_b64_tr_b16 v[118:119], v249 offset:30720
    v_mfma_f32_16x16x32_bf16 v[60:63], v[124:127], a[116:119], v[60:63]
    s_waitcnt vmcnt(20) lgkmcnt(8)
    v_mfma_f32_16x16x32_bf16 v[0:3], v[96:99], a[120:123], v[0:3]
    ds_read_b64_tr_b16 v[120:121], v250 offset:26624
    ds_read_b64_tr_b16 v[122:123], v250 offset:30720
    v_mfma_f32_16x16x32_bf16 v[16:19], v[96:99], a[124:127], v[16:19]
    buffer_load_dwordx4 a[168:171], v226, s[36:39], s53 offen offset:2048 sc1
    v_mfma_f32_16x16x32_bf16 v[4:7], v[100:103], a[120:123], v[4:7]
    ds_read_b64_tr_b16 v[124:125], v251 offset:26624
    ds_read_b64_tr_b16 v[126:127], v251 offset:30720
    v_mfma_f32_16x16x32_bf16 v[20:23], v[100:103], a[124:127], v[20:23]
    s_waitcnt vmcnt(20) lgkmcnt(8)
    s_barrier
    v_mfma_f32_16x16x32_bf16 v[8:11], v[104:107], a[120:123], v[8:11]
    ds_read_b64_tr_b16 v[96:97], v244 offset:16384
    ds_read_b64_tr_b16 v[98:99], v244 offset:20480
    v_mfma_f32_16x16x32_bf16 v[24:27], v[104:107], a[124:127], v[24:27]
    buffer_load_dwordx4 v233, s[96:99], s52 offen offset:1024 lds
    v_mfma_f32_16x16x32_bf16 v[12:15], v[108:111], a[120:123], v[12:15]
    ds_read_b64_tr_b16 v[100:101], v245 offset:16384
    ds_read_b64_tr_b16 v[102:103], v245 offset:20480
    v_mfma_f32_16x16x32_bf16 v[28:31], v[108:111], a[124:127], v[28:31]
    s_waitcnt lgkmcnt(8)
    v_mfma_f32_16x16x32_bf16 v[32:35], v[112:115], a[120:123], v[32:35]
    ds_read_b64_tr_b16 v[104:105], v246 offset:16384
    ds_read_b64_tr_b16 v[106:107], v246 offset:20480
    v_mfma_f32_16x16x32_bf16 v[48:51], v[112:115], a[124:127], v[48:51]
    buffer_load_dwordx4 a[172:175], v226, s[36:39], s53 offen offset:3072 sc1
    v_mfma_f32_16x16x32_bf16 v[36:39], v[116:119], a[120:123], v[36:39]
    ds_read_b64_tr_b16 v[108:109], v247 offset:16384
    ds_read_b64_tr_b16 v[110:111], v247 offset:20480
    v_mfma_f32_16x16x32_bf16 v[52:55], v[116:119], a[124:127], v[52:55]
    s_waitcnt lgkmcnt(8)
    v_mfma_f32_16x16x32_bf16 v[40:43], v[120:123], a[120:123], v[40:43]
    ds_read_b64_tr_b16 v[112:113], v244 offset:18432
    ds_read_b64_tr_b16 v[114:115], v244 offset:22528
    v_mfma_f32_16x16x32_bf16 v[56:59], v[120:123], a[124:127], v[56:59]
    v_mfma_f32_16x16x32_bf16 v[44:47], v[124:127], a[120:123], v[44:47]
    ds_read_b64_tr_b16 v[116:117], v245 offset:18432
    ds_read_b64_tr_b16 v[118:119], v245 offset:22528
    v_mfma_f32_16x16x32_bf16 v[60:63], v[124:127], a[124:127], v[60:63]
    s_waitcnt vmcnt(20) lgkmcnt(8)
    v_mfma_f32_16x16x32_bf16 v[0:3], v[96:99], a[128:131], v[0:3]
    s_mov_b32 s53, 110592
    ds_read_b64_tr_b16 v[120:121], v246 offset:18432
    ds_read_b64_tr_b16 v[122:123], v246 offset:22528
    v_mfma_f32_16x16x32_bf16 v[16:19], v[96:99], a[132:135], v[16:19]
    buffer_load_dwordx4 a[176:179], v226, s[36:39], s53 offen offset:0 sc1
    v_mfma_f32_16x16x32_bf16 v[4:7], v[100:103], a[128:131], v[4:7]
    ds_read_b64_tr_b16 v[124:125], v247 offset:18432
    ds_read_b64_tr_b16 v[126:127], v247 offset:22528
    v_mfma_f32_16x16x32_bf16 v[20:23], v[100:103], a[132:135], v[20:23]
    s_waitcnt lgkmcnt(8)
    v_mfma_f32_16x16x32_bf16 v[8:11], v[104:107], a[128:131], v[8:11]
    ds_read_b64_tr_b16 v[96:97], v244 offset:24576
    ds_read_b64_tr_b16 v[98:99], v244 offset:28672
    v_mfma_f32_16x16x32_bf16 v[24:27], v[104:107], a[132:135], v[24:27]
    v_mfma_f32_16x16x32_bf16 v[12:15], v[108:111], a[128:131], v[12:15]
    ds_read_b64_tr_b16 v[100:101], v245 offset:24576
    ds_read_b64_tr_b16 v[102:103], v245 offset:28672
    v_mfma_f32_16x16x32_bf16 v[28:31], v[108:111], a[132:135], v[28:31]
    s_waitcnt lgkmcnt(8)
    v_mfma_f32_16x16x32_bf16 v[32:35], v[112:115], a[128:131], v[32:35]
    ds_read_b64_tr_b16 v[104:105], v246 offset:24576
    ds_read_b64_tr_b16 v[106:107], v246 offset:28672
    v_mfma_f32_16x16x32_bf16 v[48:51], v[112:115], a[132:135], v[48:51]
    buffer_load_dwordx4 a[180:183], v226, s[36:39], s53 offen offset:1024 sc1
    v_mfma_f32_16x16x32_bf16 v[36:39], v[116:119], a[128:131], v[36:39]
    ds_read_b64_tr_b16 v[108:109], v247 offset:24576
    ds_read_b64_tr_b16 v[110:111], v247 offset:28672
    v_mfma_f32_16x16x32_bf16 v[52:55], v[116:119], a[132:135], v[52:55]
    s_waitcnt lgkmcnt(8)
    v_mfma_f32_16x16x32_bf16 v[40:43], v[120:123], a[128:131], v[40:43]
    ds_read_b64_tr_b16 v[112:113], v244 offset:26624
    ds_read_b64_tr_b16 v[114:115], v244 offset:30720
    v_mfma_f32_16x16x32_bf16 v[56:59], v[120:123], a[132:135], v[56:59]
    v_mfma_f32_16x16x32_bf16 v[44:47], v[124:127], a[128:131], v[44:47]
    ds_read_b64_tr_b16 v[116:117], v245 offset:26624
    ds_read_b64_tr_b16 v[118:119], v245 offset:30720
    v_mfma_f32_16x16x32_bf16 v[60:63], v[124:127], a[132:135], v[60:63]
    s_waitcnt vmcnt(18) lgkmcnt(8)
    v_mfma_f32_16x16x32_bf16 v[0:3], v[96:99], a[136:139], v[0:3]
    ds_read_b64_tr_b16 v[120:121], v246 offset:26624
    ds_read_b64_tr_b16 v[122:123], v246 offset:30720
    v_mfma_f32_16x16x32_bf16 v[16:19], v[96:99], a[140:143], v[16:19]
    buffer_load_dwordx4 a[184:187], v226, s[36:39], s53 offen offset:2048 sc1
    v_mfma_f32_16x16x32_bf16 v[4:7], v[100:103], a[136:139], v[4:7]
Lpad_19:
    s_cbranch_execz Lback_d2
    ds_read_b64_tr_b16 v[124:125], v247 offset:26624
    ds_read_b64_tr_b16 v[126:127], v247 offset:30720
    v_mfma_f32_16x16x32_bf16 v[20:23], v[100:103], a[140:143], v[20:23]
    s_waitcnt lgkmcnt(8)
    v_mfma_f32_16x16x32_bf16 v[8:11], v[104:107], a[136:139], v[8:11]
    ds_read_b64_tr_b16 v[96:97], v244 offset:32768
    ds_read_b64_tr_b16 v[98:99], v244 offset:36864
    v_mfma_f32_16x16x32_bf16 v[24:27], v[104:107], a[140:143], v[24:27]
    v_mfma_f32_16x16x32_bf16 v[12:15], v[108:111], a[136:139], v[12:15]
    ds_read_b64_tr_b16 v[100:101], v245 offset:32768
    ds_read_b64_tr_b16 v[102:103], v245 offset:36864
    v_mfma_f32_16x16x32_bf16 v[28:31], v[108:111], a[140:143], v[28:31]
    s_waitcnt lgkmcnt(8)
    v_mfma_f32_16x16x32_bf16 v[32:35], v[112:115], a[136:139], v[32:35]
    ds_read_b64_tr_b16 v[104:105], v246 offset:32768
    ds_read_b64_tr_b16 v[106:107], v246 offset:36864
    v_mfma_f32_16x16x32_bf16 v[48:51], v[112:115], a[140:143], v[48:51]
    buffer_load_dwordx4 a[188:191], v226, s[36:39], s53 offen offset:3072 sc1
    v_mfma_f32_16x16x32_bf16 v[36:39], v[116:119], a[136:139], v[36:39]
    ds_read_b64_tr_b16 v[108:109], v247 offset:32768
    ds_read_b64_tr_b16 v[110:111], v247 offset:36864
    v_mfma_f32_16x16x32_bf16 v[52:55], v[116:119], a[140:143], v[52:55]
    s_waitcnt lgkmcnt(8)
    v_mfma_f32_16x16x32_bf16 v[40:43], v[120:123], a[136:139], v[40:43]
    ds_read_b64_tr_b16 v[112:113], v244 offset:34816
    ds_read_b64_tr_b16 v[114:115], v244 offset:38912
    v_mfma_f32_16x16x32_bf16 v[56:59], v[120:123], a[140:143], v[56:59]
    v_mfma_f32_16x16x32_bf16 v[44:47], v[124:127], a[136:139], v[44:47]
    ds_read_b64_tr_b16 v[116:117], v245 offset:34816
    ds_read_b64_tr_b16 v[118:119], v245 offset:38912
    v_mfma_f32_16x16x32_bf16 v[60:63], v[124:127], a[140:143], v[60:63]
    s_waitcnt vmcnt(17) lgkmcnt(8)
    v_mfma_f32_16x16x32_bf16 v[0:3], v[96:99], a[144:147], v[0:3]
    ds_read_b64_tr_b16 v[120:121], v246 offset:34816
    ds_read_b64_tr_b16 v[122:123], v246 offset:38912
    v_mfma_f32_16x16x32_bf16 v[16:19], v[96:99], a[148:151], v[16:19]
    buffer_load_dwordx4 v[64:67], v226, s[40:43], 0 offen offset:0 sc1
    v_mfma_f32_16x16x32_bf16 v[4:7], v[100:103], a[144:147], v[4:7]
    ds_read_b64_tr_b16 v[124:125], v247 offset:34816
    ds_read_b64_tr_b16 v[126:127], v247 offset:38912
    v_mfma_f32_16x16x32_bf16 v[20:23], v[100:103], a[148:151], v[20:23]
    s_waitcnt lgkmcnt(8)
    v_mfma_f32_16x16x32_bf16 v[8:11], v[104:107], a[144:147], v[8:11]
    ds_read_b64_tr_b16 v[96:97], v244 offset:40960
    ds_read_b64_tr_b16 v[98:99], v244 offset:45056
    v_mfma_f32_16x16x32_bf16 v[24:27], v[104:107], a[148:151], v[24:27]
    buffer_load_dwordx4 v[68:71], v226, s[40:43], 0 offen offset:2048 sc1
    v_mfma_f32_16x16x32_bf16 v[12:15], v[108:111], a[144:147], v[12:15]
    ds_read_b64_tr_b16 v[100:101], v245 offset:40960
    ds_read_b64_tr_b16 v[102:103], v245 offset:45056
    v_mfma_f32_16x16x32_bf16 v[28:31], v[108:111], a[148:151], v[28:31]
    s_waitcnt lgkmcnt(8)
    v_mfma_f32_16x16x32_bf16 v[32:35], v[112:115], a[144:147], v[32:35]
    ds_read_b64_tr_b16 v[104:105], v246 offset:40960
    ds_read_b64_tr_b16 v[106:107], v246 offset:45056
    v_mfma_f32_16x16x32_bf16 v[48:51], v[112:115], a[148:151], v[48:51]
    buffer_load_dwordx4 v[72:75], v226, s[40:43], 0 offen offset:1024 sc1
    v_mfma_f32_16x16x32_bf16 v[36:39], v[116:119], a[144:147], v[36:39]
    ds_read_b64_tr_b16 v[108:109], v247 offset:40960
    ds_read_b64_tr_b16 v[110:111], v247 offset:45056
    v_mfma_f32_16x16x32_bf16 v[52:55], v[116:119], a[148:151], v[52:55]
    s_waitcnt lgkmcnt(8)
    v_mfma_f32_16x16x32_bf16 v[40:43], v[120:123], a[144:147], v[40:43]
    ds_read_b64_tr_b16 v[112:113], v244 offset:43008
    ds_read_b64_tr_b16 v[114:115], v244 offset:47104
    v_mfma_f32_16x16x32_bf16 v[56:59], v[120:123], a[148:151], v[56:59]
    buffer_load_dwordx4 v[76:79], v226, s[40:43], 0 offen offset:3072 sc1
    v_mfma_f32_16x16x32_bf16 v[44:47], v[124:127], a[144:147], v[44:47]
    ds_read_b64_tr_b16 v[116:117], v245 offset:43008
    ds_read_b64_tr_b16 v[118:119], v245 offset:47104
    v_mfma_f32_16x16x32_bf16 v[60:63], v[124:127], a[148:151], v[60:63]
    s_waitcnt vmcnt(17) lgkmcnt(8)
    v_mfma_f32_16x16x32_bf16 v[0:3], v[96:99], a[152:155], v[0:3]
    ds_read_b64_tr_b16 v[120:121], v246 offset:43008
    ds_read_b64_tr_b16 v[122:123], v246 offset:47104
    v_mfma_f32_16x16x32_bf16 v[16:19], v[96:99], a[156:159], v[16:19]
    buffer_load_dword v80, v235, s[48:51], s63 offen offset:0 sc1
    v_mfma_f32_16x16x32_bf16 v[4:7], v[100:103], a[152:155], v[4:7]
    ds_read_b64_tr_b16 v[124:125], v247 offset:43008
    ds_read_b64_tr_b16 v[126:127], v247 offset:47104
    v_mfma_f32_16x16x32_bf16 v[20:23], v[100:103], a[156:159], v[20:23]
    s_waitcnt vmcnt(10) lgkmcnt(8)
    s_barrier
    v_mfma_f32_16x16x32_bf16 v[8:11], v[104:107], a[152:155], v[8:11]
    ds_read_b64_tr_b16 v[96:97], v240 offset:2048
    ds_read_b64_tr_b16 v[98:99], v240 offset:6144
    v_mfma_f32_16x16x32_bf16 v[24:27], v[104:107], a[156:159], v[24:27]
    buffer_load_dword v82, v235, s[48:51], s62 offen offset:0 sc1
    v_mfma_f32_16x16x32_bf16 v[12:15], v[108:111], a[152:155], v[12:15]
    ds_read_b64_tr_b16 v[100:101], v241 offset:2048
    ds_read_b64_tr_b16 v[102:103], v241 offset:6144
    v_mfma_f32_16x16x32_bf16 v[28:31], v[108:111], a[156:159], v[28:31]
    s_waitcnt lgkmcnt(8)
    v_mfma_f32_16x16x32_bf16 v[32:35], v[112:115], a[152:155], v[32:35]
    ds_read_b64_tr_b16 v[104:105], v242 offset:2048
    ds_read_b64_tr_b16 v[106:107], v242 offset:6144
    v_mfma_f32_16x16x32_bf16 v[48:51], v[112:115], a[156:159], v[48:51]
    buffer_load_dword v81, v235, s[48:51], s63 offen offset:64 sc1
    v_mfma_f32_16x16x32_bf16 v[36:39], v[116:119], a[152:155], v[36:39]
    ds_read_b64_tr_b16 v[108:109], v243 offset:2048
    ds_read_b64_tr_b16 v[110:111], v243 offset:6144
    v_mfma_f32_16x16x32_bf16 v[52:55], v[116:119], a[156:159], v[52:55]
    s_waitcnt lgkmcnt(8)
    v_mfma_f32_16x16x32_bf16 v[40:43], v[120:123], a[152:155], v[40:43]
    ds_read_b64_tr_b16 v[112:113], v240 offset:10240
    ds_read_b64_tr_b16 v[114:115], v240 offset:14336
    v_mfma_f32_16x16x32_bf16 v[56:59], v[120:123], a[156:159], v[56:59]
    buffer_load_dword v83, v235, s[48:51], s62 offen offset:64 sc1
    v_mfma_f32_16x16x32_bf16 v[44:47], v[124:127], a[152:155], v[44:47]
    ds_read_b64_tr_b16 v[116:117], v241 offset:10240
    ds_read_b64_tr_b16 v[118:119], v241 offset:14336
    v_mfma_f32_16x16x32_bf16 v[60:63], v[124:127], a[156:159], v[60:63]
    s_waitcnt lgkmcnt(8)
    v_mfma_f32_16x16x32_bf16 v[32:35], v[96:99], a[160:163], v[32:35]
    ds_read_b64_tr_b16 v[120:121], v242 offset:10240
    ds_read_b64_tr_b16 v[122:123], v242 offset:14336
    v_mfma_f32_16x16x32_bf16 v[48:51], v[96:99], a[164:167], v[48:51]
    v_mfma_f32_16x16x32_bf16 v[36:39], v[100:103], a[160:163], v[36:39]
    ds_read_b64_tr_b16 v[124:125], v243 offset:10240
    ds_read_b64_tr_b16 v[126:127], v243 offset:14336
    v_mfma_f32_16x16x32_bf16 v[52:55], v[100:103], a[164:167], v[52:55]
    s_waitcnt lgkmcnt(8)
    v_mfma_f32_16x16x32_bf16 v[40:43], v[104:107], a[160:163], v[40:43]
    ds_read_b64_tr_b16 v[96:97], v240 offset:18432
    ds_read_b64_tr_b16 v[98:99], v240 offset:22528
    v_mfma_f32_16x16x32_bf16 v[56:59], v[104:107], a[164:167], v[56:59]
    v_mfma_f32_16x16x32_bf16 v[44:47], v[108:111], a[160:163], v[44:47]
    ds_read_b64_tr_b16 v[100:101], v241 offset:18432
    ds_read_b64_tr_b16 v[102:103], v241 offset:22528
    v_mfma_f32_16x16x32_bf16 v[60:63], v[108:111], a[164:167], v[60:63]
    s_waitcnt vmcnt(12) lgkmcnt(8)
    v_mfma_f32_16x16x32_bf16 v[32:35], v[112:115], a[168:171], v[32:35]
    ds_read_b64_tr_b16 v[104:105], v242 offset:18432
    ds_read_b64_tr_b16 v[106:107], v242 offset:22528
    v_mfma_f32_16x16x32_bf16 v[48:51], v[112:115], a[172:175], v[48:51]
    v_mfma_f32_16x16x32_bf16 v[36:39], v[116:119], a[168:171], v[36:39]
    ds_read_b64_tr_b16 v[108:109], v243 offset:18432
    ds_read_b64_tr_b16 v[110:111], v243 offset:22528
    v_mfma_f32_16x16x32_bf16 v[52:55], v[116:119], a[172:175], v[52:55]
    s_waitcnt lgkmcnt(8)
    v_mfma_f32_16x16x32_bf16 v[40:43], v[120:123], a[168:171], v[40:43]
    ds_read_b64_tr_b16 v[112:113], v240 offset:26624
    ds_read_b64_tr_b16 v[114:115], v240 offset:30720
    v_mfma_f32_16x16x32_bf16 v[56:59], v[120:123], a[172:175], v[56:59]
    v_mfma_f32_16x16x32_bf16 v[44:47], v[124:127], a[168:171], v[44:47]
    ds_read_b64_tr_b16 v[116:117], v241 offset:26624
    ds_read_b64_tr_b16 v[118:119], v241 offset:30720
    v_mfma_f32_16x16x32_bf16 v[60:63], v[124:127], a[172:175], v[60:63]
    s_waitcnt vmcnt(10) lgkmcnt(8)
    v_mfma_f32_16x16x32_bf16 v[32:35], v[96:99], a[176:179], v[32:35]
    ds_read_b64_tr_b16 v[120:121], v242 offset:26624
    ds_read_b64_tr_b16 v[122:123], v242 offset:30720
    v_mfma_f32_16x16x32_bf16 v[48:51], v[96:99], a[180:183], v[48:51]
    v_mfma_f32_16x16x32_bf16 v[36:39], v[100:103], a[176:179], v[36:39]
    ds_read_b64_tr_b16 v[124:125], v243 offset:26624
    ds_read_b64_tr_b16 v[126:127], v243 offset:30720
    v_mfma_f32_16x16x32_bf16 v[52:55], v[100:103], a[180:183], v[52:55]
    s_waitcnt lgkmcnt(8)
    v_mfma_f32_16x16x32_bf16 v[40:43], v[104:107], a[176:179], v[40:43]
    ds_read_b64_tr_b16 v[96:97], v240 offset:0
    ds_read_b64_tr_b16 v[98:99], v240 offset:4096
    v_mfma_f32_16x16x32_bf16 v[56:59], v[104:107], a[180:183], v[56:59]
    v_mfma_f32_16x16x32_bf16 v[44:47], v[108:111], a[176:179], v[44:47]
    ds_read_b64_tr_b16 v[100:101], v241 offset:0
    ds_read_b64_tr_b16 v[102:103], v241 offset:4096
    v_mfma_f32_16x16x32_bf16 v[60:63], v[108:111], a[180:183], v[60:63]
    s_waitcnt vmcnt(8) lgkmcnt(8)
    v_mfma_f32_16x16x32_bf16 v[32:35], v[112:115], a[184:187], v[32:35]
    ds_read_b64_tr_b16 v[104:105], v242 offset:0
    ds_read_b64_tr_b16 v[106:107], v242 offset:4096
    v_mfma_f32_16x16x32_bf16 v[48:51], v[112:115], a[188:191], v[48:51]
    v_mfma_f32_16x16x32_bf16 v[36:39], v[116:119], a[184:187], v[36:39]
    ds_read_b64_tr_b16 v[108:109], v243 offset:0
    ds_read_b64_tr_b16 v[110:111], v243 offset:4096
    v_mfma_f32_16x16x32_bf16 v[52:55], v[116:119], a[188:191], v[52:55]
    s_waitcnt lgkmcnt(8)
    v_mfma_f32_16x16x32_bf16 v[40:43], v[120:123], a[184:187], v[40:43]
    ds_read_b64_tr_b16 v[112:113], v240 offset:8192
    ds_read_b64_tr_b16 v[114:115], v240 offset:12288
    v_mfma_f32_16x16x32_bf16 v[56:59], v[120:123], a[188:191], v[56:59]
    v_mfma_f32_16x16x32_bf16 v[44:47], v[124:127], a[184:187], v[44:47]
    ds_read_b64_tr_b16 v[116:117], v241 offset:8192
    ds_read_b64_tr_b16 v[118:119], v241 offset:12288
    v_mfma_f32_16x16x32_bf16 v[60:63], v[124:127], a[188:191], v[60:63]
    s_waitcnt lgkmcnt(8)
    v_mfma_f32_16x16x32_bf16 v[0:3], v[96:99], a[160:163], v[0:3]
    ds_read_b64_tr_b16 v[120:121], v242 offset:8192
    ds_read_b64_tr_b16 v[122:123], v242 offset:12288
    v_mfma_f32_16x16x32_bf16 v[16:19], v[96:99], a[164:167], v[16:19]
    v_mfma_f32_16x16x32_bf16 v[4:7], v[100:103], a[160:163], v[4:7]
    ds_read_b64_tr_b16 v[124:125], v243 offset:8192
    ds_read_b64_tr_b16 v[126:127], v243 offset:12288
    v_mfma_f32_16x16x32_bf16 v[20:23], v[100:103], a[164:167], v[20:23]
    s_waitcnt lgkmcnt(8)
    v_mfma_f32_16x16x32_bf16 v[8:11], v[104:107], a[160:163], v[8:11]
    ds_read_b64_tr_b16 v[96:97], v240 offset:16384
    ds_read_b64_tr_b16 v[98:99], v240 offset:20480
    v_mfma_f32_16x16x32_bf16 v[24:27], v[104:107], a[164:167], v[24:27]
    v_cvt_pk_bf16_f32 v160, v32, v33
    v_cvt_pk_bf16_f32 v161, v34, v35
    v_cvt_pk_bf16_f32 v162, v36, v37
    v_mfma_f32_16x16x32_bf16 v[12:15], v[108:111], a[160:163], v[12:15]
    ds_read_b64_tr_b16 v[100:101], v241 offset:16384
    ds_read_b64_tr_b16 v[102:103], v241 offset:20480
    v_mfma_f32_16x16x32_bf16 v[28:31], v[108:111], a[164:167], v[28:31]
    s_waitcnt lgkmcnt(8)
    v_cvt_pk_bf16_f32 v163, v38, v39
    v_mfma_f32_16x16x32_bf16 v[0:3], v[112:115], a[168:171], v[0:3]
    ds_read_b64_tr_b16 v[104:105], v242 offset:16384
    ds_read_b64_tr_b16 v[106:107], v242 offset:20480
    v_mfma_f32_16x16x32_bf16 v[16:19], v[112:115], a[172:175], v[16:19]
    buffer_store_dwordx4 v[160:163], v226, s[64:67], s101 offen offset:0 sc1
    v_cvt_pk_bf16_f32 v164, v40, v41
    v_mfma_f32_16x16x32_bf16 v[4:7], v[116:119], a[168:171], v[4:7]
    ds_read_b64_tr_b16 v[108:109], v243 offset:16384
    ds_read_b64_tr_b16 v[110:111], v243 offset:20480
    v_mfma_f32_16x16x32_bf16 v[20:23], v[116:119], a[172:175], v[20:23]
    s_waitcnt lgkmcnt(8)
    v_cvt_pk_bf16_f32 v165, v42, v43
    v_cvt_pk_bf16_f32 v166, v44, v45
    v_mfma_f32_16x16x32_bf16 v[8:11], v[120:123], a[168:171], v[8:11]
    ds_read_b64_tr_b16 v[112:113], v240 offset:24576
    ds_read_b64_tr_b16 v[114:115], v240 offset:28672
    v_mfma_f32_16x16x32_bf16 v[24:27], v[120:123], a[172:175], v[24:27]
    v_cvt_pk_bf16_f32 v167, v46, v47
    v_mfma_f32_16x16x32_bf16 v[12:15], v[124:127], a[168:171], v[12:15]
    ds_read_b64_tr_b16 v[116:117], v241 offset:24576
    ds_read_b64_tr_b16 v[118:119], v241 offset:28672
    v_mfma_f32_16x16x32_bf16 v[28:31], v[124:127], a[172:175], v[28:31]
    s_waitcnt lgkmcnt(8)
    buffer_store_dwordx4 v[164:167], v226, s[64:67], s101 offen offset:1024 sc1
    v_mfma_f32_16x16x32_bf16 v[0:3], v[96:99], a[176:179], v[0:3]
    ds_read_b64_tr_b16 v[120:121], v242 offset:24576
    ds_read_b64_tr_b16 v[122:123], v242 offset:28672
    v_mfma_f32_16x16x32_bf16 v[16:19], v[96:99], a[180:183], v[16:19]
    v_cvt_pk_bf16_f32 v168, v48, v49
    v_cvt_pk_bf16_f32 v169, v50, v51
    v_cvt_pk_bf16_f32 v170, v52, v53
    v_mfma_f32_16x16x32_bf16 v[4:7], v[100:103], a[176:179], v[4:7]
    ds_read_b64_tr_b16 v[124:125], v243 offset:24576
    ds_read_b64_tr_b16 v[126:127], v243 offset:28672
    v_mfma_f32_16x16x32_bf16 v[20:23], v[100:103], a[180:183], v[20:23]
    s_waitcnt lgkmcnt(8)
    v_cvt_pk_bf16_f32 v171, v54, v55
    v_mfma_f32_16x16x32_bf16 v[8:11], v[104:107], a[176:179], v[8:11]
    buffer_store_dwordx4 v[168:171], v226, s[64:67], s101 offen offset:2048 sc1
    v_mfma_f32_16x16x32_bf16 v[24:27], v[104:107], a[180:183], v[24:27]
    v_cvt_pk_bf16_f32 v172, v56, v57
    v_cvt_pk_bf16_f32 v173, v58, v59
    v_cvt_pk_bf16_f32 v174, v60, v61
    v_mfma_f32_16x16x32_bf16 v[12:15], v[108:111], a[176:179], v[12:15]
    v_cvt_pk_bf16_f32 v175, v62, v63
    v_mfma_f32_16x16x32_bf16 v[28:31], v[108:111], a[180:183], v[28:31]
    s_waitcnt lgkmcnt(4)
    buffer_store_dwordx4 v[172:175], v226, s[64:67], s101 offen offset:3072 sc1
    v_mfma_f32_16x16x32_bf16 v[0:3], v[112:115], a[184:187], v[0:3]
    s_waitcnt vmcnt(4)
    v_lshlrev_b32 v128, 16, v64
    v_and_b32 v129, s60, v64
    v_mfma_f32_16x16x32_bf16 v[16:19], v[112:115], a[188:191], v[16:19]
    v_add_f32 v128, v128, v80
    v_add_f32 v129, v129, v80
    v_lshlrev_b32 v130, 16, v65
    v_mfma_f32_16x16x32_bf16 v[4:7], v[116:119], a[184:187], v[4:7]
    v_and_b32 v131, s60, v65
    v_add_f32 v130, v130, v80
    v_mfma_f32_16x16x32_bf16 v[20:23], v[116:119], a[188:191], v[20:23]
    s_waitcnt lgkmcnt(0)
    v_add_f32 v131, v131, v80
    v_lshlrev_b32 v132, 16, v66
    v_mfma_f32_16x16x32_bf16 v[8:11], v[120:123], a[184:187], v[8:11]
    v_and_b32 v133, s60, v66
    v_add_f32 v132, v132, v80
    v_mfma_f32_16x16x32_bf16 v[24:27], v[120:123], a[188:191], v[24:27]
    v_add_f32 v133, v133, v80
    v_lshlrev_b32 v134, 16, v67
    v_and_b32 v135, s60, v67
    v_mfma_f32_16x16x32_bf16 v[12:15], v[124:127], a[184:187], v[12:15]
    v_add_f32 v134, v134, v80
    v_add_f32 v135, v135, v80
    v_mfma_f32_16x16x32_bf16 v[28:31], v[124:127], a[188:191], v[28:31]
    v_lshlrev_b32 v136, 16, v68
    v_and_b32 v137, s60, v68
    v_add_f32 v136, v136, v80
    v_add_f32 v137, v137, v80
    v_lshlrev_b32 v138, 16, v69
    v_and_b32 v139, s60, v69
    v_add_f32 v138, v138, v80
    v_add_f32 v139, v139, v80
    v_lshlrev_b32 v140, 16, v70
    v_and_b32 v141, s60, v70
    v_pk_add_f32 v[140:141], v[140:141], v[80:81] op_sel:[0,0] op_sel_hi:[1,0]
    v_lshlrev_b32 v142, 16, v71
    v_and_b32 v143, s60, v71
    v_pk_add_f32 v[142:143], v[142:143], v[80:81] op_sel:[0,0] op_sel_hi:[1,0]
    v_lshlrev_b32 v144, 16, v72
    v_and_b32 v145, s60, v72
    v_pk_add_f32 v[144:145], v[144:145], v[80:81] op_sel:[0,1] op_sel_hi:[1,1]
    v_lshlrev_b32 v146, 16, v73
    v_and_b32 v147, s60, v73
    v_pk_add_f32 v[146:147], v[146:147], v[80:81] op_sel:[0,1] op_sel_hi:[1,1]
    v_lshlrev_b32 v148, 16, v74
    v_and_b32 v149, s60, v74
    v_pk_add_f32 v[148:149], v[148:149], v[80:81] op_sel:[0,1] op_sel_hi:[1,1]
    v_lshlrev_b32 v150, 16, v75
    v_and_b32 v151, s60, v75
    v_pk_add_f32 v[150:151], v[150:151], v[80:81] op_sel:[0,1] op_sel_hi:[1,1]
    v_lshlrev_b32 v152, 16, v76
    v_and_b32 v153, s60, v76
    v_pk_add_f32 v[152:153], v[152:153], v[80:81] op_sel:[0,1] op_sel_hi:[1,1]
    v_lshlrev_b32 v154, 16, v77
    v_and_b32 v155, s60, v77
    v_pk_add_f32 v[154:155], v[154:155], v[80:81] op_sel:[0,1] op_sel_hi:[1,1]
    v_lshlrev_b32 v156, 16, v78
    v_and_b32 v157, s60, v78
    v_pk_add_f32 v[156:157], v[156:157], v[80:81] op_sel:[0,1] op_sel_hi:[1,1]
    v_lshlrev_b32 v158, 16, v79
    v_and_b32 v159, s60, v79
    v_pk_add_f32 v[158:159], v[158:159], v[80:81] op_sel:[0,1] op_sel_hi:[1,1]
    s_waitcnt vmcnt(0)
    s_mov_b32 s27, 0x40000
    buffer_load_dwordx4 v[176:179], v226, s[64:67], s100 offen offset:0 sc1
    buffer_load_dwordx4 v[180:183], v226, s[64:67], s100 offen offset:1024 sc1
    buffer_load_dwordx4 v[184:187], v226, s[64:67], s100 offen offset:2048 sc1
    buffer_load_dwordx4 v[188:191], v226, s[64:67], s100 offen offset:3072 sc1
    v_pk_fma_f32 v[128:129], v[0:1], v[82:83], v[128:129] op_sel:[0,0,0] op_sel_hi:[1,0,1]
    v_pk_fma_f32 v[130:131], v[2:3], v[82:83], v[130:131] op_sel:[0,0,0] op_sel_hi:[1,0,1]
    v_pk_fma_f32 v[132:133], v[4:5], v[82:83], v[132:133] op_sel:[0,0,0] op_sel_hi:[1,0,1]
    v_pk_fma_f32 v[134:135], v[6:7], v[82:83], v[134:135] op_sel:[0,0,0] op_sel_hi:[1,0,1]
    v_pk_fma_f32 v[136:137], v[8:9], v[82:83], v[136:137] op_sel:[0,0,0] op_sel_hi:[1,0,1]
    v_pk_fma_f32 v[138:139], v[10:11], v[82:83], v[138:139] op_sel:[0,0,0] op_sel_hi:[1,0,1]
    v_pk_fma_f32 v[140:141], v[12:13], v[82:83], v[140:141] op_sel:[0,0,0] op_sel_hi:[1,0,1]
    v_pk_fma_f32 v[142:143], v[14:15], v[82:83], v[142:143] op_sel:[0,0,0] op_sel_hi:[1,0,1]
    v_pk_fma_f32 v[144:145], v[16:17], v[82:83], v[144:145] op_sel:[0,1,0] op_sel_hi:[1,1,1]
    v_pk_fma_f32 v[146:147], v[18:19], v[82:83], v[146:147] op_sel:[0,1,0] op_sel_hi:[1,1,1]
    v_pk_fma_f32 v[148:149], v[20:21], v[82:83], v[148:149] op_sel:[0,1,0] op_sel_hi:[1,1,1]
    v_pk_fma_f32 v[150:151], v[22:23], v[82:83], v[150:151] op_sel:[0,1,0] op_sel_hi:[1,1,1]
    v_pk_fma_f32 v[152:153], v[24:25], v[82:83], v[152:153] op_sel:[0,1,0] op_sel_hi:[1,1,1]
    v_pk_fma_f32 v[154:155], v[26:27], v[82:83], v[154:155] op_sel:[0,1,0] op_sel_hi:[1,1,1]
    v_pk_fma_f32 v[156:157], v[28:29], v[82:83], v[156:157] op_sel:[0,1,0] op_sel_hi:[1,1,1]
    v_pk_fma_f32 v[158:159], v[30:31], v[82:83], v[158:159] op_sel:[0,1,0] op_sel_hi:[1,1,1]
Lrcv_17:
    s_waitcnt vmcnt(0)
    v_max3_u32 v252, v176, v177, v178
    v_max3_u32 v252, v252, v179, v180
    v_max3_u32 v252, v252, v181, v182
    v_max3_u32 v252, v252, v183, v184
    v_max3_u32 v252, v252, v185, v186
    v_max3_u32 v252, v252, v187, v188
    v_max3_u32 v252, v252, v189, v190
    v_max_u32 v252, v252, v191
    v_cmp_eq_u32 vcc, -1, v252
    s_sub_u32 s27, s27, 1
    s_cbranch_scc1 Lgot_18
    s_cmp_eq_u64 vcc, 0
    s_cbranch_scc1 Lgot_18
    s_sleep 1
    buffer_load_dwordx4 v[176:179], v226, s[64:67], s100 offen offset:0 sc1
    buffer_load_dwordx4 v[180:183], v226, s[64:67], s100 offen offset:1024 sc1
    buffer_load_dwordx4 v[184:187], v226, s[64:67], s100 offen offset:2048 sc1
    buffer_load_dwordx4 v[188:191], v226, s[64:67], s100 offen offset:3072 sc1
    s_branch Lrcv_17
Lgot_18:
    v_lshlrev_b32 v0, 16, v176
    v_and_b32 v1, s60, v176
    v_pk_fma_f32 v[0:1], v[0:1], v[82:83], v[128:129] op_sel:[0,0,0] op_sel_hi:[1,0,1]
    v_lshlrev_b32 v2, 16, v177
    v_and_b32 v3, s60, v177
    v_pk_fma_f32 v[2:3], v[2:3], v[82:83], v[130:131] op_sel:[0,0,0] op_sel_hi:[1,0,1]
    v_lshlrev_b32 v4, 16, v178
    v_and_b32 v5, s60, v178
    v_pk_fma_f32 v[4:5], v[4:5], v[82:83], v[132:133] op_sel:[0,0,0] op_sel_hi:[1,0,1]
    v_lshlrev_b32 v6, 16, v179
    v_and_b32 v7, s60, v179
    v_pk_fma_f32 v[6:7], v[6:7], v[82:83], v[134:135] op_sel:[0,0,0] op_sel_hi:[1,0,1]
    v_lshlrev_b32 v8, 16, v180
    v_and_b32 v9, s60, v180
    v_pk_fma_f32 v[8:9], v[8:9], v[82:83], v[136:137] op_sel:[0,0,0] op_sel_hi:[1,0,1]
    v_lshlrev_b32 v10, 16, v181
    v_and_b32 v11, s60, v181
    v_pk_fma_f32 v[10:11], v[10:11], v[82:83], v[138:139] op_sel:[0,0,0] op_sel_hi:[1,0,1]
    v_lshlrev_b32 v12, 16, v182
    v_and_b32 v13, s60, v182
    v_pk_fma_f32 v[12:13], v[12:13], v[82:83], v[140:141] op_sel:[0,0,0] op_sel_hi:[1,0,1]
    v_lshlrev_b32 v14, 16, v183
    v_and_b32 v15, s60, v183
    v_pk_fma_f32 v[14:15], v[14:15], v[82:83], v[142:143] op_sel:[0,0,0] op_sel_hi:[1,0,1]
    v_cvt_pk_bf16_f32 v64, v0, v1
    v_cvt_pk_bf16_f32 v65, v2, v3
    v_cvt_pk_bf16_f32 v66, v4, v5
    v_cvt_pk_bf16_f32 v67, v6, v7
    v_cvt_pk_bf16_f32 v68, v8, v9
    v_cvt_pk_bf16_f32 v69, v10, v11
    v_cvt_pk_bf16_f32 v70, v12, v13
    v_cvt_pk_bf16_f32 v71, v14, v15
    s_nop 1
    v_permlane16_swap_b32 v64, v66
    v_permlane16_swap_b32 v65, v67
    v_permlane16_swap_b32 v68, v70
    v_permlane16_swap_b32 v69, v71
    buffer_store_dwordx4 v[64:67], v234, s[56:59], 0 offen offset:0 nt
    buffer_store_dwordx4 v[68:71], v234, s[56:59], 0 offen offset:64 nt
    v_lshlrev_b32 v16, 16, v184
    v_and_b32 v17, s60, v184
    v_pk_fma_f32 v[16:17], v[16:17], v[82:83], v[144:145] op_sel:[0,1,0] op_sel_hi:[1,1,1]
    v_lshlrev_b32 v18, 16, v185
    v_and_b32 v19, s60, v185
    v_pk_fma_f32 v[18:19], v[18:19], v[82:83], v[146:147] op_sel:[0,1,0] op_sel_hi:[1,1,1]
    v_lshlrev_b32 v20, 16, v186
    v_and_b32 v21, s60, v186
    v_pk_fma_f32 v[20:21], v[20:21], v[82:83], v[148:149] op_sel:[0,1,0] op_sel_hi:[1,1,1]
    v_lshlrev_b32 v22, 16, v187
    v_and_b32 v23, s60, v187
    v_pk_fma_f32 v[22:23], v[22:23], v[82:83], v[150:151] op_sel:[0,1,0] op_sel_hi:[1,1,1]
    v_lshlrev_b32 v24, 16, v188
    v_and_b32 v25, s60, v188
    v_pk_fma_f32 v[24:25], v[24:25], v[82:83], v[152:153] op_sel:[0,1,0] op_sel_hi:[1,1,1]
    v_lshlrev_b32 v26, 16, v189
    v_and_b32 v27, s60, v189
    v_pk_fma_f32 v[26:27], v[26:27], v[82:83], v[154:155] op_sel:[0,1,0] op_sel_hi:[1,1,1]
    v_lshlrev_b32 v28, 16, v190
    v_and_b32 v29, s60, v190
    v_pk_fma_f32 v[28:29], v[28:29], v[82:83], v[156:157] op_sel:[0,1,0] op_sel_hi:[1,1,1]
    v_lshlrev_b32 v30, 16, v191
    v_and_b32 v31, s60, v191
    v_pk_fma_f32 v[30:31], v[30:31], v[82:83], v[158:159] op_sel:[0,1,0] op_sel_hi:[1,1,1]
    v_cvt_pk_bf16_f32 v72, v16, v17
    v_cvt_pk_bf16_f32 v73, v18, v19
    v_cvt_pk_bf16_f32 v74, v20, v21
    v_cvt_pk_bf16_f32 v75, v22, v23
    v_cvt_pk_bf16_f32 v76, v24, v25
    v_cvt_pk_bf16_f32 v77, v26, v27
    v_cvt_pk_bf16_f32 v78, v28, v29
    v_cvt_pk_bf16_f32 v79, v30, v31
    s_nop 1
    v_permlane16_swap_b32 v72, v74
    v_permlane16_swap_b32 v73, v75
    v_permlane16_swap_b32 v76, v78
    v_permlane16_swap_b32 v77, v79
    buffer_store_dwordx4 v[72:75], v234, s[56:59], s61 offen offset:0 nt
    buffer_store_dwordx4 v[76:79], v234, s[56:59], s61 offen offset:64 nt
Lend_1:
    s_endpgm
Lcode_end:
    s_endpgm
.section .rodata,"a"
.p2align 6
.amdhsa_kernel sequential_preLN__linear_attn_block__glu_gated_glu__prompt_kernel
  .amdhsa_next_free_vgpr 512
  .amdhsa_next_free_sgpr 102
  .amdhsa_accum_offset 256
  .amdhsa_group_segment_fixed_size 0
  .amdhsa_kernarg_size 80
  .amdhsa_user_sgpr_count 2
  .amdhsa_user_sgpr_kernarg_segment_ptr 1
  .amdhsa_system_sgpr_workgroup_id_x 1
  .amdhsa_float_denorm_mode_32 3
.end_amdhsa_kernel
```
